```python
import torch

def _softmax(x, axis=-1):
    return torch.softmax(x, dim=axis)
def _gelu(x):
    return torch.nn.functional.gelu(x, approximate="tanh")
def _silu(x):
    return torch.nn.functional.silu(x)
def _sigmoid(x):
    return torch.sigmoid(x)
def _layernorm(x, axis=-1, eps=1e-5):
    m = x.mean(dim=axis, keepdim=True)
    v = x.var(dim=axis, keepdim=True, unbiased=False)
    return (x - m) / torch.sqrt(v + eps)
def _scatter_add(tgt, idx, src, axis=0):
    return tgt.clone().index_add_(axis, idx, src)
def _segment_sum(src, seg, n):
    out = torch.zeros((n,) + src.shape[1:], dtype=src.dtype)
    return out.index_add_(0, seg, src)
def _pad(x, pw):
    flat = tuple(v for pair in reversed(pw) for v in pair)
    return torch.nn.functional.pad(x, flat)

kernel_name = 'parallel_sum__spectral_gfnet__glu_gated_bilinear__prompt'

def setup_inputs():

    _w = (lambda a: (lambda t: t.to(torch.bfloat16) if t.is_floating_point() else t)(torch.as_tensor(a)))
    def _A_setup():
        B, S, D = 1, 2048, 576
        Df = D // 2 + 1
        return {
            "x": _w((lambda *s: torch.randn(*s, dtype=torch.bfloat16) * 0.05)(B, S, D)),
            "w_r": _w((lambda *s: torch.randn(*s, dtype=torch.bfloat16) * 0.4)(S, Df) * 0.02),
            "w_i": _w((lambda *s: torch.randn(*s, dtype=torch.bfloat16) * 0.4)(S, Df) * 0.02),
        }
    _A_in = _A_setup()

    def _B_setup():
        B, S, D, F = 1, 2048, 576, 4608
        return {
            "x": _w((lambda *s: torch.randn(*s, dtype=torch.bfloat16) * 0.05)(B, S, D)),
            "w_gate": _w((lambda *s: torch.randn(*s, dtype=torch.bfloat16) * 0.2)(D, F) * (D ** -0.5)),
            "w_up": _w((lambda *s: torch.randn(*s, dtype=torch.bfloat16) * 0.2)(D, F) * (D ** -0.5)),
            "w_down": _w((lambda *s: torch.randn(*s, dtype=torch.bfloat16) * 0.2)(F, D) * (F ** -0.5)),
        }
    _B_in = _B_setup()

    return {
        "A_x": _A_in["x"],
        "A_w_r": _A_in["w_r"],
        "A_w_i": _A_in["w_i"],
        "B_x": _B_in["x"],
        "B_w_gate": _B_in["w_gate"],
        "B_w_up": _B_in["w_up"],
        "B_w_down": _B_in["w_down"],
    }

def reference(A_x, A_w_r, A_w_i, B_x, B_w_gate, B_w_up, B_w_down):
    def _A_ref(x, w_r, w_i):
        B, S, D = x.shape
        X = (lambda x, axes=(-2,-1): torch.fft.rfft2(x.float(), dim=axes))(x, axes=(-2, -1))
        W = w_r + 1j * w_i
        X = X * W
        y = (lambda x, s, axes=(-2,-1): torch.fft.irfft2(x, s=s, dim=axes).to(torch.bfloat16))(X, (S, D), axes=(-2, -1))
        return y

    def _B_ref(x, w_gate, w_up, w_down):
        g = torch.einsum("bsd,df->bsf", x, w_gate)
        u = torch.einsum("bsd,df->bsf", x, w_up)
        h = g * u
        return torch.einsum("bsf,fd->bsd", h, w_down)

    x = A_x
    xn = _layernorm(x, axis=-1)
    return x + _A_ref(xn, A_w_r, A_w_i) + _B_ref(xn, B_w_gate, B_w_up, B_w_down)
```

```asm
; @launch grid=(256,1,1) block=(256,1,1) lds=156672
.amdgcn_target "amdgcn-amd-amdhsa--gfx950"
.text
.globl parallel_sum__spectral_gfnet__glu_gated_bilinear__prompt_kernel
.p2align 8
.type parallel_sum__spectral_gfnet__glu_gated_bilinear__prompt_kernel,@function
parallel_sum__spectral_gfnet__glu_gated_bilinear__prompt_kernel:
    s_cmp_ge_u32 s2, 256
    s_cbranch_scc1 FK_end
    s_load_dwordx16 s[60:75], s[0:1], 0
    s_load_dwordx2 s[8:9], s[0:1], 72
    v_lshrrev_b32 v1, 6, v0
    v_and_b32 v0, 63, v0
    v_readfirstlane_b32 s3, v1
    s_getpc_b64 s[4:5]
    s_nop 2
    s_cmp_eq_u32 s3, 3
    s_cbranch_scc0 FK_np
    v_lshlrev_b32 v2, 7, v0
    global_load_dword v253, v2, s[4:5]
    s_lshr_b32 s6, s2, 3
    s_mul_i32 s6, s6, 21
    v_add_u32 v2, s6, v0
    v_lshlrev_b32 v2, 7, v2
    v_cmp_gt_u32 vcc, 21, v0
    s_nop 3
    s_and_saveexec_b64 s[6:7], vcc
    global_load_dword v254, v2, s[4:5]
    s_mov_b64 exec, s[6:7]
FK_np:
    s_lshr_b32 s46, s2, 3
    s_and_b32 s42, s46, 3
    s_lshr_b32 s40, s46, 2
    s_and_b32 s40, s40, 3
    s_and_b32 s47, s2, 1
    s_lshl_b32 s47, s47, 2
    s_add_u32 s40, s40, s47
    s_lshr_b32 s41, s46, 4
    s_lshr_b32 s47, s2, 1
    s_and_b32 s47, s47, 3
    s_lshl_b32 s47, s47, 1
    s_add_u32 s41, s41, s47
    s_lshl_b32 s43, s41, 2
    s_add_u32 s43, s43, s42
    s_lshl_b32 s49, s40, 5
    s_add_u32 s49, s49, s43
    s_getreg_b32 s59, hwreg(HW_REG_XCC_ID, 0, 4)
    s_waitcnt lgkmcnt(0)
    s_mov_b32 s80, s60
    s_mov_b32 s81, s61
    s_mov_b32 s82, 0x240000
    s_mov_b32 s83, 0x20000
    v_lshrrev_b32 v97, 3, v0
    v_and_b32 v98, 7, v0
    s_lshl_b32 s84, s49, 3
    v_add_u32 v99, s84, v97
    v_mul_u32_u24 v99, 1152, v99
    s_mul_i32 s85, s3, 288
    v_lshl_add_u32 v96, v98, 4, v99
    v_add_u32 v96, s85, v96
    buffer_load_dwordx4 v[100:103], v96, s[80:83], 0 offen
    buffer_load_dwordx4 v[104:107], v96, s[80:83], 0 offen offset:128
    buffer_load_ushort v95, v99, s[80:83], 0 offen
    s_mov_b32 s86, 0x03030303
    s_mov_b32 s87, 0x03030303
    s_mov_b64 exec, s[86:87]
    buffer_load_dwordx4 v[108:111], v96, s[80:83], 0 offen offset:256
    s_mov_b64 exec, -1
    s_add_u32 s76, s8, 0x5000000
    s_addc_u32 s77, s9, 0
    s_mov_b32 s78, 0x10000
    s_mov_b32 s79, 0x20000
    v_mov_b32 v2, 0
    buffer_load_dword v8, v2, s[76:79], 0 offen sc1
    s_mov_b32 s4, s68
    s_mov_b32 s5, s69
    s_mov_b32 s6, s70
    s_mov_b32 s7, s71
    s_and_b32 s44, s3, 1
    s_cmp_eq_u32 s44, 0
    s_cselect_b32 s12, s4, s6
    s_cselect_b32 s13, s5, s7
    s_mov_b32 s14, 0x510000
    s_mov_b32 s15, 0x20000
    s_mul_i32 s32, s41, 1152
    s_lshl_b32 s45, s42, 7
    s_add_u32 s32, s32, s45
    s_lshr_b32 s45, s3, 1
    s_mul_i32 s45, s45, 294912
    s_add_u32 s32, s32, s45
    s_lshl_b32 s34, s3, 12
    v_lshrrev_b32 v2, 3, v0
    v_bfe_u32 v3, v0, 1, 2
    v_bfe_u32 v4, v0, 4, 2
    v_xor_b32 v3, v3, v4
    v_and_b32 v4, 1, v0
    v_lshlrev_b32 v3, 5, v3
    v_lshl_add_u32 v3, v4, 4, v3
    v_lshrrev_b32 v4, 2, v2
    v_and_b32 v2, 3, v2
    v_lshl_add_u32 v2, v4, 3, v2
    v_mul_u32_u24 v2, 9216, v2
    v_add_u32 v10, v2, v3
    v_add_u32 v11, 147456, v10
    v_add_u32 v12, 36864, v10
    v_add_u32 v13, 184320, v10
    s_add_u32 m0, s34, 0
    s_nop 0
    buffer_load_dwordx4 v10, s[12:15], s32 offen lds
    s_add_u32 m0, s34, 1024
    s_nop 0
    buffer_load_dwordx4 v11, s[12:15], s32 offen lds
    s_add_u32 m0, s34, 2048
    s_nop 0
    buffer_load_dwordx4 v12, s[12:15], s32 offen lds
    s_add_u32 m0, s34, 3072
    s_nop 0
    buffer_load_dwordx4 v13, s[12:15], s32 offen lds
    s_add_u32 s32, s32, 589824
    s_lshl_b32 s45, s42, 5
    s_sub_u32 s38, 4718080, s45
    s_mov_b32 s20, s8
    s_mov_b32 s21, s9
    s_mov_b32 s22, 0x240000
    s_mov_b32 s23, 0x20000
    s_add_u32 s24, s8, 0x240000
    s_addc_u32 s25, s9, 0
    s_mov_b32 s26, 0xa2000
    s_mov_b32 s27, 0x20000
    s_mul_i32 s33, s40, 294912
    s_and_b32 s44, s3, 1
    v_lshlrev_b32 v6, 4, v0
    s_mul_i32 s45, s44, 18432
    s_lshr_b32 s46, s3, 1
    s_lshl_b32 s46, s46, 10
    s_add_u32 s45, s45, s46
    v_add_u32 v14, s45, v6
    s_min_u32 s45, s43, 17
    s_mul_i32 s35, s45, 36864
    v_add_u32 v2, 0, v0
    v_mul_u32_u24 v3, 6554, v2
    v_lshrrev_b32 v3, 16, v3
    v_mul_u32_u24 v4, 10, v3
    v_sub_u32 v4, v2, v4
    v_bfe_u32 v5, v3, 2, 2
    v_lshlrev_b32 v5, 3, v5
    v_lshrrev_b32 v7, 4, v3
    v_lshl_add_u32 v5, v7, 2, v5
    v_and_b32 v3, 3, v3
    v_add_u32 v3, v3, v5
    v_mul_u32_u24 v3, 9216, v3
    v_lshl_add_u32 v22, v4, 4, v3
    v_add_u32 v2, 64, v0
    v_mul_u32_u24 v3, 6554, v2
    v_lshrrev_b32 v3, 16, v3
    v_mul_u32_u24 v4, 10, v3
    v_sub_u32 v4, v2, v4
    v_bfe_u32 v5, v3, 2, 2
    v_lshlrev_b32 v5, 3, v5
    v_lshrrev_b32 v7, 4, v3
    v_lshl_add_u32 v5, v7, 2, v5
    v_and_b32 v3, 3, v3
    v_add_u32 v3, v3, v5
    v_mul_u32_u24 v3, 9216, v3
    v_lshl_add_u32 v23, v4, 4, v3
    v_add_u32 v2, 128, v0
    v_mul_u32_u24 v3, 6554, v2
    v_lshrrev_b32 v3, 16, v3
    v_mul_u32_u24 v4, 10, v3
    v_sub_u32 v4, v2, v4
    v_bfe_u32 v5, v3, 2, 2
    v_lshlrev_b32 v5, 3, v5
    v_lshrrev_b32 v7, 4, v3
    v_lshl_add_u32 v5, v7, 2, v5
    v_and_b32 v3, 3, v3
    v_add_u32 v3, v3, v5
    v_mul_u32_u24 v3, 9216, v3
    v_lshl_add_u32 v24, v4, 4, v3
    v_add_u32 v2, 192, v0
    v_mul_u32_u24 v3, 6554, v2
    v_lshrrev_b32 v3, 16, v3
    v_mul_u32_u24 v4, 10, v3
    v_sub_u32 v4, v2, v4
    v_bfe_u32 v5, v3, 2, 2
    v_lshlrev_b32 v5, 3, v5
    v_lshrrev_b32 v7, 4, v3
    v_lshl_add_u32 v5, v7, 2, v5
    v_and_b32 v3, 3, v3
    v_add_u32 v3, v3, v5
    v_mul_u32_u24 v3, 9216, v3
    v_lshl_add_u32 v25, v4, 4, v3
    v_add_u32 v2, 256, v0
    v_mul_u32_u24 v3, 6554, v2
    v_lshrrev_b32 v3, 16, v3
    v_mul_u32_u24 v4, 10, v3
    v_sub_u32 v4, v2, v4
    v_bfe_u32 v5, v3, 2, 2
    v_lshlrev_b32 v5, 3, v5
    v_lshrrev_b32 v7, 4, v3
    v_lshl_add_u32 v5, v7, 2, v5
    v_and_b32 v3, 3, v3
    v_add_u32 v3, v3, v5
    v_mul_u32_u24 v3, 9216, v3
    v_lshl_add_u32 v26, v4, 4, v3
    s_mul_i32 s45, s3, 73728
    v_add_u32 v16, s45, v6
    v_add_u32 v17, 18432, v16
    v_add_u32 v18, 18432, v17
    v_add_u32 v19, 18432, v18
    v_lshrrev_b32 v2, 4, v0
    v_bfe_u32 v3, v0, 2, 2
    v_lshl_add_u32 v2, v2, 2, v3
    v_and_b32 v3, 3, v0
    v_lshlrev_b32 v3, 3, v3
    v_bfe_u32 v4, v2, 1, 2
    v_lshlrev_b32 v5, 7, v2
    v_add_u32 v5, v5, v3
    v_xor_b32 v7, 0, v4
    v_lshl_add_u32 v28, v7, 5, v5
    v_add_u32 v32, 61440, v28
    v_xor_b32 v7, 1, v4
    v_lshl_add_u32 v29, v7, 5, v5
    v_add_u32 v33, 61440, v29
    v_xor_b32 v7, 2, v4
    v_lshl_add_u32 v30, v7, 5, v5
    v_add_u32 v34, 61440, v30
    v_xor_b32 v7, 3, v4
    v_lshl_add_u32 v31, v7, 5, v5
    v_add_u32 v35, 61440, v31
    v_lshl_add_u32 v36, v2, 5, v3
    v_add_u32 v37, 61440, v36
    v_mul_u32_u24 v38, 160, v2
    v_add_u32 v38, v38, v3
    v_add_u32 v39, 61440, v38
    s_lshl_b32 s36, s3, 10
    s_add_u32 s36, s36, 16384
    s_mul_i32 s37, s3, 5120
    s_add_u32 s16, s8, 0x1000000
    s_addc_u32 s17, s9, 0
    s_mov_b32 s18, 0x1200000
    s_mov_b32 s19, 0x20000
    s_add_u32 s28, s8, 0x700000
    s_addc_u32 s29, s9, 0
    s_mov_b32 s30, 0x240000
    s_mov_b32 s31, 0x20000
    s_mov_b32 s44, 0x3ae38e39
    s_mov_b32 s45, 0xc4100000
    s_lshl_b32 s46, s3, 6
    v_add_u32 v141, s46, v0
    v_mov_b32 v153, 0x3e800000
    s_mul_i32 s47, s49, 648
    s_mov_b32 s48, 3
FK_efl:
    v_add_u32 v142, s47, v141
    v_lshrrev_b32 v143, 10, v142
    v_mul_u32_u24 v143, 7282, v143
    v_lshrrev_b32 v143, 16, v143
    v_mul_u32_u24 v144, 9216, v143
    v_sub_u32 v144, v142, v144
    v_cmp_le_u32 vcc, 4608, v144
    s_nop 1
    v_cndmask_b32 v148, 0, 1, vcc
    v_mul_u32_u24 v145, 4608, v148
    v_sub_u32 v144, v144, v145
    v_lshrrev_b32 v146, 3, v144
    v_and_b32 v144, 7, v144
    v_bfe_u32 v145, v146, 2, 2
    v_lshlrev_b32 v145, 3, v145
    v_bfe_u32 v147, v146, 4, 1
    v_lshl_add_u32 v145, v147, 2, v145
    v_and_b32 v147, 3, v146
    v_add_u32 v145, v145, v147
    v_and_b32 v147, 0xffffffe0, v146
    v_add_u32 v145, v145, v147
    v_lshlrev_b32 v147, 4, v143
    v_lshl_add_u32 v147, v144, 1, v147
    v_cvt_f32_u32 v149, v145
    v_cvt_f32_u32 v150, v147
    v_add_f32 v151, 1.0, v150
    v_cvt_f32_u32 v152, v148
    v_fma_f32 v152, v152, v153, v153
    v_cmp_eq_u32 vcc, 0, v147
    v_cmp_eq_u32 s[50:51], 1, v148
    s_nop 3
    s_and_b64 vcc, vcc, s[50:51]
    v_mov_b32 v154, 0x43900000
    v_cndmask_b32 v150, v150, v154, vcc
    v_cndmask_b32 v155, v152, v153, vcc
    v_mul_f32 v156, v150, v149
    v_mul_f32 v157, s44, v156
    v_floor_f32 v157, v157
    v_fma_f32 v156, v157, s45, v156
    v_fma_f32 v156, v156, s44, v155
    v_sin_f32 v160, v156
    v_mul_f32 v158, v151, v149
    v_mul_f32 v159, s44, v158
    v_floor_f32 v159, v159
    v_fma_f32 v158, v159, s45, v158
    v_fma_f32 v158, v158, s44, v152
    v_sin_f32 v161, v158
    s_nop 0
    v_cvt_pk_bf16_f32 v160, v160, v161
    v_lshlrev_b32 v162, 2, v142
    v_cmp_gt_u32 vcc, 648, v141
    v_mov_b32 v163, -1
    s_nop 0
    v_cndmask_b32 v162, v163, v162, vcc
    buffer_store_dword v160, v162, s[24:27], 0 offen sc1
    v_add_u32 v141, 256, v141
    s_sub_u32 s48, s48, 1
    s_cmp_lg_u32 s48, 0
    s_cbranch_scc1 FK_efl
    s_mov_b32 s88, s8
    s_mov_b32 s89, s9
    s_mov_b32 s90, 0x240000
    s_mov_b32 s91, 0x20000
    s_mul_i32 s84, s3, 18
    v_add_u32 v94, s84, v98
    v_lshrrev_b32 v93, 2, v94
    v_lshlrev_b32 v93, 10, v93
    v_and_b32 v94, 3, v94
    v_lshl_add_u32 v93, v94, 8, v93
    v_lshl_add_u32 v93, v97, 4, v93
    s_lshr_b32 s84, s49, 1
    s_mul_i32 s84, s84, 18432
    s_and_b32 s85, s49, 1
    s_lshl_b32 s85, s85, 7
    s_add_u32 s84, s84, s85
    v_add_u32 v93, s84, v93
    v_mov_b32 v92, 0x3f803f80
    v_mov_b32 v90, 0
    v_mov_b32 v88, 0
    v_mov_b32 v89, 0
    s_mov_b32 s92, 0xffff0000
    s_waitcnt vmcnt(6)
    v_lshlrev_b32 v95, 16, v95
    v_sub_f32 v86, 0, v95
    v_mov_b32 v87, v86
    v_dot2_f32_bf16 v90, v100, v92, v90
    v_lshlrev_b32 v112, 16, v100
    v_and_b32 v113, s92, v100
    v_pk_add_f32 v[112:113], v[112:113], v[86:87]
    v_pk_fma_f32 v[88:89], v[112:113], v[112:113], v[88:89]
    v_dot2_f32_bf16 v90, v101, v92, v90
    v_lshlrev_b32 v114, 16, v101
    v_and_b32 v115, s92, v101
    v_pk_add_f32 v[114:115], v[114:115], v[86:87]
    v_pk_fma_f32 v[88:89], v[114:115], v[114:115], v[88:89]
    v_dot2_f32_bf16 v90, v102, v92, v90
    v_lshlrev_b32 v116, 16, v102
    v_and_b32 v117, s92, v102
    v_pk_add_f32 v[116:117], v[116:117], v[86:87]
    v_pk_fma_f32 v[88:89], v[116:117], v[116:117], v[88:89]
    v_dot2_f32_bf16 v90, v103, v92, v90
    v_lshlrev_b32 v118, 16, v103
    v_and_b32 v119, s92, v103
    v_pk_add_f32 v[118:119], v[118:119], v[86:87]
    v_pk_fma_f32 v[88:89], v[118:119], v[118:119], v[88:89]
    v_dot2_f32_bf16 v90, v104, v92, v90
    v_lshlrev_b32 v120, 16, v104
    v_and_b32 v121, s92, v104
    v_pk_add_f32 v[120:121], v[120:121], v[86:87]
    v_pk_fma_f32 v[88:89], v[120:121], v[120:121], v[88:89]
    v_dot2_f32_bf16 v90, v105, v92, v90
    v_lshlrev_b32 v122, 16, v105
    v_and_b32 v123, s92, v105
    v_pk_add_f32 v[122:123], v[122:123], v[86:87]
    v_pk_fma_f32 v[88:89], v[122:123], v[122:123], v[88:89]
    v_dot2_f32_bf16 v90, v106, v92, v90
    v_lshlrev_b32 v124, 16, v106
    v_and_b32 v125, s92, v106
    v_pk_add_f32 v[124:125], v[124:125], v[86:87]
    v_pk_fma_f32 v[88:89], v[124:125], v[124:125], v[88:89]
    v_dot2_f32_bf16 v90, v107, v92, v90
    v_lshlrev_b32 v126, 16, v107
    v_and_b32 v127, s92, v107
    v_pk_add_f32 v[126:127], v[126:127], v[86:87]
    v_pk_fma_f32 v[88:89], v[126:127], v[126:127], v[88:89]
    s_mov_b64 exec, s[86:87]
    v_dot2_f32_bf16 v90, v108, v92, v90
    v_lshlrev_b32 v128, 16, v108
    v_and_b32 v129, s92, v108
    v_pk_add_f32 v[128:129], v[128:129], v[86:87]
    v_pk_fma_f32 v[88:89], v[128:129], v[128:129], v[88:89]
    v_dot2_f32_bf16 v90, v109, v92, v90
    v_lshlrev_b32 v130, 16, v109
    v_and_b32 v131, s92, v109
    v_pk_add_f32 v[130:131], v[130:131], v[86:87]
    v_pk_fma_f32 v[88:89], v[130:131], v[130:131], v[88:89]
    v_dot2_f32_bf16 v90, v110, v92, v90
    v_lshlrev_b32 v132, 16, v110
    v_and_b32 v133, s92, v110
    v_pk_add_f32 v[132:133], v[132:133], v[86:87]
    v_pk_fma_f32 v[88:89], v[132:133], v[132:133], v[88:89]
    v_dot2_f32_bf16 v90, v111, v92, v90
    v_lshlrev_b32 v134, 16, v111
    v_and_b32 v135, s92, v111
    v_pk_add_f32 v[134:135], v[134:135], v[86:87]
    v_pk_fma_f32 v[88:89], v[134:135], v[134:135], v[88:89]
    s_mov_b64 exec, -1
    s_nop 1
    v_add_f32 v91, v88, v89
    v_add_f32_dpp v90, v90, v90 quad_perm:[1,0,3,2] row_mask:0xf bank_mask:0xf
    s_nop 0
    v_add_f32_dpp v91, v91, v91 quad_perm:[1,0,3,2] row_mask:0xf bank_mask:0xf
    v_add_f32_dpp v90, v90, v90 quad_perm:[2,3,0,1] row_mask:0xf bank_mask:0xf
    s_nop 0
    v_add_f32_dpp v91, v91, v91 quad_perm:[2,3,0,1] row_mask:0xf bank_mask:0xf
    v_add_f32_dpp v90, v90, v90 row_half_mirror row_mask:0xf bank_mask:0xf
    s_nop 0
    v_add_f32_dpp v91, v91, v91 row_half_mirror row_mask:0xf bank_mask:0xf
    s_lshl_b32 s84, s3, 6
    s_add_u32 s84, s84, 156224
    v_lshlrev_b32 v85, 3, v97
    v_add_u32 v84, s84, v85
    ds_write_b64 v84, v[90:91]
    v_add_u32 v85, 156224, v85
    s_waitcnt lgkmcnt(0)
    s_barrier
    ds_read_b64 v[76:77], v85 offset:0
    ds_read_b64 v[78:79], v85 offset:64
    ds_read_b64 v[80:81], v85 offset:128
    ds_read_b64 v[82:83], v85 offset:192
    s_mov_b32 s93, 0x3ae38e39
    s_waitcnt lgkmcnt(0)
    v_pk_add_f32 v[76:77], v[76:77], v[78:79]
    v_pk_add_f32 v[80:81], v[80:81], v[82:83]
    v_pk_add_f32 v[76:77], v[76:77], v[80:81]
    v_mul_f32 v76, s93, v76
    v_mul_f32 v77, s93, v77
    v_sub_f32 v78, v76, v95
    v_fma_f32 v77, -v78, v78, v77
    v_max_f32 v77, 0, v77
    v_cvt_pk_bf16_f32 v79, v76, v77
    v_and_b32 v77, s92, v79
    v_lshlrev_b32 v76, 16, v79
    v_add_f32 v77, 0x3727c5ac, v77
    v_cvt_pk_bf16_f32 v77, v77, v77
    v_lshlrev_b32 v77, 16, v77
    v_sqrt_f32 v77, v77
    s_nop 0
    v_cvt_pk_bf16_f32 v77, v77, v77
    v_lshlrev_b32 v77, 16, v77
    v_rcp_f32 v80, v77
    v_sub_f32 v82, v95, v76
    v_mul_f32 v82, v82, v80
    v_pk_fma_f32 v[112:113], v[112:113], v[80:81], v[82:83] op_sel_hi:[1,0,0]
    s_nop 0
    v_cvt_pk_bf16_f32 v100, v112, v113
    v_pk_fma_f32 v[114:115], v[114:115], v[80:81], v[82:83] op_sel_hi:[1,0,0]
    s_nop 0
    v_cvt_pk_bf16_f32 v101, v114, v115
    v_pk_fma_f32 v[116:117], v[116:117], v[80:81], v[82:83] op_sel_hi:[1,0,0]
    s_nop 0
    v_cvt_pk_bf16_f32 v102, v116, v117
    v_pk_fma_f32 v[118:119], v[118:119], v[80:81], v[82:83] op_sel_hi:[1,0,0]
    s_nop 0
    v_cvt_pk_bf16_f32 v103, v118, v119
    buffer_store_dwordx4 v[100:103], v93, s[88:91], 0 offen sc1
    v_pk_fma_f32 v[120:121], v[120:121], v[80:81], v[82:83] op_sel_hi:[1,0,0]
    s_nop 0
    v_cvt_pk_bf16_f32 v104, v120, v121
    v_pk_fma_f32 v[122:123], v[122:123], v[80:81], v[82:83] op_sel_hi:[1,0,0]
    s_nop 0
    v_cvt_pk_bf16_f32 v105, v122, v123
    v_pk_fma_f32 v[124:125], v[124:125], v[80:81], v[82:83] op_sel_hi:[1,0,0]
    s_nop 0
    v_cvt_pk_bf16_f32 v106, v124, v125
    v_pk_fma_f32 v[126:127], v[126:127], v[80:81], v[82:83] op_sel_hi:[1,0,0]
    s_nop 0
    v_cvt_pk_bf16_f32 v107, v126, v127
    buffer_store_dwordx4 v[104:107], v93, s[88:91], 0 offen offset:2048 sc1
    s_mov_b64 exec, s[86:87]
    v_pk_fma_f32 v[128:129], v[128:129], v[80:81], v[82:83] op_sel_hi:[1,0,0]
    s_nop 0
    v_cvt_pk_bf16_f32 v108, v128, v129
    v_pk_fma_f32 v[130:131], v[130:131], v[80:81], v[82:83] op_sel_hi:[1,0,0]
    s_nop 0
    v_cvt_pk_bf16_f32 v109, v130, v131
    v_pk_fma_f32 v[132:133], v[132:133], v[80:81], v[82:83] op_sel_hi:[1,0,0]
    s_nop 0
    v_cvt_pk_bf16_f32 v110, v132, v133
    v_pk_fma_f32 v[134:135], v[134:135], v[80:81], v[82:83] op_sel_hi:[1,0,0]
    s_nop 0
    v_cvt_pk_bf16_f32 v111, v134, v135
    s_movk_i32 s84, 0x1000
    buffer_store_dwordx4 v[108:111], v93, s[88:91], s84 offen sc1
    s_mov_b64 exec, -1
    s_waitcnt vmcnt(0)
    v_readfirstlane_b32 s39, v8
    s_mul_i32 s50, s40, 18
    s_add_u32 s50, s50, s43
    s_nop 2
    s_and_b32 s39, s39, 0xfffffff0
    s_add_u32 s39, s39, 0x10
    s_barrier
    s_cmp_eq_u32 s3, 0
    s_cbranch_scc1 FK_w0
    s_add_u32 m0, s34, 20480
    s_nop 0
    buffer_load_dwordx4 v10, s[12:15], s32 offen lds
    s_add_u32 m0, s34, 21504
    s_nop 0
    buffer_load_dwordx4 v11, s[12:15], s32 offen lds
    s_add_u32 m0, s34, 22528
    s_nop 0
    buffer_load_dwordx4 v12, s[12:15], s32 offen lds
    s_add_u32 m0, s34, 23552
    s_nop 0
    buffer_load_dwordx4 v13, s[12:15], s32 offen lds
    s_add_u32 s32, s32, 589824
    s_add_u32 m0, s34, 40960
    s_nop 0
    buffer_load_dwordx4 v10, s[12:15], s32 offen lds
    s_add_u32 m0, s34, 41984
    s_nop 0
    buffer_load_dwordx4 v11, s[12:15], s32 offen lds
    s_add_u32 m0, s34, 43008
    s_nop 0
    buffer_load_dwordx4 v12, s[12:15], s32 offen lds
    s_add_u32 m0, s34, 44032
    s_nop 0
    buffer_load_dwordx4 v13, s[12:15], s32 offen lds
    s_add_u32 s32, s32, 589824
    s_add_u32 m0, s34, 61440
    s_nop 0
    buffer_load_dwordx4 v10, s[12:15], s32 offen lds
    s_add_u32 m0, s34, 62464
    s_nop 0
    buffer_load_dwordx4 v11, s[12:15], s32 offen lds
    s_add_u32 m0, s34, 63488
    s_nop 0
    buffer_load_dwordx4 v12, s[12:15], s32 offen lds
    s_add_u32 m0, s34, 64512
    s_nop 0
    buffer_load_dwordx4 v13, s[12:15], s32 offen lds
    s_add_u32 s32, s32, 589824
    s_cmp_eq_u32 s3, 2
    s_cbranch_scc0 FK_w1
    s_mov_b32 s51, s32
    s_sub_u32 s32, s32, 2064384
    s_sub_u32 s34, s34, 8192
    s_add_u32 m0, s34, 20480
    s_nop 0
    buffer_load_dwordx4 v10, s[12:15], s32 offen lds
    s_add_u32 m0, s34, 21504
    s_nop 0
    buffer_load_dwordx4 v11, s[12:15], s32 offen lds
    s_add_u32 m0, s34, 22528
    s_nop 0
    buffer_load_dwordx4 v12, s[12:15], s32 offen lds
    s_add_u32 m0, s34, 23552
    s_nop 0
    buffer_load_dwordx4 v13, s[12:15], s32 offen lds
    s_add_u32 s32, s32, 589824
    s_add_u32 m0, s34, 40960
    s_nop 0
    buffer_load_dwordx4 v10, s[12:15], s32 offen lds
    s_add_u32 m0, s34, 41984
    s_nop 0
    buffer_load_dwordx4 v11, s[12:15], s32 offen lds
    s_add_u32 m0, s34, 43008
    s_nop 0
    buffer_load_dwordx4 v12, s[12:15], s32 offen lds
    s_add_u32 m0, s34, 44032
    s_nop 0
    buffer_load_dwordx4 v13, s[12:15], s32 offen lds
    s_add_u32 s32, s32, 589824
    s_add_u32 m0, s34, 61440
    s_nop 0
    buffer_load_dwordx4 v10, s[12:15], s32 offen lds
    s_add_u32 m0, s34, 62464
    s_nop 0
    buffer_load_dwordx4 v11, s[12:15], s32 offen lds
    s_add_u32 m0, s34, 63488
    s_nop 0
    buffer_load_dwordx4 v12, s[12:15], s32 offen lds
    s_add_u32 m0, s34, 64512
    s_nop 0
    buffer_load_dwordx4 v13, s[12:15], s32 offen lds
    s_add_u32 s32, s32, 589824
    s_mov_b32 s32, s51
    s_add_u32 s34, s34, 8192
FK_w1:
    s_cmp_ge_u32 s43, 18
    s_cbranch_scc1 FK_b9
    s_cmp_ge_u32 s50, 128
    s_cbranch_scc1 FK_tb
    s_mov_b32 s80, s62
    s_mov_b32 s81, s63
    s_mov_b32 s82, 0x121000
    s_mov_b32 s83, 0x20000
    s_mov_b32 s84, s64
    s_mov_b32 s85, s65
    s_mov_b32 s86, 0x121000
    s_mov_b32 s87, 0x20000
    s_and_b32 s44, s50, 7
    s_lshr_b32 s45, s50, 3
    s_lshl_b32 s46, s45, 7
    s_lshl_b32 s47, s44, 3
    s_add_u32 s46, s46, s47
    s_lshr_b32 s47, s3, 1
    s_lshl_b32 s47, s47, 6
    s_add_u32 s46, s46, s47
    s_and_b32 s47, s3, 1
    s_lshl_b32 s47, s47, 2
    s_add_u32 s46, s46, s47
    s_mul_i32 s46, s46, 578
    s_mul_i32 s47, s3, 4160
    s_add_u32 s47, s47, 122880
    v_lshlrev_b32 v2, 4, v0
    s_mov_b64 s[6:7], exec
    s_mov_b32 exec_lo, -1
    s_mov_b32 exec_hi, 0xf
    s_add_u32 m0, s47, 0
    s_add_u32 s44, s46, 0
    buffer_load_dwordx4 v2, s[80:83], s44 offen lds
    s_add_u32 m0, s47, 1040
    s_add_u32 s44, s46, 578
    buffer_load_dwordx4 v2, s[80:83], s44 offen lds
    s_add_u32 m0, s47, 2080
    s_add_u32 s44, s46, 1156
    buffer_load_dwordx4 v2, s[80:83], s44 offen lds
    s_add_u32 m0, s47, 3120
    s_add_u32 s44, s46, 1734
    buffer_load_dwordx4 v2, s[80:83], s44 offen lds
    s_add_u32 m0, s47, 16640
    s_add_u32 s44, s46, 0
    buffer_load_dwordx4 v2, s[84:87], s44 offen lds
    s_add_u32 m0, s47, 17680
    s_add_u32 s44, s46, 578
    buffer_load_dwordx4 v2, s[84:87], s44 offen lds
    s_add_u32 m0, s47, 18720
    s_add_u32 s44, s46, 1156
    buffer_load_dwordx4 v2, s[84:87], s44 offen lds
    s_add_u32 m0, s47, 19760
    s_add_u32 s44, s46, 1734
    buffer_load_dwordx4 v2, s[84:87], s44 offen lds
    s_mov_b64 exec, s[6:7]
    s_cmp_eq_u32 s3, 3
    s_cbranch_scc0 FK_b9
    s_mov_b32 s51, 0
    s_mov_b32 s80, s62
    s_mov_b32 s81, s63
    s_mov_b32 s82, 0x121000
    s_mov_b32 s83, 0x20000
    s_mov_b32 s84, s64
    s_mov_b32 s85, s65
    s_mov_b32 s86, 0x121000
    s_mov_b32 s87, 0x20000
    s_and_b32 s44, s50, 7
    s_lshr_b32 s45, s50, 3
    s_lshl_b32 s46, s45, 7
    s_lshl_b32 s47, s44, 3
    s_add_u32 s46, s46, s47
    s_lshr_b32 s47, s51, 1
    s_lshl_b32 s47, s47, 6
    s_add_u32 s46, s46, s47
    s_and_b32 s47, s51, 1
    s_lshl_b32 s47, s47, 2
    s_add_u32 s46, s46, s47
    s_mul_i32 s46, s46, 578
    s_mul_i32 s47, s51, 4160
    s_add_u32 s47, s47, 122880
    v_lshlrev_b32 v2, 4, v0
    s_mov_b64 s[6:7], exec
    s_mov_b32 exec_lo, -1
    s_mov_b32 exec_hi, 0xf
    s_add_u32 m0, s47, 0
    s_add_u32 s44, s46, 0
    buffer_load_dwordx4 v2, s[80:83], s44 offen lds
    s_add_u32 m0, s47, 1040
    s_add_u32 s44, s46, 578
    buffer_load_dwordx4 v2, s[80:83], s44 offen lds
    s_add_u32 m0, s47, 2080
    s_add_u32 s44, s46, 1156
    buffer_load_dwordx4 v2, s[80:83], s44 offen lds
    s_add_u32 m0, s47, 3120
    s_add_u32 s44, s46, 1734
    buffer_load_dwordx4 v2, s[80:83], s44 offen lds
    s_add_u32 m0, s47, 16640
    s_add_u32 s44, s46, 0
    buffer_load_dwordx4 v2, s[84:87], s44 offen lds
    s_add_u32 m0, s47, 17680
    s_add_u32 s44, s46, 578
    buffer_load_dwordx4 v2, s[84:87], s44 offen lds
    s_add_u32 m0, s47, 18720
    s_add_u32 s44, s46, 1156
    buffer_load_dwordx4 v2, s[84:87], s44 offen lds
    s_add_u32 m0, s47, 19760
    s_add_u32 s44, s46, 1734
    buffer_load_dwordx4 v2, s[84:87], s44 offen lds
    s_cmp_eq_u32 s51, 0
    s_cbranch_scc0 FKb_w288
    s_mov_b64 exec, 0xffff
    v_and_b32 v3, 7, v0
    v_lshrrev_b32 v2, 3, v0
    v_lshl_add_u32 v3, v2, 6, v3
    v_mul_u32_u24 v3, 578, v3
    s_mov_b32 m0, 123456
    s_add_u32 s44, s46, 576
    buffer_load_ushort v3, s[80:83], s44 offen lds
    s_mov_b32 m0, 140096
    s_add_u32 s44, s46, 576
    buffer_load_ushort v3, s[84:87], s44 offen lds
FKb_w288:
    s_mov_b64 exec, s[6:7]
    s_branch FK_b9
FK_tb:
    s_sub_u32 s51, s50, 128
    s_mul_i32 s51, s51, 12
    s_sub_u32 s52, s3, 1
    s_lshl_b32 s52, s52, 2
    s_add_u32 s51, s51, s52
    s_mov_b32 s52, 4
FK_tbl:
    s_cmp_ge_u32 s51, 192
    s_cbranch_scc1 FKa_tabd
    s_cmp_ge_u32 s51, 160
    s_cbranch_scc1 FKa_tw
    s_cmp_ge_u32 s51, 128
    s_mov_b32 s91, 0x3c800000
    s_mov_b32 s48, 0x3d000000
    s_cselect_b32 s91, s48, s91
    s_mov_b32 s94, 0
    s_mov_b32 s48, 128
    s_cselect_b32 s94, s48, s94
    s_mov_b32 s92, 12
    s_mov_b32 s48, 10
    s_cselect_b32 s92, s48, s92
    s_mov_b32 s90, 13672448
    s_mov_b32 s48, 13631488
    s_cselect_b32 s90, s48, s90
    s_add_u32 s80, s8, s90
    s_addc_u32 s81, s9, 0
    s_mov_b32 s82, 40960
    s_mov_b32 s83, 0x20000
    s_sub_u32 s95, s51, s94
    s_lshl_b32 s95, s95, 6
    v_add_u32 v104, s95, v0
    v_lshrrev_b32 v103, s92, v104
    v_and_b32 v105, 3, v104
    v_bfe_u32 v106, v104, 2, 6
    s_sub_u32 s92, s92, 8
    v_bfe_u32 v107, v104, 8, s92
    v_and_b32 v108, 31, v106
    v_lshrrev_b32 v109, 3, v107
    v_lshl_add_u32 v108, v109, 5, v108
    v_and_b32 v109, 7, v107
    v_lshrrev_b32 v110, 5, v106
    v_lshlrev_b32 v109, 3, v109
    v_lshl_add_u32 v109, v110, 2, v109
    v_add_u32 v109, v109, v105
    v_mul_u32_u24 v108, v108, v109
    v_cvt_f32_u32 v108, v108
    v_mul_f32 v108, s91, v108
    v_fract_f32 v108, v108
    v_cos_f32 v110, v108
    v_sin_f32 v111, v108
    v_cmp_eq_u32 vcc, 1, v103
    v_sub_f32 v112, 0, v111
    s_nop 0
    v_cndmask_b32 v114, v110, v112, vcc
    v_cndmask_b32 v115, v111, v110, vcc
    v_cvt_pk_bf16_f32 v110, v114, v115
    s_lshl_b32 s95, s51, 8
    v_lshl_add_u32 v112, v0, 2, s95
    buffer_store_dword v110, v112, s[80:83], 0 offen sc1
    s_branch FKa_tabd
FKa_tw:
    s_cmp_ge_u32 s51, 176
    s_mov_b32 s90, 13631488
    s_mov_b32 s48, 13647872
    s_cselect_b32 s90, s48, s90
    s_mov_b32 s94, 160
    s_mov_b32 s48, 176
    s_cselect_b32 s94, s48, s94
    s_cselect_b32 s91, 1.0, 0x35e38e39
    s_cselect_b64 vcc, -1, 0
    s_add_u32 s80, s8, s90
    s_addc_u32 s81, s9, 0
    s_mov_b32 s82, 16384
    s_mov_b32 s83, 0x20000
    s_sub_u32 s95, s51, s94
    s_lshl_b32 s95, s95, 6
    v_add_u32 v104, s95, v0
    v_and_b32 v106, 63, v104
    v_bfe_u32 v107, v104, 6, 3
    v_lshrrev_b32 v108, 9, v104
    v_lshlrev_b32 v108, 5, v108
    v_lshrrev_b32 v109, 1, v107
    v_and_b32 v110, 1, v107
    v_lshlrev_b32 v110, 1, v110
    v_lshrrev_b32 v111, 5, v106
    v_lshl_add_u32 v110, v111, 2, v110
    v_lshl_add_u32 v110, v109, 3, v110
    v_and_b32 v111, 31, v106
    v_add_u32 v112, 0, v110
    v_cndmask_b32 v113, v112, v111, vcc
    v_mul_u32_u24 v113, v108, v113
    v_mul_u32_u24 v112, v112, v111
    v_add_u32 v112, v112, v113
    v_cvt_f32_u32 v112, v112
    v_mul_f32 v112, 0x3a000000, v112
    v_cos_f32 v116, v112
    v_sin_f32 v118, v112
    v_add_u32 v112, 1, v110
    v_cndmask_b32 v113, v112, v111, vcc
    v_mul_u32_u24 v113, v108, v113
    v_mul_u32_u24 v112, v112, v111
    v_add_u32 v112, v112, v113
    v_cvt_f32_u32 v112, v112
    v_mul_f32 v112, 0x3a000000, v112
    v_cos_f32 v117, v112
    v_sin_f32 v119, v112
    v_mul_f32 v116, s91, v116
    v_mul_f32 v117, s91, v117
    v_mul_f32 v118, s91, v118
    v_mul_f32 v119, s91, v119
    v_lshlrev_b32 v112, 4, v104
    buffer_store_dwordx4 v[116:119], v112, s[80:83], 0 offen sc1
FKa_tabd:
    s_add_u32 s51, s51, 1
    s_sub_u32 s52, s52, 1
    s_cmp_lg_u32 s52, 0
    s_cbranch_scc1 FK_tbl
    s_branch FK_b9
FK_w0:
    s_add_u32 s32, s32, 1769472
    s_and_b32 s59, s59, 7
    s_add_u32 s45, s39, s59
    s_lshl_b32 s46, s49, 2
    s_add_u32 s46, s46, 4096
    s_mov_b64 s[6:7], exec
    s_mov_b64 exec, 1
    v_mov_b32 v4, s45
    v_mov_b32 v5, 0
    buffer_store_dword v4, v5, s[76:79], s46 offen sc1
    s_mov_b64 exec, s[6:7]
    s_lshl_b32 s46, s40, 7
    s_add_u32 s46, s46, 4096
    v_and_b32 v2, 31, v0
    v_lshlrev_b32 v3, 2, v2
    v_add_u32 v3, s46, v3
    s_lshl_b32 s47, s43, 7
    s_mul_i32 s48, s47, 7282
    s_lshr_b32 s48, s48, 16
    s_add_u32 s47, s47, 127
    s_mul_i32 s47, s47, 7282
    s_lshr_b32 s47, s47, 16
    v_add_u32 v2, s48, v2
    v_min_u32 v2, s47, v2
    v_lshlrev_b32 v2, 2, v2
    v_add_u32 v2, 4096, v2
    s_cmp_ge_u32 s43, 18
    s_cselect_b32 s47, -1, 0
    s_mov_b32 s46, -1
    s_mov_b64 vcc, s[46:47]
    v_cndmask_b32 v2, v2, v3, vcc
    s_mov_b32 s5, 0
FK_p0:
    buffer_load_dword v4, v2, s[76:79], 0 offen sc1
    s_add_u32 s5, s5, 1
    s_waitcnt vmcnt(0)
    v_subrev_u32 v5, s39, v4
    v_cmp_le_u32 vcc, 8, v5
    s_cmp_ge_u32 s5, 20000
    s_cbranch_scc1 FK_p0x
    s_nop 1
    s_cmp_eq_u64 vcc, 0
    s_cbranch_scc1 FK_p0x
    s_branch FK_p0
FK_p0x:
    s_lshl_b32 s46, s41, 2
    v_readlane_b32 s47, v5, s46
    s_add_u32 s46, s46, 1
    s_nop 3
    v_readlane_b32 s48, v5, s46
    s_add_u32 s46, s46, 1
    s_nop 3
    v_readlane_b32 s51, v5, s46
    s_add_u32 s46, s46, 1
    s_nop 3
    v_readlane_b32 s52, v5, s46
    s_nop 3
    s_xor_b32 s48, s48, s47
    s_xor_b32 s51, s51, s47
    s_xor_b32 s52, s52, s47
    s_or_b32 s48, s48, s51
    s_or_b32 s48, s48, s52
    s_cmp_eq_u32 s48, 0
    s_cselect_b32 s59, 1, 0
    v_mov_b32 v2, 156160
    v_mov_b32 v3, s59
    ds_write_b32 v2, v3
    s_waitcnt lgkmcnt(0)
FK_b9:
    s_barrier
    v_mov_b32 v2, 156160
    ds_read_b32 v3, v2
    s_and_b32 s44, s41, 1
    s_lshl_b32 s44, s44, 2
    s_add_u32 s44, s44, s42
    s_lshl_b32 s44, s44, 1
    s_and_b32 s45, s3, 1
    s_add_u32 s44, s44, s45
    s_lshl_b32 s45, s40, 4
    s_add_u32 s44, s44, s45
    s_mul_i32 s44, s44, 18432
    s_lshr_b32 s45, s3, 1
    s_lshl_b32 s45, s45, 12
    s_add_u32 s44, s44, s45
    v_lshrrev_b32 v2, 1, v0
    v_lshlrev_b32 v2, 7, v2
    buffer_load_dword v27, v2, s[20:23], s44 offen sc1
    s_waitcnt vmcnt(0) lgkmcnt(0)
    v_readfirstlane_b32 s59, v3
    s_barrier
    s_cmp_ge_u32 s43, 18
    s_cbranch_scc1 FK_noE
    s_add_u32 m0, s36, 0
    s_nop 0
    buffer_load_dwordx4 v14, s[24:27], s35 offen lds
    s_add_u32 s35, s35, 2048
    buffer_load_dwordx4 a[0:3], v16, s[20:23], s33 offen offset:0 sc1
    buffer_load_dwordx4 a[16:19], v16, s[20:23], s33 offen offset:1024 sc1
    buffer_load_dwordx4 a[4:7], v17, s[20:23], s33 offen offset:0 sc1
    buffer_load_dwordx4 a[20:23], v17, s[20:23], s33 offen offset:1024 sc1
    buffer_load_dwordx4 a[8:11], v18, s[20:23], s33 offen offset:0 sc1
    buffer_load_dwordx4 a[24:27], v18, s[20:23], s33 offen offset:1024 sc1
    buffer_load_dwordx4 a[12:15], v19, s[20:23], s33 offen offset:0 sc1
    buffer_load_dwordx4 a[28:31], v19, s[20:23], s33 offen offset:1024 sc1
    s_add_u32 s33, s33, 2048
    s_add_u32 m0, s36, 20480
    s_nop 0
    buffer_load_dwordx4 v14, s[24:27], s35 offen lds
    s_add_u32 s35, s35, 2048
    buffer_load_dwordx4 a[32:35], v16, s[20:23], s33 offen offset:0 sc1
    buffer_load_dwordx4 a[48:51], v16, s[20:23], s33 offen offset:1024 sc1
    buffer_load_dwordx4 a[36:39], v17, s[20:23], s33 offen offset:0 sc1
    buffer_load_dwordx4 a[52:55], v17, s[20:23], s33 offen offset:1024 sc1
    buffer_load_dwordx4 a[40:43], v18, s[20:23], s33 offen offset:0 sc1
    buffer_load_dwordx4 a[56:59], v18, s[20:23], s33 offen offset:1024 sc1
    buffer_load_dwordx4 a[44:47], v19, s[20:23], s33 offen offset:0 sc1
    buffer_load_dwordx4 a[60:63], v19, s[20:23], s33 offen offset:1024 sc1
    s_add_u32 s33, s33, 2048
    s_cmp_ge_u32 s50, 128
    s_cbranch_scc1 FKE_tw
    s_add_u32 s80, s8, 0x4000000
    s_addc_u32 s81, s9, 0
    s_mov_b32 s82, 0x242000
    s_mov_b32 s83, 0x20000
    s_and_b32 s92, s50, 7
    s_lshr_b32 s93, s50, 3
    s_lshr_b32 s94, s92, 2
    s_lshl_b32 s94, s94, 12
    s_lshr_b32 s95, s93, 2
    s_lshl_b32 s95, s95, 1
    s_and_b32 s4, s93, 1
    s_add_u32 s95, s95, s4
    s_lshl_b32 s95, s95, 9
    s_add_u32 s94, s94, s95
    s_lshr_b32 s95, s93, 1
    s_and_b32 s95, s95, 1
    s_lshl_b32 s95, s95, 8
    s_add_u32 s94, s94, s95
    s_and_b32 s95, s92, 3
    s_lshl_b32 s95, s95, 6
    s_add_u32 s94, s94, s95
    v_and_b32 v1, 7, v0
    v_lshrrev_b32 v2, 3, v0
    s_lshl_b32 s95, s3, 3
    v_add_u32 v2, s95, v2
    v_lshlrev_b32 v3, 13, v2
    v_lshl_add_u32 v3, v1, 3, v3
    v_add_u32 v3, s94, v3
    v_mul_u32_u24 v4, 1040, v1
    v_lshl_add_u32 v4, v2, 1, v4
    v_add_u32 v4, 122880, v4
    ds_read_u16 v40, v4 offset:0
    ds_read_u16 v41, v4 offset:8320
    ds_read_u16 v42, v4 offset:16640
    ds_read_u16 v43, v4 offset:24960
    ds_read_u16 v44, v4 offset:64
    ds_read_u16 v45, v4 offset:8384
    ds_read_u16 v46, v4 offset:16704
    ds_read_u16 v47, v4 offset:25024
    s_waitcnt lgkmcnt(4)
    v_cmp_eq_u32 vcc, 0, v2
    v_mov_b32 v5, 1.0
    s_nop 0
    v_cndmask_b32 v5, v5, 0.5, vcc
    v_lshlrev_b32 v40, 16, v40
    v_lshlrev_b32 v41, 16, v41
    v_lshlrev_b32 v42, 16, v42
    v_lshlrev_b32 v43, 16, v43
    v_mul_f32 v40, v5, v40
    v_mul_f32 v41, v5, v41
    v_mul_f32 v42, v5, v42
    v_mul_f32 v43, v5, v43
    v_cvt_pk_bf16_f32 v40, v40, v41
    v_cvt_pk_bf16_f32 v41, v42, v43
    buffer_store_dwordx2 v[40:41], v3, s[80:83], 0 offen sc1
    v_add_u32 v3, 262144, v3
    ds_read_u16 v40, v4 offset:128
    ds_read_u16 v41, v4 offset:8448
    ds_read_u16 v42, v4 offset:16768
    ds_read_u16 v43, v4 offset:25088
    s_waitcnt lgkmcnt(4)
    v_lshl_or_b32 v44, v45, 16, v44
    v_lshl_or_b32 v45, v47, 16, v46
    buffer_store_dwordx2 v[44:45], v3, s[80:83], 0 offen sc1
    v_add_u32 v3, 262144, v3
    ds_read_u16 v44, v4 offset:192
    ds_read_u16 v45, v4 offset:8512
    ds_read_u16 v46, v4 offset:16832
    ds_read_u16 v47, v4 offset:25152
    s_waitcnt lgkmcnt(4)
    v_lshl_or_b32 v40, v41, 16, v40
    v_lshl_or_b32 v41, v43, 16, v42
    buffer_store_dwordx2 v[40:41], v3, s[80:83], 0 offen sc1
    v_add_u32 v3, 262144, v3
    ds_read_u16 v40, v4 offset:256
    ds_read_u16 v41, v4 offset:8576
    ds_read_u16 v42, v4 offset:16896
    ds_read_u16 v43, v4 offset:25216
    s_waitcnt lgkmcnt(4)
    v_lshl_or_b32 v44, v45, 16, v44
    v_lshl_or_b32 v45, v47, 16, v46
    buffer_store_dwordx2 v[44:45], v3, s[80:83], 0 offen sc1
    v_add_u32 v3, 262144, v3
    ds_read_u16 v44, v4 offset:320
    ds_read_u16 v45, v4 offset:8640
    ds_read_u16 v46, v4 offset:16960
    ds_read_u16 v47, v4 offset:25280
    s_waitcnt lgkmcnt(4)
    v_lshl_or_b32 v40, v41, 16, v40
    v_lshl_or_b32 v41, v43, 16, v42
    buffer_store_dwordx2 v[40:41], v3, s[80:83], 0 offen sc1
    v_add_u32 v3, 262144, v3
    ds_read_u16 v40, v4 offset:384
    ds_read_u16 v41, v4 offset:8704
    ds_read_u16 v42, v4 offset:17024
    ds_read_u16 v43, v4 offset:25344
    s_waitcnt lgkmcnt(4)
    v_lshl_or_b32 v44, v45, 16, v44
    v_lshl_or_b32 v45, v47, 16, v46
    buffer_store_dwordx2 v[44:45], v3, s[80:83], 0 offen sc1
    v_add_u32 v3, 262144, v3
    ds_read_u16 v44, v4 offset:448
    ds_read_u16 v45, v4 offset:8768
    ds_read_u16 v46, v4 offset:17088
    ds_read_u16 v47, v4 offset:25408
    s_waitcnt lgkmcnt(4)
    v_lshl_or_b32 v40, v41, 16, v40
    v_lshl_or_b32 v41, v43, 16, v42
    buffer_store_dwordx2 v[40:41], v3, s[80:83], 0 offen sc1
    v_add_u32 v3, 262144, v3
    ds_read_u16 v40, v4 offset:512
    ds_read_u16 v41, v4 offset:8832
    ds_read_u16 v42, v4 offset:17152
    ds_read_u16 v43, v4 offset:25472
    s_waitcnt lgkmcnt(4)
    v_lshl_or_b32 v44, v45, 16, v44
    v_lshl_or_b32 v45, v47, 16, v46
    buffer_store_dwordx2 v[44:45], v3, s[80:83], 0 offen sc1
    v_add_u32 v3, 262144, v3
    s_waitcnt lgkmcnt(0)
    v_lshl_or_b32 v40, v41, 16, v40
    v_lshl_or_b32 v41, v43, 16, v42
    buffer_store_dwordx2 v[40:41], v3, s[80:83], 0 offen sc1
    v_add_u32 v3, 262144, v3
    s_cmp_eq_u32 s3, 0
    s_cbranch_scc0 FKE_wtx
    v_lshlrev_b32 v5, 2, v1
    v_add_u32 v5, 123456, v5
    ds_read_b32 v40, v5 offset:0
    ds_read_b32 v41, v5 offset:32
    ds_read_b32 v42, v5 offset:16640
    ds_read_b32 v43, v5 offset:16672
    v_lshlrev_b32 v3, 3, v1
    v_add_u32 v3, s94, v3
    v_add_u32 v3, 2359296, v3
    v_mov_b32 v5, 0.5
    s_waitcnt lgkmcnt(0)
    v_lshlrev_b32 v40, 16, v40
    v_lshlrev_b32 v41, 16, v41
    v_lshlrev_b32 v42, 16, v42
    v_lshlrev_b32 v43, 16, v43
    v_mul_f32 v40, v5, v40
    v_mul_f32 v41, v5, v41
    v_mul_f32 v42, v5, v42
    v_mul_f32 v43, v5, v43
    v_cvt_pk_bf16_f32 v40, v40, v41
    v_cvt_pk_bf16_f32 v41, v42, v43
    s_mov_b64 s[92:93], exec
    s_mov_b64 exec, 0xff
    buffer_store_dwordx2 v[40:41], v3, s[80:83], 0 offen sc1
    s_mov_b64 exec, s[92:93]
FKE_wtx:
    s_branch FKE_f0b
FKE_tw:
    s_waitcnt vmcnt(9)
    s_cmp_eq_u32 s3, 0
    s_cbranch_scc0 FKE_f0b
    s_sub_u32 s46, s50, 128
    s_lshl_b32 s46, s46, 2
    s_add_u32 s46, s46, 12288
    s_mov_b64 s[6:7], exec
    s_mov_b64 exec, 1
    v_mov_b32 v4, s39
    v_mov_b32 v5, 0
    buffer_store_dword v4, v5, s[76:79], s46 offen sc1
    s_mov_b64 exec, s[6:7]
FKE_f0b:
    s_waitcnt vmcnt(18)
    s_barrier
    ds_read_b64_tr_b16 v[48:49], v28 offset:0
    ds_read_b64_tr_b16 v[50:51], v28 offset:2048
    ds_read_b64_tr_b16 v[52:53], v28 offset:4096
    ds_read_b64_tr_b16 v[54:55], v28 offset:6144
    ds_read_b64_tr_b16 v[56:57], v29 offset:0
    ds_read_b64_tr_b16 v[58:59], v29 offset:2048
    s_waitcnt vmcnt(9) lgkmcnt(4)
    v_mfma_f32_16x16x32_bf16 v[96:99], v[48:51], a[0:3], 0
    ds_read_b64_tr_b16 v[60:61], v29 offset:4096
    v_mfma_f32_16x16x32_bf16 v[100:103], v[48:51], a[4:7], 0
    ds_read_b64_tr_b16 v[62:63], v29 offset:6144
    v_mfma_f32_16x16x32_bf16 v[104:107], v[48:51], a[8:11], 0
    v_mfma_f32_16x16x32_bf16 v[108:111], v[48:51], a[12:15], 0
    s_waitcnt vmcnt(8)
    s_barrier
    s_waitcnt lgkmcnt(4)
    v_mfma_f32_16x16x32_bf16 v[112:115], v[52:55], a[0:3], 0
    ds_read_b64_tr_b16 v[48:49], v30 offset:0
    v_mfma_f32_16x16x32_bf16 v[116:119], v[52:55], a[4:7], 0
    ds_read_b64_tr_b16 v[50:51], v30 offset:2048
    v_mfma_f32_16x16x32_bf16 v[120:123], v[52:55], a[8:11], 0
    buffer_load_dwordx4 a[64:67], v16, s[20:23], s33 offen offset:0 sc1
    v_mfma_f32_16x16x32_bf16 v[124:127], v[52:55], a[12:15], 0
    s_waitcnt lgkmcnt(4)
    v_mfma_f32_16x16x32_bf16 v[128:131], v[56:59], a[0:3], 0
    ds_read_b64_tr_b16 v[52:53], v30 offset:4096
    v_mfma_f32_16x16x32_bf16 v[132:135], v[56:59], a[4:7], 0
    ds_read_b64_tr_b16 v[54:55], v30 offset:6144
    v_mfma_f32_16x16x32_bf16 v[136:139], v[56:59], a[8:11], 0
    buffer_load_dwordx4 a[80:83], v16, s[20:23], s33 offen offset:1024 sc1
    v_mfma_f32_16x16x32_bf16 v[140:143], v[56:59], a[12:15], 0
    s_waitcnt lgkmcnt(4)
    v_mfma_f32_16x16x32_bf16 v[144:147], v[60:63], a[0:3], 0
    ds_read_b64_tr_b16 v[56:57], v31 offset:0
    v_mfma_f32_16x16x32_bf16 v[148:151], v[60:63], a[4:7], 0
    ds_read_b64_tr_b16 v[58:59], v31 offset:2048
    v_mfma_f32_16x16x32_bf16 v[152:155], v[60:63], a[8:11], 0
    buffer_load_dwordx4 a[68:71], v17, s[20:23], s33 offen offset:0 sc1
    v_mfma_f32_16x16x32_bf16 v[156:159], v[60:63], a[12:15], 0
    s_waitcnt lgkmcnt(4)
    v_mfma_f32_16x16x32_bf16 v[160:163], v[48:51], a[0:3], 0
    ds_read_b64_tr_b16 v[60:61], v31 offset:4096
    v_mfma_f32_16x16x32_bf16 v[164:167], v[48:51], a[4:7], 0
    ds_read_b64_tr_b16 v[62:63], v31 offset:6144
    v_mfma_f32_16x16x32_bf16 v[168:171], v[48:51], a[8:11], 0
    buffer_load_dwordx4 a[84:87], v17, s[20:23], s33 offen offset:1024 sc1
    v_mfma_f32_16x16x32_bf16 v[172:175], v[48:51], a[12:15], 0
    s_waitcnt lgkmcnt(4)
    v_mfma_f32_16x16x32_bf16 v[176:179], v[52:55], a[0:3], 0
    ds_read_b64_tr_b16 v[48:49], v36 offset:16384
    v_mfma_f32_16x16x32_bf16 v[180:183], v[52:55], a[4:7], 0
    ds_read_b64_tr_b16 v[50:51], v36 offset:16896
    v_mfma_f32_16x16x32_bf16 v[184:187], v[52:55], a[8:11], 0
    buffer_load_dwordx4 a[72:75], v18, s[20:23], s33 offen offset:0 sc1
    v_mfma_f32_16x16x32_bf16 v[188:191], v[52:55], a[12:15], 0
    s_waitcnt lgkmcnt(4)
    v_mfma_f32_16x16x32_bf16 v[192:195], v[56:59], a[0:3], 0
    ds_read_b64_tr_b16 v[52:53], v36 offset:17408
    v_mfma_f32_16x16x32_bf16 v[196:199], v[56:59], a[4:7], 0
    ds_read_b64_tr_b16 v[54:55], v36 offset:17920
    v_mfma_f32_16x16x32_bf16 v[200:203], v[56:59], a[8:11], 0
    buffer_load_dwordx4 a[88:91], v18, s[20:23], s33 offen offset:1024 sc1
    v_mfma_f32_16x16x32_bf16 v[204:207], v[56:59], a[12:15], 0
    s_waitcnt lgkmcnt(4)
    v_mfma_f32_16x16x32_bf16 v[208:211], v[60:63], a[0:3], 0
    ds_read_b64_tr_b16 v[56:57], v28 offset:8192
    v_mfma_f32_16x16x32_bf16 v[212:215], v[60:63], a[4:7], 0
    ds_read_b64_tr_b16 v[58:59], v28 offset:10240
    v_mfma_f32_16x16x32_bf16 v[216:219], v[60:63], a[8:11], 0
    buffer_load_dwordx4 a[76:79], v19, s[20:23], s33 offen offset:0 sc1
    v_mfma_f32_16x16x32_bf16 v[220:223], v[60:63], a[12:15], 0
    s_waitcnt lgkmcnt(4)
    v_mfma_f32_16x16x32_bf16 v[224:227], v[48:51], a[0:3], 0
    ds_read_b64_tr_b16 v[60:61], v28 offset:12288
    v_mfma_f32_16x16x32_bf16 v[228:231], v[48:51], a[4:7], 0
    ds_read_b64_tr_b16 v[62:63], v28 offset:14336
    v_mfma_f32_16x16x32_bf16 v[232:235], v[48:51], a[8:11], 0
    buffer_load_dwordx4 a[92:95], v19, s[20:23], s33 offen offset:1024 sc1
    s_add_u32 s33, s33, 2048
    v_mfma_f32_16x16x32_bf16 v[236:239], v[48:51], a[12:15], 0
    s_waitcnt lgkmcnt(4)
    v_mfma_f32_16x16x32_bf16 v[240:243], v[52:55], a[0:3], 0
    ds_read_b64_tr_b16 v[48:49], v29 offset:8192
    v_mfma_f32_16x16x32_bf16 v[244:247], v[52:55], a[4:7], 0
    ds_read_b64_tr_b16 v[50:51], v29 offset:10240
    v_mfma_f32_16x16x32_bf16 v[248:251], v[52:55], a[8:11], 0
    v_mfma_f32_16x16x32_bf16 v[252:255], v[52:55], a[12:15], 0
    s_waitcnt lgkmcnt(4)
    v_mfma_f32_16x16x32_bf16 v[96:99], v[56:59], a[16:19], v[96:99]
    ds_read_b64_tr_b16 v[52:53], v29 offset:12288
    v_mfma_f32_16x16x32_bf16 v[100:103], v[56:59], a[20:23], v[100:103]
    ds_read_b64_tr_b16 v[54:55], v29 offset:14336
    v_mfma_f32_16x16x32_bf16 v[104:107], v[56:59], a[24:27], v[104:107]
    s_and_b32 s44, s41, 1
    s_lshl_b32 s44, s44, 2
    v_mfma_f32_16x16x32_bf16 v[108:111], v[56:59], a[28:31], v[108:111]
    s_add_u32 s44, s44, s42
    s_waitcnt lgkmcnt(4)
    v_mfma_f32_16x16x32_bf16 v[112:115], v[60:63], a[16:19], v[112:115]
    ds_read_b64_tr_b16 v[56:57], v30 offset:8192
    v_mfma_f32_16x16x32_bf16 v[116:119], v[60:63], a[20:23], v[116:119]
    ds_read_b64_tr_b16 v[58:59], v30 offset:10240
    v_mfma_f32_16x16x32_bf16 v[120:123], v[60:63], a[24:27], v[120:123]
    s_lshl_b32 s44, s44, 1
    s_and_b32 s45, s3, 1
    v_mfma_f32_16x16x32_bf16 v[124:127], v[60:63], a[28:31], v[124:127]
    s_add_u32 s44, s44, s45
    s_waitcnt lgkmcnt(4)
    v_mfma_f32_16x16x32_bf16 v[128:131], v[48:51], a[16:19], v[128:131]
    ds_read_b64_tr_b16 v[60:61], v30 offset:12288
    v_mfma_f32_16x16x32_bf16 v[132:135], v[48:51], a[20:23], v[132:135]
    ds_read_b64_tr_b16 v[62:63], v30 offset:14336
    v_mfma_f32_16x16x32_bf16 v[136:139], v[48:51], a[24:27], v[136:139]
    s_lshl_b32 s45, s40, 4
    s_add_u32 s44, s44, s45
    v_mfma_f32_16x16x32_bf16 v[140:143], v[48:51], a[28:31], v[140:143]
    s_mul_i32 s44, s44, 18432
    s_waitcnt lgkmcnt(4)
    v_mfma_f32_16x16x32_bf16 v[144:147], v[52:55], a[16:19], v[144:147]
    ds_read_b64_tr_b16 v[48:49], v31 offset:8192
    v_mfma_f32_16x16x32_bf16 v[148:151], v[52:55], a[20:23], v[148:151]
    ds_read_b64_tr_b16 v[50:51], v31 offset:10240
    v_mfma_f32_16x16x32_bf16 v[152:155], v[52:55], a[24:27], v[152:155]
    s_lshr_b32 s45, s3, 1
    s_add_u32 s45, s45, 8
    v_mfma_f32_16x16x32_bf16 v[156:159], v[52:55], a[28:31], v[156:159]
    s_lshl_b32 s45, s45, 10
    s_waitcnt lgkmcnt(4)
    v_mfma_f32_16x16x32_bf16 v[160:163], v[56:59], a[16:19], v[160:163]
    ds_read_b64_tr_b16 v[52:53], v31 offset:12288
    v_mfma_f32_16x16x32_bf16 v[164:167], v[56:59], a[20:23], v[164:167]
    ds_read_b64_tr_b16 v[54:55], v31 offset:14336
    v_mfma_f32_16x16x32_bf16 v[168:171], v[56:59], a[24:27], v[168:171]
    s_add_u32 s89, s44, s45
    v_lshrrev_b32 v21, 3, v0
    v_mfma_f32_16x16x32_bf16 v[172:175], v[56:59], a[28:31], v[172:175]
    v_lshlrev_b32 v21, 7, v21
    s_waitcnt lgkmcnt(4)
    v_mfma_f32_16x16x32_bf16 v[176:179], v[60:63], a[16:19], v[176:179]
    ds_read_b64_tr_b16 v[56:57], v36 offset:18432
    v_mfma_f32_16x16x32_bf16 v[180:183], v[60:63], a[20:23], v[180:183]
    ds_read_b64_tr_b16 v[58:59], v36 offset:18944
    v_mfma_f32_16x16x32_bf16 v[184:187], v[60:63], a[24:27], v[184:187]
    buffer_load_dword v27, v21, s[20:23], s89 offen sc1
    s_add_u32 s89, s89, 2048
    v_mfma_f32_16x16x32_bf16 v[188:191], v[60:63], a[28:31], v[188:191]
    s_add_u32 m0, s36, 40960
    s_waitcnt lgkmcnt(4)
    v_mfma_f32_16x16x32_bf16 v[192:195], v[48:51], a[16:19], v[192:195]
    ds_read_b64_tr_b16 v[60:61], v36 offset:19456
    v_mfma_f32_16x16x32_bf16 v[196:199], v[48:51], a[20:23], v[196:199]
    ds_read_b64_tr_b16 v[62:63], v36 offset:19968
    v_mfma_f32_16x16x32_bf16 v[200:203], v[48:51], a[24:27], v[200:203]
    buffer_load_dwordx4 v14, s[24:27], s35 offen lds
    s_add_u32 s35, s35, 2048
    v_mfma_f32_16x16x32_bf16 v[204:207], v[48:51], a[28:31], v[204:207]
    s_add_u32 m0, s36, 61440
    s_waitcnt lgkmcnt(4)
    v_mfma_f32_16x16x32_bf16 v[208:211], v[52:55], a[16:19], v[208:211]
    ds_read_b64_tr_b16 v[48:49], v28 offset:20480
    v_mfma_f32_16x16x32_bf16 v[212:215], v[52:55], a[20:23], v[212:215]
    ds_read_b64_tr_b16 v[50:51], v28 offset:22528
    v_mfma_f32_16x16x32_bf16 v[216:219], v[52:55], a[24:27], v[216:219]
    buffer_load_dwordx4 v14, s[24:27], s35 offen lds
    s_add_u32 s35, s35, 2048
    v_mfma_f32_16x16x32_bf16 v[220:223], v[52:55], a[28:31], v[220:223]
    s_add_u32 m0, s34, 81920
    s_waitcnt lgkmcnt(4)
    v_mfma_f32_16x16x32_bf16 v[224:227], v[56:59], a[16:19], v[224:227]
    ds_read_b64_tr_b16 v[52:53], v28 offset:24576
    v_mfma_f32_16x16x32_bf16 v[228:231], v[56:59], a[20:23], v[228:231]
    ds_read_b64_tr_b16 v[54:55], v28 offset:26624
    v_mfma_f32_16x16x32_bf16 v[232:235], v[56:59], a[24:27], v[232:235]
    buffer_load_dwordx4 v10, s[12:15], s32 offen lds
    s_add_u32 m0, s34, 82944
    v_mfma_f32_16x16x32_bf16 v[236:239], v[56:59], a[28:31], v[236:239]
    buffer_load_dwordx4 v11, s[12:15], s32 offen lds
    s_waitcnt lgkmcnt(4)
    v_mfma_f32_16x16x32_bf16 v[240:243], v[60:63], a[16:19], v[240:243]
    ds_read_b64_tr_b16 v[56:57], v29 offset:20480
    v_mfma_f32_16x16x32_bf16 v[244:247], v[60:63], a[20:23], v[244:247]
    ds_read_b64_tr_b16 v[58:59], v29 offset:22528
    v_mfma_f32_16x16x32_bf16 v[248:251], v[60:63], a[24:27], v[248:251]
    s_add_u32 m0, s34, 83968
    v_mfma_f32_16x16x32_bf16 v[252:255], v[60:63], a[28:31], v[252:255]
    buffer_load_dwordx4 v12, s[12:15], s32 offen lds
    s_add_u32 m0, s34, 84992
    s_nop 0
    buffer_load_dwordx4 v13, s[12:15], s32 offen lds
    s_add_u32 s32, s32, 589824
    s_add_u32 m0, s36, 81920
    s_nop 0
    buffer_load_dwordx4 v14, s[24:27], s35 offen lds
    s_add_u32 s35, s35, 2048
    s_waitcnt vmcnt(16) lgkmcnt(4)
    v_mfma_f32_16x16x32_bf16 v[96:99], v[48:51], a[32:35], v[96:99]
    ds_read_b64_tr_b16 v[60:61], v29 offset:24576
    v_mfma_f32_16x16x32_bf16 v[100:103], v[48:51], a[36:39], v[100:103]
    ds_read_b64_tr_b16 v[62:63], v29 offset:26624
    v_mfma_f32_16x16x32_bf16 v[104:107], v[48:51], a[40:43], v[104:107]
    v_mfma_f32_16x16x32_bf16 v[108:111], v[48:51], a[44:47], v[108:111]
    s_waitcnt vmcnt(6)
    s_barrier
    s_cmp_eq_u32 s3, 0
    s_cbranch_scc0 FKE_fw
    s_cmp_ge_u32 s50, 128
    s_cbranch_scc1 FKE_fw
    s_lshl_b32 s46, s50, 2
    s_add_u32 s46, s46, 45056
    s_mov_b64 s[6:7], exec
    s_mov_b64 exec, 1
    v_mov_b32 v4, s39
    v_mov_b32 v5, 0
    buffer_store_dword v4, v5, s[76:79], s46 offen sc1
    s_mov_b64 exec, s[6:7]
FKE_fw:
    s_waitcnt lgkmcnt(4)
    v_mfma_f32_16x16x32_bf16 v[112:115], v[52:55], a[32:35], v[112:115]
    ds_read_b64_tr_b16 v[48:49], v30 offset:20480
    v_mfma_f32_16x16x32_bf16 v[116:119], v[52:55], a[36:39], v[116:119]
    ds_read_b64_tr_b16 v[50:51], v30 offset:22528
    v_mfma_f32_16x16x32_bf16 v[120:123], v[52:55], a[40:43], v[120:123]
    buffer_load_dwordx4 a[96:99], v16, s[20:23], s33 offen offset:0 sc1
    v_mfma_f32_16x16x32_bf16 v[124:127], v[52:55], a[44:47], v[124:127]
    s_waitcnt lgkmcnt(4)
    v_mfma_f32_16x16x32_bf16 v[128:131], v[56:59], a[32:35], v[128:131]
    ds_read_b64_tr_b16 v[52:53], v30 offset:24576
    v_mfma_f32_16x16x32_bf16 v[132:135], v[56:59], a[36:39], v[132:135]
    ds_read_b64_tr_b16 v[54:55], v30 offset:26624
    v_mfma_f32_16x16x32_bf16 v[136:139], v[56:59], a[40:43], v[136:139]
    buffer_load_dwordx4 a[112:115], v16, s[20:23], s33 offen offset:1024 sc1
    v_mfma_f32_16x16x32_bf16 v[140:143], v[56:59], a[44:47], v[140:143]
    s_waitcnt lgkmcnt(4)
    v_mfma_f32_16x16x32_bf16 v[144:147], v[60:63], a[32:35], v[144:147]
    ds_read_b64_tr_b16 v[56:57], v31 offset:20480
    v_mfma_f32_16x16x32_bf16 v[148:151], v[60:63], a[36:39], v[148:151]
    ds_read_b64_tr_b16 v[58:59], v31 offset:22528
    v_mfma_f32_16x16x32_bf16 v[152:155], v[60:63], a[40:43], v[152:155]
    buffer_load_dwordx4 a[100:103], v17, s[20:23], s33 offen offset:0 sc1
    v_mfma_f32_16x16x32_bf16 v[156:159], v[60:63], a[44:47], v[156:159]
    s_waitcnt lgkmcnt(4)
    v_mfma_f32_16x16x32_bf16 v[160:163], v[48:51], a[32:35], v[160:163]
    ds_read_b64_tr_b16 v[60:61], v31 offset:24576
    v_mfma_f32_16x16x32_bf16 v[164:167], v[48:51], a[36:39], v[164:167]
    ds_read_b64_tr_b16 v[62:63], v31 offset:26624
    v_mfma_f32_16x16x32_bf16 v[168:171], v[48:51], a[40:43], v[168:171]
    buffer_load_dwordx4 a[116:119], v17, s[20:23], s33 offen offset:1024 sc1
    v_mfma_f32_16x16x32_bf16 v[172:175], v[48:51], a[44:47], v[172:175]
    s_waitcnt lgkmcnt(4)
    v_mfma_f32_16x16x32_bf16 v[176:179], v[52:55], a[32:35], v[176:179]
    ds_read_b64_tr_b16 v[48:49], v36 offset:36864
    v_mfma_f32_16x16x32_bf16 v[180:183], v[52:55], a[36:39], v[180:183]
    ds_read_b64_tr_b16 v[50:51], v36 offset:37376
    v_mfma_f32_16x16x32_bf16 v[184:187], v[52:55], a[40:43], v[184:187]
    v_mfma_f32_16x16x32_bf16 v[188:191], v[52:55], a[44:47], v[188:191]
    s_waitcnt lgkmcnt(4)
    v_mfma_f32_16x16x32_bf16 v[192:195], v[56:59], a[32:35], v[192:195]
    ds_read_b64_tr_b16 v[52:53], v36 offset:37888
    v_mfma_f32_16x16x32_bf16 v[196:199], v[56:59], a[36:39], v[196:199]
    ds_read_b64_tr_b16 v[54:55], v36 offset:38400
    v_mfma_f32_16x16x32_bf16 v[200:203], v[56:59], a[40:43], v[200:203]
    buffer_load_dwordx4 a[104:107], v18, s[20:23], s33 offen offset:0 sc1
    v_mfma_f32_16x16x32_bf16 v[204:207], v[56:59], a[44:47], v[204:207]
    s_waitcnt lgkmcnt(4)
    v_mfma_f32_16x16x32_bf16 v[208:211], v[60:63], a[32:35], v[208:211]
    ds_read_b64_tr_b16 v[56:57], v28 offset:28672
    v_mfma_f32_16x16x32_bf16 v[212:215], v[60:63], a[36:39], v[212:215]
    ds_read_b64_tr_b16 v[58:59], v28 offset:30720
    v_mfma_f32_16x16x32_bf16 v[216:219], v[60:63], a[40:43], v[216:219]
    buffer_load_dwordx4 a[120:123], v18, s[20:23], s33 offen offset:1024 sc1
    v_mfma_f32_16x16x32_bf16 v[220:223], v[60:63], a[44:47], v[220:223]
    s_waitcnt lgkmcnt(4)
    v_mfma_f32_16x16x32_bf16 v[224:227], v[48:51], a[32:35], v[224:227]
    ds_read_b64_tr_b16 v[60:61], v28 offset:32768
    v_mfma_f32_16x16x32_bf16 v[228:231], v[48:51], a[36:39], v[228:231]
    ds_read_b64_tr_b16 v[62:63], v28 offset:34816
    v_mfma_f32_16x16x32_bf16 v[232:235], v[48:51], a[40:43], v[232:235]
    buffer_load_dwordx4 a[108:111], v19, s[20:23], s33 offen offset:0 sc1
    v_mfma_f32_16x16x32_bf16 v[236:239], v[48:51], a[44:47], v[236:239]
    s_waitcnt lgkmcnt(4)
    v_mfma_f32_16x16x32_bf16 v[240:243], v[52:55], a[32:35], v[240:243]
    ds_read_b64_tr_b16 v[48:49], v29 offset:28672
    v_mfma_f32_16x16x32_bf16 v[244:247], v[52:55], a[36:39], v[244:247]
    ds_read_b64_tr_b16 v[50:51], v29 offset:30720
    v_mfma_f32_16x16x32_bf16 v[248:251], v[52:55], a[40:43], v[248:251]
    v_mfma_f32_16x16x32_bf16 v[252:255], v[52:55], a[44:47], v[252:255]
    s_waitcnt lgkmcnt(4)
    v_mfma_f32_16x16x32_bf16 v[96:99], v[56:59], a[48:51], v[96:99]
    ds_read_b64_tr_b16 v[52:53], v29 offset:32768
    v_mfma_f32_16x16x32_bf16 v[100:103], v[56:59], a[52:55], v[100:103]
    ds_read_b64_tr_b16 v[54:55], v29 offset:34816
    v_mfma_f32_16x16x32_bf16 v[104:107], v[56:59], a[56:59], v[104:107]
    buffer_load_dwordx4 a[124:127], v19, s[20:23], s33 offen offset:1024 sc1
    s_add_u32 s33, s33, 2048
    v_mfma_f32_16x16x32_bf16 v[108:111], v[56:59], a[60:63], v[108:111]
    s_waitcnt lgkmcnt(4)
    v_mfma_f32_16x16x32_bf16 v[112:115], v[60:63], a[48:51], v[112:115]
    ds_read_b64_tr_b16 v[56:57], v30 offset:28672
    v_mfma_f32_16x16x32_bf16 v[116:119], v[60:63], a[52:55], v[116:119]
    ds_read_b64_tr_b16 v[58:59], v30 offset:30720
    v_mfma_f32_16x16x32_bf16 v[120:123], v[60:63], a[56:59], v[120:123]
    buffer_load_dword v27, v21, s[20:23], s89 offen sc1
    s_add_u32 s89, s89, 2048
    v_mfma_f32_16x16x32_bf16 v[124:127], v[60:63], a[60:63], v[124:127]
    s_waitcnt lgkmcnt(4)
    v_mfma_f32_16x16x32_bf16 v[128:131], v[48:51], a[48:51], v[128:131]
    ds_read_b64_tr_b16 v[60:61], v30 offset:32768
    v_mfma_f32_16x16x32_bf16 v[132:135], v[48:51], a[52:55], v[132:135]
    ds_read_b64_tr_b16 v[62:63], v30 offset:34816
    v_mfma_f32_16x16x32_bf16 v[136:139], v[48:51], a[56:59], v[136:139]
    s_add_u32 m0, s34, 0
    v_mfma_f32_16x16x32_bf16 v[140:143], v[48:51], a[60:63], v[140:143]
    buffer_load_dwordx4 v10, s[12:15], s32 offen lds
    s_waitcnt lgkmcnt(4)
    v_mfma_f32_16x16x32_bf16 v[144:147], v[52:55], a[48:51], v[144:147]
    ds_read_b64_tr_b16 v[48:49], v31 offset:28672
    v_mfma_f32_16x16x32_bf16 v[148:151], v[52:55], a[52:55], v[148:151]
    ds_read_b64_tr_b16 v[50:51], v31 offset:30720
    v_mfma_f32_16x16x32_bf16 v[152:155], v[52:55], a[56:59], v[152:155]
    s_add_u32 m0, s34, 1024
    v_mfma_f32_16x16x32_bf16 v[156:159], v[52:55], a[60:63], v[156:159]
    buffer_load_dwordx4 v11, s[12:15], s32 offen lds
    s_waitcnt lgkmcnt(4)
    v_mfma_f32_16x16x32_bf16 v[160:163], v[56:59], a[48:51], v[160:163]
    ds_read_b64_tr_b16 v[52:53], v31 offset:32768
    v_mfma_f32_16x16x32_bf16 v[164:167], v[56:59], a[52:55], v[164:167]
    ds_read_b64_tr_b16 v[54:55], v31 offset:34816
    v_mfma_f32_16x16x32_bf16 v[168:171], v[56:59], a[56:59], v[168:171]
    v_mfma_f32_16x16x32_bf16 v[172:175], v[56:59], a[60:63], v[172:175]
    s_waitcnt lgkmcnt(4)
    v_mfma_f32_16x16x32_bf16 v[176:179], v[60:63], a[48:51], v[176:179]
    ds_read_b64_tr_b16 v[56:57], v36 offset:38912
    v_mfma_f32_16x16x32_bf16 v[180:183], v[60:63], a[52:55], v[180:183]
    ds_read_b64_tr_b16 v[58:59], v36 offset:39424
    v_mfma_f32_16x16x32_bf16 v[184:187], v[60:63], a[56:59], v[184:187]
    s_add_u32 m0, s34, 2048
    v_mfma_f32_16x16x32_bf16 v[188:191], v[60:63], a[60:63], v[188:191]
    buffer_load_dwordx4 v12, s[12:15], s32 offen lds
    s_waitcnt lgkmcnt(4)
    v_mfma_f32_16x16x32_bf16 v[192:195], v[48:51], a[48:51], v[192:195]
    ds_read_b64_tr_b16 v[60:61], v36 offset:39936
    v_mfma_f32_16x16x32_bf16 v[196:199], v[48:51], a[52:55], v[196:199]
    ds_read_b64_tr_b16 v[62:63], v36 offset:40448
    v_mfma_f32_16x16x32_bf16 v[200:203], v[48:51], a[56:59], v[200:203]
    s_add_u32 m0, s34, 3072
    v_mfma_f32_16x16x32_bf16 v[204:207], v[48:51], a[60:63], v[204:207]
    buffer_load_dwordx4 v13, s[12:15], s32 offen lds
    s_waitcnt lgkmcnt(4)
    v_mfma_f32_16x16x32_bf16 v[208:211], v[52:55], a[48:51], v[208:211]
    ds_read_b64_tr_b16 v[48:49], v28 offset:40960
    v_mfma_f32_16x16x32_bf16 v[212:215], v[52:55], a[52:55], v[212:215]
    ds_read_b64_tr_b16 v[50:51], v28 offset:43008
    v_mfma_f32_16x16x32_bf16 v[216:219], v[52:55], a[56:59], v[216:219]
    s_add_u32 s32, s32, 589824
    s_add_u32 m0, s36, 0
    v_mfma_f32_16x16x32_bf16 v[220:223], v[52:55], a[60:63], v[220:223]
    buffer_load_dwordx4 v14, s[24:27], s35 offen lds
    s_waitcnt lgkmcnt(4)
    v_mfma_f32_16x16x32_bf16 v[224:227], v[56:59], a[48:51], v[224:227]
    ds_read_b64_tr_b16 v[52:53], v28 offset:45056
    v_mfma_f32_16x16x32_bf16 v[228:231], v[56:59], a[52:55], v[228:231]
    ds_read_b64_tr_b16 v[54:55], v28 offset:47104
    v_mfma_f32_16x16x32_bf16 v[232:235], v[56:59], a[56:59], v[232:235]
    s_add_u32 s35, s35, 2048
    v_mfma_f32_16x16x32_bf16 v[236:239], v[56:59], a[60:63], v[236:239]
    s_waitcnt lgkmcnt(4)
    v_mfma_f32_16x16x32_bf16 v[240:243], v[60:63], a[48:51], v[240:243]
    ds_read_b64_tr_b16 v[56:57], v29 offset:40960
    v_mfma_f32_16x16x32_bf16 v[244:247], v[60:63], a[52:55], v[244:247]
    ds_read_b64_tr_b16 v[58:59], v29 offset:43008
    v_mfma_f32_16x16x32_bf16 v[248:251], v[60:63], a[56:59], v[248:251]
    v_mfma_f32_16x16x32_bf16 v[252:255], v[60:63], a[60:63], v[252:255]
    s_waitcnt vmcnt(22) lgkmcnt(4)
    v_mfma_f32_16x16x32_bf16 v[96:99], v[48:51], a[64:67], v[96:99]
    ds_read_b64_tr_b16 v[60:61], v29 offset:45056
    v_mfma_f32_16x16x32_bf16 v[100:103], v[48:51], a[68:71], v[100:103]
    ds_read_b64_tr_b16 v[62:63], v29 offset:47104
    v_mfma_f32_16x16x32_bf16 v[104:107], v[48:51], a[72:75], v[104:107]
    v_mfma_f32_16x16x32_bf16 v[108:111], v[48:51], a[76:79], v[108:111]
    s_waitcnt vmcnt(19)
    s_barrier
    s_waitcnt lgkmcnt(4)
    v_mfma_f32_16x16x32_bf16 v[112:115], v[52:55], a[64:67], v[112:115]
    ds_read_b64_tr_b16 v[48:49], v30 offset:40960
    v_mfma_f32_16x16x32_bf16 v[116:119], v[52:55], a[68:71], v[116:119]
    ds_read_b64_tr_b16 v[50:51], v30 offset:43008
    v_mfma_f32_16x16x32_bf16 v[120:123], v[52:55], a[72:75], v[120:123]
    buffer_load_dwordx4 a[128:131], v16, s[20:23], s33 offen offset:0 sc1
    v_mfma_f32_16x16x32_bf16 v[124:127], v[52:55], a[76:79], v[124:127]
    s_waitcnt lgkmcnt(4)
    v_mfma_f32_16x16x32_bf16 v[128:131], v[56:59], a[64:67], v[128:131]
    ds_read_b64_tr_b16 v[52:53], v30 offset:45056
    v_mfma_f32_16x16x32_bf16 v[132:135], v[56:59], a[68:71], v[132:135]
    ds_read_b64_tr_b16 v[54:55], v30 offset:47104
    v_mfma_f32_16x16x32_bf16 v[136:139], v[56:59], a[72:75], v[136:139]
    buffer_load_dwordx4 a[144:147], v16, s[20:23], s33 offen offset:1024 sc1
    v_mfma_f32_16x16x32_bf16 v[140:143], v[56:59], a[76:79], v[140:143]
    s_waitcnt lgkmcnt(4)
    v_mfma_f32_16x16x32_bf16 v[144:147], v[60:63], a[64:67], v[144:147]
    ds_read_b64_tr_b16 v[56:57], v31 offset:40960
    v_mfma_f32_16x16x32_bf16 v[148:151], v[60:63], a[68:71], v[148:151]
    ds_read_b64_tr_b16 v[58:59], v31 offset:43008
    v_mfma_f32_16x16x32_bf16 v[152:155], v[60:63], a[72:75], v[152:155]
    buffer_load_dwordx4 a[132:135], v17, s[20:23], s33 offen offset:0 sc1
    v_mfma_f32_16x16x32_bf16 v[156:159], v[60:63], a[76:79], v[156:159]
    s_waitcnt lgkmcnt(4)
    v_mfma_f32_16x16x32_bf16 v[160:163], v[48:51], a[64:67], v[160:163]
    ds_read_b64_tr_b16 v[60:61], v31 offset:45056
    v_mfma_f32_16x16x32_bf16 v[164:167], v[48:51], a[68:71], v[164:167]
    ds_read_b64_tr_b16 v[62:63], v31 offset:47104
    v_mfma_f32_16x16x32_bf16 v[168:171], v[48:51], a[72:75], v[168:171]
    buffer_load_dwordx4 a[148:151], v17, s[20:23], s33 offen offset:1024 sc1
    v_mfma_f32_16x16x32_bf16 v[172:175], v[48:51], a[76:79], v[172:175]
    s_waitcnt lgkmcnt(4)
    v_mfma_f32_16x16x32_bf16 v[176:179], v[52:55], a[64:67], v[176:179]
    ds_read_b64_tr_b16 v[48:49], v36 offset:57344
    v_mfma_f32_16x16x32_bf16 v[180:183], v[52:55], a[68:71], v[180:183]
    ds_read_b64_tr_b16 v[50:51], v36 offset:57856
    v_mfma_f32_16x16x32_bf16 v[184:187], v[52:55], a[72:75], v[184:187]
    v_mfma_f32_16x16x32_bf16 v[188:191], v[52:55], a[76:79], v[188:191]
    s_waitcnt lgkmcnt(4)
    v_mfma_f32_16x16x32_bf16 v[192:195], v[56:59], a[64:67], v[192:195]
    ds_read_b64_tr_b16 v[52:53], v36 offset:58368
    v_mfma_f32_16x16x32_bf16 v[196:199], v[56:59], a[68:71], v[196:199]
    ds_read_b64_tr_b16 v[54:55], v36 offset:58880
    v_mfma_f32_16x16x32_bf16 v[200:203], v[56:59], a[72:75], v[200:203]
    buffer_load_dwordx4 a[136:139], v18, s[20:23], s33 offen offset:0 sc1
    v_mfma_f32_16x16x32_bf16 v[204:207], v[56:59], a[76:79], v[204:207]
    s_waitcnt lgkmcnt(4)
    v_mfma_f32_16x16x32_bf16 v[208:211], v[60:63], a[64:67], v[208:211]
    ds_read_b64_tr_b16 v[56:57], v28 offset:49152
    v_mfma_f32_16x16x32_bf16 v[212:215], v[60:63], a[68:71], v[212:215]
    ds_read_b64_tr_b16 v[58:59], v28 offset:51200
    v_mfma_f32_16x16x32_bf16 v[216:219], v[60:63], a[72:75], v[216:219]
    buffer_load_dwordx4 a[152:155], v18, s[20:23], s33 offen offset:1024 sc1
    v_mfma_f32_16x16x32_bf16 v[220:223], v[60:63], a[76:79], v[220:223]
    s_waitcnt lgkmcnt(4)
    v_mfma_f32_16x16x32_bf16 v[224:227], v[48:51], a[64:67], v[224:227]
    ds_read_b64_tr_b16 v[60:61], v28 offset:53248
    v_mfma_f32_16x16x32_bf16 v[228:231], v[48:51], a[68:71], v[228:231]
    ds_read_b64_tr_b16 v[62:63], v28 offset:55296
    v_mfma_f32_16x16x32_bf16 v[232:235], v[48:51], a[72:75], v[232:235]
    buffer_load_dwordx4 a[140:143], v19, s[20:23], s33 offen offset:0 sc1
    v_mfma_f32_16x16x32_bf16 v[236:239], v[48:51], a[76:79], v[236:239]
    s_waitcnt lgkmcnt(4)
    v_mfma_f32_16x16x32_bf16 v[240:243], v[52:55], a[64:67], v[240:243]
    ds_read_b64_tr_b16 v[48:49], v29 offset:49152
    v_mfma_f32_16x16x32_bf16 v[244:247], v[52:55], a[68:71], v[244:247]
    ds_read_b64_tr_b16 v[50:51], v29 offset:51200
    v_mfma_f32_16x16x32_bf16 v[248:251], v[52:55], a[72:75], v[248:251]
    v_mfma_f32_16x16x32_bf16 v[252:255], v[52:55], a[76:79], v[252:255]
    s_waitcnt lgkmcnt(4)
    v_mfma_f32_16x16x32_bf16 v[96:99], v[56:59], a[80:83], v[96:99]
    ds_read_b64_tr_b16 v[52:53], v29 offset:53248
    v_mfma_f32_16x16x32_bf16 v[100:103], v[56:59], a[84:87], v[100:103]
    ds_read_b64_tr_b16 v[54:55], v29 offset:55296
    v_mfma_f32_16x16x32_bf16 v[104:107], v[56:59], a[88:91], v[104:107]
    buffer_load_dwordx4 a[156:159], v19, s[20:23], s33 offen offset:1024 sc1
    s_add_u32 s33, s33, 2048
    v_mfma_f32_16x16x32_bf16 v[108:111], v[56:59], a[92:95], v[108:111]
    s_waitcnt lgkmcnt(4)
    v_mfma_f32_16x16x32_bf16 v[112:115], v[60:63], a[80:83], v[112:115]
    ds_read_b64_tr_b16 v[56:57], v30 offset:49152
    v_mfma_f32_16x16x32_bf16 v[116:119], v[60:63], a[84:87], v[116:119]
    ds_read_b64_tr_b16 v[58:59], v30 offset:51200
    v_mfma_f32_16x16x32_bf16 v[120:123], v[60:63], a[88:91], v[120:123]
    buffer_load_dword v27, v21, s[20:23], s89 offen sc1
    s_add_u32 s89, s89, 2048
    v_mfma_f32_16x16x32_bf16 v[124:127], v[60:63], a[92:95], v[124:127]
    s_waitcnt lgkmcnt(4)
    v_mfma_f32_16x16x32_bf16 v[128:131], v[48:51], a[80:83], v[128:131]
    ds_read_b64_tr_b16 v[60:61], v30 offset:53248
    v_mfma_f32_16x16x32_bf16 v[132:135], v[48:51], a[84:87], v[132:135]
    ds_read_b64_tr_b16 v[62:63], v30 offset:55296
    v_mfma_f32_16x16x32_bf16 v[136:139], v[48:51], a[88:91], v[136:139]
    s_add_u32 m0, s34, 20480
    v_mfma_f32_16x16x32_bf16 v[140:143], v[48:51], a[92:95], v[140:143]
    buffer_load_dwordx4 v10, s[12:15], s32 offen lds
    s_waitcnt lgkmcnt(4)
    v_mfma_f32_16x16x32_bf16 v[144:147], v[52:55], a[80:83], v[144:147]
    ds_read_b64_tr_b16 v[48:49], v31 offset:49152
    v_mfma_f32_16x16x32_bf16 v[148:151], v[52:55], a[84:87], v[148:151]
    ds_read_b64_tr_b16 v[50:51], v31 offset:51200
    v_mfma_f32_16x16x32_bf16 v[152:155], v[52:55], a[88:91], v[152:155]
    s_add_u32 m0, s34, 21504
    v_mfma_f32_16x16x32_bf16 v[156:159], v[52:55], a[92:95], v[156:159]
    buffer_load_dwordx4 v11, s[12:15], s32 offen lds
    s_waitcnt lgkmcnt(4)
    v_mfma_f32_16x16x32_bf16 v[160:163], v[56:59], a[80:83], v[160:163]
    ds_read_b64_tr_b16 v[52:53], v31 offset:53248
    v_mfma_f32_16x16x32_bf16 v[164:167], v[56:59], a[84:87], v[164:167]
    ds_read_b64_tr_b16 v[54:55], v31 offset:55296
    v_mfma_f32_16x16x32_bf16 v[168:171], v[56:59], a[88:91], v[168:171]
    v_mfma_f32_16x16x32_bf16 v[172:175], v[56:59], a[92:95], v[172:175]
    s_waitcnt lgkmcnt(4)
    v_mfma_f32_16x16x32_bf16 v[176:179], v[60:63], a[80:83], v[176:179]
    ds_read_b64_tr_b16 v[56:57], v36 offset:59392
    v_mfma_f32_16x16x32_bf16 v[180:183], v[60:63], a[84:87], v[180:183]
    ds_read_b64_tr_b16 v[58:59], v36 offset:59904
    v_mfma_f32_16x16x32_bf16 v[184:187], v[60:63], a[88:91], v[184:187]
    s_add_u32 m0, s34, 22528
    v_mfma_f32_16x16x32_bf16 v[188:191], v[60:63], a[92:95], v[188:191]
    buffer_load_dwordx4 v12, s[12:15], s32 offen lds
    s_waitcnt lgkmcnt(4)
    v_mfma_f32_16x16x32_bf16 v[192:195], v[48:51], a[80:83], v[192:195]
    ds_read_b64_tr_b16 v[60:61], v36 offset:60416
    v_mfma_f32_16x16x32_bf16 v[196:199], v[48:51], a[84:87], v[196:199]
    ds_read_b64_tr_b16 v[62:63], v36 offset:60928
    v_mfma_f32_16x16x32_bf16 v[200:203], v[48:51], a[88:91], v[200:203]
    s_add_u32 m0, s34, 23552
    v_mfma_f32_16x16x32_bf16 v[204:207], v[48:51], a[92:95], v[204:207]
    buffer_load_dwordx4 v13, s[12:15], s32 offen lds
    s_waitcnt lgkmcnt(4)
    v_mfma_f32_16x16x32_bf16 v[208:211], v[52:55], a[80:83], v[208:211]
    ds_read_b64_tr_b16 v[48:49], v32 offset:0
    v_mfma_f32_16x16x32_bf16 v[212:215], v[52:55], a[84:87], v[212:215]
    ds_read_b64_tr_b16 v[50:51], v32 offset:2048
    v_mfma_f32_16x16x32_bf16 v[216:219], v[52:55], a[88:91], v[216:219]
    s_add_u32 s32, s32, 589824
    s_add_u32 m0, s36, 20480
    v_mfma_f32_16x16x32_bf16 v[220:223], v[52:55], a[92:95], v[220:223]
    buffer_load_dwordx4 v14, s[24:27], s35 offen lds
    s_waitcnt lgkmcnt(4)
    v_mfma_f32_16x16x32_bf16 v[224:227], v[56:59], a[80:83], v[224:227]
    ds_read_b64_tr_b16 v[52:53], v32 offset:4096
    v_mfma_f32_16x16x32_bf16 v[228:231], v[56:59], a[84:87], v[228:231]
    ds_read_b64_tr_b16 v[54:55], v32 offset:6144
    v_mfma_f32_16x16x32_bf16 v[232:235], v[56:59], a[88:91], v[232:235]
    s_add_u32 s35, s35, 2048
    v_mfma_f32_16x16x32_bf16 v[236:239], v[56:59], a[92:95], v[236:239]
    s_waitcnt lgkmcnt(4)
    v_mfma_f32_16x16x32_bf16 v[240:243], v[60:63], a[80:83], v[240:243]
    ds_read_b64_tr_b16 v[56:57], v33 offset:0
    v_mfma_f32_16x16x32_bf16 v[244:247], v[60:63], a[84:87], v[244:247]
    ds_read_b64_tr_b16 v[58:59], v33 offset:2048
    v_mfma_f32_16x16x32_bf16 v[248:251], v[60:63], a[88:91], v[248:251]
    v_mfma_f32_16x16x32_bf16 v[252:255], v[60:63], a[92:95], v[252:255]
    s_waitcnt vmcnt(20) lgkmcnt(4)
    v_mfma_f32_16x16x32_bf16 v[96:99], v[48:51], a[96:99], v[96:99]
    ds_read_b64_tr_b16 v[60:61], v33 offset:4096
    v_mfma_f32_16x16x32_bf16 v[100:103], v[48:51], a[100:103], v[100:103]
    ds_read_b64_tr_b16 v[62:63], v33 offset:6144
    v_mfma_f32_16x16x32_bf16 v[104:107], v[48:51], a[104:107], v[104:107]
    v_mfma_f32_16x16x32_bf16 v[108:111], v[48:51], a[108:111], v[108:111]
    s_waitcnt vmcnt(28)
    s_barrier
    s_waitcnt lgkmcnt(4)
    v_mfma_f32_16x16x32_bf16 v[112:115], v[52:55], a[96:99], v[112:115]
    ds_read_b64_tr_b16 v[48:49], v34 offset:0
    v_mfma_f32_16x16x32_bf16 v[116:119], v[52:55], a[100:103], v[116:119]
    ds_read_b64_tr_b16 v[50:51], v34 offset:2048
    v_mfma_f32_16x16x32_bf16 v[120:123], v[52:55], a[104:107], v[120:123]
    buffer_load_dwordx4 a[160:163], v16, s[20:23], s33 offen offset:0 sc1
    v_mfma_f32_16x16x32_bf16 v[124:127], v[52:55], a[108:111], v[124:127]
    s_waitcnt lgkmcnt(4)
    v_mfma_f32_16x16x32_bf16 v[128:131], v[56:59], a[96:99], v[128:131]
    ds_read_b64_tr_b16 v[52:53], v34 offset:4096
    v_mfma_f32_16x16x32_bf16 v[132:135], v[56:59], a[100:103], v[132:135]
    ds_read_b64_tr_b16 v[54:55], v34 offset:6144
    v_mfma_f32_16x16x32_bf16 v[136:139], v[56:59], a[104:107], v[136:139]
    buffer_load_dwordx4 a[176:179], v16, s[20:23], s33 offen offset:1024 sc1
    v_mfma_f32_16x16x32_bf16 v[140:143], v[56:59], a[108:111], v[140:143]
    s_waitcnt lgkmcnt(4)
    v_mfma_f32_16x16x32_bf16 v[144:147], v[60:63], a[96:99], v[144:147]
    ds_read_b64_tr_b16 v[56:57], v35 offset:0
    v_mfma_f32_16x16x32_bf16 v[148:151], v[60:63], a[100:103], v[148:151]
    ds_read_b64_tr_b16 v[58:59], v35 offset:2048
    v_mfma_f32_16x16x32_bf16 v[152:155], v[60:63], a[104:107], v[152:155]
    buffer_load_dwordx4 a[164:167], v17, s[20:23], s33 offen offset:0 sc1
    v_mfma_f32_16x16x32_bf16 v[156:159], v[60:63], a[108:111], v[156:159]
    s_waitcnt lgkmcnt(4)
    v_mfma_f32_16x16x32_bf16 v[160:163], v[48:51], a[96:99], v[160:163]
    ds_read_b64_tr_b16 v[60:61], v35 offset:4096
    v_mfma_f32_16x16x32_bf16 v[164:167], v[48:51], a[100:103], v[164:167]
    ds_read_b64_tr_b16 v[62:63], v35 offset:6144
    v_mfma_f32_16x16x32_bf16 v[168:171], v[48:51], a[104:107], v[168:171]
    buffer_load_dwordx4 a[180:183], v17, s[20:23], s33 offen offset:1024 sc1
    v_mfma_f32_16x16x32_bf16 v[172:175], v[48:51], a[108:111], v[172:175]
    s_waitcnt lgkmcnt(4)
    v_mfma_f32_16x16x32_bf16 v[176:179], v[52:55], a[96:99], v[176:179]
    ds_read_b64_tr_b16 v[48:49], v37 offset:16384
    v_mfma_f32_16x16x32_bf16 v[180:183], v[52:55], a[100:103], v[180:183]
    ds_read_b64_tr_b16 v[50:51], v37 offset:16896
    v_mfma_f32_16x16x32_bf16 v[184:187], v[52:55], a[104:107], v[184:187]
    v_mfma_f32_16x16x32_bf16 v[188:191], v[52:55], a[108:111], v[188:191]
    s_waitcnt lgkmcnt(4)
    v_mfma_f32_16x16x32_bf16 v[192:195], v[56:59], a[96:99], v[192:195]
    ds_read_b64_tr_b16 v[52:53], v37 offset:17408
    v_mfma_f32_16x16x32_bf16 v[196:199], v[56:59], a[100:103], v[196:199]
    ds_read_b64_tr_b16 v[54:55], v37 offset:17920
    v_mfma_f32_16x16x32_bf16 v[200:203], v[56:59], a[104:107], v[200:203]
    buffer_load_dwordx4 a[168:171], v18, s[20:23], s33 offen offset:0 sc1
    v_mfma_f32_16x16x32_bf16 v[204:207], v[56:59], a[108:111], v[204:207]
    s_waitcnt lgkmcnt(4)
    v_mfma_f32_16x16x32_bf16 v[208:211], v[60:63], a[96:99], v[208:211]
    ds_read_b64_tr_b16 v[56:57], v32 offset:8192
    v_mfma_f32_16x16x32_bf16 v[212:215], v[60:63], a[100:103], v[212:215]
    ds_read_b64_tr_b16 v[58:59], v32 offset:10240
    v_mfma_f32_16x16x32_bf16 v[216:219], v[60:63], a[104:107], v[216:219]
    buffer_load_dwordx4 a[184:187], v18, s[20:23], s33 offen offset:1024 sc1
    v_mfma_f32_16x16x32_bf16 v[220:223], v[60:63], a[108:111], v[220:223]
    s_waitcnt lgkmcnt(4)
    v_mfma_f32_16x16x32_bf16 v[224:227], v[48:51], a[96:99], v[224:227]
    ds_read_b64_tr_b16 v[60:61], v32 offset:12288
    v_mfma_f32_16x16x32_bf16 v[228:231], v[48:51], a[100:103], v[228:231]
    ds_read_b64_tr_b16 v[62:63], v32 offset:14336
    v_mfma_f32_16x16x32_bf16 v[232:235], v[48:51], a[104:107], v[232:235]
    buffer_load_dwordx4 a[172:175], v19, s[20:23], s33 offen offset:0 sc1
    v_mfma_f32_16x16x32_bf16 v[236:239], v[48:51], a[108:111], v[236:239]
    s_waitcnt lgkmcnt(4)
    v_mfma_f32_16x16x32_bf16 v[240:243], v[52:55], a[96:99], v[240:243]
    ds_read_b64_tr_b16 v[48:49], v33 offset:8192
    v_mfma_f32_16x16x32_bf16 v[244:247], v[52:55], a[100:103], v[244:247]
    ds_read_b64_tr_b16 v[50:51], v33 offset:10240
    v_mfma_f32_16x16x32_bf16 v[248:251], v[52:55], a[104:107], v[248:251]
    v_mfma_f32_16x16x32_bf16 v[252:255], v[52:55], a[108:111], v[252:255]
    s_waitcnt lgkmcnt(4)
    v_mfma_f32_16x16x32_bf16 v[96:99], v[56:59], a[112:115], v[96:99]
    ds_read_b64_tr_b16 v[52:53], v33 offset:12288
    v_mfma_f32_16x16x32_bf16 v[100:103], v[56:59], a[116:119], v[100:103]
    ds_read_b64_tr_b16 v[54:55], v33 offset:14336
    v_mfma_f32_16x16x32_bf16 v[104:107], v[56:59], a[120:123], v[104:107]
    buffer_load_dwordx4 a[188:191], v19, s[20:23], s33 offen offset:1024 sc1
    s_add_u32 s33, s33, 2048
    v_mfma_f32_16x16x32_bf16 v[108:111], v[56:59], a[124:127], v[108:111]
    s_waitcnt lgkmcnt(4)
    v_mfma_f32_16x16x32_bf16 v[112:115], v[60:63], a[112:115], v[112:115]
    ds_read_b64_tr_b16 v[56:57], v34 offset:8192
    v_mfma_f32_16x16x32_bf16 v[116:119], v[60:63], a[116:119], v[116:119]
    ds_read_b64_tr_b16 v[58:59], v34 offset:10240
    v_mfma_f32_16x16x32_bf16 v[120:123], v[60:63], a[120:123], v[120:123]
    buffer_load_dword v27, v21, s[20:23], s89 offen sc1
    s_add_u32 s89, s89, 2048
    v_mfma_f32_16x16x32_bf16 v[124:127], v[60:63], a[124:127], v[124:127]
    s_waitcnt lgkmcnt(4)
    v_mfma_f32_16x16x32_bf16 v[128:131], v[48:51], a[112:115], v[128:131]
    ds_read_b64_tr_b16 v[60:61], v34 offset:12288
    v_mfma_f32_16x16x32_bf16 v[132:135], v[48:51], a[116:119], v[132:135]
    ds_read_b64_tr_b16 v[62:63], v34 offset:14336
    v_mfma_f32_16x16x32_bf16 v[136:139], v[48:51], a[120:123], v[136:139]
    s_add_u32 m0, s34, 40960
    v_mfma_f32_16x16x32_bf16 v[140:143], v[48:51], a[124:127], v[140:143]
    buffer_load_dwordx4 v10, s[12:15], s32 offen lds
    s_waitcnt lgkmcnt(4)
    v_mfma_f32_16x16x32_bf16 v[144:147], v[52:55], a[112:115], v[144:147]
    ds_read_b64_tr_b16 v[48:49], v35 offset:8192
    v_mfma_f32_16x16x32_bf16 v[148:151], v[52:55], a[116:119], v[148:151]
    ds_read_b64_tr_b16 v[50:51], v35 offset:10240
    v_mfma_f32_16x16x32_bf16 v[152:155], v[52:55], a[120:123], v[152:155]
    s_add_u32 m0, s34, 41984
    v_mfma_f32_16x16x32_bf16 v[156:159], v[52:55], a[124:127], v[156:159]
    buffer_load_dwordx4 v11, s[12:15], s32 offen lds
    s_waitcnt lgkmcnt(4)
    v_mfma_f32_16x16x32_bf16 v[160:163], v[56:59], a[112:115], v[160:163]
    ds_read_b64_tr_b16 v[52:53], v35 offset:12288
    v_mfma_f32_16x16x32_bf16 v[164:167], v[56:59], a[116:119], v[164:167]
    ds_read_b64_tr_b16 v[54:55], v35 offset:14336
    v_mfma_f32_16x16x32_bf16 v[168:171], v[56:59], a[120:123], v[168:171]
    v_mfma_f32_16x16x32_bf16 v[172:175], v[56:59], a[124:127], v[172:175]
    s_waitcnt lgkmcnt(4)
    v_mfma_f32_16x16x32_bf16 v[176:179], v[60:63], a[112:115], v[176:179]
    ds_read_b64_tr_b16 v[56:57], v37 offset:18432
    v_mfma_f32_16x16x32_bf16 v[180:183], v[60:63], a[116:119], v[180:183]
    ds_read_b64_tr_b16 v[58:59], v37 offset:18944
    v_mfma_f32_16x16x32_bf16 v[184:187], v[60:63], a[120:123], v[184:187]
    s_add_u32 m0, s34, 43008
    v_mfma_f32_16x16x32_bf16 v[188:191], v[60:63], a[124:127], v[188:191]
    buffer_load_dwordx4 v12, s[12:15], s32 offen lds
    s_waitcnt lgkmcnt(4)
    v_mfma_f32_16x16x32_bf16 v[192:195], v[48:51], a[112:115], v[192:195]
    ds_read_b64_tr_b16 v[60:61], v37 offset:19456
    v_mfma_f32_16x16x32_bf16 v[196:199], v[48:51], a[116:119], v[196:199]
    ds_read_b64_tr_b16 v[62:63], v37 offset:19968
    v_mfma_f32_16x16x32_bf16 v[200:203], v[48:51], a[120:123], v[200:203]
    s_add_u32 m0, s34, 44032
    v_mfma_f32_16x16x32_bf16 v[204:207], v[48:51], a[124:127], v[204:207]
    buffer_load_dwordx4 v13, s[12:15], s32 offen lds
    s_waitcnt lgkmcnt(4)
    v_mfma_f32_16x16x32_bf16 v[208:211], v[52:55], a[112:115], v[208:211]
    ds_read_b64_tr_b16 v[48:49], v32 offset:20480
    v_mfma_f32_16x16x32_bf16 v[212:215], v[52:55], a[116:119], v[212:215]
    ds_read_b64_tr_b16 v[50:51], v32 offset:22528
    v_mfma_f32_16x16x32_bf16 v[216:219], v[52:55], a[120:123], v[216:219]
    s_add_u32 s32, s32, 589824
    s_add_u32 m0, s36, 40960
    v_mfma_f32_16x16x32_bf16 v[220:223], v[52:55], a[124:127], v[220:223]
    buffer_load_dwordx4 v14, s[24:27], s35 offen lds
    s_waitcnt lgkmcnt(4)
    v_mfma_f32_16x16x32_bf16 v[224:227], v[56:59], a[112:115], v[224:227]
    ds_read_b64_tr_b16 v[52:53], v32 offset:24576
    v_mfma_f32_16x16x32_bf16 v[228:231], v[56:59], a[116:119], v[228:231]
    ds_read_b64_tr_b16 v[54:55], v32 offset:26624
    v_mfma_f32_16x16x32_bf16 v[232:235], v[56:59], a[120:123], v[232:235]
    s_add_u32 s35, s35, 2048
    v_mfma_f32_16x16x32_bf16 v[236:239], v[56:59], a[124:127], v[236:239]
    s_waitcnt lgkmcnt(4)
    v_mfma_f32_16x16x32_bf16 v[240:243], v[60:63], a[112:115], v[240:243]
    ds_read_b64_tr_b16 v[56:57], v33 offset:20480
    v_mfma_f32_16x16x32_bf16 v[244:247], v[60:63], a[116:119], v[244:247]
    ds_read_b64_tr_b16 v[58:59], v33 offset:22528
    v_mfma_f32_16x16x32_bf16 v[248:251], v[60:63], a[120:123], v[248:251]
    v_mfma_f32_16x16x32_bf16 v[252:255], v[60:63], a[124:127], v[252:255]
    s_waitcnt vmcnt(20) lgkmcnt(4)
    v_mfma_f32_16x16x32_bf16 v[96:99], v[48:51], a[128:131], v[96:99]
    ds_read_b64_tr_b16 v[60:61], v33 offset:24576
    v_mfma_f32_16x16x32_bf16 v[100:103], v[48:51], a[132:135], v[100:103]
    ds_read_b64_tr_b16 v[62:63], v33 offset:26624
    v_mfma_f32_16x16x32_bf16 v[104:107], v[48:51], a[136:139], v[104:107]
    v_mfma_f32_16x16x32_bf16 v[108:111], v[48:51], a[140:143], v[108:111]
    s_waitcnt vmcnt(28)
    s_barrier
    s_waitcnt lgkmcnt(4)
    v_mfma_f32_16x16x32_bf16 v[112:115], v[52:55], a[128:131], v[112:115]
    ds_read_b64_tr_b16 v[48:49], v34 offset:20480
    v_mfma_f32_16x16x32_bf16 v[116:119], v[52:55], a[132:135], v[116:119]
    ds_read_b64_tr_b16 v[50:51], v34 offset:22528
    v_mfma_f32_16x16x32_bf16 v[120:123], v[52:55], a[136:139], v[120:123]
    buffer_load_dwordx4 a[192:195], v16, s[20:23], s33 offen offset:0 sc1
    v_mfma_f32_16x16x32_bf16 v[124:127], v[52:55], a[140:143], v[124:127]
    s_waitcnt lgkmcnt(4)
    v_mfma_f32_16x16x32_bf16 v[128:131], v[56:59], a[128:131], v[128:131]
    ds_read_b64_tr_b16 v[52:53], v34 offset:24576
    v_mfma_f32_16x16x32_bf16 v[132:135], v[56:59], a[132:135], v[132:135]
    ds_read_b64_tr_b16 v[54:55], v34 offset:26624
    v_mfma_f32_16x16x32_bf16 v[136:139], v[56:59], a[136:139], v[136:139]
    buffer_load_dwordx4 a[208:211], v16, s[20:23], s33 offen offset:1024 sc1
    v_mfma_f32_16x16x32_bf16 v[140:143], v[56:59], a[140:143], v[140:143]
    s_waitcnt lgkmcnt(4)
    v_mfma_f32_16x16x32_bf16 v[144:147], v[60:63], a[128:131], v[144:147]
    ds_read_b64_tr_b16 v[56:57], v35 offset:20480
    v_mfma_f32_16x16x32_bf16 v[148:151], v[60:63], a[132:135], v[148:151]
    ds_read_b64_tr_b16 v[58:59], v35 offset:22528
    v_mfma_f32_16x16x32_bf16 v[152:155], v[60:63], a[136:139], v[152:155]
    buffer_load_dwordx4 a[196:199], v17, s[20:23], s33 offen offset:0 sc1
    v_mfma_f32_16x16x32_bf16 v[156:159], v[60:63], a[140:143], v[156:159]
    s_waitcnt lgkmcnt(4)
    v_mfma_f32_16x16x32_bf16 v[160:163], v[48:51], a[128:131], v[160:163]
    ds_read_b64_tr_b16 v[60:61], v35 offset:24576
    v_mfma_f32_16x16x32_bf16 v[164:167], v[48:51], a[132:135], v[164:167]
    ds_read_b64_tr_b16 v[62:63], v35 offset:26624
    v_mfma_f32_16x16x32_bf16 v[168:171], v[48:51], a[136:139], v[168:171]
    buffer_load_dwordx4 a[212:215], v17, s[20:23], s33 offen offset:1024 sc1
    v_mfma_f32_16x16x32_bf16 v[172:175], v[48:51], a[140:143], v[172:175]
    s_waitcnt lgkmcnt(4)
    v_mfma_f32_16x16x32_bf16 v[176:179], v[52:55], a[128:131], v[176:179]
    ds_read_b64_tr_b16 v[48:49], v37 offset:36864
    v_mfma_f32_16x16x32_bf16 v[180:183], v[52:55], a[132:135], v[180:183]
    ds_read_b64_tr_b16 v[50:51], v37 offset:37376
    v_mfma_f32_16x16x32_bf16 v[184:187], v[52:55], a[136:139], v[184:187]
    buffer_load_dwordx4 a[200:203], v18, s[20:23], s33 offen offset:0 sc1
    v_mfma_f32_16x16x32_bf16 v[188:191], v[52:55], a[140:143], v[188:191]
    s_waitcnt lgkmcnt(4)
    v_mfma_f32_16x16x32_bf16 v[192:195], v[56:59], a[128:131], v[192:195]
    ds_read_b64_tr_b16 v[52:53], v37 offset:37888
    v_mfma_f32_16x16x32_bf16 v[196:199], v[56:59], a[132:135], v[196:199]
    ds_read_b64_tr_b16 v[54:55], v37 offset:38400
    v_mfma_f32_16x16x32_bf16 v[200:203], v[56:59], a[136:139], v[200:203]
    v_mfma_f32_16x16x32_bf16 v[204:207], v[56:59], a[140:143], v[204:207]
    s_waitcnt lgkmcnt(4)
    v_mfma_f32_16x16x32_bf16 v[208:211], v[60:63], a[128:131], v[208:211]
    ds_read_b64_tr_b16 v[56:57], v32 offset:28672
    v_mfma_f32_16x16x32_bf16 v[212:215], v[60:63], a[132:135], v[212:215]
    ds_read_b64_tr_b16 v[58:59], v32 offset:30720
    v_mfma_f32_16x16x32_bf16 v[216:219], v[60:63], a[136:139], v[216:219]
    buffer_load_dwordx4 a[216:219], v18, s[20:23], s33 offen offset:1024 sc1
    v_mfma_f32_16x16x32_bf16 v[220:223], v[60:63], a[140:143], v[220:223]
    s_waitcnt lgkmcnt(4)
    v_mfma_f32_16x16x32_bf16 v[224:227], v[48:51], a[128:131], v[224:227]
    ds_read_b64_tr_b16 v[60:61], v32 offset:32768
    v_mfma_f32_16x16x32_bf16 v[228:231], v[48:51], a[132:135], v[228:231]
    ds_read_b64_tr_b16 v[62:63], v32 offset:34816
    v_mfma_f32_16x16x32_bf16 v[232:235], v[48:51], a[136:139], v[232:235]
    buffer_load_dwordx4 a[204:207], v19, s[20:23], s33 offen offset:0 sc1
    v_mfma_f32_16x16x32_bf16 v[236:239], v[48:51], a[140:143], v[236:239]
    s_waitcnt lgkmcnt(4)
    v_mfma_f32_16x16x32_bf16 v[240:243], v[52:55], a[128:131], v[240:243]
    ds_read_b64_tr_b16 v[48:49], v33 offset:28672
    v_mfma_f32_16x16x32_bf16 v[244:247], v[52:55], a[132:135], v[244:247]
    ds_read_b64_tr_b16 v[50:51], v33 offset:30720
    v_mfma_f32_16x16x32_bf16 v[248:251], v[52:55], a[136:139], v[248:251]
    buffer_load_dwordx4 a[220:223], v19, s[20:23], s33 offen offset:1024 sc1
    s_add_u32 s33, s33, 2048
    v_mfma_f32_16x16x32_bf16 v[252:255], v[52:55], a[140:143], v[252:255]
    s_waitcnt lgkmcnt(4)
    v_mfma_f32_16x16x32_bf16 v[96:99], v[56:59], a[144:147], v[96:99]
    ds_read_b64_tr_b16 v[52:53], v33 offset:32768
    v_mfma_f32_16x16x32_bf16 v[100:103], v[56:59], a[148:151], v[100:103]
    ds_read_b64_tr_b16 v[54:55], v33 offset:34816
    v_mfma_f32_16x16x32_bf16 v[104:107], v[56:59], a[152:155], v[104:107]
    buffer_load_dword v27, v21, s[20:23], s89 offen sc1
    s_add_u32 s89, s89, 2048
    v_mfma_f32_16x16x32_bf16 v[108:111], v[56:59], a[156:159], v[108:111]
    s_waitcnt lgkmcnt(4)
    v_mfma_f32_16x16x32_bf16 v[112:115], v[60:63], a[144:147], v[112:115]
    ds_read_b64_tr_b16 v[56:57], v34 offset:28672
    v_mfma_f32_16x16x32_bf16 v[116:119], v[60:63], a[148:151], v[116:119]
    ds_read_b64_tr_b16 v[58:59], v34 offset:30720
    v_mfma_f32_16x16x32_bf16 v[120:123], v[60:63], a[152:155], v[120:123]
    s_add_u32 m0, s34, 61440
    v_mfma_f32_16x16x32_bf16 v[124:127], v[60:63], a[156:159], v[124:127]
    buffer_load_dwordx4 v10, s[12:15], s32 offen lds
    s_waitcnt lgkmcnt(4)
    v_mfma_f32_16x16x32_bf16 v[128:131], v[48:51], a[144:147], v[128:131]
    ds_read_b64_tr_b16 v[60:61], v34 offset:32768
    v_mfma_f32_16x16x32_bf16 v[132:135], v[48:51], a[148:151], v[132:135]
    ds_read_b64_tr_b16 v[62:63], v34 offset:34816
    v_mfma_f32_16x16x32_bf16 v[136:139], v[48:51], a[152:155], v[136:139]
    v_mfma_f32_16x16x32_bf16 v[140:143], v[48:51], a[156:159], v[140:143]
    s_waitcnt lgkmcnt(4)
    v_mfma_f32_16x16x32_bf16 v[144:147], v[52:55], a[144:147], v[144:147]
    ds_read_b64_tr_b16 v[48:49], v35 offset:28672
    v_mfma_f32_16x16x32_bf16 v[148:151], v[52:55], a[148:151], v[148:151]
    ds_read_b64_tr_b16 v[50:51], v35 offset:30720
    v_mfma_f32_16x16x32_bf16 v[152:155], v[52:55], a[152:155], v[152:155]
    s_add_u32 m0, s34, 62464
    v_mfma_f32_16x16x32_bf16 v[156:159], v[52:55], a[156:159], v[156:159]
    buffer_load_dwordx4 v11, s[12:15], s32 offen lds
    s_waitcnt lgkmcnt(4)
    v_mfma_f32_16x16x32_bf16 v[160:163], v[56:59], a[144:147], v[160:163]
    ds_read_b64_tr_b16 v[52:53], v35 offset:32768
    v_mfma_f32_16x16x32_bf16 v[164:167], v[56:59], a[148:151], v[164:167]
    ds_read_b64_tr_b16 v[54:55], v35 offset:34816
    v_mfma_f32_16x16x32_bf16 v[168:171], v[56:59], a[152:155], v[168:171]
    s_add_u32 m0, s34, 63488
    v_mfma_f32_16x16x32_bf16 v[172:175], v[56:59], a[156:159], v[172:175]
    buffer_load_dwordx4 v12, s[12:15], s32 offen lds
    s_waitcnt lgkmcnt(4)
    v_mfma_f32_16x16x32_bf16 v[176:179], v[60:63], a[144:147], v[176:179]
    ds_read_b64_tr_b16 v[56:57], v37 offset:38912
    v_mfma_f32_16x16x32_bf16 v[180:183], v[60:63], a[148:151], v[180:183]
    ds_read_b64_tr_b16 v[58:59], v37 offset:39424
    v_mfma_f32_16x16x32_bf16 v[184:187], v[60:63], a[152:155], v[184:187]
    s_add_u32 m0, s34, 64512
    v_mfma_f32_16x16x32_bf16 v[188:191], v[60:63], a[156:159], v[188:191]
    buffer_load_dwordx4 v13, s[12:15], s32 offen lds
    s_waitcnt lgkmcnt(4)
    v_mfma_f32_16x16x32_bf16 v[192:195], v[48:51], a[144:147], v[192:195]
    ds_read_b64_tr_b16 v[60:61], v37 offset:39936
    v_mfma_f32_16x16x32_bf16 v[196:199], v[48:51], a[148:151], v[196:199]
    ds_read_b64_tr_b16 v[62:63], v37 offset:40448
    v_mfma_f32_16x16x32_bf16 v[200:203], v[48:51], a[152:155], v[200:203]
    s_sub_u32 s32, s32, s38
    s_add_u32 m0, s36, 61440
    v_mfma_f32_16x16x32_bf16 v[204:207], v[48:51], a[156:159], v[204:207]
    buffer_load_dwordx4 v14, s[24:27], s35 offen lds
    s_waitcnt lgkmcnt(4)
    v_mfma_f32_16x16x32_bf16 v[208:211], v[52:55], a[144:147], v[208:211]
    ds_read_b64_tr_b16 v[48:49], v28 offset:0
    v_mfma_f32_16x16x32_bf16 v[212:215], v[52:55], a[148:151], v[212:215]
    ds_read_b64_tr_b16 v[50:51], v28 offset:2048
    v_mfma_f32_16x16x32_bf16 v[216:219], v[52:55], a[152:155], v[216:219]
    s_add_u32 s35, s35, 2048
    v_lshrrev_b32 v3, 2, v0
    v_mfma_f32_16x16x32_bf16 v[220:223], v[52:55], a[156:159], v[220:223]
    v_min_u32 v3, 9, v3
    s_waitcnt lgkmcnt(4)
    v_mfma_f32_16x16x32_bf16 v[224:227], v[56:59], a[144:147], v[224:227]
    ds_read_b64_tr_b16 v[52:53], v28 offset:4096
    v_mfma_f32_16x16x32_bf16 v[228:231], v[56:59], a[148:151], v[228:231]
    ds_read_b64_tr_b16 v[54:55], v28 offset:6144
    v_mfma_f32_16x16x32_bf16 v[232:235], v[56:59], a[152:155], v[232:235]
    v_and_b32 v2, 1, v3
    v_mul_u32_u24 v6, 9216, v2
    v_mfma_f32_16x16x32_bf16 v[236:239], v[56:59], a[156:159], v[236:239]
    v_lshrrev_b32 v2, 1, v3
    s_waitcnt lgkmcnt(4)
    v_mfma_f32_16x16x32_bf16 v[240:243], v[60:63], a[144:147], v[240:243]
    ds_read_b64_tr_b16 v[56:57], v29 offset:0
    v_mfma_f32_16x16x32_bf16 v[244:247], v[60:63], a[148:151], v[244:247]
    ds_read_b64_tr_b16 v[58:59], v29 offset:2048
    v_mfma_f32_16x16x32_bf16 v[248:251], v[60:63], a[152:155], v[248:251]
    v_lshl_add_u32 v6, v2, 7, v6
    s_and_b32 s90, s40, 3
    v_mfma_f32_16x16x32_bf16 v[252:255], v[60:63], a[156:159], v[252:255]
    s_lshl_b32 s90, s90, 2
    s_add_u32 s90, s90, s42
    s_lshl_b32 s90, s90, 1
    s_lshr_b32 s49, s3, 1
    s_lshl_b32 s49, s49, 5
    s_add_u32 s90, s90, s49
    s_mul_i32 s90, s90, 9216
    s_mul_i32 s49, s41, 1152
    s_add_u32 s49, s49, 512
    s_add_u32 s49, s49, s90
    buffer_load_dword v27, v6, s[12:15], s49 offen
    s_add_u32 s49, s49, 589824
    s_waitcnt vmcnt(21) lgkmcnt(4)
    v_mfma_f32_16x16x32_bf16 v[96:99], v[48:51], a[160:163], v[96:99]
    ds_read_b64_tr_b16 v[60:61], v29 offset:4096
    v_mfma_f32_16x16x32_bf16 v[100:103], v[48:51], a[164:167], v[100:103]
    ds_read_b64_tr_b16 v[62:63], v29 offset:6144
    v_mfma_f32_16x16x32_bf16 v[104:107], v[48:51], a[168:171], v[104:107]
    v_mfma_f32_16x16x32_bf16 v[108:111], v[48:51], a[172:175], v[108:111]
    s_waitcnt vmcnt(29)
    s_barrier
    s_waitcnt lgkmcnt(4)
    v_mfma_f32_16x16x32_bf16 v[112:115], v[52:55], a[160:163], v[112:115]
    ds_read_b64_tr_b16 v[48:49], v30 offset:0
    v_mfma_f32_16x16x32_bf16 v[116:119], v[52:55], a[164:167], v[116:119]
    ds_read_b64_tr_b16 v[50:51], v30 offset:2048
    v_mfma_f32_16x16x32_bf16 v[120:123], v[52:55], a[168:171], v[120:123]
    buffer_load_dwordx4 a[224:227], v16, s[20:23], s33 offen offset:0 sc1
    v_mfma_f32_16x16x32_bf16 v[124:127], v[52:55], a[172:175], v[124:127]
    s_waitcnt lgkmcnt(4)
    v_mfma_f32_16x16x32_bf16 v[128:131], v[56:59], a[160:163], v[128:131]
    ds_read_b64_tr_b16 v[52:53], v30 offset:4096
    v_mfma_f32_16x16x32_bf16 v[132:135], v[56:59], a[164:167], v[132:135]
    ds_read_b64_tr_b16 v[54:55], v30 offset:6144
    v_mfma_f32_16x16x32_bf16 v[136:139], v[56:59], a[168:171], v[136:139]
    v_mfma_f32_16x16x32_bf16 v[140:143], v[56:59], a[172:175], v[140:143]
    s_waitcnt lgkmcnt(4)
    v_mfma_f32_16x16x32_bf16 v[144:147], v[60:63], a[160:163], v[144:147]
    ds_read_b64_tr_b16 v[56:57], v31 offset:0
    v_mfma_f32_16x16x32_bf16 v[148:151], v[60:63], a[164:167], v[148:151]
    ds_read_b64_tr_b16 v[58:59], v31 offset:2048
    v_mfma_f32_16x16x32_bf16 v[152:155], v[60:63], a[168:171], v[152:155]
    buffer_load_dwordx4 a[240:243], v16, s[20:23], s33 offen offset:1024 sc1
    v_mfma_f32_16x16x32_bf16 v[156:159], v[60:63], a[172:175], v[156:159]
    s_waitcnt lgkmcnt(4)
    v_mfma_f32_16x16x32_bf16 v[160:163], v[48:51], a[160:163], v[160:163]
    ds_read_b64_tr_b16 v[60:61], v31 offset:4096
    v_mfma_f32_16x16x32_bf16 v[164:167], v[48:51], a[164:167], v[164:167]
    ds_read_b64_tr_b16 v[62:63], v31 offset:6144
    v_mfma_f32_16x16x32_bf16 v[168:171], v[48:51], a[168:171], v[168:171]
    v_mfma_f32_16x16x32_bf16 v[172:175], v[48:51], a[172:175], v[172:175]
    s_waitcnt lgkmcnt(4)
    v_mfma_f32_16x16x32_bf16 v[176:179], v[52:55], a[160:163], v[176:179]
    ds_read_b64_tr_b16 v[48:49], v36 offset:16384
    v_mfma_f32_16x16x32_bf16 v[180:183], v[52:55], a[164:167], v[180:183]
    ds_read_b64_tr_b16 v[50:51], v36 offset:16896
    v_mfma_f32_16x16x32_bf16 v[184:187], v[52:55], a[168:171], v[184:187]
    buffer_load_dwordx4 a[228:231], v17, s[20:23], s33 offen offset:0 sc1
    v_mfma_f32_16x16x32_bf16 v[188:191], v[52:55], a[172:175], v[188:191]
    s_waitcnt lgkmcnt(4)
    v_mfma_f32_16x16x32_bf16 v[192:195], v[56:59], a[160:163], v[192:195]
    ds_read_b64_tr_b16 v[52:53], v36 offset:17408
    v_mfma_f32_16x16x32_bf16 v[196:199], v[56:59], a[164:167], v[196:199]
    ds_read_b64_tr_b16 v[54:55], v36 offset:17920
    v_mfma_f32_16x16x32_bf16 v[200:203], v[56:59], a[168:171], v[200:203]
    v_mfma_f32_16x16x32_bf16 v[204:207], v[56:59], a[172:175], v[204:207]
    s_waitcnt lgkmcnt(4)
    v_mfma_f32_16x16x32_bf16 v[208:211], v[60:63], a[160:163], v[208:211]
    ds_read_b64_tr_b16 v[56:57], v28 offset:8192
    v_mfma_f32_16x16x32_bf16 v[212:215], v[60:63], a[164:167], v[212:215]
    ds_read_b64_tr_b16 v[58:59], v28 offset:10240
    v_mfma_f32_16x16x32_bf16 v[216:219], v[60:63], a[168:171], v[216:219]
    buffer_load_dwordx4 a[244:247], v17, s[20:23], s33 offen offset:1024 sc1
    v_mfma_f32_16x16x32_bf16 v[220:223], v[60:63], a[172:175], v[220:223]
    s_waitcnt lgkmcnt(4)
    v_mfma_f32_16x16x32_bf16 v[224:227], v[48:51], a[160:163], v[224:227]
    ds_read_b64_tr_b16 v[60:61], v28 offset:12288
    v_mfma_f32_16x16x32_bf16 v[228:231], v[48:51], a[164:167], v[228:231]
    ds_read_b64_tr_b16 v[62:63], v28 offset:14336
    v_mfma_f32_16x16x32_bf16 v[232:235], v[48:51], a[168:171], v[232:235]
    v_mfma_f32_16x16x32_bf16 v[236:239], v[48:51], a[172:175], v[236:239]
    s_waitcnt lgkmcnt(4)
    v_mfma_f32_16x16x32_bf16 v[240:243], v[52:55], a[160:163], v[240:243]
    ds_read_b64_tr_b16 v[48:49], v29 offset:8192
    v_mfma_f32_16x16x32_bf16 v[244:247], v[52:55], a[164:167], v[244:247]
    ds_read_b64_tr_b16 v[50:51], v29 offset:10240
    v_mfma_f32_16x16x32_bf16 v[248:251], v[52:55], a[168:171], v[248:251]
    buffer_load_dwordx4 a[232:235], v18, s[20:23], s33 offen offset:0 sc1
    v_mfma_f32_16x16x32_bf16 v[252:255], v[52:55], a[172:175], v[252:255]
    s_waitcnt lgkmcnt(4)
    v_mfma_f32_16x16x32_bf16 v[96:99], v[56:59], a[176:179], v[96:99]
    ds_read_b64_tr_b16 v[52:53], v29 offset:12288
    v_mfma_f32_16x16x32_bf16 v[100:103], v[56:59], a[180:183], v[100:103]
    ds_read_b64_tr_b16 v[54:55], v29 offset:14336
    v_mfma_f32_16x16x32_bf16 v[104:107], v[56:59], a[184:187], v[104:107]
    v_mfma_f32_16x16x32_bf16 v[108:111], v[56:59], a[188:191], v[108:111]
    s_waitcnt lgkmcnt(4)
    v_mfma_f32_16x16x32_bf16 v[112:115], v[60:63], a[176:179], v[112:115]
    ds_read_b64_tr_b16 v[56:57], v30 offset:8192
    v_mfma_f32_16x16x32_bf16 v[116:119], v[60:63], a[180:183], v[116:119]
    ds_read_b64_tr_b16 v[58:59], v30 offset:10240
    v_mfma_f32_16x16x32_bf16 v[120:123], v[60:63], a[184:187], v[120:123]
    buffer_load_dwordx4 a[248:251], v18, s[20:23], s33 offen offset:1024 sc1
    v_mfma_f32_16x16x32_bf16 v[124:127], v[60:63], a[188:191], v[124:127]
    s_waitcnt lgkmcnt(4)
    v_mfma_f32_16x16x32_bf16 v[128:131], v[48:51], a[176:179], v[128:131]
    ds_read_b64_tr_b16 v[60:61], v30 offset:12288
    v_mfma_f32_16x16x32_bf16 v[132:135], v[48:51], a[180:183], v[132:135]
    ds_read_b64_tr_b16 v[62:63], v30 offset:14336
    v_mfma_f32_16x16x32_bf16 v[136:139], v[48:51], a[184:187], v[136:139]
    v_mfma_f32_16x16x32_bf16 v[140:143], v[48:51], a[188:191], v[140:143]
    s_waitcnt lgkmcnt(4)
    v_mfma_f32_16x16x32_bf16 v[144:147], v[52:55], a[176:179], v[144:147]
    ds_read_b64_tr_b16 v[48:49], v31 offset:8192
    v_mfma_f32_16x16x32_bf16 v[148:151], v[52:55], a[180:183], v[148:151]
    ds_read_b64_tr_b16 v[50:51], v31 offset:10240
    v_mfma_f32_16x16x32_bf16 v[152:155], v[52:55], a[184:187], v[152:155]
    buffer_load_dwordx4 a[236:239], v19, s[20:23], s33 offen offset:0 sc1
    v_mfma_f32_16x16x32_bf16 v[156:159], v[52:55], a[188:191], v[156:159]
    s_waitcnt lgkmcnt(4)
    v_mfma_f32_16x16x32_bf16 v[160:163], v[56:59], a[176:179], v[160:163]
    ds_read_b64_tr_b16 v[52:53], v31 offset:12288
    v_mfma_f32_16x16x32_bf16 v[164:167], v[56:59], a[180:183], v[164:167]
    ds_read_b64_tr_b16 v[54:55], v31 offset:14336
    v_mfma_f32_16x16x32_bf16 v[168:171], v[56:59], a[184:187], v[168:171]
    v_mfma_f32_16x16x32_bf16 v[172:175], v[56:59], a[188:191], v[172:175]
    s_waitcnt lgkmcnt(4)
    v_mfma_f32_16x16x32_bf16 v[176:179], v[60:63], a[176:179], v[176:179]
    ds_read_b64_tr_b16 v[56:57], v36 offset:18432
    v_mfma_f32_16x16x32_bf16 v[180:183], v[60:63], a[180:183], v[180:183]
    ds_read_b64_tr_b16 v[58:59], v36 offset:18944
    v_mfma_f32_16x16x32_bf16 v[184:187], v[60:63], a[184:187], v[184:187]
    buffer_load_dwordx4 a[252:255], v19, s[20:23], s33 offen offset:1024 sc1
    s_add_u32 s33, s33, 2048
    v_mfma_f32_16x16x32_bf16 v[188:191], v[60:63], a[188:191], v[188:191]
    s_waitcnt lgkmcnt(4)
    v_mfma_f32_16x16x32_bf16 v[192:195], v[48:51], a[176:179], v[192:195]
    ds_read_b64_tr_b16 v[60:61], v36 offset:19456
    v_mfma_f32_16x16x32_bf16 v[196:199], v[48:51], a[180:183], v[196:199]
    ds_read_b64_tr_b16 v[62:63], v36 offset:19968
    v_mfma_f32_16x16x32_bf16 v[200:203], v[48:51], a[184:187], v[200:203]
    v_mfma_f32_16x16x32_bf16 v[204:207], v[48:51], a[188:191], v[204:207]
    s_waitcnt lgkmcnt(4)
    v_mfma_f32_16x16x32_bf16 v[208:211], v[52:55], a[176:179], v[208:211]
    ds_read_b64_tr_b16 v[48:49], v28 offset:20480
    v_mfma_f32_16x16x32_bf16 v[212:215], v[52:55], a[180:183], v[212:215]
    ds_read_b64_tr_b16 v[50:51], v28 offset:22528
    v_mfma_f32_16x16x32_bf16 v[216:219], v[52:55], a[184:187], v[216:219]
    buffer_load_dword v27, v6, s[12:15], s49 offen
    s_add_u32 s49, s49, 589824
    v_mfma_f32_16x16x32_bf16 v[220:223], v[52:55], a[188:191], v[220:223]
    s_waitcnt lgkmcnt(4)
    v_mfma_f32_16x16x32_bf16 v[224:227], v[56:59], a[176:179], v[224:227]
    ds_read_b64_tr_b16 v[52:53], v28 offset:24576
    v_mfma_f32_16x16x32_bf16 v[228:231], v[56:59], a[180:183], v[228:231]
    ds_read_b64_tr_b16 v[54:55], v28 offset:26624
    v_mfma_f32_16x16x32_bf16 v[232:235], v[56:59], a[184:187], v[232:235]
    v_mfma_f32_16x16x32_bf16 v[236:239], v[56:59], a[188:191], v[236:239]
    s_waitcnt lgkmcnt(4)
    v_mfma_f32_16x16x32_bf16 v[240:243], v[60:63], a[176:179], v[240:243]
    ds_read_b64_tr_b16 v[56:57], v29 offset:20480
    v_mfma_f32_16x16x32_bf16 v[244:247], v[60:63], a[180:183], v[244:247]
    ds_read_b64_tr_b16 v[58:59], v29 offset:22528
    v_mfma_f32_16x16x32_bf16 v[248:251], v[60:63], a[184:187], v[248:251]
    v_mfma_f32_16x16x32_bf16 v[252:255], v[60:63], a[188:191], v[252:255]
    s_waitcnt vmcnt(16) lgkmcnt(4)
    v_mfma_f32_16x16x32_bf16 v[96:99], v[48:51], a[192:195], v[96:99]
    ds_read_b64_tr_b16 v[60:61], v29 offset:24576
    v_mfma_f32_16x16x32_bf16 v[100:103], v[48:51], a[196:199], v[100:103]
    ds_read_b64_tr_b16 v[62:63], v29 offset:26624
    v_mfma_f32_16x16x32_bf16 v[104:107], v[48:51], a[200:203], v[104:107]
    v_mfma_f32_16x16x32_bf16 v[108:111], v[48:51], a[204:207], v[108:111]
    s_waitcnt vmcnt(24)
    s_barrier
    s_waitcnt lgkmcnt(4)
    v_mfma_f32_16x16x32_bf16 v[112:115], v[52:55], a[192:195], v[112:115]
    ds_read_b64_tr_b16 v[48:49], v30 offset:20480
    v_mfma_f32_16x16x32_bf16 v[116:119], v[52:55], a[196:199], v[116:119]
    ds_read_b64_tr_b16 v[50:51], v30 offset:22528
    v_mfma_f32_16x16x32_bf16 v[120:123], v[52:55], a[200:203], v[120:123]
    buffer_load_dwordx4 v[64:67], v16, s[20:23], s33 offen offset:0 sc1
    v_mfma_f32_16x16x32_bf16 v[124:127], v[52:55], a[204:207], v[124:127]
    s_waitcnt lgkmcnt(4)
    v_mfma_f32_16x16x32_bf16 v[128:131], v[56:59], a[192:195], v[128:131]
    ds_read_b64_tr_b16 v[52:53], v30 offset:24576
    v_mfma_f32_16x16x32_bf16 v[132:135], v[56:59], a[196:199], v[132:135]
    ds_read_b64_tr_b16 v[54:55], v30 offset:26624
    v_mfma_f32_16x16x32_bf16 v[136:139], v[56:59], a[200:203], v[136:139]
    buffer_load_dwordx4 v[80:83], v16, s[20:23], s33 offen offset:1024 sc1
    v_mfma_f32_16x16x32_bf16 v[140:143], v[56:59], a[204:207], v[140:143]
    s_waitcnt lgkmcnt(4)
    v_mfma_f32_16x16x32_bf16 v[144:147], v[60:63], a[192:195], v[144:147]
    ds_read_b64_tr_b16 v[56:57], v31 offset:20480
    v_mfma_f32_16x16x32_bf16 v[148:151], v[60:63], a[196:199], v[148:151]
    ds_read_b64_tr_b16 v[58:59], v31 offset:22528
    v_mfma_f32_16x16x32_bf16 v[152:155], v[60:63], a[200:203], v[152:155]
    buffer_load_dwordx4 v[68:71], v17, s[20:23], s33 offen offset:0 sc1
    v_mfma_f32_16x16x32_bf16 v[156:159], v[60:63], a[204:207], v[156:159]
    s_waitcnt lgkmcnt(4)
    v_mfma_f32_16x16x32_bf16 v[160:163], v[48:51], a[192:195], v[160:163]
    ds_read_b64_tr_b16 v[60:61], v31 offset:24576
    v_mfma_f32_16x16x32_bf16 v[164:167], v[48:51], a[196:199], v[164:167]
    ds_read_b64_tr_b16 v[62:63], v31 offset:26624
    v_mfma_f32_16x16x32_bf16 v[168:171], v[48:51], a[200:203], v[168:171]
    buffer_load_dwordx4 v[84:87], v17, s[20:23], s33 offen offset:1024 sc1
    v_mfma_f32_16x16x32_bf16 v[172:175], v[48:51], a[204:207], v[172:175]
    s_waitcnt lgkmcnt(4)
    v_mfma_f32_16x16x32_bf16 v[176:179], v[52:55], a[192:195], v[176:179]
    ds_read_b64_tr_b16 v[48:49], v36 offset:36864
    v_mfma_f32_16x16x32_bf16 v[180:183], v[52:55], a[196:199], v[180:183]
    ds_read_b64_tr_b16 v[50:51], v36 offset:37376
    v_mfma_f32_16x16x32_bf16 v[184:187], v[52:55], a[200:203], v[184:187]
    v_mfma_f32_16x16x32_bf16 v[188:191], v[52:55], a[204:207], v[188:191]
    s_waitcnt lgkmcnt(4)
    v_mfma_f32_16x16x32_bf16 v[192:195], v[56:59], a[192:195], v[192:195]
    ds_read_b64_tr_b16 v[52:53], v36 offset:37888
    v_mfma_f32_16x16x32_bf16 v[196:199], v[56:59], a[196:199], v[196:199]
    ds_read_b64_tr_b16 v[54:55], v36 offset:38400
    v_mfma_f32_16x16x32_bf16 v[200:203], v[56:59], a[200:203], v[200:203]
    buffer_load_dwordx4 v[72:75], v18, s[20:23], s33 offen offset:0 sc1
    v_mfma_f32_16x16x32_bf16 v[204:207], v[56:59], a[204:207], v[204:207]
    s_waitcnt lgkmcnt(4)
    v_mfma_f32_16x16x32_bf16 v[208:211], v[60:63], a[192:195], v[208:211]
    ds_read_b64_tr_b16 v[56:57], v28 offset:28672
    v_mfma_f32_16x16x32_bf16 v[212:215], v[60:63], a[196:199], v[212:215]
    ds_read_b64_tr_b16 v[58:59], v28 offset:30720
    v_mfma_f32_16x16x32_bf16 v[216:219], v[60:63], a[200:203], v[216:219]
    buffer_load_dwordx4 v[88:91], v18, s[20:23], s33 offen offset:1024 sc1
    v_mfma_f32_16x16x32_bf16 v[220:223], v[60:63], a[204:207], v[220:223]
    s_waitcnt lgkmcnt(4)
    v_mfma_f32_16x16x32_bf16 v[224:227], v[48:51], a[192:195], v[224:227]
    ds_read_b64_tr_b16 v[60:61], v28 offset:32768
    v_mfma_f32_16x16x32_bf16 v[228:231], v[48:51], a[196:199], v[228:231]
    ds_read_b64_tr_b16 v[62:63], v28 offset:34816
    v_mfma_f32_16x16x32_bf16 v[232:235], v[48:51], a[200:203], v[232:235]
    buffer_load_dwordx4 v[76:79], v19, s[20:23], s33 offen offset:0 sc1
    v_mfma_f32_16x16x32_bf16 v[236:239], v[48:51], a[204:207], v[236:239]
    s_waitcnt lgkmcnt(4)
    v_mfma_f32_16x16x32_bf16 v[240:243], v[52:55], a[192:195], v[240:243]
    ds_read_b64_tr_b16 v[48:49], v29 offset:28672
    v_mfma_f32_16x16x32_bf16 v[244:247], v[52:55], a[196:199], v[244:247]
    ds_read_b64_tr_b16 v[50:51], v29 offset:30720
    v_mfma_f32_16x16x32_bf16 v[248:251], v[52:55], a[200:203], v[248:251]
    v_mfma_f32_16x16x32_bf16 v[252:255], v[52:55], a[204:207], v[252:255]
    s_waitcnt lgkmcnt(4)
    v_mfma_f32_16x16x32_bf16 v[96:99], v[56:59], a[208:211], v[96:99]
    ds_read_b64_tr_b16 v[52:53], v29 offset:32768
    v_mfma_f32_16x16x32_bf16 v[100:103], v[56:59], a[212:215], v[100:103]
    ds_read_b64_tr_b16 v[54:55], v29 offset:34816
    v_mfma_f32_16x16x32_bf16 v[104:107], v[56:59], a[216:219], v[104:107]
    buffer_load_dwordx4 v[92:95], v19, s[20:23], s33 offen offset:1024 sc1
    s_add_u32 s33, s33, 2048
    v_mfma_f32_16x16x32_bf16 v[108:111], v[56:59], a[220:223], v[108:111]
    s_waitcnt lgkmcnt(4)
    v_mfma_f32_16x16x32_bf16 v[112:115], v[60:63], a[208:211], v[112:115]
    ds_read_b64_tr_b16 v[56:57], v30 offset:28672
    v_mfma_f32_16x16x32_bf16 v[116:119], v[60:63], a[212:215], v[116:119]
    ds_read_b64_tr_b16 v[58:59], v30 offset:30720
    v_mfma_f32_16x16x32_bf16 v[120:123], v[60:63], a[216:219], v[120:123]
    s_add_u32 m0, s37, 0
    v_mfma_f32_16x16x32_bf16 v[124:127], v[60:63], a[220:223], v[124:127]
    buffer_load_dwordx4 v22, s[12:15], s32 offen lds
    s_waitcnt lgkmcnt(4)
    v_mfma_f32_16x16x32_bf16 v[128:131], v[48:51], a[208:211], v[128:131]
    ds_read_b64_tr_b16 v[60:61], v30 offset:32768
    v_mfma_f32_16x16x32_bf16 v[132:135], v[48:51], a[212:215], v[132:135]
    ds_read_b64_tr_b16 v[62:63], v30 offset:34816
    v_mfma_f32_16x16x32_bf16 v[136:139], v[48:51], a[216:219], v[136:139]
    s_add_u32 m0, s37, 1024
    v_mfma_f32_16x16x32_bf16 v[140:143], v[48:51], a[220:223], v[140:143]
    buffer_load_dwordx4 v23, s[12:15], s32 offen lds
    s_waitcnt lgkmcnt(4)
    v_mfma_f32_16x16x32_bf16 v[144:147], v[52:55], a[208:211], v[144:147]
    ds_read_b64_tr_b16 v[48:49], v31 offset:28672
    v_mfma_f32_16x16x32_bf16 v[148:151], v[52:55], a[212:215], v[148:151]
    ds_read_b64_tr_b16 v[50:51], v31 offset:30720
    v_mfma_f32_16x16x32_bf16 v[152:155], v[52:55], a[216:219], v[152:155]
    s_add_u32 m0, s37, 2048
    v_mfma_f32_16x16x32_bf16 v[156:159], v[52:55], a[220:223], v[156:159]
    buffer_load_dwordx4 v24, s[12:15], s32 offen lds
    s_waitcnt lgkmcnt(4)
    v_mfma_f32_16x16x32_bf16 v[160:163], v[56:59], a[208:211], v[160:163]
    ds_read_b64_tr_b16 v[52:53], v31 offset:32768
    v_mfma_f32_16x16x32_bf16 v[164:167], v[56:59], a[212:215], v[164:167]
    ds_read_b64_tr_b16 v[54:55], v31 offset:34816
    v_mfma_f32_16x16x32_bf16 v[168:171], v[56:59], a[216:219], v[168:171]
    v_mfma_f32_16x16x32_bf16 v[172:175], v[56:59], a[220:223], v[172:175]
    s_waitcnt lgkmcnt(4)
    v_mfma_f32_16x16x32_bf16 v[176:179], v[60:63], a[208:211], v[176:179]
    ds_read_b64_tr_b16 v[56:57], v36 offset:38912
    v_mfma_f32_16x16x32_bf16 v[180:183], v[60:63], a[212:215], v[180:183]
    ds_read_b64_tr_b16 v[58:59], v36 offset:39424
    v_mfma_f32_16x16x32_bf16 v[184:187], v[60:63], a[216:219], v[184:187]
    s_add_u32 m0, s37, 3072
    v_mfma_f32_16x16x32_bf16 v[188:191], v[60:63], a[220:223], v[188:191]
    buffer_load_dwordx4 v25, s[12:15], s32 offen lds
    s_waitcnt lgkmcnt(4)
    v_mfma_f32_16x16x32_bf16 v[192:195], v[48:51], a[208:211], v[192:195]
    ds_read_b64_tr_b16 v[60:61], v36 offset:39936
    v_mfma_f32_16x16x32_bf16 v[196:199], v[48:51], a[212:215], v[196:199]
    ds_read_b64_tr_b16 v[62:63], v36 offset:40448
    v_mfma_f32_16x16x32_bf16 v[200:203], v[48:51], a[216:219], v[200:203]
    s_add_u32 m0, s37, 4096
    v_mfma_f32_16x16x32_bf16 v[204:207], v[48:51], a[220:223], v[204:207]
    buffer_load_dwordx4 v26, s[12:15], s32 offen lds
    s_waitcnt lgkmcnt(4)
    v_mfma_f32_16x16x32_bf16 v[208:211], v[52:55], a[208:211], v[208:211]
    ds_read_b64_tr_b16 v[48:49], v28 offset:40960
    v_mfma_f32_16x16x32_bf16 v[212:215], v[52:55], a[212:215], v[212:215]
    ds_read_b64_tr_b16 v[50:51], v28 offset:43008
    v_mfma_f32_16x16x32_bf16 v[216:219], v[52:55], a[216:219], v[216:219]
    s_add_u32 s32, s32, 589824
    v_mfma_f32_16x16x32_bf16 v[220:223], v[52:55], a[220:223], v[220:223]
    buffer_load_dword v27, v6, s[12:15], s49 offen
    s_waitcnt lgkmcnt(4)
    v_mfma_f32_16x16x32_bf16 v[224:227], v[56:59], a[208:211], v[224:227]
    ds_read_b64_tr_b16 v[52:53], v28 offset:45056
    v_mfma_f32_16x16x32_bf16 v[228:231], v[56:59], a[212:215], v[228:231]
    ds_read_b64_tr_b16 v[54:55], v28 offset:47104
    v_mfma_f32_16x16x32_bf16 v[232:235], v[56:59], a[216:219], v[232:235]
    s_add_u32 s49, s49, 589824
    v_mfma_f32_16x16x32_bf16 v[236:239], v[56:59], a[220:223], v[236:239]
    s_waitcnt lgkmcnt(4)
    v_mfma_f32_16x16x32_bf16 v[240:243], v[60:63], a[208:211], v[240:243]
    ds_read_b64_tr_b16 v[56:57], v29 offset:40960
    v_mfma_f32_16x16x32_bf16 v[244:247], v[60:63], a[212:215], v[244:247]
    ds_read_b64_tr_b16 v[58:59], v29 offset:43008
    v_mfma_f32_16x16x32_bf16 v[248:251], v[60:63], a[216:219], v[248:251]
    v_mfma_f32_16x16x32_bf16 v[252:255], v[60:63], a[220:223], v[252:255]
    s_waitcnt vmcnt(15) lgkmcnt(4)
    v_mfma_f32_16x16x32_bf16 v[96:99], v[48:51], a[224:227], v[96:99]
    ds_read_b64_tr_b16 v[60:61], v29 offset:45056
    v_mfma_f32_16x16x32_bf16 v[100:103], v[48:51], a[228:231], v[100:103]
    ds_read_b64_tr_b16 v[62:63], v29 offset:47104
    v_mfma_f32_16x16x32_bf16 v[104:107], v[48:51], a[232:235], v[104:107]
    v_mfma_f32_16x16x32_bf16 v[108:111], v[48:51], a[236:239], v[108:111]
    s_waitcnt vmcnt(24)
    s_barrier
    s_waitcnt lgkmcnt(4)
    v_mfma_f32_16x16x32_bf16 v[112:115], v[52:55], a[224:227], v[112:115]
    ds_read_b64_tr_b16 v[48:49], v30 offset:40960
    v_mfma_f32_16x16x32_bf16 v[116:119], v[52:55], a[228:231], v[116:119]
    ds_read_b64_tr_b16 v[50:51], v30 offset:43008
    v_mfma_f32_16x16x32_bf16 v[120:123], v[52:55], a[232:235], v[120:123]
    s_add_u32 m0, s37, 20480
    v_mfma_f32_16x16x32_bf16 v[124:127], v[52:55], a[236:239], v[124:127]
    buffer_load_dwordx4 v22, s[12:15], s32 offen lds
    s_waitcnt lgkmcnt(4)
    v_mfma_f32_16x16x32_bf16 v[128:131], v[56:59], a[224:227], v[128:131]
    ds_read_b64_tr_b16 v[52:53], v30 offset:45056
    v_mfma_f32_16x16x32_bf16 v[132:135], v[56:59], a[228:231], v[132:135]
    ds_read_b64_tr_b16 v[54:55], v30 offset:47104
    v_mfma_f32_16x16x32_bf16 v[136:139], v[56:59], a[232:235], v[136:139]
    v_mfma_f32_16x16x32_bf16 v[140:143], v[56:59], a[236:239], v[140:143]
    s_waitcnt lgkmcnt(4)
    v_mfma_f32_16x16x32_bf16 v[144:147], v[60:63], a[224:227], v[144:147]
    ds_read_b64_tr_b16 v[56:57], v31 offset:40960
    v_mfma_f32_16x16x32_bf16 v[148:151], v[60:63], a[228:231], v[148:151]
    ds_read_b64_tr_b16 v[58:59], v31 offset:43008
    v_mfma_f32_16x16x32_bf16 v[152:155], v[60:63], a[232:235], v[152:155]
    v_mfma_f32_16x16x32_bf16 v[156:159], v[60:63], a[236:239], v[156:159]
    s_waitcnt lgkmcnt(4)
    v_mfma_f32_16x16x32_bf16 v[160:163], v[48:51], a[224:227], v[160:163]
    ds_read_b64_tr_b16 v[60:61], v31 offset:45056
    v_mfma_f32_16x16x32_bf16 v[164:167], v[48:51], a[228:231], v[164:167]
    ds_read_b64_tr_b16 v[62:63], v31 offset:47104
    v_mfma_f32_16x16x32_bf16 v[168:171], v[48:51], a[232:235], v[168:171]
    s_add_u32 m0, s37, 21504
    v_mfma_f32_16x16x32_bf16 v[172:175], v[48:51], a[236:239], v[172:175]
    buffer_load_dwordx4 v23, s[12:15], s32 offen lds
    s_waitcnt lgkmcnt(4)
    v_mfma_f32_16x16x32_bf16 v[176:179], v[52:55], a[224:227], v[176:179]
    ds_read_b64_tr_b16 v[48:49], v36 offset:57344
    v_mfma_f32_16x16x32_bf16 v[180:183], v[52:55], a[228:231], v[180:183]
    ds_read_b64_tr_b16 v[50:51], v36 offset:57856
    v_mfma_f32_16x16x32_bf16 v[184:187], v[52:55], a[232:235], v[184:187]
    v_mfma_f32_16x16x32_bf16 v[188:191], v[52:55], a[236:239], v[188:191]
    s_waitcnt lgkmcnt(4)
    v_mfma_f32_16x16x32_bf16 v[192:195], v[56:59], a[224:227], v[192:195]
    ds_read_b64_tr_b16 v[52:53], v36 offset:58368
    v_mfma_f32_16x16x32_bf16 v[196:199], v[56:59], a[228:231], v[196:199]
    ds_read_b64_tr_b16 v[54:55], v36 offset:58880
    v_mfma_f32_16x16x32_bf16 v[200:203], v[56:59], a[232:235], v[200:203]
    v_mfma_f32_16x16x32_bf16 v[204:207], v[56:59], a[236:239], v[204:207]
    s_waitcnt lgkmcnt(4)
    v_mfma_f32_16x16x32_bf16 v[208:211], v[60:63], a[224:227], v[208:211]
    ds_read_b64_tr_b16 v[56:57], v28 offset:49152
    v_mfma_f32_16x16x32_bf16 v[212:215], v[60:63], a[228:231], v[212:215]
    ds_read_b64_tr_b16 v[58:59], v28 offset:51200
    v_mfma_f32_16x16x32_bf16 v[216:219], v[60:63], a[232:235], v[216:219]
    s_add_u32 m0, s37, 22528
    v_mfma_f32_16x16x32_bf16 v[220:223], v[60:63], a[236:239], v[220:223]
    buffer_load_dwordx4 v24, s[12:15], s32 offen lds
    s_waitcnt lgkmcnt(4)
    v_mfma_f32_16x16x32_bf16 v[224:227], v[48:51], a[224:227], v[224:227]
    ds_read_b64_tr_b16 v[60:61], v28 offset:53248
    v_mfma_f32_16x16x32_bf16 v[228:231], v[48:51], a[228:231], v[228:231]
    ds_read_b64_tr_b16 v[62:63], v28 offset:55296
    v_mfma_f32_16x16x32_bf16 v[232:235], v[48:51], a[232:235], v[232:235]
    v_mfma_f32_16x16x32_bf16 v[236:239], v[48:51], a[236:239], v[236:239]
    s_waitcnt lgkmcnt(4)
    v_mfma_f32_16x16x32_bf16 v[240:243], v[52:55], a[224:227], v[240:243]
    ds_read_b64_tr_b16 v[48:49], v29 offset:49152
    v_mfma_f32_16x16x32_bf16 v[244:247], v[52:55], a[228:231], v[244:247]
    ds_read_b64_tr_b16 v[50:51], v29 offset:51200
    v_mfma_f32_16x16x32_bf16 v[248:251], v[52:55], a[232:235], v[248:251]
    v_mfma_f32_16x16x32_bf16 v[252:255], v[52:55], a[236:239], v[252:255]
    s_waitcnt lgkmcnt(4)
    v_mfma_f32_16x16x32_bf16 v[96:99], v[56:59], a[240:243], v[96:99]
    ds_read_b64_tr_b16 v[52:53], v29 offset:53248
    v_mfma_f32_16x16x32_bf16 v[100:103], v[56:59], a[244:247], v[100:103]
    ds_read_b64_tr_b16 v[54:55], v29 offset:55296
    v_mfma_f32_16x16x32_bf16 v[104:107], v[56:59], a[248:251], v[104:107]
    s_add_u32 m0, s37, 23552
    v_mfma_f32_16x16x32_bf16 v[108:111], v[56:59], a[252:255], v[108:111]
    buffer_load_dwordx4 v25, s[12:15], s32 offen lds
    s_waitcnt lgkmcnt(4)
    v_mfma_f32_16x16x32_bf16 v[112:115], v[60:63], a[240:243], v[112:115]
    ds_read_b64_tr_b16 v[56:57], v30 offset:49152
    v_mfma_f32_16x16x32_bf16 v[116:119], v[60:63], a[244:247], v[116:119]
    ds_read_b64_tr_b16 v[58:59], v30 offset:51200
    v_mfma_f32_16x16x32_bf16 v[120:123], v[60:63], a[248:251], v[120:123]
    v_mfma_f32_16x16x32_bf16 v[124:127], v[60:63], a[252:255], v[124:127]
    s_waitcnt lgkmcnt(4)
    v_mfma_f32_16x16x32_bf16 v[128:131], v[48:51], a[240:243], v[128:131]
    ds_read_b64_tr_b16 v[60:61], v30 offset:53248
    v_mfma_f32_16x16x32_bf16 v[132:135], v[48:51], a[244:247], v[132:135]
    ds_read_b64_tr_b16 v[62:63], v30 offset:55296
    v_mfma_f32_16x16x32_bf16 v[136:139], v[48:51], a[248:251], v[136:139]
    v_mfma_f32_16x16x32_bf16 v[140:143], v[48:51], a[252:255], v[140:143]
    s_waitcnt lgkmcnt(4)
    v_mfma_f32_16x16x32_bf16 v[144:147], v[52:55], a[240:243], v[144:147]
    ds_read_b64_tr_b16 v[48:49], v31 offset:49152
    v_mfma_f32_16x16x32_bf16 v[148:151], v[52:55], a[244:247], v[148:151]
    ds_read_b64_tr_b16 v[50:51], v31 offset:51200
    v_mfma_f32_16x16x32_bf16 v[152:155], v[52:55], a[248:251], v[152:155]
    s_add_u32 m0, s37, 24576
    v_mfma_f32_16x16x32_bf16 v[156:159], v[52:55], a[252:255], v[156:159]
    buffer_load_dwordx4 v26, s[12:15], s32 offen lds
    s_waitcnt lgkmcnt(4)
    v_mfma_f32_16x16x32_bf16 v[160:163], v[56:59], a[240:243], v[160:163]
    ds_read_b64_tr_b16 v[52:53], v31 offset:53248
    v_mfma_f32_16x16x32_bf16 v[164:167], v[56:59], a[244:247], v[164:167]
    ds_read_b64_tr_b16 v[54:55], v31 offset:55296
    v_mfma_f32_16x16x32_bf16 v[168:171], v[56:59], a[248:251], v[168:171]
    s_add_u32 s32, s32, 589824
    v_mfma_f32_16x16x32_bf16 v[172:175], v[56:59], a[252:255], v[172:175]
    s_waitcnt lgkmcnt(4)
    v_mfma_f32_16x16x32_bf16 v[176:179], v[60:63], a[240:243], v[176:179]
    ds_read_b64_tr_b16 v[56:57], v36 offset:59392
    v_mfma_f32_16x16x32_bf16 v[180:183], v[60:63], a[244:247], v[180:183]
    ds_read_b64_tr_b16 v[58:59], v36 offset:59904
    v_mfma_f32_16x16x32_bf16 v[184:187], v[60:63], a[248:251], v[184:187]
    v_mfma_f32_16x16x32_bf16 v[188:191], v[60:63], a[252:255], v[188:191]
    s_waitcnt lgkmcnt(4)
    v_mfma_f32_16x16x32_bf16 v[192:195], v[48:51], a[240:243], v[192:195]
    ds_read_b64_tr_b16 v[60:61], v36 offset:60416
    v_mfma_f32_16x16x32_bf16 v[196:199], v[48:51], a[244:247], v[196:199]
    ds_read_b64_tr_b16 v[62:63], v36 offset:60928
    v_mfma_f32_16x16x32_bf16 v[200:203], v[48:51], a[248:251], v[200:203]
    buffer_load_dword v27, v6, s[12:15], s49 offen
    s_add_u32 s49, s49, 589824
    v_mfma_f32_16x16x32_bf16 v[204:207], v[48:51], a[252:255], v[204:207]
    s_waitcnt lgkmcnt(4)
    v_mfma_f32_16x16x32_bf16 v[208:211], v[52:55], a[240:243], v[208:211]
    ds_read_b64_tr_b16 v[48:49], v32 offset:0
    v_mfma_f32_16x16x32_bf16 v[212:215], v[52:55], a[244:247], v[212:215]
    ds_read_b64_tr_b16 v[50:51], v32 offset:2048
    v_mfma_f32_16x16x32_bf16 v[216:219], v[52:55], a[248:251], v[216:219]
    v_mfma_f32_16x16x32_bf16 v[220:223], v[52:55], a[252:255], v[220:223]
    s_waitcnt lgkmcnt(4)
    v_mfma_f32_16x16x32_bf16 v[224:227], v[56:59], a[240:243], v[224:227]
    ds_read_b64_tr_b16 v[52:53], v32 offset:4096
    v_mfma_f32_16x16x32_bf16 v[228:231], v[56:59], a[244:247], v[228:231]
    ds_read_b64_tr_b16 v[54:55], v32 offset:6144
    v_mfma_f32_16x16x32_bf16 v[232:235], v[56:59], a[248:251], v[232:235]
    v_mfma_f32_16x16x32_bf16 v[236:239], v[56:59], a[252:255], v[236:239]
    s_waitcnt lgkmcnt(4)
    v_mfma_f32_16x16x32_bf16 v[240:243], v[60:63], a[240:243], v[240:243]
    ds_read_b64_tr_b16 v[56:57], v33 offset:0
    v_mfma_f32_16x16x32_bf16 v[244:247], v[60:63], a[244:247], v[244:247]
    ds_read_b64_tr_b16 v[58:59], v33 offset:2048
    v_mfma_f32_16x16x32_bf16 v[248:251], v[60:63], a[248:251], v[248:251]
    v_mfma_f32_16x16x32_bf16 v[252:255], v[60:63], a[252:255], v[252:255]
    s_waitcnt vmcnt(12) lgkmcnt(4)
    v_mfma_f32_16x16x32_bf16 v[96:99], v[48:51], v[64:67], v[96:99]
    ds_read_b64_tr_b16 v[60:61], v33 offset:4096
    v_mfma_f32_16x16x32_bf16 v[100:103], v[48:51], v[68:71], v[100:103]
    ds_read_b64_tr_b16 v[62:63], v33 offset:6144
    v_mfma_f32_16x16x32_bf16 v[104:107], v[48:51], v[72:75], v[104:107]
    v_mfma_f32_16x16x32_bf16 v[108:111], v[48:51], v[76:79], v[108:111]
    s_waitcnt vmcnt(7)
    s_barrier
    s_waitcnt lgkmcnt(4)
    v_mfma_f32_16x16x32_bf16 v[112:115], v[52:55], v[64:67], v[112:115]
    ds_read_b64_tr_b16 v[48:49], v34 offset:0
    v_mfma_f32_16x16x32_bf16 v[116:119], v[52:55], v[68:71], v[116:119]
    ds_read_b64_tr_b16 v[50:51], v34 offset:2048
    v_mfma_f32_16x16x32_bf16 v[120:123], v[52:55], v[72:75], v[120:123]
    s_add_u32 m0, s37, 40960
    v_mfma_f32_16x16x32_bf16 v[124:127], v[52:55], v[76:79], v[124:127]
    buffer_load_dwordx4 v22, s[12:15], s32 offen lds
    s_waitcnt lgkmcnt(4)
    v_mfma_f32_16x16x32_bf16 v[128:131], v[56:59], v[64:67], v[128:131]
    ds_read_b64_tr_b16 v[52:53], v34 offset:4096
    v_mfma_f32_16x16x32_bf16 v[132:135], v[56:59], v[68:71], v[132:135]
    ds_read_b64_tr_b16 v[54:55], v34 offset:6144
    v_mfma_f32_16x16x32_bf16 v[136:139], v[56:59], v[72:75], v[136:139]
    v_mfma_f32_16x16x32_bf16 v[140:143], v[56:59], v[76:79], v[140:143]
    s_waitcnt lgkmcnt(4)
    v_mfma_f32_16x16x32_bf16 v[144:147], v[60:63], v[64:67], v[144:147]
    ds_read_b64_tr_b16 v[56:57], v35 offset:0
    v_mfma_f32_16x16x32_bf16 v[148:151], v[60:63], v[68:71], v[148:151]
    ds_read_b64_tr_b16 v[58:59], v35 offset:2048
    v_mfma_f32_16x16x32_bf16 v[152:155], v[60:63], v[72:75], v[152:155]
    s_add_u32 m0, s37, 41984
    v_mfma_f32_16x16x32_bf16 v[156:159], v[60:63], v[76:79], v[156:159]
    buffer_load_dwordx4 v23, s[12:15], s32 offen lds
    s_waitcnt lgkmcnt(4)
    v_mfma_f32_16x16x32_bf16 v[160:163], v[48:51], v[64:67], v[160:163]
    ds_read_b64_tr_b16 v[60:61], v35 offset:4096
    v_mfma_f32_16x16x32_bf16 v[164:167], v[48:51], v[68:71], v[164:167]
    ds_read_b64_tr_b16 v[62:63], v35 offset:6144
    v_mfma_f32_16x16x32_bf16 v[168:171], v[48:51], v[72:75], v[168:171]
    v_mfma_f32_16x16x32_bf16 v[172:175], v[48:51], v[76:79], v[172:175]
    s_waitcnt lgkmcnt(4)
    v_mfma_f32_16x16x32_bf16 v[176:179], v[52:55], v[64:67], v[176:179]
    ds_read_b64_tr_b16 v[48:49], v37 offset:16384
    v_mfma_f32_16x16x32_bf16 v[180:183], v[52:55], v[68:71], v[180:183]
    ds_read_b64_tr_b16 v[50:51], v37 offset:16896
    v_mfma_f32_16x16x32_bf16 v[184:187], v[52:55], v[72:75], v[184:187]
    v_mfma_f32_16x16x32_bf16 v[188:191], v[52:55], v[76:79], v[188:191]
    s_waitcnt lgkmcnt(4)
    v_mfma_f32_16x16x32_bf16 v[192:195], v[56:59], v[64:67], v[192:195]
    ds_read_b64_tr_b16 v[52:53], v37 offset:17408
    v_mfma_f32_16x16x32_bf16 v[196:199], v[56:59], v[68:71], v[196:199]
    ds_read_b64_tr_b16 v[54:55], v37 offset:17920
    v_mfma_f32_16x16x32_bf16 v[200:203], v[56:59], v[72:75], v[200:203]
    s_add_u32 m0, s37, 43008
    v_mfma_f32_16x16x32_bf16 v[204:207], v[56:59], v[76:79], v[204:207]
    buffer_load_dwordx4 v24, s[12:15], s32 offen lds
    s_waitcnt lgkmcnt(4)
    v_mfma_f32_16x16x32_bf16 v[208:211], v[60:63], v[64:67], v[208:211]
    ds_read_b64_tr_b16 v[56:57], v32 offset:8192
    v_mfma_f32_16x16x32_bf16 v[212:215], v[60:63], v[68:71], v[212:215]
    ds_read_b64_tr_b16 v[58:59], v32 offset:10240
    v_mfma_f32_16x16x32_bf16 v[216:219], v[60:63], v[72:75], v[216:219]
    v_mfma_f32_16x16x32_bf16 v[220:223], v[60:63], v[76:79], v[220:223]
    s_waitcnt lgkmcnt(4)
    v_mfma_f32_16x16x32_bf16 v[224:227], v[48:51], v[64:67], v[224:227]
    ds_read_b64_tr_b16 v[60:61], v32 offset:12288
    v_mfma_f32_16x16x32_bf16 v[228:231], v[48:51], v[68:71], v[228:231]
    ds_read_b64_tr_b16 v[62:63], v32 offset:14336
    v_mfma_f32_16x16x32_bf16 v[232:235], v[48:51], v[72:75], v[232:235]
    s_add_u32 m0, s37, 44032
    v_mfma_f32_16x16x32_bf16 v[236:239], v[48:51], v[76:79], v[236:239]
    buffer_load_dwordx4 v25, s[12:15], s32 offen lds
    s_waitcnt lgkmcnt(4)
    v_mfma_f32_16x16x32_bf16 v[240:243], v[52:55], v[64:67], v[240:243]
    ds_read_b64_tr_b16 v[48:49], v33 offset:8192
    v_mfma_f32_16x16x32_bf16 v[244:247], v[52:55], v[68:71], v[244:247]
    ds_read_b64_tr_b16 v[50:51], v33 offset:10240
    v_mfma_f32_16x16x32_bf16 v[248:251], v[52:55], v[72:75], v[248:251]
    v_mfma_f32_16x16x32_bf16 v[252:255], v[52:55], v[76:79], v[252:255]
    s_waitcnt lgkmcnt(4)
    v_mfma_f32_16x16x32_bf16 v[96:99], v[56:59], v[80:83], v[96:99]
    ds_read_b64_tr_b16 v[52:53], v33 offset:12288
    v_mfma_f32_16x16x32_bf16 v[100:103], v[56:59], v[84:87], v[100:103]
    ds_read_b64_tr_b16 v[54:55], v33 offset:14336
    v_mfma_f32_16x16x32_bf16 v[104:107], v[56:59], v[88:91], v[104:107]
    v_mfma_f32_16x16x32_bf16 v[108:111], v[56:59], v[92:95], v[108:111]
    s_waitcnt lgkmcnt(4)
    v_mfma_f32_16x16x32_bf16 v[112:115], v[60:63], v[80:83], v[112:115]
    ds_read_b64_tr_b16 v[56:57], v34 offset:8192
    v_mfma_f32_16x16x32_bf16 v[116:119], v[60:63], v[84:87], v[116:119]
    ds_read_b64_tr_b16 v[58:59], v34 offset:10240
    v_mfma_f32_16x16x32_bf16 v[120:123], v[60:63], v[88:91], v[120:123]
    s_add_u32 m0, s37, 45056
    v_mfma_f32_16x16x32_bf16 v[124:127], v[60:63], v[92:95], v[124:127]
    buffer_load_dwordx4 v26, s[12:15], s32 offen lds
    s_waitcnt lgkmcnt(4)
    v_mfma_f32_16x16x32_bf16 v[128:131], v[48:51], v[80:83], v[128:131]
    ds_read_b64_tr_b16 v[60:61], v34 offset:12288
    v_mfma_f32_16x16x32_bf16 v[132:135], v[48:51], v[84:87], v[132:135]
    ds_read_b64_tr_b16 v[62:63], v34 offset:14336
    v_mfma_f32_16x16x32_bf16 v[136:139], v[48:51], v[88:91], v[136:139]
    s_add_u32 s32, s32, 589824
    v_mfma_f32_16x16x32_bf16 v[140:143], v[48:51], v[92:95], v[140:143]
    s_waitcnt lgkmcnt(4)
    v_mfma_f32_16x16x32_bf16 v[144:147], v[52:55], v[80:83], v[144:147]
    ds_read_b64_tr_b16 v[48:49], v35 offset:8192
    v_mfma_f32_16x16x32_bf16 v[148:151], v[52:55], v[84:87], v[148:151]
    ds_read_b64_tr_b16 v[50:51], v35 offset:10240
    v_mfma_f32_16x16x32_bf16 v[152:155], v[52:55], v[88:91], v[152:155]
    buffer_load_dword v27, v6, s[12:15], s49 offen
    s_add_u32 s49, s49, 589824
    v_mfma_f32_16x16x32_bf16 v[156:159], v[52:55], v[92:95], v[156:159]
    s_waitcnt lgkmcnt(4)
    v_mfma_f32_16x16x32_bf16 v[160:163], v[56:59], v[80:83], v[160:163]
    ds_read_b64_tr_b16 v[52:53], v35 offset:12288
    v_mfma_f32_16x16x32_bf16 v[164:167], v[56:59], v[84:87], v[164:167]
    ds_read_b64_tr_b16 v[54:55], v35 offset:14336
    v_mfma_f32_16x16x32_bf16 v[168:171], v[56:59], v[88:91], v[168:171]
    v_mfma_f32_16x16x32_bf16 v[172:175], v[56:59], v[92:95], v[172:175]
    s_waitcnt lgkmcnt(4)
    v_mfma_f32_16x16x32_bf16 v[176:179], v[60:63], v[80:83], v[176:179]
    ds_read_b64_tr_b16 v[56:57], v37 offset:18432
    v_mfma_f32_16x16x32_bf16 v[180:183], v[60:63], v[84:87], v[180:183]
    ds_read_b64_tr_b16 v[58:59], v37 offset:18944
    v_mfma_f32_16x16x32_bf16 v[184:187], v[60:63], v[88:91], v[184:187]
    v_mfma_f32_16x16x32_bf16 v[188:191], v[60:63], v[92:95], v[188:191]
    s_waitcnt lgkmcnt(4)
    v_mfma_f32_16x16x32_bf16 v[192:195], v[48:51], v[80:83], v[192:195]
    ds_read_b64_tr_b16 v[60:61], v37 offset:19456
    v_mfma_f32_16x16x32_bf16 v[196:199], v[48:51], v[84:87], v[196:199]
    ds_read_b64_tr_b16 v[62:63], v37 offset:19968
    v_mfma_f32_16x16x32_bf16 v[200:203], v[48:51], v[88:91], v[200:203]
    s_mov_b32 s92, s72
    s_mov_b32 s93, s73
    v_mfma_f32_16x16x32_bf16 v[204:207], v[48:51], v[92:95], v[204:207]
    s_mov_b32 s94, 0x510000
    s_waitcnt lgkmcnt(4)
    v_mfma_f32_16x16x32_bf16 v[208:211], v[52:55], v[80:83], v[208:211]
    s_mov_b32 s95, 0x20000
    v_mfma_f32_16x16x32_bf16 v[212:215], v[52:55], v[84:87], v[212:215]
    v_lshrrev_b32 v5, 2, v0
    v_mfma_f32_16x16x32_bf16 v[216:219], v[52:55], v[88:91], v[216:219]
    v_min_u32 v5, 11, v5
    v_and_b32 v1, 3, v5
    v_mfma_f32_16x16x32_bf16 v[220:223], v[52:55], v[92:95], v[220:223]
    v_mul_u32_u24 v1, 1152, v1
    s_waitcnt lgkmcnt(2)
    v_mfma_f32_16x16x32_bf16 v[224:227], v[56:59], v[80:83], v[224:227]
    s_mul_i32 s90, s42, 160
    v_mfma_f32_16x16x32_bf16 v[228:231], v[56:59], v[84:87], v[228:231]
    s_add_u32 s90, s90, 512
    v_mfma_f32_16x16x32_bf16 v[232:235], v[56:59], v[88:91], v[232:235]
    s_and_b32 s90, s90, 0xffffff80
    v_lshrrev_b32 v2, 2, v5
    v_mfma_f32_16x16x32_bf16 v[236:239], v[56:59], v[92:95], v[236:239]
    v_lshlrev_b32 v3, 7, v2
    s_waitcnt lgkmcnt(0)
    v_mfma_f32_16x16x32_bf16 v[240:243], v[60:63], v[80:83], v[240:243]
    v_add_u32 v3, s90, v3
    v_mfma_f32_16x16x32_bf16 v[244:247], v[60:63], v[84:87], v[244:247]
    s_lshl_b32 s90, s42, 7
    v_mfma_f32_16x16x32_bf16 v[248:251], v[60:63], v[88:91], v[248:251]
    v_mov_b32 v4, s90
    v_cmp_le_u32 vcc, 2, v2
    v_mfma_f32_16x16x32_bf16 v[252:255], v[60:63], v[92:95], v[252:255]
    s_nop 1
    v_cndmask_b32 v3, v3, v4, vcc
    v_add_u32 v1, v1, v3
    s_mul_i32 s100, s41, 576
    s_and_b32 s90, s40, 3
    s_lshl_b32 s90, s90, 4
    s_add_u32 s100, s100, s90
    s_lshl_b32 s90, s3, 2
    s_add_u32 s100, s100, s90
    s_mul_i32 s100, s100, 1152
    buffer_load_dword v27, v1, s[92:95], s100 offen
    s_add_u32 s100, s100, 73728
    s_nop 7
    v_lshrrev_b32 v3, 4, v0
    v_lshlrev_b32 v3, 15, v3
    v_and_b32 v4, 15, v0
    v_lshl_add_u32 v3, v4, 2, v3
    s_lshl_b32 s45, s43, 17
    s_lshl_b32 s46, s40, 10
    s_add_u32 s45, s45, s46
    s_lshl_b32 s46, s3, 8
    s_add_u32 s45, s45, s46
    v_cvt_pk_bf16_f32 v40, v224, v240
    buffer_store_dword v40, v3, s[28:31], s45 offen offset:0 sc1
    v_cvt_pk_bf16_f32 v41, v228, v244
    buffer_store_dword v41, v3, s[28:31], s45 offen offset:64 sc1
    v_cvt_pk_bf16_f32 v42, v232, v248
    buffer_store_dword v42, v3, s[28:31], s45 offen offset:128 sc1
    v_cvt_pk_bf16_f32 v43, v236, v252
    buffer_store_dword v43, v3, s[28:31], s45 offen offset:192 sc1
    s_add_u32 s45, s45, 8192
    v_cvt_pk_bf16_f32 v44, v225, v241
    buffer_store_dword v44, v3, s[28:31], s45 offen offset:0 sc1
    v_cvt_pk_bf16_f32 v45, v229, v245
    buffer_store_dword v45, v3, s[28:31], s45 offen offset:64 sc1
    v_cvt_pk_bf16_f32 v46, v233, v249
    buffer_store_dword v46, v3, s[28:31], s45 offen offset:128 sc1
    v_cvt_pk_bf16_f32 v47, v237, v253
    buffer_store_dword v47, v3, s[28:31], s45 offen offset:192 sc1
    s_add_u32 s45, s45, 8192
    v_cvt_pk_bf16_f32 v40, v226, v242
    buffer_store_dword v40, v3, s[28:31], s45 offen offset:0 sc1
    v_cvt_pk_bf16_f32 v41, v230, v246
    buffer_store_dword v41, v3, s[28:31], s45 offen offset:64 sc1
    v_cvt_pk_bf16_f32 v42, v234, v250
    buffer_store_dword v42, v3, s[28:31], s45 offen offset:128 sc1
    v_cvt_pk_bf16_f32 v43, v238, v254
    buffer_store_dword v43, v3, s[28:31], s45 offen offset:192 sc1
    s_add_u32 s45, s45, 8192
    v_cvt_pk_bf16_f32 v44, v227, v243
    buffer_store_dword v44, v3, s[28:31], s45 offen offset:0 sc1
    v_cvt_pk_bf16_f32 v45, v231, v247
    buffer_store_dword v45, v3, s[28:31], s45 offen offset:64 sc1
    v_cvt_pk_bf16_f32 v46, v235, v251
    buffer_store_dword v46, v3, s[28:31], s45 offen offset:128 sc1
    v_cvt_pk_bf16_f32 v47, v239, v255
    buffer_store_dword v47, v3, s[28:31], s45 offen offset:192 sc1
    s_add_u32 s45, s45, 8192
    s_cmp_eq_u32 s59, 1
    s_cbranch_scc0 FKE_hs0
    s_lshl_b32 s45, s40, 4
    s_lshl_b32 s46, s3, 2
    s_add_u32 s45, s45, s46
    s_mul_i32 s50, s45, 147456
    s_mul_i32 s46, s41, 18432
    s_add_u32 s50, s50, s46
    s_lshl_b32 s46, s42, 11
    s_add_u32 s51, s50, s46
    v_lshlrev_b32 v2, 4, v0
    v_pk_mul_f32 v[96:97], v[96:97], v[112:113]
    v_pk_mul_f32 v[98:99], v[98:99], v[114:115]
    v_cvt_pk_bf16_f32 v40, v96, v97
    v_cvt_pk_bf16_f32 v41, v98, v99
    v_pk_mul_f32 v[128:129], v[128:129], v[144:145]
    v_pk_mul_f32 v[130:131], v[130:131], v[146:147]
    v_cvt_pk_bf16_f32 v42, v128, v129
    v_cvt_pk_bf16_f32 v43, v130, v131
    buffer_store_dwordx4 v[40:43], v2, s[16:19], s51 offen offset:0
    v_pk_mul_f32 v[160:161], v[160:161], v[176:177]
    v_pk_mul_f32 v[162:163], v[162:163], v[178:179]
    v_cvt_pk_bf16_f32 v44, v160, v161
    v_cvt_pk_bf16_f32 v45, v162, v163
    v_pk_mul_f32 v[192:193], v[192:193], v[208:209]
    v_pk_mul_f32 v[194:195], v[194:195], v[210:211]
    v_cvt_pk_bf16_f32 v46, v192, v193
    v_cvt_pk_bf16_f32 v47, v194, v195
    buffer_store_dwordx4 v[44:47], v2, s[16:19], s51 offen offset:1024
    s_add_u32 s51, s51, 147456
    v_pk_mul_f32 v[100:101], v[100:101], v[116:117]
    v_pk_mul_f32 v[102:103], v[102:103], v[118:119]
    v_cvt_pk_bf16_f32 v40, v100, v101
    v_cvt_pk_bf16_f32 v41, v102, v103
    v_pk_mul_f32 v[132:133], v[132:133], v[148:149]
    v_pk_mul_f32 v[134:135], v[134:135], v[150:151]
    v_cvt_pk_bf16_f32 v42, v132, v133
    v_cvt_pk_bf16_f32 v43, v134, v135
    buffer_store_dwordx4 v[40:43], v2, s[16:19], s51 offen offset:0
    v_pk_mul_f32 v[164:165], v[164:165], v[180:181]
    v_pk_mul_f32 v[166:167], v[166:167], v[182:183]
    v_cvt_pk_bf16_f32 v44, v164, v165
    v_cvt_pk_bf16_f32 v45, v166, v167
    v_pk_mul_f32 v[196:197], v[196:197], v[212:213]
    v_pk_mul_f32 v[198:199], v[198:199], v[214:215]
    v_cvt_pk_bf16_f32 v46, v196, v197
    v_cvt_pk_bf16_f32 v47, v198, v199
    buffer_store_dwordx4 v[44:47], v2, s[16:19], s51 offen offset:1024
    s_add_u32 s51, s51, 147456
    v_pk_mul_f32 v[104:105], v[104:105], v[120:121]
    v_pk_mul_f32 v[106:107], v[106:107], v[122:123]
    v_cvt_pk_bf16_f32 v40, v104, v105
    v_cvt_pk_bf16_f32 v41, v106, v107
    v_pk_mul_f32 v[136:137], v[136:137], v[152:153]
    v_pk_mul_f32 v[138:139], v[138:139], v[154:155]
    v_cvt_pk_bf16_f32 v42, v136, v137
    v_cvt_pk_bf16_f32 v43, v138, v139
    buffer_store_dwordx4 v[40:43], v2, s[16:19], s51 offen offset:0
    v_pk_mul_f32 v[168:169], v[168:169], v[184:185]
    v_pk_mul_f32 v[170:171], v[170:171], v[186:187]
    v_cvt_pk_bf16_f32 v44, v168, v169
    v_cvt_pk_bf16_f32 v45, v170, v171
    v_pk_mul_f32 v[200:201], v[200:201], v[216:217]
    v_pk_mul_f32 v[202:203], v[202:203], v[218:219]
    v_cvt_pk_bf16_f32 v46, v200, v201
    v_cvt_pk_bf16_f32 v47, v202, v203
    buffer_store_dwordx4 v[44:47], v2, s[16:19], s51 offen offset:1024
    s_add_u32 s51, s51, 147456
    v_pk_mul_f32 v[108:109], v[108:109], v[124:125]
    v_pk_mul_f32 v[110:111], v[110:111], v[126:127]
    v_cvt_pk_bf16_f32 v40, v108, v109
    v_cvt_pk_bf16_f32 v41, v110, v111
    v_pk_mul_f32 v[140:141], v[140:141], v[156:157]
    v_pk_mul_f32 v[142:143], v[142:143], v[158:159]
    v_cvt_pk_bf16_f32 v42, v140, v141
    v_cvt_pk_bf16_f32 v43, v142, v143
    buffer_store_dwordx4 v[40:43], v2, s[16:19], s51 offen offset:0
    v_pk_mul_f32 v[172:173], v[172:173], v[188:189]
    v_pk_mul_f32 v[174:175], v[174:175], v[190:191]
    v_cvt_pk_bf16_f32 v44, v172, v173
    v_cvt_pk_bf16_f32 v45, v174, v175
    v_pk_mul_f32 v[204:205], v[204:205], v[220:221]
    v_pk_mul_f32 v[206:207], v[206:207], v[222:223]
    v_cvt_pk_bf16_f32 v46, v204, v205
    v_cvt_pk_bf16_f32 v47, v206, v207
    buffer_store_dwordx4 v[44:47], v2, s[16:19], s51 offen offset:1024
    s_branch FKE_hd0
FKE_hs0:
    s_lshl_b32 s45, s40, 4
    s_lshl_b32 s46, s3, 2
    s_add_u32 s45, s45, s46
    s_mul_i32 s50, s45, 147456
    s_mul_i32 s46, s41, 18432
    s_add_u32 s50, s50, s46
    s_lshl_b32 s46, s42, 11
    s_add_u32 s51, s50, s46
    v_lshlrev_b32 v2, 4, v0
    v_pk_mul_f32 v[96:97], v[96:97], v[112:113]
    v_pk_mul_f32 v[98:99], v[98:99], v[114:115]
    v_cvt_pk_bf16_f32 v40, v96, v97
    v_cvt_pk_bf16_f32 v41, v98, v99
    v_pk_mul_f32 v[128:129], v[128:129], v[144:145]
    v_pk_mul_f32 v[130:131], v[130:131], v[146:147]
    v_cvt_pk_bf16_f32 v42, v128, v129
    v_cvt_pk_bf16_f32 v43, v130, v131
    buffer_store_dwordx4 v[40:43], v2, s[16:19], s51 offen offset:0 sc1
    v_pk_mul_f32 v[160:161], v[160:161], v[176:177]
    v_pk_mul_f32 v[162:163], v[162:163], v[178:179]
    v_cvt_pk_bf16_f32 v44, v160, v161
    v_cvt_pk_bf16_f32 v45, v162, v163
    v_pk_mul_f32 v[192:193], v[192:193], v[208:209]
    v_pk_mul_f32 v[194:195], v[194:195], v[210:211]
    v_cvt_pk_bf16_f32 v46, v192, v193
    v_cvt_pk_bf16_f32 v47, v194, v195
    buffer_store_dwordx4 v[44:47], v2, s[16:19], s51 offen offset:1024 sc1
    s_add_u32 s51, s51, 147456
    v_pk_mul_f32 v[100:101], v[100:101], v[116:117]
    v_pk_mul_f32 v[102:103], v[102:103], v[118:119]
    v_cvt_pk_bf16_f32 v40, v100, v101
    v_cvt_pk_bf16_f32 v41, v102, v103
    v_pk_mul_f32 v[132:133], v[132:133], v[148:149]
    v_pk_mul_f32 v[134:135], v[134:135], v[150:151]
    v_cvt_pk_bf16_f32 v42, v132, v133
    v_cvt_pk_bf16_f32 v43, v134, v135
    buffer_store_dwordx4 v[40:43], v2, s[16:19], s51 offen offset:0 sc1
    v_pk_mul_f32 v[164:165], v[164:165], v[180:181]
    v_pk_mul_f32 v[166:167], v[166:167], v[182:183]
    v_cvt_pk_bf16_f32 v44, v164, v165
    v_cvt_pk_bf16_f32 v45, v166, v167
    v_pk_mul_f32 v[196:197], v[196:197], v[212:213]
    v_pk_mul_f32 v[198:199], v[198:199], v[214:215]
    v_cvt_pk_bf16_f32 v46, v196, v197
    v_cvt_pk_bf16_f32 v47, v198, v199
    buffer_store_dwordx4 v[44:47], v2, s[16:19], s51 offen offset:1024 sc1
    s_add_u32 s51, s51, 147456
    v_pk_mul_f32 v[104:105], v[104:105], v[120:121]
    v_pk_mul_f32 v[106:107], v[106:107], v[122:123]
    v_cvt_pk_bf16_f32 v40, v104, v105
    v_cvt_pk_bf16_f32 v41, v106, v107
    v_pk_mul_f32 v[136:137], v[136:137], v[152:153]
    v_pk_mul_f32 v[138:139], v[138:139], v[154:155]
    v_cvt_pk_bf16_f32 v42, v136, v137
    v_cvt_pk_bf16_f32 v43, v138, v139
    buffer_store_dwordx4 v[40:43], v2, s[16:19], s51 offen offset:0 sc1
    v_pk_mul_f32 v[168:169], v[168:169], v[184:185]
    v_pk_mul_f32 v[170:171], v[170:171], v[186:187]
    v_cvt_pk_bf16_f32 v44, v168, v169
    v_cvt_pk_bf16_f32 v45, v170, v171
    v_pk_mul_f32 v[200:201], v[200:201], v[216:217]
    v_pk_mul_f32 v[202:203], v[202:203], v[218:219]
    v_cvt_pk_bf16_f32 v46, v200, v201
    v_cvt_pk_bf16_f32 v47, v202, v203
    buffer_store_dwordx4 v[44:47], v2, s[16:19], s51 offen offset:1024 sc1
    s_add_u32 s51, s51, 147456
    v_pk_mul_f32 v[108:109], v[108:109], v[124:125]
    v_pk_mul_f32 v[110:111], v[110:111], v[126:127]
    v_cvt_pk_bf16_f32 v40, v108, v109
    v_cvt_pk_bf16_f32 v41, v110, v111
    v_pk_mul_f32 v[140:141], v[140:141], v[156:157]
    v_pk_mul_f32 v[142:143], v[142:143], v[158:159]
    v_cvt_pk_bf16_f32 v42, v140, v141
    v_cvt_pk_bf16_f32 v43, v142, v143
    buffer_store_dwordx4 v[40:43], v2, s[16:19], s51 offen offset:0 sc1
    v_pk_mul_f32 v[172:173], v[172:173], v[188:189]
    v_pk_mul_f32 v[174:175], v[174:175], v[190:191]
    v_cvt_pk_bf16_f32 v44, v172, v173
    v_cvt_pk_bf16_f32 v45, v174, v175
    v_pk_mul_f32 v[204:205], v[204:205], v[220:221]
    v_pk_mul_f32 v[206:207], v[206:207], v[222:223]
    v_cvt_pk_bf16_f32 v46, v204, v205
    v_cvt_pk_bf16_f32 v47, v206, v207
    buffer_store_dwordx4 v[44:47], v2, s[16:19], s51 offen offset:1024 sc1
FKE_hd0:
    ds_read_b64_tr_b16 v[48:49], v38 offset:0
    ds_read_b64_tr_b16 v[50:51], v38 offset:2560
    ds_read_b64_tr_b16 v[52:53], v38 offset:5120
    ds_read_b64_tr_b16 v[54:55], v38 offset:7680
    ds_read_b64_tr_b16 v[56:57], v38 offset:32
    ds_read_b64_tr_b16 v[58:59], v38 offset:2592
    s_waitcnt lgkmcnt(4)
    v_mfma_f32_16x16x32_bf16 v[96:99], v[48:51], a[0:3], 0
    ds_read_b64_tr_b16 v[60:61], v38 offset:5152
    v_mfma_f32_16x16x32_bf16 v[100:103], v[48:51], a[4:7], 0
    ds_read_b64_tr_b16 v[62:63], v38 offset:7712
    v_mfma_f32_16x16x32_bf16 v[104:107], v[48:51], a[8:11], 0
    v_mfma_f32_16x16x32_bf16 v[108:111], v[48:51], a[12:15], 0
    s_waitcnt vmcnt(32)
    s_barrier
    s_waitcnt lgkmcnt(4)
    v_mfma_f32_16x16x32_bf16 v[112:115], v[52:55], a[0:3], 0
    ds_read_b64_tr_b16 v[48:49], v38 offset:64
    v_mfma_f32_16x16x32_bf16 v[116:119], v[52:55], a[4:7], 0
    ds_read_b64_tr_b16 v[50:51], v38 offset:2624
    v_mfma_f32_16x16x32_bf16 v[120:123], v[52:55], a[8:11], 0
    s_add_u32 m0, s37, 61440
    v_mfma_f32_16x16x32_bf16 v[124:127], v[52:55], a[12:15], 0
    buffer_load_dwordx4 v22, s[12:15], s32 offen lds
    s_waitcnt lgkmcnt(4)
    v_mfma_f32_16x16x32_bf16 v[128:131], v[56:59], a[0:3], 0
    ds_read_b64_tr_b16 v[52:53], v38 offset:5184
    v_mfma_f32_16x16x32_bf16 v[132:135], v[56:59], a[4:7], 0
    ds_read_b64_tr_b16 v[54:55], v38 offset:7744
    v_mfma_f32_16x16x32_bf16 v[136:139], v[56:59], a[8:11], 0
    s_mov_b32 s28, s72
    s_mov_b32 s29, s73
    v_mfma_f32_16x16x32_bf16 v[140:143], v[56:59], a[12:15], 0
    s_mov_b32 s30, 0x510000
    s_waitcnt lgkmcnt(4)
    v_mfma_f32_16x16x32_bf16 v[144:147], v[60:63], a[0:3], 0
    ds_read_b64_tr_b16 v[56:57], v38 offset:96
    v_mfma_f32_16x16x32_bf16 v[148:151], v[60:63], a[4:7], 0
    ds_read_b64_tr_b16 v[58:59], v38 offset:2656
    v_mfma_f32_16x16x32_bf16 v[152:155], v[60:63], a[8:11], 0
    s_mov_b32 s31, 0x20000
    s_mul_i32 s44, s41, 576
    v_mfma_f32_16x16x32_bf16 v[156:159], v[60:63], a[12:15], 0
    s_lshl_b32 s45, s3, 5
    s_waitcnt lgkmcnt(4)
    v_mfma_f32_16x16x32_bf16 v[160:163], v[48:51], a[0:3], 0
    ds_read_b64_tr_b16 v[60:61], v38 offset:5216
    v_mfma_f32_16x16x32_bf16 v[164:167], v[48:51], a[4:7], 0
    ds_read_b64_tr_b16 v[62:63], v38 offset:7776
    v_mfma_f32_16x16x32_bf16 v[168:171], v[48:51], a[8:11], 0
    s_add_u32 s52, s44, s45
    s_add_u32 s53, s52, 128
    v_mfma_f32_16x16x32_bf16 v[172:175], v[48:51], a[12:15], 0
    s_lshr_b32 s46, s3, 1
    s_waitcnt lgkmcnt(4)
    v_mfma_f32_16x16x32_bf16 v[176:179], v[52:55], a[0:3], 0
    ds_read_b64_tr_b16 v[48:49], v38 offset:128
    v_mfma_f32_16x16x32_bf16 v[180:183], v[52:55], a[4:7], 0
    ds_read_b64_tr_b16 v[50:51], v38 offset:2688
    v_mfma_f32_16x16x32_bf16 v[184:187], v[52:55], a[8:11], 0
    s_mul_i32 s46, s46, 80
    s_and_b32 s47, s3, 1
    v_mfma_f32_16x16x32_bf16 v[188:191], v[52:55], a[12:15], 0
    s_lshl_b32 s47, s47, 5
    s_waitcnt lgkmcnt(4)
    v_mfma_f32_16x16x32_bf16 v[192:195], v[56:59], a[0:3], 0
    ds_read_b64_tr_b16 v[52:53], v38 offset:5248
    v_mfma_f32_16x16x32_bf16 v[196:199], v[56:59], a[4:7], 0
    ds_read_b64_tr_b16 v[54:55], v38 offset:7808
    v_mfma_f32_16x16x32_bf16 v[200:203], v[56:59], a[8:11], 0
    s_add_u32 m0, s37, 62464
    v_mfma_f32_16x16x32_bf16 v[204:207], v[56:59], a[12:15], 0
    buffer_load_dwordx4 v23, s[12:15], s32 offen lds
    s_waitcnt lgkmcnt(4)
    v_mfma_f32_16x16x32_bf16 v[208:211], v[60:63], a[0:3], 0
    ds_read_b64_tr_b16 v[56:57], v38 offset:10240
    v_mfma_f32_16x16x32_bf16 v[212:215], v[60:63], a[4:7], 0
    ds_read_b64_tr_b16 v[58:59], v38 offset:12800
    v_mfma_f32_16x16x32_bf16 v[216:219], v[60:63], a[8:11], 0
    s_add_u32 s54, s44, s46
    s_add_u32 s54, s54, s47
    v_mfma_f32_16x16x32_bf16 v[220:223], v[60:63], a[12:15], 0
    s_add_u32 s54, s54, 256
    s_waitcnt lgkmcnt(4)
    v_mfma_f32_16x16x32_bf16 v[224:227], v[48:51], a[0:3], 0
    ds_read_b64_tr_b16 v[60:61], v38 offset:15360
    v_mfma_f32_16x16x32_bf16 v[228:231], v[48:51], a[4:7], 0
    ds_read_b64_tr_b16 v[62:63], v38 offset:17920
    v_mfma_f32_16x16x32_bf16 v[232:235], v[48:51], a[8:11], 0
    s_add_u32 s55, s54, 160
    s_mul_i32 s46, s3, 160
    v_mfma_f32_16x16x32_bf16 v[236:239], v[48:51], a[12:15], 0
    s_add_u32 s56, s44, s46
    s_waitcnt lgkmcnt(4)
    v_mfma_f32_16x16x32_bf16 v[240:243], v[52:55], a[0:3], 0
    ds_read_b64_tr_b16 v[48:49], v38 offset:10272
    v_mfma_f32_16x16x32_bf16 v[244:247], v[52:55], a[4:7], 0
    ds_read_b64_tr_b16 v[50:51], v38 offset:12832
    v_mfma_f32_16x16x32_bf16 v[248:251], v[52:55], a[8:11], 0
    s_add_u32 s56, s56, 320
    s_mul_i32 s52, s52, 1152
    v_mfma_f32_16x16x32_bf16 v[252:255], v[52:55], a[12:15], 0
    s_mul_i32 s53, s53, 1152
    s_waitcnt lgkmcnt(4)
    v_mfma_f32_16x16x32_bf16 v[96:99], v[56:59], a[16:19], v[96:99]
    ds_read_b64_tr_b16 v[52:53], v38 offset:15392
    v_mfma_f32_16x16x32_bf16 v[100:103], v[56:59], a[20:23], v[100:103]
    ds_read_b64_tr_b16 v[54:55], v38 offset:17952
    v_mfma_f32_16x16x32_bf16 v[104:107], v[56:59], a[24:27], v[104:107]
    s_mul_i32 s54, s54, 1152
    s_mul_i32 s55, s55, 1152
    v_mfma_f32_16x16x32_bf16 v[108:111], v[56:59], a[28:31], v[108:111]
    s_mul_i32 s56, s56, 1152
    s_waitcnt lgkmcnt(4)
    v_mfma_f32_16x16x32_bf16 v[112:115], v[60:63], a[16:19], v[112:115]
    ds_read_b64_tr_b16 v[56:57], v38 offset:10304
    v_mfma_f32_16x16x32_bf16 v[116:119], v[60:63], a[20:23], v[116:119]
    ds_read_b64_tr_b16 v[58:59], v38 offset:12864
    v_mfma_f32_16x16x32_bf16 v[120:123], v[60:63], a[24:27], v[120:123]
    s_mul_i32 s57, s42, 160
    s_add_u32 s57, s57, 512
    v_mfma_f32_16x16x32_bf16 v[124:127], v[60:63], a[28:31], v[124:127]
    s_lshl_b32 s58, s42, 7
    s_waitcnt lgkmcnt(4)
    v_mfma_f32_16x16x32_bf16 v[128:131], v[48:51], a[16:19], v[128:131]
    ds_read_b64_tr_b16 v[60:61], v38 offset:15424
    v_mfma_f32_16x16x32_bf16 v[132:135], v[48:51], a[20:23], v[132:135]
    ds_read_b64_tr_b16 v[62:63], v38 offset:17984
    v_mfma_f32_16x16x32_bf16 v[136:139], v[48:51], a[24:27], v[136:139]
    v_add_u32 v2, 0, v0
    v_mul_u32_u24 v3, 6554, v2
    v_mfma_f32_16x16x32_bf16 v[140:143], v[48:51], a[28:31], v[140:143]
    v_lshrrev_b32 v3, 16, v3
    s_waitcnt lgkmcnt(4)
    v_mfma_f32_16x16x32_bf16 v[144:147], v[52:55], a[16:19], v[144:147]
    ds_read_b64_tr_b16 v[48:49], v38 offset:10336
    v_mfma_f32_16x16x32_bf16 v[148:151], v[52:55], a[20:23], v[148:151]
    ds_read_b64_tr_b16 v[50:51], v38 offset:12896
    v_mfma_f32_16x16x32_bf16 v[152:155], v[52:55], a[24:27], v[152:155]
    s_add_u32 m0, s37, 63488
    v_mfma_f32_16x16x32_bf16 v[156:159], v[52:55], a[28:31], v[156:159]
    buffer_load_dwordx4 v24, s[12:15], s32 offen lds
    s_waitcnt lgkmcnt(4)
    v_mfma_f32_16x16x32_bf16 v[160:163], v[56:59], a[16:19], v[160:163]
    ds_read_b64_tr_b16 v[52:53], v38 offset:15456
    v_mfma_f32_16x16x32_bf16 v[164:167], v[56:59], a[20:23], v[164:167]
    ds_read_b64_tr_b16 v[54:55], v38 offset:18016
    v_mfma_f32_16x16x32_bf16 v[168:171], v[56:59], a[24:27], v[168:171]
    v_mul_u32_u24 v4, 10, v3
    v_sub_u32 v4, v2, v4
    v_mfma_f32_16x16x32_bf16 v[172:175], v[56:59], a[28:31], v[172:175]
    v_mul_u32_u24 v5, 1152, v3
    s_waitcnt lgkmcnt(4)
    v_mfma_f32_16x16x32_bf16 v[176:179], v[60:63], a[16:19], v[176:179]
    ds_read_b64_tr_b16 v[56:57], v38 offset:10368
    v_mfma_f32_16x16x32_bf16 v[180:183], v[60:63], a[20:23], v[180:183]
    ds_read_b64_tr_b16 v[58:59], v38 offset:12928
    v_mfma_f32_16x16x32_bf16 v[184:187], v[60:63], a[24:27], v[184:187]
    v_lshl_add_u32 v10, v4, 4, v5
    v_add_u32 v2, 64, v0
    v_mfma_f32_16x16x32_bf16 v[188:191], v[60:63], a[28:31], v[188:191]
    v_mul_u32_u24 v3, 6554, v2
    s_waitcnt lgkmcnt(4)
    v_mfma_f32_16x16x32_bf16 v[192:195], v[48:51], a[16:19], v[192:195]
    ds_read_b64_tr_b16 v[60:61], v38 offset:15488
    v_mfma_f32_16x16x32_bf16 v[196:199], v[48:51], a[20:23], v[196:199]
    ds_read_b64_tr_b16 v[62:63], v38 offset:18048
    v_mfma_f32_16x16x32_bf16 v[200:203], v[48:51], a[24:27], v[200:203]
    v_lshrrev_b32 v3, 16, v3
    v_mul_u32_u24 v4, 10, v3
    v_mfma_f32_16x16x32_bf16 v[204:207], v[48:51], a[28:31], v[204:207]
    v_sub_u32 v4, v2, v4
    s_waitcnt lgkmcnt(4)
    v_mfma_f32_16x16x32_bf16 v[208:211], v[52:55], a[16:19], v[208:211]
    ds_read_b64_tr_b16 v[48:49], v38 offset:20480
    v_mfma_f32_16x16x32_bf16 v[212:215], v[52:55], a[20:23], v[212:215]
    ds_read_b64_tr_b16 v[50:51], v38 offset:23040
    v_mfma_f32_16x16x32_bf16 v[216:219], v[52:55], a[24:27], v[216:219]
    v_mul_u32_u24 v5, 1152, v3
    v_lshl_add_u32 v11, v4, 4, v5
    v_mfma_f32_16x16x32_bf16 v[220:223], v[52:55], a[28:31], v[220:223]
    v_add_u32 v2, 128, v0
    s_waitcnt lgkmcnt(4)
    v_mfma_f32_16x16x32_bf16 v[224:227], v[56:59], a[16:19], v[224:227]
    ds_read_b64_tr_b16 v[52:53], v38 offset:25600
    v_mfma_f32_16x16x32_bf16 v[228:231], v[56:59], a[20:23], v[228:231]
    ds_read_b64_tr_b16 v[54:55], v38 offset:28160
    v_mfma_f32_16x16x32_bf16 v[232:235], v[56:59], a[24:27], v[232:235]
    s_add_u32 m0, s37, 64512
    v_mfma_f32_16x16x32_bf16 v[236:239], v[56:59], a[28:31], v[236:239]
    buffer_load_dwordx4 v25, s[12:15], s32 offen lds
    s_waitcnt lgkmcnt(4)
    v_mfma_f32_16x16x32_bf16 v[240:243], v[60:63], a[16:19], v[240:243]
    ds_read_b64_tr_b16 v[56:57], v38 offset:20512
    v_mfma_f32_16x16x32_bf16 v[244:247], v[60:63], a[20:23], v[244:247]
    ds_read_b64_tr_b16 v[58:59], v38 offset:23072
    v_mfma_f32_16x16x32_bf16 v[248:251], v[60:63], a[24:27], v[248:251]
    v_mul_u32_u24 v3, 6554, v2
    v_lshrrev_b32 v3, 16, v3
    v_mfma_f32_16x16x32_bf16 v[252:255], v[60:63], a[28:31], v[252:255]
    v_mul_u32_u24 v4, 10, v3
    v_sub_u32 v4, v2, v4
    v_mul_u32_u24 v5, 1152, v3
    v_lshl_add_u32 v12, v4, 4, v5
    v_add_u32 v2, 192, v0
    v_mul_u32_u24 v3, 6554, v2
    v_lshrrev_b32 v3, 16, v3
    v_mul_u32_u24 v4, 10, v3
    v_sub_u32 v4, v2, v4
    v_mul_u32_u24 v5, 1152, v3
    v_lshl_add_u32 v13, v4, 4, v5
    v_add_u32 v2, 256, v0
    v_mul_u32_u24 v3, 6554, v2
    v_lshrrev_b32 v3, 16, v3
    v_mul_u32_u24 v4, 10, v3
    v_sub_u32 v4, v2, v4
    s_add_u32 m0, s37, 65536
    s_nop 0
    buffer_load_dwordx4 v26, s[12:15], s32 offen lds
    s_add_u32 s32, s32, 589824
    v_mul_u32_u24 v5, 1152, v3
    v_lshl_add_u32 v14, v4, 4, v5
    s_mul_i32 s34, s3, 5120
    buffer_load_dword v27, v6, s[12:15], s49 offen
    s_add_u32 s49, s49, 589824
    buffer_load_dword v27, v1, s[92:95], s100 offen
    s_add_u32 s100, s100, 73728
    s_waitcnt lgkmcnt(4)
    v_mfma_f32_16x16x32_bf16 v[96:99], v[48:51], a[32:35], v[96:99]
    ds_read_b64_tr_b16 v[60:61], v38 offset:25632
    v_mfma_f32_16x16x32_bf16 v[100:103], v[48:51], a[36:39], v[100:103]
    ds_read_b64_tr_b16 v[62:63], v38 offset:28192
    v_mfma_f32_16x16x32_bf16 v[104:107], v[48:51], a[40:43], v[104:107]
    v_mfma_f32_16x16x32_bf16 v[108:111], v[48:51], a[44:47], v[108:111]
    s_waitcnt vmcnt(7)
    s_barrier
    s_cmp_eq_u32 s3, 0
    s_cbranch_scc0 FKE_fl1
    s_lshl_b32 s46, s40, 3
    s_add_u32 s46, s46, s41
    s_lshl_b32 s46, s46, 7
    s_lshl_b32 s47, s42, 2
    s_add_u32 s46, s46, s47
    s_add_u32 s46, s46, 20480
    s_lshl_b32 s47, s43, 7
    s_lshl_b32 s51, s40, 2
    s_add_u32 s47, s47, s51
    s_add_u32 s47, s47, 16384
    s_mov_b64 s[6:7], exec
    s_mov_b64 exec, 1
    v_mov_b32 v4, s39
    v_mov_b32 v5, 0
    buffer_store_dword v4, v5, s[76:79], s46 offen sc1
    buffer_store_dword v4, v5, s[76:79], s47 offen sc1
    s_mov_b64 exec, s[6:7]
FKE_fl1:
    s_waitcnt lgkmcnt(4)
    v_mfma_f32_16x16x32_bf16 v[112:115], v[52:55], a[32:35], v[112:115]
    ds_read_b64_tr_b16 v[48:49], v38 offset:20544
    v_mfma_f32_16x16x32_bf16 v[116:119], v[52:55], a[36:39], v[116:119]
    ds_read_b64_tr_b16 v[50:51], v38 offset:23104
    v_mfma_f32_16x16x32_bf16 v[120:123], v[52:55], a[40:43], v[120:123]
    s_add_u32 m0, s37, 0
    v_mfma_f32_16x16x32_bf16 v[124:127], v[52:55], a[44:47], v[124:127]
    buffer_load_dwordx4 v22, s[12:15], s32 offen lds
    s_waitcnt lgkmcnt(4)
    v_mfma_f32_16x16x32_bf16 v[128:131], v[56:59], a[32:35], v[128:131]
    ds_read_b64_tr_b16 v[52:53], v38 offset:25664
    v_mfma_f32_16x16x32_bf16 v[132:135], v[56:59], a[36:39], v[132:135]
    ds_read_b64_tr_b16 v[54:55], v38 offset:28224
    v_mfma_f32_16x16x32_bf16 v[136:139], v[56:59], a[40:43], v[136:139]
    v_mfma_f32_16x16x32_bf16 v[140:143], v[56:59], a[44:47], v[140:143]
    s_waitcnt lgkmcnt(4)
    v_mfma_f32_16x16x32_bf16 v[144:147], v[60:63], a[32:35], v[144:147]
    ds_read_b64_tr_b16 v[56:57], v38 offset:20576
    v_mfma_f32_16x16x32_bf16 v[148:151], v[60:63], a[36:39], v[148:151]
    ds_read_b64_tr_b16 v[58:59], v38 offset:23136
    v_mfma_f32_16x16x32_bf16 v[152:155], v[60:63], a[40:43], v[152:155]
    s_add_u32 m0, s37, 1024
    v_mfma_f32_16x16x32_bf16 v[156:159], v[60:63], a[44:47], v[156:159]
    buffer_load_dwordx4 v23, s[12:15], s32 offen lds
    s_waitcnt lgkmcnt(4)
    v_mfma_f32_16x16x32_bf16 v[160:163], v[48:51], a[32:35], v[160:163]
    ds_read_b64_tr_b16 v[60:61], v38 offset:25696
    v_mfma_f32_16x16x32_bf16 v[164:167], v[48:51], a[36:39], v[164:167]
    ds_read_b64_tr_b16 v[62:63], v38 offset:28256
    v_mfma_f32_16x16x32_bf16 v[168:171], v[48:51], a[40:43], v[168:171]
    v_mfma_f32_16x16x32_bf16 v[172:175], v[48:51], a[44:47], v[172:175]
    s_waitcnt lgkmcnt(4)
    v_mfma_f32_16x16x32_bf16 v[176:179], v[52:55], a[32:35], v[176:179]
    ds_read_b64_tr_b16 v[48:49], v38 offset:20608
    v_mfma_f32_16x16x32_bf16 v[180:183], v[52:55], a[36:39], v[180:183]
    ds_read_b64_tr_b16 v[50:51], v38 offset:23168
    v_mfma_f32_16x16x32_bf16 v[184:187], v[52:55], a[40:43], v[184:187]
    v_mfma_f32_16x16x32_bf16 v[188:191], v[52:55], a[44:47], v[188:191]
    s_waitcnt lgkmcnt(4)
    v_mfma_f32_16x16x32_bf16 v[192:195], v[56:59], a[32:35], v[192:195]
    ds_read_b64_tr_b16 v[52:53], v38 offset:25728
    v_mfma_f32_16x16x32_bf16 v[196:199], v[56:59], a[36:39], v[196:199]
    ds_read_b64_tr_b16 v[54:55], v38 offset:28288
    v_mfma_f32_16x16x32_bf16 v[200:203], v[56:59], a[40:43], v[200:203]
    s_add_u32 m0, s37, 2048
    v_mfma_f32_16x16x32_bf16 v[204:207], v[56:59], a[44:47], v[204:207]
    buffer_load_dwordx4 v24, s[12:15], s32 offen lds
    s_waitcnt lgkmcnt(4)
    v_mfma_f32_16x16x32_bf16 v[208:211], v[60:63], a[32:35], v[208:211]
    ds_read_b64_tr_b16 v[56:57], v38 offset:30720
    v_mfma_f32_16x16x32_bf16 v[212:215], v[60:63], a[36:39], v[212:215]
    ds_read_b64_tr_b16 v[58:59], v38 offset:33280
    v_mfma_f32_16x16x32_bf16 v[216:219], v[60:63], a[40:43], v[216:219]
    v_mfma_f32_16x16x32_bf16 v[220:223], v[60:63], a[44:47], v[220:223]
    s_waitcnt lgkmcnt(4)
    v_mfma_f32_16x16x32_bf16 v[224:227], v[48:51], a[32:35], v[224:227]
    ds_read_b64_tr_b16 v[60:61], v38 offset:35840
    v_mfma_f32_16x16x32_bf16 v[228:231], v[48:51], a[36:39], v[228:231]
    ds_read_b64_tr_b16 v[62:63], v38 offset:38400
    v_mfma_f32_16x16x32_bf16 v[232:235], v[48:51], a[40:43], v[232:235]
    s_add_u32 m0, s37, 3072
    v_mfma_f32_16x16x32_bf16 v[236:239], v[48:51], a[44:47], v[236:239]
    buffer_load_dwordx4 v25, s[12:15], s32 offen lds
    s_waitcnt lgkmcnt(4)
    v_mfma_f32_16x16x32_bf16 v[240:243], v[52:55], a[32:35], v[240:243]
    ds_read_b64_tr_b16 v[48:49], v38 offset:30752
    v_mfma_f32_16x16x32_bf16 v[244:247], v[52:55], a[36:39], v[244:247]
    ds_read_b64_tr_b16 v[50:51], v38 offset:33312
    v_mfma_f32_16x16x32_bf16 v[248:251], v[52:55], a[40:43], v[248:251]
    v_mfma_f32_16x16x32_bf16 v[252:255], v[52:55], a[44:47], v[252:255]
    s_waitcnt lgkmcnt(4)
    v_mfma_f32_16x16x32_bf16 v[96:99], v[56:59], a[48:51], v[96:99]
    ds_read_b64_tr_b16 v[52:53], v38 offset:35872
    v_mfma_f32_16x16x32_bf16 v[100:103], v[56:59], a[52:55], v[100:103]
    ds_read_b64_tr_b16 v[54:55], v38 offset:38432
    v_mfma_f32_16x16x32_bf16 v[104:107], v[56:59], a[56:59], v[104:107]
    v_mfma_f32_16x16x32_bf16 v[108:111], v[56:59], a[60:63], v[108:111]
    s_waitcnt lgkmcnt(4)
    v_mfma_f32_16x16x32_bf16 v[112:115], v[60:63], a[48:51], v[112:115]
    ds_read_b64_tr_b16 v[56:57], v38 offset:30784
    v_mfma_f32_16x16x32_bf16 v[116:119], v[60:63], a[52:55], v[116:119]
    ds_read_b64_tr_b16 v[58:59], v38 offset:33344
    v_mfma_f32_16x16x32_bf16 v[120:123], v[60:63], a[56:59], v[120:123]
    s_add_u32 m0, s37, 4096
    v_mfma_f32_16x16x32_bf16 v[124:127], v[60:63], a[60:63], v[124:127]
    buffer_load_dwordx4 v26, s[12:15], s32 offen lds
    s_waitcnt lgkmcnt(4)
    v_mfma_f32_16x16x32_bf16 v[128:131], v[48:51], a[48:51], v[128:131]
    ds_read_b64_tr_b16 v[60:61], v38 offset:35904
    v_mfma_f32_16x16x32_bf16 v[132:135], v[48:51], a[52:55], v[132:135]
    ds_read_b64_tr_b16 v[62:63], v38 offset:38464
    v_mfma_f32_16x16x32_bf16 v[136:139], v[48:51], a[56:59], v[136:139]
    s_add_u32 s32, s32, 589824
    v_mfma_f32_16x16x32_bf16 v[140:143], v[48:51], a[60:63], v[140:143]
    s_waitcnt lgkmcnt(4)
    v_mfma_f32_16x16x32_bf16 v[144:147], v[52:55], a[48:51], v[144:147]
    ds_read_b64_tr_b16 v[48:49], v38 offset:30816
    v_mfma_f32_16x16x32_bf16 v[148:151], v[52:55], a[52:55], v[148:151]
    ds_read_b64_tr_b16 v[50:51], v38 offset:33376
    v_mfma_f32_16x16x32_bf16 v[152:155], v[52:55], a[56:59], v[152:155]
    buffer_load_dword v27, v6, s[12:15], s49 offen
    s_add_u32 s49, s49, 589824
    v_mfma_f32_16x16x32_bf16 v[156:159], v[52:55], a[60:63], v[156:159]
    s_waitcnt lgkmcnt(4)
    v_mfma_f32_16x16x32_bf16 v[160:163], v[56:59], a[48:51], v[160:163]
    ds_read_b64_tr_b16 v[52:53], v38 offset:35936
    v_mfma_f32_16x16x32_bf16 v[164:167], v[56:59], a[52:55], v[164:167]
    ds_read_b64_tr_b16 v[54:55], v38 offset:38496
    v_mfma_f32_16x16x32_bf16 v[168:171], v[56:59], a[56:59], v[168:171]
    v_mfma_f32_16x16x32_bf16 v[172:175], v[56:59], a[60:63], v[172:175]
    s_waitcnt lgkmcnt(4)
    v_mfma_f32_16x16x32_bf16 v[176:179], v[60:63], a[48:51], v[176:179]
    ds_read_b64_tr_b16 v[56:57], v38 offset:30848
    v_mfma_f32_16x16x32_bf16 v[180:183], v[60:63], a[52:55], v[180:183]
    ds_read_b64_tr_b16 v[58:59], v38 offset:33408
    v_mfma_f32_16x16x32_bf16 v[184:187], v[60:63], a[56:59], v[184:187]
    v_mfma_f32_16x16x32_bf16 v[188:191], v[60:63], a[60:63], v[188:191]
    s_waitcnt lgkmcnt(4)
    v_mfma_f32_16x16x32_bf16 v[192:195], v[48:51], a[48:51], v[192:195]
    ds_read_b64_tr_b16 v[60:61], v38 offset:35968
    v_mfma_f32_16x16x32_bf16 v[196:199], v[48:51], a[52:55], v[196:199]
    ds_read_b64_tr_b16 v[62:63], v38 offset:38528
    v_mfma_f32_16x16x32_bf16 v[200:203], v[48:51], a[56:59], v[200:203]
    buffer_load_dword v27, v1, s[92:95], s100 offen
    s_add_u32 s100, s100, 73728
    v_mfma_f32_16x16x32_bf16 v[204:207], v[48:51], a[60:63], v[204:207]
    s_waitcnt lgkmcnt(4)
    v_mfma_f32_16x16x32_bf16 v[208:211], v[52:55], a[48:51], v[208:211]
    ds_read_b64_tr_b16 v[48:49], v38 offset:40960
    v_mfma_f32_16x16x32_bf16 v[212:215], v[52:55], a[52:55], v[212:215]
    ds_read_b64_tr_b16 v[50:51], v38 offset:43520
    v_mfma_f32_16x16x32_bf16 v[216:219], v[52:55], a[56:59], v[216:219]
    v_mfma_f32_16x16x32_bf16 v[220:223], v[52:55], a[60:63], v[220:223]
    s_waitcnt lgkmcnt(4)
    v_mfma_f32_16x16x32_bf16 v[224:227], v[56:59], a[48:51], v[224:227]
    ds_read_b64_tr_b16 v[52:53], v38 offset:46080
    v_mfma_f32_16x16x32_bf16 v[228:231], v[56:59], a[52:55], v[228:231]
    ds_read_b64_tr_b16 v[54:55], v38 offset:48640
    v_mfma_f32_16x16x32_bf16 v[232:235], v[56:59], a[56:59], v[232:235]
    v_mfma_f32_16x16x32_bf16 v[236:239], v[56:59], a[60:63], v[236:239]
    s_waitcnt lgkmcnt(4)
    v_mfma_f32_16x16x32_bf16 v[240:243], v[60:63], a[48:51], v[240:243]
    ds_read_b64_tr_b16 v[56:57], v38 offset:40992
    v_mfma_f32_16x16x32_bf16 v[244:247], v[60:63], a[52:55], v[244:247]
    ds_read_b64_tr_b16 v[58:59], v38 offset:43552
    v_mfma_f32_16x16x32_bf16 v[248:251], v[60:63], a[56:59], v[248:251]
    v_mfma_f32_16x16x32_bf16 v[252:255], v[60:63], a[60:63], v[252:255]
    s_waitcnt lgkmcnt(4)
    v_mfma_f32_16x16x32_bf16 v[96:99], v[48:51], a[64:67], v[96:99]
    ds_read_b64_tr_b16 v[60:61], v38 offset:46112
    v_mfma_f32_16x16x32_bf16 v[100:103], v[48:51], a[68:71], v[100:103]
    ds_read_b64_tr_b16 v[62:63], v38 offset:48672
    v_mfma_f32_16x16x32_bf16 v[104:107], v[48:51], a[72:75], v[104:107]
    v_mfma_f32_16x16x32_bf16 v[108:111], v[48:51], a[76:79], v[108:111]
    s_waitcnt vmcnt(9)
    s_barrier
    s_waitcnt lgkmcnt(4)
    v_mfma_f32_16x16x32_bf16 v[112:115], v[52:55], a[64:67], v[112:115]
    ds_read_b64_tr_b16 v[48:49], v38 offset:41024
    v_mfma_f32_16x16x32_bf16 v[116:119], v[52:55], a[68:71], v[116:119]
    ds_read_b64_tr_b16 v[50:51], v38 offset:43584
    v_mfma_f32_16x16x32_bf16 v[120:123], v[52:55], a[72:75], v[120:123]
    s_add_u32 m0, s37, 20480
    v_mfma_f32_16x16x32_bf16 v[124:127], v[52:55], a[76:79], v[124:127]
    buffer_load_dwordx4 v22, s[12:15], s32 offen lds
    s_waitcnt lgkmcnt(4)
    v_mfma_f32_16x16x32_bf16 v[128:131], v[56:59], a[64:67], v[128:131]
    ds_read_b64_tr_b16 v[52:53], v38 offset:46144
    v_mfma_f32_16x16x32_bf16 v[132:135], v[56:59], a[68:71], v[132:135]
    ds_read_b64_tr_b16 v[54:55], v38 offset:48704
    v_mfma_f32_16x16x32_bf16 v[136:139], v[56:59], a[72:75], v[136:139]
    v_mfma_f32_16x16x32_bf16 v[140:143], v[56:59], a[76:79], v[140:143]
    s_waitcnt lgkmcnt(4)
    v_mfma_f32_16x16x32_bf16 v[144:147], v[60:63], a[64:67], v[144:147]
    ds_read_b64_tr_b16 v[56:57], v38 offset:41056
    v_mfma_f32_16x16x32_bf16 v[148:151], v[60:63], a[68:71], v[148:151]
    ds_read_b64_tr_b16 v[58:59], v38 offset:43616
    v_mfma_f32_16x16x32_bf16 v[152:155], v[60:63], a[72:75], v[152:155]
    s_add_u32 m0, s37, 21504
    v_mfma_f32_16x16x32_bf16 v[156:159], v[60:63], a[76:79], v[156:159]
    buffer_load_dwordx4 v23, s[12:15], s32 offen lds
    s_waitcnt lgkmcnt(4)
    v_mfma_f32_16x16x32_bf16 v[160:163], v[48:51], a[64:67], v[160:163]
    ds_read_b64_tr_b16 v[60:61], v38 offset:46176
    v_mfma_f32_16x16x32_bf16 v[164:167], v[48:51], a[68:71], v[164:167]
    ds_read_b64_tr_b16 v[62:63], v38 offset:48736
    v_mfma_f32_16x16x32_bf16 v[168:171], v[48:51], a[72:75], v[168:171]
    v_mfma_f32_16x16x32_bf16 v[172:175], v[48:51], a[76:79], v[172:175]
    s_waitcnt lgkmcnt(4)
    v_mfma_f32_16x16x32_bf16 v[176:179], v[52:55], a[64:67], v[176:179]
    ds_read_b64_tr_b16 v[48:49], v38 offset:41088
    v_mfma_f32_16x16x32_bf16 v[180:183], v[52:55], a[68:71], v[180:183]
    ds_read_b64_tr_b16 v[50:51], v38 offset:43648
    v_mfma_f32_16x16x32_bf16 v[184:187], v[52:55], a[72:75], v[184:187]
    v_mfma_f32_16x16x32_bf16 v[188:191], v[52:55], a[76:79], v[188:191]
    s_waitcnt lgkmcnt(4)
    v_mfma_f32_16x16x32_bf16 v[192:195], v[56:59], a[64:67], v[192:195]
    ds_read_b64_tr_b16 v[52:53], v38 offset:46208
    v_mfma_f32_16x16x32_bf16 v[196:199], v[56:59], a[68:71], v[196:199]
    ds_read_b64_tr_b16 v[54:55], v38 offset:48768
    v_mfma_f32_16x16x32_bf16 v[200:203], v[56:59], a[72:75], v[200:203]
    s_add_u32 m0, s37, 22528
    v_mfma_f32_16x16x32_bf16 v[204:207], v[56:59], a[76:79], v[204:207]
    buffer_load_dwordx4 v24, s[12:15], s32 offen lds
    s_waitcnt lgkmcnt(4)
    v_mfma_f32_16x16x32_bf16 v[208:211], v[60:63], a[64:67], v[208:211]
    ds_read_b64_tr_b16 v[56:57], v38 offset:51200
    v_mfma_f32_16x16x32_bf16 v[212:215], v[60:63], a[68:71], v[212:215]
    ds_read_b64_tr_b16 v[58:59], v38 offset:53760
    v_mfma_f32_16x16x32_bf16 v[216:219], v[60:63], a[72:75], v[216:219]
    v_mfma_f32_16x16x32_bf16 v[220:223], v[60:63], a[76:79], v[220:223]
    s_waitcnt lgkmcnt(4)
    v_mfma_f32_16x16x32_bf16 v[224:227], v[48:51], a[64:67], v[224:227]
    ds_read_b64_tr_b16 v[60:61], v38 offset:56320
    v_mfma_f32_16x16x32_bf16 v[228:231], v[48:51], a[68:71], v[228:231]
    ds_read_b64_tr_b16 v[62:63], v38 offset:58880
    v_mfma_f32_16x16x32_bf16 v[232:235], v[48:51], a[72:75], v[232:235]
    s_add_u32 m0, s37, 23552
    v_mfma_f32_16x16x32_bf16 v[236:239], v[48:51], a[76:79], v[236:239]
    buffer_load_dwordx4 v25, s[12:15], s32 offen lds
    s_waitcnt lgkmcnt(4)
    v_mfma_f32_16x16x32_bf16 v[240:243], v[52:55], a[64:67], v[240:243]
    ds_read_b64_tr_b16 v[48:49], v38 offset:51232
    v_mfma_f32_16x16x32_bf16 v[244:247], v[52:55], a[68:71], v[244:247]
    ds_read_b64_tr_b16 v[50:51], v38 offset:53792
    v_mfma_f32_16x16x32_bf16 v[248:251], v[52:55], a[72:75], v[248:251]
    v_mfma_f32_16x16x32_bf16 v[252:255], v[52:55], a[76:79], v[252:255]
    s_waitcnt lgkmcnt(4)
    v_mfma_f32_16x16x32_bf16 v[96:99], v[56:59], a[80:83], v[96:99]
    ds_read_b64_tr_b16 v[52:53], v38 offset:56352
    v_mfma_f32_16x16x32_bf16 v[100:103], v[56:59], a[84:87], v[100:103]
    ds_read_b64_tr_b16 v[54:55], v38 offset:58912
    v_mfma_f32_16x16x32_bf16 v[104:107], v[56:59], a[88:91], v[104:107]
    v_mfma_f32_16x16x32_bf16 v[108:111], v[56:59], a[92:95], v[108:111]
    s_waitcnt lgkmcnt(4)
    v_mfma_f32_16x16x32_bf16 v[112:115], v[60:63], a[80:83], v[112:115]
    ds_read_b64_tr_b16 v[56:57], v38 offset:51264
    v_mfma_f32_16x16x32_bf16 v[116:119], v[60:63], a[84:87], v[116:119]
    ds_read_b64_tr_b16 v[58:59], v38 offset:53824
    v_mfma_f32_16x16x32_bf16 v[120:123], v[60:63], a[88:91], v[120:123]
    s_add_u32 m0, s37, 24576
    v_mfma_f32_16x16x32_bf16 v[124:127], v[60:63], a[92:95], v[124:127]
    buffer_load_dwordx4 v26, s[12:15], s32 offen lds
    s_waitcnt lgkmcnt(4)
    v_mfma_f32_16x16x32_bf16 v[128:131], v[48:51], a[80:83], v[128:131]
    ds_read_b64_tr_b16 v[60:61], v38 offset:56384
    v_mfma_f32_16x16x32_bf16 v[132:135], v[48:51], a[84:87], v[132:135]
    ds_read_b64_tr_b16 v[62:63], v38 offset:58944
    v_mfma_f32_16x16x32_bf16 v[136:139], v[48:51], a[88:91], v[136:139]
    s_add_u32 s32, s32, 589824
    v_mfma_f32_16x16x32_bf16 v[140:143], v[48:51], a[92:95], v[140:143]
    s_waitcnt lgkmcnt(4)
    v_mfma_f32_16x16x32_bf16 v[144:147], v[52:55], a[80:83], v[144:147]
    ds_read_b64_tr_b16 v[48:49], v38 offset:51296
    v_mfma_f32_16x16x32_bf16 v[148:151], v[52:55], a[84:87], v[148:151]
    ds_read_b64_tr_b16 v[50:51], v38 offset:53856
    v_mfma_f32_16x16x32_bf16 v[152:155], v[52:55], a[88:91], v[152:155]
    buffer_load_dword v27, v6, s[12:15], s49 offen
    s_add_u32 s49, s49, 589824
    v_mfma_f32_16x16x32_bf16 v[156:159], v[52:55], a[92:95], v[156:159]
    s_waitcnt lgkmcnt(4)
    v_mfma_f32_16x16x32_bf16 v[160:163], v[56:59], a[80:83], v[160:163]
    ds_read_b64_tr_b16 v[52:53], v38 offset:56416
    v_mfma_f32_16x16x32_bf16 v[164:167], v[56:59], a[84:87], v[164:167]
    ds_read_b64_tr_b16 v[54:55], v38 offset:58976
    v_mfma_f32_16x16x32_bf16 v[168:171], v[56:59], a[88:91], v[168:171]
    v_mfma_f32_16x16x32_bf16 v[172:175], v[56:59], a[92:95], v[172:175]
    s_waitcnt lgkmcnt(4)
    v_mfma_f32_16x16x32_bf16 v[176:179], v[60:63], a[80:83], v[176:179]
    ds_read_b64_tr_b16 v[56:57], v38 offset:51328
    v_mfma_f32_16x16x32_bf16 v[180:183], v[60:63], a[84:87], v[180:183]
    ds_read_b64_tr_b16 v[58:59], v38 offset:53888
    v_mfma_f32_16x16x32_bf16 v[184:187], v[60:63], a[88:91], v[184:187]
    v_mfma_f32_16x16x32_bf16 v[188:191], v[60:63], a[92:95], v[188:191]
    s_waitcnt lgkmcnt(4)
    v_mfma_f32_16x16x32_bf16 v[192:195], v[48:51], a[80:83], v[192:195]
    ds_read_b64_tr_b16 v[60:61], v38 offset:56448
    v_mfma_f32_16x16x32_bf16 v[196:199], v[48:51], a[84:87], v[196:199]
    ds_read_b64_tr_b16 v[62:63], v38 offset:59008
    v_mfma_f32_16x16x32_bf16 v[200:203], v[48:51], a[88:91], v[200:203]
    buffer_load_dword v27, v1, s[92:95], s100 offen
    s_add_u32 s100, s100, 73728
    v_mfma_f32_16x16x32_bf16 v[204:207], v[48:51], a[92:95], v[204:207]
    s_waitcnt lgkmcnt(4)
    v_mfma_f32_16x16x32_bf16 v[208:211], v[52:55], a[80:83], v[208:211]
    ds_read_b64_tr_b16 v[48:49], v39 offset:0
    v_mfma_f32_16x16x32_bf16 v[212:215], v[52:55], a[84:87], v[212:215]
    ds_read_b64_tr_b16 v[50:51], v39 offset:2560
    v_mfma_f32_16x16x32_bf16 v[216:219], v[52:55], a[88:91], v[216:219]
    v_mfma_f32_16x16x32_bf16 v[220:223], v[52:55], a[92:95], v[220:223]
    s_waitcnt lgkmcnt(4)
    v_mfma_f32_16x16x32_bf16 v[224:227], v[56:59], a[80:83], v[224:227]
    ds_read_b64_tr_b16 v[52:53], v39 offset:5120
    v_mfma_f32_16x16x32_bf16 v[228:231], v[56:59], a[84:87], v[228:231]
    ds_read_b64_tr_b16 v[54:55], v39 offset:7680
    v_mfma_f32_16x16x32_bf16 v[232:235], v[56:59], a[88:91], v[232:235]
    v_mfma_f32_16x16x32_bf16 v[236:239], v[56:59], a[92:95], v[236:239]
    s_waitcnt lgkmcnt(4)
    v_mfma_f32_16x16x32_bf16 v[240:243], v[60:63], a[80:83], v[240:243]
    ds_read_b64_tr_b16 v[56:57], v39 offset:32
    v_mfma_f32_16x16x32_bf16 v[244:247], v[60:63], a[84:87], v[244:247]
    ds_read_b64_tr_b16 v[58:59], v39 offset:2592
    v_mfma_f32_16x16x32_bf16 v[248:251], v[60:63], a[88:91], v[248:251]
    v_mfma_f32_16x16x32_bf16 v[252:255], v[60:63], a[92:95], v[252:255]
    s_waitcnt lgkmcnt(4)
    v_mfma_f32_16x16x32_bf16 v[96:99], v[48:51], a[96:99], v[96:99]
    ds_read_b64_tr_b16 v[60:61], v39 offset:5152
    v_mfma_f32_16x16x32_bf16 v[100:103], v[48:51], a[100:103], v[100:103]
    ds_read_b64_tr_b16 v[62:63], v39 offset:7712
    v_mfma_f32_16x16x32_bf16 v[104:107], v[48:51], a[104:107], v[104:107]
    v_mfma_f32_16x16x32_bf16 v[108:111], v[48:51], a[108:111], v[108:111]
    s_waitcnt vmcnt(9)
    s_barrier
    s_waitcnt lgkmcnt(4)
    v_mfma_f32_16x16x32_bf16 v[112:115], v[52:55], a[96:99], v[112:115]
    ds_read_b64_tr_b16 v[48:49], v39 offset:64
    v_mfma_f32_16x16x32_bf16 v[116:119], v[52:55], a[100:103], v[116:119]
    ds_read_b64_tr_b16 v[50:51], v39 offset:2624
    v_mfma_f32_16x16x32_bf16 v[120:123], v[52:55], a[104:107], v[120:123]
    s_add_u32 m0, s37, 40960
    v_mfma_f32_16x16x32_bf16 v[124:127], v[52:55], a[108:111], v[124:127]
    buffer_load_dwordx4 v22, s[12:15], s32 offen lds
    s_waitcnt lgkmcnt(4)
    v_mfma_f32_16x16x32_bf16 v[128:131], v[56:59], a[96:99], v[128:131]
    ds_read_b64_tr_b16 v[52:53], v39 offset:5184
    v_mfma_f32_16x16x32_bf16 v[132:135], v[56:59], a[100:103], v[132:135]
    ds_read_b64_tr_b16 v[54:55], v39 offset:7744
    v_mfma_f32_16x16x32_bf16 v[136:139], v[56:59], a[104:107], v[136:139]
    v_mfma_f32_16x16x32_bf16 v[140:143], v[56:59], a[108:111], v[140:143]
    s_waitcnt lgkmcnt(4)
    v_mfma_f32_16x16x32_bf16 v[144:147], v[60:63], a[96:99], v[144:147]
    ds_read_b64_tr_b16 v[56:57], v39 offset:96
    v_mfma_f32_16x16x32_bf16 v[148:151], v[60:63], a[100:103], v[148:151]
    ds_read_b64_tr_b16 v[58:59], v39 offset:2656
    v_mfma_f32_16x16x32_bf16 v[152:155], v[60:63], a[104:107], v[152:155]
    s_add_u32 m0, s37, 41984
    v_mfma_f32_16x16x32_bf16 v[156:159], v[60:63], a[108:111], v[156:159]
    buffer_load_dwordx4 v23, s[12:15], s32 offen lds
    s_waitcnt lgkmcnt(4)
    v_mfma_f32_16x16x32_bf16 v[160:163], v[48:51], a[96:99], v[160:163]
    ds_read_b64_tr_b16 v[60:61], v39 offset:5216
    v_mfma_f32_16x16x32_bf16 v[164:167], v[48:51], a[100:103], v[164:167]
    ds_read_b64_tr_b16 v[62:63], v39 offset:7776
    v_mfma_f32_16x16x32_bf16 v[168:171], v[48:51], a[104:107], v[168:171]
    v_mfma_f32_16x16x32_bf16 v[172:175], v[48:51], a[108:111], v[172:175]
    s_waitcnt lgkmcnt(4)
    v_mfma_f32_16x16x32_bf16 v[176:179], v[52:55], a[96:99], v[176:179]
    ds_read_b64_tr_b16 v[48:49], v39 offset:128
    v_mfma_f32_16x16x32_bf16 v[180:183], v[52:55], a[100:103], v[180:183]
    ds_read_b64_tr_b16 v[50:51], v39 offset:2688
    v_mfma_f32_16x16x32_bf16 v[184:187], v[52:55], a[104:107], v[184:187]
    v_mfma_f32_16x16x32_bf16 v[188:191], v[52:55], a[108:111], v[188:191]
    s_waitcnt lgkmcnt(4)
    v_mfma_f32_16x16x32_bf16 v[192:195], v[56:59], a[96:99], v[192:195]
    ds_read_b64_tr_b16 v[52:53], v39 offset:5248
    v_mfma_f32_16x16x32_bf16 v[196:199], v[56:59], a[100:103], v[196:199]
    ds_read_b64_tr_b16 v[54:55], v39 offset:7808
    v_mfma_f32_16x16x32_bf16 v[200:203], v[56:59], a[104:107], v[200:203]
    s_add_u32 m0, s37, 43008
    v_mfma_f32_16x16x32_bf16 v[204:207], v[56:59], a[108:111], v[204:207]
    buffer_load_dwordx4 v24, s[12:15], s32 offen lds
    s_waitcnt lgkmcnt(4)
    v_mfma_f32_16x16x32_bf16 v[208:211], v[60:63], a[96:99], v[208:211]
    ds_read_b64_tr_b16 v[56:57], v39 offset:10240
    v_mfma_f32_16x16x32_bf16 v[212:215], v[60:63], a[100:103], v[212:215]
    ds_read_b64_tr_b16 v[58:59], v39 offset:12800
    v_mfma_f32_16x16x32_bf16 v[216:219], v[60:63], a[104:107], v[216:219]
    v_mfma_f32_16x16x32_bf16 v[220:223], v[60:63], a[108:111], v[220:223]
    s_waitcnt lgkmcnt(4)
    v_mfma_f32_16x16x32_bf16 v[224:227], v[48:51], a[96:99], v[224:227]
    ds_read_b64_tr_b16 v[60:61], v39 offset:15360
    v_mfma_f32_16x16x32_bf16 v[228:231], v[48:51], a[100:103], v[228:231]
    ds_read_b64_tr_b16 v[62:63], v39 offset:17920
    v_mfma_f32_16x16x32_bf16 v[232:235], v[48:51], a[104:107], v[232:235]
    s_add_u32 m0, s37, 44032
    v_mfma_f32_16x16x32_bf16 v[236:239], v[48:51], a[108:111], v[236:239]
    buffer_load_dwordx4 v25, s[12:15], s32 offen lds
    s_waitcnt lgkmcnt(4)
    v_mfma_f32_16x16x32_bf16 v[240:243], v[52:55], a[96:99], v[240:243]
    ds_read_b64_tr_b16 v[48:49], v39 offset:10272
    v_mfma_f32_16x16x32_bf16 v[244:247], v[52:55], a[100:103], v[244:247]
    ds_read_b64_tr_b16 v[50:51], v39 offset:12832
    v_mfma_f32_16x16x32_bf16 v[248:251], v[52:55], a[104:107], v[248:251]
    v_mfma_f32_16x16x32_bf16 v[252:255], v[52:55], a[108:111], v[252:255]
    s_waitcnt lgkmcnt(4)
    v_mfma_f32_16x16x32_bf16 v[96:99], v[56:59], a[112:115], v[96:99]
    ds_read_b64_tr_b16 v[52:53], v39 offset:15392
    v_mfma_f32_16x16x32_bf16 v[100:103], v[56:59], a[116:119], v[100:103]
    ds_read_b64_tr_b16 v[54:55], v39 offset:17952
    v_mfma_f32_16x16x32_bf16 v[104:107], v[56:59], a[120:123], v[104:107]
    v_mfma_f32_16x16x32_bf16 v[108:111], v[56:59], a[124:127], v[108:111]
    s_waitcnt lgkmcnt(4)
    v_mfma_f32_16x16x32_bf16 v[112:115], v[60:63], a[112:115], v[112:115]
    ds_read_b64_tr_b16 v[56:57], v39 offset:10304
    v_mfma_f32_16x16x32_bf16 v[116:119], v[60:63], a[116:119], v[116:119]
    ds_read_b64_tr_b16 v[58:59], v39 offset:12864
    v_mfma_f32_16x16x32_bf16 v[120:123], v[60:63], a[120:123], v[120:123]
    s_add_u32 m0, s37, 45056
    v_mfma_f32_16x16x32_bf16 v[124:127], v[60:63], a[124:127], v[124:127]
    buffer_load_dwordx4 v26, s[12:15], s32 offen lds
    s_waitcnt lgkmcnt(4)
    v_mfma_f32_16x16x32_bf16 v[128:131], v[48:51], a[112:115], v[128:131]
    ds_read_b64_tr_b16 v[60:61], v39 offset:15424
    v_mfma_f32_16x16x32_bf16 v[132:135], v[48:51], a[116:119], v[132:135]
    ds_read_b64_tr_b16 v[62:63], v39 offset:17984
    v_mfma_f32_16x16x32_bf16 v[136:139], v[48:51], a[120:123], v[136:139]
    s_add_u32 s32, s32, 589824
    v_mfma_f32_16x16x32_bf16 v[140:143], v[48:51], a[124:127], v[140:143]
    s_waitcnt lgkmcnt(4)
    v_mfma_f32_16x16x32_bf16 v[144:147], v[52:55], a[112:115], v[144:147]
    ds_read_b64_tr_b16 v[48:49], v39 offset:10336
    v_mfma_f32_16x16x32_bf16 v[148:151], v[52:55], a[116:119], v[148:151]
    ds_read_b64_tr_b16 v[50:51], v39 offset:12896
    v_mfma_f32_16x16x32_bf16 v[152:155], v[52:55], a[120:123], v[152:155]
    buffer_load_dword v27, v6, s[12:15], s49 offen
    s_add_u32 s49, s49, 589824
    v_mfma_f32_16x16x32_bf16 v[156:159], v[52:55], a[124:127], v[156:159]
    s_waitcnt lgkmcnt(4)
    v_mfma_f32_16x16x32_bf16 v[160:163], v[56:59], a[112:115], v[160:163]
    ds_read_b64_tr_b16 v[52:53], v39 offset:15456
    v_mfma_f32_16x16x32_bf16 v[164:167], v[56:59], a[116:119], v[164:167]
    ds_read_b64_tr_b16 v[54:55], v39 offset:18016
    v_mfma_f32_16x16x32_bf16 v[168:171], v[56:59], a[120:123], v[168:171]
    v_mfma_f32_16x16x32_bf16 v[172:175], v[56:59], a[124:127], v[172:175]
    s_waitcnt lgkmcnt(4)
    v_mfma_f32_16x16x32_bf16 v[176:179], v[60:63], a[112:115], v[176:179]
    ds_read_b64_tr_b16 v[56:57], v39 offset:10368
    v_mfma_f32_16x16x32_bf16 v[180:183], v[60:63], a[116:119], v[180:183]
    ds_read_b64_tr_b16 v[58:59], v39 offset:12928
    v_mfma_f32_16x16x32_bf16 v[184:187], v[60:63], a[120:123], v[184:187]
    v_mfma_f32_16x16x32_bf16 v[188:191], v[60:63], a[124:127], v[188:191]
    s_waitcnt lgkmcnt(4)
    v_mfma_f32_16x16x32_bf16 v[192:195], v[48:51], a[112:115], v[192:195]
    ds_read_b64_tr_b16 v[60:61], v39 offset:15488
    v_mfma_f32_16x16x32_bf16 v[196:199], v[48:51], a[116:119], v[196:199]
    ds_read_b64_tr_b16 v[62:63], v39 offset:18048
    v_mfma_f32_16x16x32_bf16 v[200:203], v[48:51], a[120:123], v[200:203]
    buffer_load_dword v27, v1, s[92:95], s100 offen
    s_add_u32 s100, s100, 73728
    v_mfma_f32_16x16x32_bf16 v[204:207], v[48:51], a[124:127], v[204:207]
    s_waitcnt lgkmcnt(4)
    v_mfma_f32_16x16x32_bf16 v[208:211], v[52:55], a[112:115], v[208:211]
    ds_read_b64_tr_b16 v[48:49], v38 offset:0
    v_mfma_f32_16x16x32_bf16 v[212:215], v[52:55], a[116:119], v[212:215]
    ds_read_b64_tr_b16 v[50:51], v38 offset:2560
    v_mfma_f32_16x16x32_bf16 v[216:219], v[52:55], a[120:123], v[216:219]
    v_mfma_f32_16x16x32_bf16 v[220:223], v[52:55], a[124:127], v[220:223]
    s_waitcnt lgkmcnt(4)
    v_mfma_f32_16x16x32_bf16 v[224:227], v[56:59], a[112:115], v[224:227]
    ds_read_b64_tr_b16 v[52:53], v38 offset:5120
    v_mfma_f32_16x16x32_bf16 v[228:231], v[56:59], a[116:119], v[228:231]
    ds_read_b64_tr_b16 v[54:55], v38 offset:7680
    v_mfma_f32_16x16x32_bf16 v[232:235], v[56:59], a[120:123], v[232:235]
    v_mfma_f32_16x16x32_bf16 v[236:239], v[56:59], a[124:127], v[236:239]
    s_waitcnt lgkmcnt(4)
    v_mfma_f32_16x16x32_bf16 v[240:243], v[60:63], a[112:115], v[240:243]
    ds_read_b64_tr_b16 v[56:57], v38 offset:32
    v_mfma_f32_16x16x32_bf16 v[244:247], v[60:63], a[116:119], v[244:247]
    ds_read_b64_tr_b16 v[58:59], v38 offset:2592
    v_mfma_f32_16x16x32_bf16 v[248:251], v[60:63], a[120:123], v[248:251]
    v_mfma_f32_16x16x32_bf16 v[252:255], v[60:63], a[124:127], v[252:255]
    s_waitcnt lgkmcnt(4)
    v_mfma_f32_16x16x32_bf16 v[96:99], v[48:51], a[128:131], v[96:99]
    ds_read_b64_tr_b16 v[60:61], v38 offset:5152
    v_mfma_f32_16x16x32_bf16 v[100:103], v[48:51], a[132:135], v[100:103]
    ds_read_b64_tr_b16 v[62:63], v38 offset:7712
    v_mfma_f32_16x16x32_bf16 v[104:107], v[48:51], a[136:139], v[104:107]
    v_mfma_f32_16x16x32_bf16 v[108:111], v[48:51], a[140:143], v[108:111]
    s_waitcnt vmcnt(9)
    s_barrier
    s_waitcnt lgkmcnt(4)
    v_mfma_f32_16x16x32_bf16 v[112:115], v[52:55], a[128:131], v[112:115]
    ds_read_b64_tr_b16 v[48:49], v38 offset:64
    v_mfma_f32_16x16x32_bf16 v[116:119], v[52:55], a[132:135], v[116:119]
    ds_read_b64_tr_b16 v[50:51], v38 offset:2624
    v_mfma_f32_16x16x32_bf16 v[120:123], v[52:55], a[136:139], v[120:123]
    s_add_u32 m0, s37, 61440
    v_mfma_f32_16x16x32_bf16 v[124:127], v[52:55], a[140:143], v[124:127]
    buffer_load_dwordx4 v22, s[12:15], s32 offen lds
    s_waitcnt lgkmcnt(4)
    v_mfma_f32_16x16x32_bf16 v[128:131], v[56:59], a[128:131], v[128:131]
    ds_read_b64_tr_b16 v[52:53], v38 offset:5184
    v_mfma_f32_16x16x32_bf16 v[132:135], v[56:59], a[132:135], v[132:135]
    ds_read_b64_tr_b16 v[54:55], v38 offset:7744
    v_mfma_f32_16x16x32_bf16 v[136:139], v[56:59], a[136:139], v[136:139]
    v_mfma_f32_16x16x32_bf16 v[140:143], v[56:59], a[140:143], v[140:143]
    s_waitcnt lgkmcnt(4)
    v_mfma_f32_16x16x32_bf16 v[144:147], v[60:63], a[128:131], v[144:147]
    ds_read_b64_tr_b16 v[56:57], v38 offset:96
    v_mfma_f32_16x16x32_bf16 v[148:151], v[60:63], a[132:135], v[148:151]
    ds_read_b64_tr_b16 v[58:59], v38 offset:2656
    v_mfma_f32_16x16x32_bf16 v[152:155], v[60:63], a[136:139], v[152:155]
    v_mfma_f32_16x16x32_bf16 v[156:159], v[60:63], a[140:143], v[156:159]
    s_waitcnt lgkmcnt(4)
    v_mfma_f32_16x16x32_bf16 v[160:163], v[48:51], a[128:131], v[160:163]
    ds_read_b64_tr_b16 v[60:61], v38 offset:5216
    v_mfma_f32_16x16x32_bf16 v[164:167], v[48:51], a[132:135], v[164:167]
    ds_read_b64_tr_b16 v[62:63], v38 offset:7776
    v_mfma_f32_16x16x32_bf16 v[168:171], v[48:51], a[136:139], v[168:171]
    s_add_u32 m0, s37, 62464
    v_mfma_f32_16x16x32_bf16 v[172:175], v[48:51], a[140:143], v[172:175]
    buffer_load_dwordx4 v23, s[12:15], s32 offen lds
    s_waitcnt lgkmcnt(4)
    v_mfma_f32_16x16x32_bf16 v[176:179], v[52:55], a[128:131], v[176:179]
    ds_read_b64_tr_b16 v[48:49], v38 offset:128
    v_mfma_f32_16x16x32_bf16 v[180:183], v[52:55], a[132:135], v[180:183]
    ds_read_b64_tr_b16 v[50:51], v38 offset:2688
    v_mfma_f32_16x16x32_bf16 v[184:187], v[52:55], a[136:139], v[184:187]
    v_mfma_f32_16x16x32_bf16 v[188:191], v[52:55], a[140:143], v[188:191]
    s_waitcnt lgkmcnt(4)
    v_mfma_f32_16x16x32_bf16 v[192:195], v[56:59], a[128:131], v[192:195]
    ds_read_b64_tr_b16 v[52:53], v38 offset:5248
    v_mfma_f32_16x16x32_bf16 v[196:199], v[56:59], a[132:135], v[196:199]
    ds_read_b64_tr_b16 v[54:55], v38 offset:7808
    v_mfma_f32_16x16x32_bf16 v[200:203], v[56:59], a[136:139], v[200:203]
    v_mfma_f32_16x16x32_bf16 v[204:207], v[56:59], a[140:143], v[204:207]
    s_waitcnt lgkmcnt(4)
    v_mfma_f32_16x16x32_bf16 v[208:211], v[60:63], a[128:131], v[208:211]
    ds_read_b64_tr_b16 v[56:57], v38 offset:10240
    v_mfma_f32_16x16x32_bf16 v[212:215], v[60:63], a[132:135], v[212:215]
    ds_read_b64_tr_b16 v[58:59], v38 offset:12800
    v_mfma_f32_16x16x32_bf16 v[216:219], v[60:63], a[136:139], v[216:219]
    s_add_u32 m0, s37, 63488
    v_mfma_f32_16x16x32_bf16 v[220:223], v[60:63], a[140:143], v[220:223]
    buffer_load_dwordx4 v24, s[12:15], s32 offen lds
    s_waitcnt lgkmcnt(4)
    v_mfma_f32_16x16x32_bf16 v[224:227], v[48:51], a[128:131], v[224:227]
    ds_read_b64_tr_b16 v[60:61], v38 offset:15360
    v_mfma_f32_16x16x32_bf16 v[228:231], v[48:51], a[132:135], v[228:231]
    ds_read_b64_tr_b16 v[62:63], v38 offset:17920
    v_mfma_f32_16x16x32_bf16 v[232:235], v[48:51], a[136:139], v[232:235]
    v_mfma_f32_16x16x32_bf16 v[236:239], v[48:51], a[140:143], v[236:239]
    s_waitcnt lgkmcnt(4)
    v_mfma_f32_16x16x32_bf16 v[240:243], v[52:55], a[128:131], v[240:243]
    ds_read_b64_tr_b16 v[48:49], v38 offset:10272
    v_mfma_f32_16x16x32_bf16 v[244:247], v[52:55], a[132:135], v[244:247]
    ds_read_b64_tr_b16 v[50:51], v38 offset:12832
    v_mfma_f32_16x16x32_bf16 v[248:251], v[52:55], a[136:139], v[248:251]
    v_mfma_f32_16x16x32_bf16 v[252:255], v[52:55], a[140:143], v[252:255]
    s_waitcnt lgkmcnt(4)
    v_mfma_f32_16x16x32_bf16 v[96:99], v[56:59], a[144:147], v[96:99]
    ds_read_b64_tr_b16 v[52:53], v38 offset:15392
    v_mfma_f32_16x16x32_bf16 v[100:103], v[56:59], a[148:151], v[100:103]
    ds_read_b64_tr_b16 v[54:55], v38 offset:17952
    v_mfma_f32_16x16x32_bf16 v[104:107], v[56:59], a[152:155], v[104:107]
    s_add_u32 m0, s37, 64512
    v_mfma_f32_16x16x32_bf16 v[108:111], v[56:59], a[156:159], v[108:111]
    buffer_load_dwordx4 v25, s[12:15], s32 offen lds
    s_waitcnt lgkmcnt(4)
    v_mfma_f32_16x16x32_bf16 v[112:115], v[60:63], a[144:147], v[112:115]
    ds_read_b64_tr_b16 v[56:57], v38 offset:10304
    v_mfma_f32_16x16x32_bf16 v[116:119], v[60:63], a[148:151], v[116:119]
    ds_read_b64_tr_b16 v[58:59], v38 offset:12864
    v_mfma_f32_16x16x32_bf16 v[120:123], v[60:63], a[152:155], v[120:123]
    v_mfma_f32_16x16x32_bf16 v[124:127], v[60:63], a[156:159], v[124:127]
    s_waitcnt lgkmcnt(4)
    v_mfma_f32_16x16x32_bf16 v[128:131], v[48:51], a[144:147], v[128:131]
    ds_read_b64_tr_b16 v[60:61], v38 offset:15424
    v_mfma_f32_16x16x32_bf16 v[132:135], v[48:51], a[148:151], v[132:135]
    ds_read_b64_tr_b16 v[62:63], v38 offset:17984
    v_mfma_f32_16x16x32_bf16 v[136:139], v[48:51], a[152:155], v[136:139]
    v_mfma_f32_16x16x32_bf16 v[140:143], v[48:51], a[156:159], v[140:143]
    s_waitcnt lgkmcnt(4)
    v_mfma_f32_16x16x32_bf16 v[144:147], v[52:55], a[144:147], v[144:147]
    ds_read_b64_tr_b16 v[48:49], v38 offset:10336
    v_mfma_f32_16x16x32_bf16 v[148:151], v[52:55], a[148:151], v[148:151]
    ds_read_b64_tr_b16 v[50:51], v38 offset:12896
    v_mfma_f32_16x16x32_bf16 v[152:155], v[52:55], a[152:155], v[152:155]
    s_add_u32 m0, s37, 65536
    v_mfma_f32_16x16x32_bf16 v[156:159], v[52:55], a[156:159], v[156:159]
    buffer_load_dwordx4 v26, s[12:15], s32 offen lds
    s_waitcnt lgkmcnt(4)
    v_mfma_f32_16x16x32_bf16 v[160:163], v[56:59], a[144:147], v[160:163]
    ds_read_b64_tr_b16 v[52:53], v38 offset:15456
    v_mfma_f32_16x16x32_bf16 v[164:167], v[56:59], a[148:151], v[164:167]
    ds_read_b64_tr_b16 v[54:55], v38 offset:18016
    v_mfma_f32_16x16x32_bf16 v[168:171], v[56:59], a[152:155], v[168:171]
    s_add_u32 s32, s32, 589824
    v_mfma_f32_16x16x32_bf16 v[172:175], v[56:59], a[156:159], v[172:175]
    s_waitcnt lgkmcnt(4)
    v_mfma_f32_16x16x32_bf16 v[176:179], v[60:63], a[144:147], v[176:179]
    ds_read_b64_tr_b16 v[56:57], v38 offset:10368
    v_mfma_f32_16x16x32_bf16 v[180:183], v[60:63], a[148:151], v[180:183]
    ds_read_b64_tr_b16 v[58:59], v38 offset:12928
    v_mfma_f32_16x16x32_bf16 v[184:187], v[60:63], a[152:155], v[184:187]
    v_mfma_f32_16x16x32_bf16 v[188:191], v[60:63], a[156:159], v[188:191]
    s_waitcnt lgkmcnt(4)
    v_mfma_f32_16x16x32_bf16 v[192:195], v[48:51], a[144:147], v[192:195]
    ds_read_b64_tr_b16 v[60:61], v38 offset:15488
    v_mfma_f32_16x16x32_bf16 v[196:199], v[48:51], a[148:151], v[196:199]
    ds_read_b64_tr_b16 v[62:63], v38 offset:18048
    v_mfma_f32_16x16x32_bf16 v[200:203], v[48:51], a[152:155], v[200:203]
    buffer_load_dword v27, v1, s[92:95], s100 offen
    s_add_u32 s100, s100, 73728
    v_mfma_f32_16x16x32_bf16 v[204:207], v[48:51], a[156:159], v[204:207]
    s_waitcnt lgkmcnt(4)
    v_mfma_f32_16x16x32_bf16 v[208:211], v[52:55], a[144:147], v[208:211]
    ds_read_b64_tr_b16 v[48:49], v38 offset:20480
    v_mfma_f32_16x16x32_bf16 v[212:215], v[52:55], a[148:151], v[212:215]
    ds_read_b64_tr_b16 v[50:51], v38 offset:23040
    v_mfma_f32_16x16x32_bf16 v[216:219], v[52:55], a[152:155], v[216:219]
    v_mfma_f32_16x16x32_bf16 v[220:223], v[52:55], a[156:159], v[220:223]
    s_waitcnt lgkmcnt(4)
    v_mfma_f32_16x16x32_bf16 v[224:227], v[56:59], a[144:147], v[224:227]
    ds_read_b64_tr_b16 v[52:53], v38 offset:25600
    v_mfma_f32_16x16x32_bf16 v[228:231], v[56:59], a[148:151], v[228:231]
    ds_read_b64_tr_b16 v[54:55], v38 offset:28160
    v_mfma_f32_16x16x32_bf16 v[232:235], v[56:59], a[152:155], v[232:235]
    v_mfma_f32_16x16x32_bf16 v[236:239], v[56:59], a[156:159], v[236:239]
    s_waitcnt lgkmcnt(4)
    v_mfma_f32_16x16x32_bf16 v[240:243], v[60:63], a[144:147], v[240:243]
    ds_read_b64_tr_b16 v[56:57], v38 offset:20512
    v_mfma_f32_16x16x32_bf16 v[244:247], v[60:63], a[148:151], v[244:247]
    ds_read_b64_tr_b16 v[58:59], v38 offset:23072
    v_mfma_f32_16x16x32_bf16 v[248:251], v[60:63], a[152:155], v[248:251]
    v_mfma_f32_16x16x32_bf16 v[252:255], v[60:63], a[156:159], v[252:255]
    s_waitcnt lgkmcnt(4)
    v_mfma_f32_16x16x32_bf16 v[96:99], v[48:51], a[160:163], v[96:99]
    ds_read_b64_tr_b16 v[60:61], v38 offset:25632
    v_mfma_f32_16x16x32_bf16 v[100:103], v[48:51], a[164:167], v[100:103]
    ds_read_b64_tr_b16 v[62:63], v38 offset:28192
    v_mfma_f32_16x16x32_bf16 v[104:107], v[48:51], a[168:171], v[104:107]
    v_mfma_f32_16x16x32_bf16 v[108:111], v[48:51], a[172:175], v[108:111]
    s_waitcnt vmcnt(8)
    s_barrier
    s_waitcnt lgkmcnt(4)
    v_mfma_f32_16x16x32_bf16 v[112:115], v[52:55], a[160:163], v[112:115]
    ds_read_b64_tr_b16 v[48:49], v38 offset:20544
    v_mfma_f32_16x16x32_bf16 v[116:119], v[52:55], a[164:167], v[116:119]
    ds_read_b64_tr_b16 v[50:51], v38 offset:23104
    v_mfma_f32_16x16x32_bf16 v[120:123], v[52:55], a[168:171], v[120:123]
    s_add_u32 m0, s37, 0
    v_mfma_f32_16x16x32_bf16 v[124:127], v[52:55], a[172:175], v[124:127]
    buffer_load_dwordx4 v22, s[12:15], s32 offen lds
    s_waitcnt lgkmcnt(4)
    v_mfma_f32_16x16x32_bf16 v[128:131], v[56:59], a[160:163], v[128:131]
    ds_read_b64_tr_b16 v[52:53], v38 offset:25664
    v_mfma_f32_16x16x32_bf16 v[132:135], v[56:59], a[164:167], v[132:135]
    ds_read_b64_tr_b16 v[54:55], v38 offset:28224
    v_mfma_f32_16x16x32_bf16 v[136:139], v[56:59], a[168:171], v[136:139]
    v_mfma_f32_16x16x32_bf16 v[140:143], v[56:59], a[172:175], v[140:143]
    s_waitcnt lgkmcnt(4)
    v_mfma_f32_16x16x32_bf16 v[144:147], v[60:63], a[160:163], v[144:147]
    ds_read_b64_tr_b16 v[56:57], v38 offset:20576
    v_mfma_f32_16x16x32_bf16 v[148:151], v[60:63], a[164:167], v[148:151]
    ds_read_b64_tr_b16 v[58:59], v38 offset:23136
    v_mfma_f32_16x16x32_bf16 v[152:155], v[60:63], a[168:171], v[152:155]
    v_mfma_f32_16x16x32_bf16 v[156:159], v[60:63], a[172:175], v[156:159]
    s_waitcnt lgkmcnt(4)
    v_mfma_f32_16x16x32_bf16 v[160:163], v[48:51], a[160:163], v[160:163]
    ds_read_b64_tr_b16 v[60:61], v38 offset:25696
    v_mfma_f32_16x16x32_bf16 v[164:167], v[48:51], a[164:167], v[164:167]
    ds_read_b64_tr_b16 v[62:63], v38 offset:28256
    v_mfma_f32_16x16x32_bf16 v[168:171], v[48:51], a[168:171], v[168:171]
    s_add_u32 m0, s37, 1024
    v_mfma_f32_16x16x32_bf16 v[172:175], v[48:51], a[172:175], v[172:175]
    buffer_load_dwordx4 v23, s[12:15], s32 offen lds
    s_waitcnt lgkmcnt(4)
    v_mfma_f32_16x16x32_bf16 v[176:179], v[52:55], a[160:163], v[176:179]
    ds_read_b64_tr_b16 v[48:49], v38 offset:20608
    v_mfma_f32_16x16x32_bf16 v[180:183], v[52:55], a[164:167], v[180:183]
    ds_read_b64_tr_b16 v[50:51], v38 offset:23168
    v_mfma_f32_16x16x32_bf16 v[184:187], v[52:55], a[168:171], v[184:187]
    v_mfma_f32_16x16x32_bf16 v[188:191], v[52:55], a[172:175], v[188:191]
    s_waitcnt lgkmcnt(4)
    v_mfma_f32_16x16x32_bf16 v[192:195], v[56:59], a[160:163], v[192:195]
    ds_read_b64_tr_b16 v[52:53], v38 offset:25728
    v_mfma_f32_16x16x32_bf16 v[196:199], v[56:59], a[164:167], v[196:199]
    ds_read_b64_tr_b16 v[54:55], v38 offset:28288
    v_mfma_f32_16x16x32_bf16 v[200:203], v[56:59], a[168:171], v[200:203]
    v_mfma_f32_16x16x32_bf16 v[204:207], v[56:59], a[172:175], v[204:207]
    s_waitcnt lgkmcnt(4)
    v_mfma_f32_16x16x32_bf16 v[208:211], v[60:63], a[160:163], v[208:211]
    ds_read_b64_tr_b16 v[56:57], v38 offset:30720
    v_mfma_f32_16x16x32_bf16 v[212:215], v[60:63], a[164:167], v[212:215]
    ds_read_b64_tr_b16 v[58:59], v38 offset:33280
    v_mfma_f32_16x16x32_bf16 v[216:219], v[60:63], a[168:171], v[216:219]
    s_add_u32 m0, s37, 2048
    v_mfma_f32_16x16x32_bf16 v[220:223], v[60:63], a[172:175], v[220:223]
    buffer_load_dwordx4 v24, s[12:15], s32 offen lds
    s_waitcnt lgkmcnt(4)
    v_mfma_f32_16x16x32_bf16 v[224:227], v[48:51], a[160:163], v[224:227]
    ds_read_b64_tr_b16 v[60:61], v38 offset:35840
    v_mfma_f32_16x16x32_bf16 v[228:231], v[48:51], a[164:167], v[228:231]
    ds_read_b64_tr_b16 v[62:63], v38 offset:38400
    v_mfma_f32_16x16x32_bf16 v[232:235], v[48:51], a[168:171], v[232:235]
    v_mfma_f32_16x16x32_bf16 v[236:239], v[48:51], a[172:175], v[236:239]
    s_waitcnt lgkmcnt(4)
    v_mfma_f32_16x16x32_bf16 v[240:243], v[52:55], a[160:163], v[240:243]
    ds_read_b64_tr_b16 v[48:49], v38 offset:30752
    v_mfma_f32_16x16x32_bf16 v[244:247], v[52:55], a[164:167], v[244:247]
    ds_read_b64_tr_b16 v[50:51], v38 offset:33312
    v_mfma_f32_16x16x32_bf16 v[248:251], v[52:55], a[168:171], v[248:251]
    v_mfma_f32_16x16x32_bf16 v[252:255], v[52:55], a[172:175], v[252:255]
    s_waitcnt lgkmcnt(4)
    v_mfma_f32_16x16x32_bf16 v[96:99], v[56:59], a[176:179], v[96:99]
    ds_read_b64_tr_b16 v[52:53], v38 offset:35872
    v_mfma_f32_16x16x32_bf16 v[100:103], v[56:59], a[180:183], v[100:103]
    ds_read_b64_tr_b16 v[54:55], v38 offset:38432
    v_mfma_f32_16x16x32_bf16 v[104:107], v[56:59], a[184:187], v[104:107]
    s_add_u32 m0, s37, 3072
    v_mfma_f32_16x16x32_bf16 v[108:111], v[56:59], a[188:191], v[108:111]
    buffer_load_dwordx4 v25, s[12:15], s32 offen lds
    s_waitcnt lgkmcnt(4)
    v_mfma_f32_16x16x32_bf16 v[112:115], v[60:63], a[176:179], v[112:115]
    ds_read_b64_tr_b16 v[56:57], v38 offset:30784
    v_mfma_f32_16x16x32_bf16 v[116:119], v[60:63], a[180:183], v[116:119]
    ds_read_b64_tr_b16 v[58:59], v38 offset:33344
    v_mfma_f32_16x16x32_bf16 v[120:123], v[60:63], a[184:187], v[120:123]
    v_mfma_f32_16x16x32_bf16 v[124:127], v[60:63], a[188:191], v[124:127]
    s_waitcnt lgkmcnt(4)
    v_mfma_f32_16x16x32_bf16 v[128:131], v[48:51], a[176:179], v[128:131]
    ds_read_b64_tr_b16 v[60:61], v38 offset:35904
    v_mfma_f32_16x16x32_bf16 v[132:135], v[48:51], a[180:183], v[132:135]
    ds_read_b64_tr_b16 v[62:63], v38 offset:38464
    v_mfma_f32_16x16x32_bf16 v[136:139], v[48:51], a[184:187], v[136:139]
    v_mfma_f32_16x16x32_bf16 v[140:143], v[48:51], a[188:191], v[140:143]
    s_waitcnt lgkmcnt(4)
    v_mfma_f32_16x16x32_bf16 v[144:147], v[52:55], a[176:179], v[144:147]
    ds_read_b64_tr_b16 v[48:49], v38 offset:30816
    v_mfma_f32_16x16x32_bf16 v[148:151], v[52:55], a[180:183], v[148:151]
    ds_read_b64_tr_b16 v[50:51], v38 offset:33376
    v_mfma_f32_16x16x32_bf16 v[152:155], v[52:55], a[184:187], v[152:155]
    s_add_u32 m0, s37, 4096
    v_mfma_f32_16x16x32_bf16 v[156:159], v[52:55], a[188:191], v[156:159]
    buffer_load_dwordx4 v26, s[12:15], s32 offen lds
    s_waitcnt lgkmcnt(4)
    v_mfma_f32_16x16x32_bf16 v[160:163], v[56:59], a[176:179], v[160:163]
    ds_read_b64_tr_b16 v[52:53], v38 offset:35936
    v_mfma_f32_16x16x32_bf16 v[164:167], v[56:59], a[180:183], v[164:167]
    ds_read_b64_tr_b16 v[54:55], v38 offset:38496
    v_mfma_f32_16x16x32_bf16 v[168:171], v[56:59], a[184:187], v[168:171]
    s_add_u32 s32, s32, 589824
    v_mfma_f32_16x16x32_bf16 v[172:175], v[56:59], a[188:191], v[172:175]
    s_waitcnt lgkmcnt(4)
    v_mfma_f32_16x16x32_bf16 v[176:179], v[60:63], a[176:179], v[176:179]
    ds_read_b64_tr_b16 v[56:57], v38 offset:30848
    v_mfma_f32_16x16x32_bf16 v[180:183], v[60:63], a[180:183], v[180:183]
    ds_read_b64_tr_b16 v[58:59], v38 offset:33408
    v_mfma_f32_16x16x32_bf16 v[184:187], v[60:63], a[184:187], v[184:187]
    v_mfma_f32_16x16x32_bf16 v[188:191], v[60:63], a[188:191], v[188:191]
    s_waitcnt lgkmcnt(4)
    v_mfma_f32_16x16x32_bf16 v[192:195], v[48:51], a[176:179], v[192:195]
    ds_read_b64_tr_b16 v[60:61], v38 offset:35968
    v_mfma_f32_16x16x32_bf16 v[196:199], v[48:51], a[180:183], v[196:199]
    ds_read_b64_tr_b16 v[62:63], v38 offset:38528
    v_mfma_f32_16x16x32_bf16 v[200:203], v[48:51], a[184:187], v[200:203]
    buffer_load_dword v27, v1, s[92:95], s100 offen
    s_add_u32 s100, s100, 73728
    v_mfma_f32_16x16x32_bf16 v[204:207], v[48:51], a[188:191], v[204:207]
    s_waitcnt lgkmcnt(4)
    v_mfma_f32_16x16x32_bf16 v[208:211], v[52:55], a[176:179], v[208:211]
    ds_read_b64_tr_b16 v[48:49], v38 offset:40960
    v_mfma_f32_16x16x32_bf16 v[212:215], v[52:55], a[180:183], v[212:215]
    ds_read_b64_tr_b16 v[50:51], v38 offset:43520
    v_mfma_f32_16x16x32_bf16 v[216:219], v[52:55], a[184:187], v[216:219]
    v_mfma_f32_16x16x32_bf16 v[220:223], v[52:55], a[188:191], v[220:223]
    s_waitcnt lgkmcnt(4)
    v_mfma_f32_16x16x32_bf16 v[224:227], v[56:59], a[176:179], v[224:227]
    ds_read_b64_tr_b16 v[52:53], v38 offset:46080
    v_mfma_f32_16x16x32_bf16 v[228:231], v[56:59], a[180:183], v[228:231]
    ds_read_b64_tr_b16 v[54:55], v38 offset:48640
    v_mfma_f32_16x16x32_bf16 v[232:235], v[56:59], a[184:187], v[232:235]
    v_mfma_f32_16x16x32_bf16 v[236:239], v[56:59], a[188:191], v[236:239]
    s_waitcnt lgkmcnt(4)
    v_mfma_f32_16x16x32_bf16 v[240:243], v[60:63], a[176:179], v[240:243]
    ds_read_b64_tr_b16 v[56:57], v38 offset:40992
    v_mfma_f32_16x16x32_bf16 v[244:247], v[60:63], a[180:183], v[244:247]
    ds_read_b64_tr_b16 v[58:59], v38 offset:43552
    v_mfma_f32_16x16x32_bf16 v[248:251], v[60:63], a[184:187], v[248:251]
    v_mfma_f32_16x16x32_bf16 v[252:255], v[60:63], a[188:191], v[252:255]
    s_waitcnt lgkmcnt(4)
    v_mfma_f32_16x16x32_bf16 v[96:99], v[48:51], a[192:195], v[96:99]
    ds_read_b64_tr_b16 v[60:61], v38 offset:46112
    v_mfma_f32_16x16x32_bf16 v[100:103], v[48:51], a[196:199], v[100:103]
    ds_read_b64_tr_b16 v[62:63], v38 offset:48672
    v_mfma_f32_16x16x32_bf16 v[104:107], v[48:51], a[200:203], v[104:107]
    v_mfma_f32_16x16x32_bf16 v[108:111], v[48:51], a[204:207], v[108:111]
    s_waitcnt vmcnt(7)
    s_barrier
    s_waitcnt lgkmcnt(4)
    v_mfma_f32_16x16x32_bf16 v[112:115], v[52:55], a[192:195], v[112:115]
    ds_read_b64_tr_b16 v[48:49], v38 offset:41024
    v_mfma_f32_16x16x32_bf16 v[116:119], v[52:55], a[196:199], v[116:119]
    ds_read_b64_tr_b16 v[50:51], v38 offset:43584
    v_mfma_f32_16x16x32_bf16 v[120:123], v[52:55], a[200:203], v[120:123]
    s_add_u32 s32, s52, s57
    s_add_u32 m0, s34, 20480
    v_mfma_f32_16x16x32_bf16 v[124:127], v[52:55], a[204:207], v[124:127]
    buffer_load_dwordx4 v10, s[28:31], s32 offen lds
    s_waitcnt lgkmcnt(4)
    v_mfma_f32_16x16x32_bf16 v[128:131], v[56:59], a[192:195], v[128:131]
    ds_read_b64_tr_b16 v[52:53], v38 offset:46144
    v_mfma_f32_16x16x32_bf16 v[132:135], v[56:59], a[196:199], v[132:135]
    ds_read_b64_tr_b16 v[54:55], v38 offset:48704
    v_mfma_f32_16x16x32_bf16 v[136:139], v[56:59], a[200:203], v[136:139]
    v_mfma_f32_16x16x32_bf16 v[140:143], v[56:59], a[204:207], v[140:143]
    s_waitcnt lgkmcnt(4)
    v_mfma_f32_16x16x32_bf16 v[144:147], v[60:63], a[192:195], v[144:147]
    ds_read_b64_tr_b16 v[56:57], v38 offset:41056
    v_mfma_f32_16x16x32_bf16 v[148:151], v[60:63], a[196:199], v[148:151]
    ds_read_b64_tr_b16 v[58:59], v38 offset:43616
    v_mfma_f32_16x16x32_bf16 v[152:155], v[60:63], a[200:203], v[152:155]
    v_mfma_f32_16x16x32_bf16 v[156:159], v[60:63], a[204:207], v[156:159]
    s_waitcnt lgkmcnt(4)
    v_mfma_f32_16x16x32_bf16 v[160:163], v[48:51], a[192:195], v[160:163]
    ds_read_b64_tr_b16 v[60:61], v38 offset:46176
    v_mfma_f32_16x16x32_bf16 v[164:167], v[48:51], a[196:199], v[164:167]
    ds_read_b64_tr_b16 v[62:63], v38 offset:48736
    v_mfma_f32_16x16x32_bf16 v[168:171], v[48:51], a[200:203], v[168:171]
    s_add_u32 m0, s34, 21504
    v_mfma_f32_16x16x32_bf16 v[172:175], v[48:51], a[204:207], v[172:175]
    buffer_load_dwordx4 v11, s[28:31], s32 offen lds
    s_waitcnt lgkmcnt(4)
    v_mfma_f32_16x16x32_bf16 v[176:179], v[52:55], a[192:195], v[176:179]
    ds_read_b64_tr_b16 v[48:49], v38 offset:41088
    v_mfma_f32_16x16x32_bf16 v[180:183], v[52:55], a[196:199], v[180:183]
    ds_read_b64_tr_b16 v[50:51], v38 offset:43648
    v_mfma_f32_16x16x32_bf16 v[184:187], v[52:55], a[200:203], v[184:187]
    v_mfma_f32_16x16x32_bf16 v[188:191], v[52:55], a[204:207], v[188:191]
    s_waitcnt lgkmcnt(4)
    v_mfma_f32_16x16x32_bf16 v[192:195], v[56:59], a[192:195], v[192:195]
    ds_read_b64_tr_b16 v[52:53], v38 offset:46208
    v_mfma_f32_16x16x32_bf16 v[196:199], v[56:59], a[196:199], v[196:199]
    ds_read_b64_tr_b16 v[54:55], v38 offset:48768
    v_mfma_f32_16x16x32_bf16 v[200:203], v[56:59], a[200:203], v[200:203]
    v_mfma_f32_16x16x32_bf16 v[204:207], v[56:59], a[204:207], v[204:207]
    s_waitcnt lgkmcnt(4)
    v_mfma_f32_16x16x32_bf16 v[208:211], v[60:63], a[192:195], v[208:211]
    ds_read_b64_tr_b16 v[56:57], v38 offset:51200
    v_mfma_f32_16x16x32_bf16 v[212:215], v[60:63], a[196:199], v[212:215]
    ds_read_b64_tr_b16 v[58:59], v38 offset:53760
    v_mfma_f32_16x16x32_bf16 v[216:219], v[60:63], a[200:203], v[216:219]
    s_add_u32 m0, s34, 22528
    v_mfma_f32_16x16x32_bf16 v[220:223], v[60:63], a[204:207], v[220:223]
    buffer_load_dwordx4 v12, s[28:31], s32 offen lds
    s_waitcnt lgkmcnt(4)
    v_mfma_f32_16x16x32_bf16 v[224:227], v[48:51], a[192:195], v[224:227]
    ds_read_b64_tr_b16 v[60:61], v38 offset:56320
    v_mfma_f32_16x16x32_bf16 v[228:231], v[48:51], a[196:199], v[228:231]
    ds_read_b64_tr_b16 v[62:63], v38 offset:58880
    v_mfma_f32_16x16x32_bf16 v[232:235], v[48:51], a[200:203], v[232:235]
    v_mfma_f32_16x16x32_bf16 v[236:239], v[48:51], a[204:207], v[236:239]
    s_waitcnt lgkmcnt(4)
    v_mfma_f32_16x16x32_bf16 v[240:243], v[52:55], a[192:195], v[240:243]
    ds_read_b64_tr_b16 v[48:49], v38 offset:51232
    v_mfma_f32_16x16x32_bf16 v[244:247], v[52:55], a[196:199], v[244:247]
    ds_read_b64_tr_b16 v[50:51], v38 offset:53792
    v_mfma_f32_16x16x32_bf16 v[248:251], v[52:55], a[200:203], v[248:251]
    v_mfma_f32_16x16x32_bf16 v[252:255], v[52:55], a[204:207], v[252:255]
    s_waitcnt lgkmcnt(4)
    v_mfma_f32_16x16x32_bf16 v[96:99], v[56:59], a[208:211], v[96:99]
    ds_read_b64_tr_b16 v[52:53], v38 offset:56352
    v_mfma_f32_16x16x32_bf16 v[100:103], v[56:59], a[212:215], v[100:103]
    ds_read_b64_tr_b16 v[54:55], v38 offset:58912
    v_mfma_f32_16x16x32_bf16 v[104:107], v[56:59], a[216:219], v[104:107]
    s_add_u32 m0, s34, 23552
    v_mfma_f32_16x16x32_bf16 v[108:111], v[56:59], a[220:223], v[108:111]
    buffer_load_dwordx4 v13, s[28:31], s32 offen lds
    s_waitcnt lgkmcnt(4)
    v_mfma_f32_16x16x32_bf16 v[112:115], v[60:63], a[208:211], v[112:115]
    ds_read_b64_tr_b16 v[56:57], v38 offset:51264
    v_mfma_f32_16x16x32_bf16 v[116:119], v[60:63], a[212:215], v[116:119]
    ds_read_b64_tr_b16 v[58:59], v38 offset:53824
    v_mfma_f32_16x16x32_bf16 v[120:123], v[60:63], a[216:219], v[120:123]
    v_mfma_f32_16x16x32_bf16 v[124:127], v[60:63], a[220:223], v[124:127]
    s_waitcnt lgkmcnt(4)
    v_mfma_f32_16x16x32_bf16 v[128:131], v[48:51], a[208:211], v[128:131]
    ds_read_b64_tr_b16 v[60:61], v38 offset:56384
    v_mfma_f32_16x16x32_bf16 v[132:135], v[48:51], a[212:215], v[132:135]
    ds_read_b64_tr_b16 v[62:63], v38 offset:58944
    v_mfma_f32_16x16x32_bf16 v[136:139], v[48:51], a[216:219], v[136:139]
    v_mfma_f32_16x16x32_bf16 v[140:143], v[48:51], a[220:223], v[140:143]
    s_waitcnt lgkmcnt(4)
    v_mfma_f32_16x16x32_bf16 v[144:147], v[52:55], a[208:211], v[144:147]
    ds_read_b64_tr_b16 v[48:49], v38 offset:51296
    v_mfma_f32_16x16x32_bf16 v[148:151], v[52:55], a[212:215], v[148:151]
    ds_read_b64_tr_b16 v[50:51], v38 offset:53856
    v_mfma_f32_16x16x32_bf16 v[152:155], v[52:55], a[216:219], v[152:155]
    s_add_u32 m0, s34, 24576
    v_mfma_f32_16x16x32_bf16 v[156:159], v[52:55], a[220:223], v[156:159]
    buffer_load_dwordx4 v14, s[28:31], s32 offen lds
    s_waitcnt lgkmcnt(4)
    v_mfma_f32_16x16x32_bf16 v[160:163], v[56:59], a[208:211], v[160:163]
    ds_read_b64_tr_b16 v[52:53], v38 offset:56416
    v_mfma_f32_16x16x32_bf16 v[164:167], v[56:59], a[212:215], v[164:167]
    ds_read_b64_tr_b16 v[54:55], v38 offset:58976
    v_mfma_f32_16x16x32_bf16 v[168:171], v[56:59], a[216:219], v[168:171]
    v_mfma_f32_16x16x32_bf16 v[172:175], v[56:59], a[220:223], v[172:175]
    s_waitcnt lgkmcnt(4)
    v_mfma_f32_16x16x32_bf16 v[176:179], v[60:63], a[208:211], v[176:179]
    ds_read_b64_tr_b16 v[56:57], v38 offset:51328
    v_mfma_f32_16x16x32_bf16 v[180:183], v[60:63], a[212:215], v[180:183]
    ds_read_b64_tr_b16 v[58:59], v38 offset:53888
    v_mfma_f32_16x16x32_bf16 v[184:187], v[60:63], a[216:219], v[184:187]
    v_mfma_f32_16x16x32_bf16 v[188:191], v[60:63], a[220:223], v[188:191]
    s_waitcnt lgkmcnt(4)
    v_mfma_f32_16x16x32_bf16 v[192:195], v[48:51], a[208:211], v[192:195]
    ds_read_b64_tr_b16 v[60:61], v38 offset:56448
    v_mfma_f32_16x16x32_bf16 v[196:199], v[48:51], a[212:215], v[196:199]
    ds_read_b64_tr_b16 v[62:63], v38 offset:59008
    v_mfma_f32_16x16x32_bf16 v[200:203], v[48:51], a[216:219], v[200:203]
    buffer_load_dword v27, v1, s[92:95], s100 offen
    s_add_u32 s100, s100, 73728
    v_mfma_f32_16x16x32_bf16 v[204:207], v[48:51], a[220:223], v[204:207]
    s_waitcnt lgkmcnt(4)
    v_mfma_f32_16x16x32_bf16 v[208:211], v[52:55], a[208:211], v[208:211]
    ds_read_b64_tr_b16 v[48:49], v39 offset:0
    v_mfma_f32_16x16x32_bf16 v[212:215], v[52:55], a[212:215], v[212:215]
    ds_read_b64_tr_b16 v[50:51], v39 offset:2560
    v_mfma_f32_16x16x32_bf16 v[216:219], v[52:55], a[216:219], v[216:219]
    v_mfma_f32_16x16x32_bf16 v[220:223], v[52:55], a[220:223], v[220:223]
    s_waitcnt lgkmcnt(4)
    v_mfma_f32_16x16x32_bf16 v[224:227], v[56:59], a[208:211], v[224:227]
    ds_read_b64_tr_b16 v[52:53], v39 offset:5120
    v_mfma_f32_16x16x32_bf16 v[228:231], v[56:59], a[212:215], v[228:231]
    ds_read_b64_tr_b16 v[54:55], v39 offset:7680
    v_mfma_f32_16x16x32_bf16 v[232:235], v[56:59], a[216:219], v[232:235]
    v_mfma_f32_16x16x32_bf16 v[236:239], v[56:59], a[220:223], v[236:239]
    s_waitcnt lgkmcnt(4)
    v_mfma_f32_16x16x32_bf16 v[240:243], v[60:63], a[208:211], v[240:243]
    ds_read_b64_tr_b16 v[56:57], v39 offset:32
    v_mfma_f32_16x16x32_bf16 v[244:247], v[60:63], a[212:215], v[244:247]
    ds_read_b64_tr_b16 v[58:59], v39 offset:2592
    v_mfma_f32_16x16x32_bf16 v[248:251], v[60:63], a[216:219], v[248:251]
    v_mfma_f32_16x16x32_bf16 v[252:255], v[60:63], a[220:223], v[252:255]
    s_waitcnt lgkmcnt(4)
    v_mfma_f32_16x16x32_bf16 v[96:99], v[48:51], a[224:227], v[96:99]
    ds_read_b64_tr_b16 v[60:61], v39 offset:5152
    v_mfma_f32_16x16x32_bf16 v[100:103], v[48:51], a[228:231], v[100:103]
    ds_read_b64_tr_b16 v[62:63], v39 offset:7712
    v_mfma_f32_16x16x32_bf16 v[104:107], v[48:51], a[232:235], v[104:107]
    v_mfma_f32_16x16x32_bf16 v[108:111], v[48:51], a[236:239], v[108:111]
    s_waitcnt vmcnt(7)
    s_barrier
    s_waitcnt lgkmcnt(4)
    v_mfma_f32_16x16x32_bf16 v[112:115], v[52:55], a[224:227], v[112:115]
    ds_read_b64_tr_b16 v[48:49], v39 offset:64
    v_mfma_f32_16x16x32_bf16 v[116:119], v[52:55], a[228:231], v[116:119]
    ds_read_b64_tr_b16 v[50:51], v39 offset:2624
    v_mfma_f32_16x16x32_bf16 v[120:123], v[52:55], a[232:235], v[120:123]
    s_add_u32 s32, s53, s57
    s_add_u32 m0, s34, 40960
    v_mfma_f32_16x16x32_bf16 v[124:127], v[52:55], a[236:239], v[124:127]
    buffer_load_dwordx4 v10, s[28:31], s32 offen lds
    s_waitcnt lgkmcnt(4)
    v_mfma_f32_16x16x32_bf16 v[128:131], v[56:59], a[224:227], v[128:131]
    ds_read_b64_tr_b16 v[52:53], v39 offset:5184
    v_mfma_f32_16x16x32_bf16 v[132:135], v[56:59], a[228:231], v[132:135]
    ds_read_b64_tr_b16 v[54:55], v39 offset:7744
    v_mfma_f32_16x16x32_bf16 v[136:139], v[56:59], a[232:235], v[136:139]
    v_mfma_f32_16x16x32_bf16 v[140:143], v[56:59], a[236:239], v[140:143]
    s_waitcnt lgkmcnt(4)
    v_mfma_f32_16x16x32_bf16 v[144:147], v[60:63], a[224:227], v[144:147]
    ds_read_b64_tr_b16 v[56:57], v39 offset:96
    v_mfma_f32_16x16x32_bf16 v[148:151], v[60:63], a[228:231], v[148:151]
    ds_read_b64_tr_b16 v[58:59], v39 offset:2656
    v_mfma_f32_16x16x32_bf16 v[152:155], v[60:63], a[232:235], v[152:155]
    v_mfma_f32_16x16x32_bf16 v[156:159], v[60:63], a[236:239], v[156:159]
    s_waitcnt lgkmcnt(4)
    v_mfma_f32_16x16x32_bf16 v[160:163], v[48:51], a[224:227], v[160:163]
    ds_read_b64_tr_b16 v[60:61], v39 offset:5216
    v_mfma_f32_16x16x32_bf16 v[164:167], v[48:51], a[228:231], v[164:167]
    ds_read_b64_tr_b16 v[62:63], v39 offset:7776
    v_mfma_f32_16x16x32_bf16 v[168:171], v[48:51], a[232:235], v[168:171]
    s_add_u32 m0, s34, 41984
    v_mfma_f32_16x16x32_bf16 v[172:175], v[48:51], a[236:239], v[172:175]
    buffer_load_dwordx4 v11, s[28:31], s32 offen lds
    s_waitcnt lgkmcnt(4)
    v_mfma_f32_16x16x32_bf16 v[176:179], v[52:55], a[224:227], v[176:179]
    ds_read_b64_tr_b16 v[48:49], v39 offset:128
    v_mfma_f32_16x16x32_bf16 v[180:183], v[52:55], a[228:231], v[180:183]
    ds_read_b64_tr_b16 v[50:51], v39 offset:2688
    v_mfma_f32_16x16x32_bf16 v[184:187], v[52:55], a[232:235], v[184:187]
    v_mfma_f32_16x16x32_bf16 v[188:191], v[52:55], a[236:239], v[188:191]
    s_waitcnt lgkmcnt(4)
    v_mfma_f32_16x16x32_bf16 v[192:195], v[56:59], a[224:227], v[192:195]
    ds_read_b64_tr_b16 v[52:53], v39 offset:5248
    v_mfma_f32_16x16x32_bf16 v[196:199], v[56:59], a[228:231], v[196:199]
    ds_read_b64_tr_b16 v[54:55], v39 offset:7808
    v_mfma_f32_16x16x32_bf16 v[200:203], v[56:59], a[232:235], v[200:203]
    v_mfma_f32_16x16x32_bf16 v[204:207], v[56:59], a[236:239], v[204:207]
    s_waitcnt lgkmcnt(4)
    v_mfma_f32_16x16x32_bf16 v[208:211], v[60:63], a[224:227], v[208:211]
    ds_read_b64_tr_b16 v[56:57], v39 offset:10240
    v_mfma_f32_16x16x32_bf16 v[212:215], v[60:63], a[228:231], v[212:215]
    ds_read_b64_tr_b16 v[58:59], v39 offset:12800
    v_mfma_f32_16x16x32_bf16 v[216:219], v[60:63], a[232:235], v[216:219]
    s_add_u32 m0, s34, 43008
    v_mfma_f32_16x16x32_bf16 v[220:223], v[60:63], a[236:239], v[220:223]
    buffer_load_dwordx4 v12, s[28:31], s32 offen lds
    s_waitcnt lgkmcnt(4)
    v_mfma_f32_16x16x32_bf16 v[224:227], v[48:51], a[224:227], v[224:227]
    ds_read_b64_tr_b16 v[60:61], v39 offset:15360
    v_mfma_f32_16x16x32_bf16 v[228:231], v[48:51], a[228:231], v[228:231]
    ds_read_b64_tr_b16 v[62:63], v39 offset:17920
    v_mfma_f32_16x16x32_bf16 v[232:235], v[48:51], a[232:235], v[232:235]
    v_mfma_f32_16x16x32_bf16 v[236:239], v[48:51], a[236:239], v[236:239]
    s_waitcnt lgkmcnt(4)
    v_mfma_f32_16x16x32_bf16 v[240:243], v[52:55], a[224:227], v[240:243]
    ds_read_b64_tr_b16 v[48:49], v39 offset:10272
    v_mfma_f32_16x16x32_bf16 v[244:247], v[52:55], a[228:231], v[244:247]
    ds_read_b64_tr_b16 v[50:51], v39 offset:12832
    v_mfma_f32_16x16x32_bf16 v[248:251], v[52:55], a[232:235], v[248:251]
    v_mfma_f32_16x16x32_bf16 v[252:255], v[52:55], a[236:239], v[252:255]
    s_waitcnt lgkmcnt(4)
    v_mfma_f32_16x16x32_bf16 v[96:99], v[56:59], a[240:243], v[96:99]
    ds_read_b64_tr_b16 v[52:53], v39 offset:15392
    v_mfma_f32_16x16x32_bf16 v[100:103], v[56:59], a[244:247], v[100:103]
    ds_read_b64_tr_b16 v[54:55], v39 offset:17952
    v_mfma_f32_16x16x32_bf16 v[104:107], v[56:59], a[248:251], v[104:107]
    s_add_u32 m0, s34, 44032
    v_mfma_f32_16x16x32_bf16 v[108:111], v[56:59], a[252:255], v[108:111]
    buffer_load_dwordx4 v13, s[28:31], s32 offen lds
    s_waitcnt lgkmcnt(4)
    v_mfma_f32_16x16x32_bf16 v[112:115], v[60:63], a[240:243], v[112:115]
    ds_read_b64_tr_b16 v[56:57], v39 offset:10304
    v_mfma_f32_16x16x32_bf16 v[116:119], v[60:63], a[244:247], v[116:119]
    ds_read_b64_tr_b16 v[58:59], v39 offset:12864
    v_mfma_f32_16x16x32_bf16 v[120:123], v[60:63], a[248:251], v[120:123]
    v_mfma_f32_16x16x32_bf16 v[124:127], v[60:63], a[252:255], v[124:127]
    s_waitcnt lgkmcnt(4)
    v_mfma_f32_16x16x32_bf16 v[128:131], v[48:51], a[240:243], v[128:131]
    ds_read_b64_tr_b16 v[60:61], v39 offset:15424
    v_mfma_f32_16x16x32_bf16 v[132:135], v[48:51], a[244:247], v[132:135]
    ds_read_b64_tr_b16 v[62:63], v39 offset:17984
    v_mfma_f32_16x16x32_bf16 v[136:139], v[48:51], a[248:251], v[136:139]
    v_mfma_f32_16x16x32_bf16 v[140:143], v[48:51], a[252:255], v[140:143]
    s_waitcnt lgkmcnt(4)
    v_mfma_f32_16x16x32_bf16 v[144:147], v[52:55], a[240:243], v[144:147]
    ds_read_b64_tr_b16 v[48:49], v39 offset:10336
    v_mfma_f32_16x16x32_bf16 v[148:151], v[52:55], a[244:247], v[148:151]
    ds_read_b64_tr_b16 v[50:51], v39 offset:12896
    v_mfma_f32_16x16x32_bf16 v[152:155], v[52:55], a[248:251], v[152:155]
    s_add_u32 m0, s34, 45056
    v_mfma_f32_16x16x32_bf16 v[156:159], v[52:55], a[252:255], v[156:159]
    buffer_load_dwordx4 v14, s[28:31], s32 offen lds
    s_waitcnt lgkmcnt(4)
    v_mfma_f32_16x16x32_bf16 v[160:163], v[56:59], a[240:243], v[160:163]
    ds_read_b64_tr_b16 v[52:53], v39 offset:15456
    v_mfma_f32_16x16x32_bf16 v[164:167], v[56:59], a[244:247], v[164:167]
    ds_read_b64_tr_b16 v[54:55], v39 offset:18016
    v_mfma_f32_16x16x32_bf16 v[168:171], v[56:59], a[248:251], v[168:171]
    v_mfma_f32_16x16x32_bf16 v[172:175], v[56:59], a[252:255], v[172:175]
    s_waitcnt lgkmcnt(4)
    v_mfma_f32_16x16x32_bf16 v[176:179], v[60:63], a[240:243], v[176:179]
    ds_read_b64_tr_b16 v[56:57], v39 offset:10368
    v_mfma_f32_16x16x32_bf16 v[180:183], v[60:63], a[244:247], v[180:183]
    ds_read_b64_tr_b16 v[58:59], v39 offset:12928
    v_mfma_f32_16x16x32_bf16 v[184:187], v[60:63], a[248:251], v[184:187]
    v_mfma_f32_16x16x32_bf16 v[188:191], v[60:63], a[252:255], v[188:191]
    s_waitcnt lgkmcnt(4)
    v_mfma_f32_16x16x32_bf16 v[192:195], v[48:51], a[240:243], v[192:195]
    ds_read_b64_tr_b16 v[60:61], v39 offset:15488
    v_mfma_f32_16x16x32_bf16 v[196:199], v[48:51], a[244:247], v[196:199]
    ds_read_b64_tr_b16 v[62:63], v39 offset:18048
    v_mfma_f32_16x16x32_bf16 v[200:203], v[48:51], a[248:251], v[200:203]
    buffer_load_dword v27, v1, s[92:95], s100 offen
    s_add_u32 s100, s100, 73728
    v_mfma_f32_16x16x32_bf16 v[204:207], v[48:51], a[252:255], v[204:207]
    s_waitcnt lgkmcnt(4)
    v_mfma_f32_16x16x32_bf16 v[208:211], v[52:55], a[240:243], v[208:211]
    ds_read_b64_tr_b16 v[48:49], v38 offset:0
    v_mfma_f32_16x16x32_bf16 v[212:215], v[52:55], a[244:247], v[212:215]
    ds_read_b64_tr_b16 v[50:51], v38 offset:2560
    v_mfma_f32_16x16x32_bf16 v[216:219], v[52:55], a[248:251], v[216:219]
    v_mfma_f32_16x16x32_bf16 v[220:223], v[52:55], a[252:255], v[220:223]
    s_waitcnt lgkmcnt(4)
    v_mfma_f32_16x16x32_bf16 v[224:227], v[56:59], a[240:243], v[224:227]
    ds_read_b64_tr_b16 v[52:53], v38 offset:5120
    v_mfma_f32_16x16x32_bf16 v[228:231], v[56:59], a[244:247], v[228:231]
    ds_read_b64_tr_b16 v[54:55], v38 offset:7680
    v_mfma_f32_16x16x32_bf16 v[232:235], v[56:59], a[248:251], v[232:235]
    v_mfma_f32_16x16x32_bf16 v[236:239], v[56:59], a[252:255], v[236:239]
    s_waitcnt lgkmcnt(4)
    v_mfma_f32_16x16x32_bf16 v[240:243], v[60:63], a[240:243], v[240:243]
    ds_read_b64_tr_b16 v[56:57], v38 offset:32
    v_mfma_f32_16x16x32_bf16 v[244:247], v[60:63], a[244:247], v[244:247]
    ds_read_b64_tr_b16 v[58:59], v38 offset:2592
    v_mfma_f32_16x16x32_bf16 v[248:251], v[60:63], a[248:251], v[248:251]
    v_mfma_f32_16x16x32_bf16 v[252:255], v[60:63], a[252:255], v[252:255]
    s_waitcnt lgkmcnt(4)
    v_mfma_f32_16x16x32_bf16 v[96:99], v[48:51], v[64:67], v[96:99]
    ds_read_b64_tr_b16 v[60:61], v38 offset:5152
    v_mfma_f32_16x16x32_bf16 v[100:103], v[48:51], v[68:71], v[100:103]
    ds_read_b64_tr_b16 v[62:63], v38 offset:7712
    v_mfma_f32_16x16x32_bf16 v[104:107], v[48:51], v[72:75], v[104:107]
    v_mfma_f32_16x16x32_bf16 v[108:111], v[48:51], v[76:79], v[108:111]
    s_barrier
    s_waitcnt lgkmcnt(4)
    v_mfma_f32_16x16x32_bf16 v[112:115], v[52:55], v[64:67], v[112:115]
    ds_read_b64_tr_b16 v[48:49], v38 offset:64
    v_mfma_f32_16x16x32_bf16 v[116:119], v[52:55], v[68:71], v[116:119]
    ds_read_b64_tr_b16 v[50:51], v38 offset:2624
    v_mfma_f32_16x16x32_bf16 v[120:123], v[52:55], v[72:75], v[120:123]
    s_add_u32 s32, s54, s57
    s_add_u32 m0, s34, 61440
    v_mfma_f32_16x16x32_bf16 v[124:127], v[52:55], v[76:79], v[124:127]
    buffer_load_dwordx4 v10, s[28:31], s32 offen lds
    s_waitcnt lgkmcnt(4)
    v_mfma_f32_16x16x32_bf16 v[128:131], v[56:59], v[64:67], v[128:131]
    ds_read_b64_tr_b16 v[52:53], v38 offset:5184
    v_mfma_f32_16x16x32_bf16 v[132:135], v[56:59], v[68:71], v[132:135]
    ds_read_b64_tr_b16 v[54:55], v38 offset:7744
    v_mfma_f32_16x16x32_bf16 v[136:139], v[56:59], v[72:75], v[136:139]
    v_mfma_f32_16x16x32_bf16 v[140:143], v[56:59], v[76:79], v[140:143]
    s_waitcnt lgkmcnt(4)
    v_mfma_f32_16x16x32_bf16 v[144:147], v[60:63], v[64:67], v[144:147]
    ds_read_b64_tr_b16 v[56:57], v38 offset:96
    v_mfma_f32_16x16x32_bf16 v[148:151], v[60:63], v[68:71], v[148:151]
    ds_read_b64_tr_b16 v[58:59], v38 offset:2656
    v_mfma_f32_16x16x32_bf16 v[152:155], v[60:63], v[72:75], v[152:155]
    v_mfma_f32_16x16x32_bf16 v[156:159], v[60:63], v[76:79], v[156:159]
    s_waitcnt lgkmcnt(4)
    v_mfma_f32_16x16x32_bf16 v[160:163], v[48:51], v[64:67], v[160:163]
    ds_read_b64_tr_b16 v[60:61], v38 offset:5216
    v_mfma_f32_16x16x32_bf16 v[164:167], v[48:51], v[68:71], v[164:167]
    ds_read_b64_tr_b16 v[62:63], v38 offset:7776
    v_mfma_f32_16x16x32_bf16 v[168:171], v[48:51], v[72:75], v[168:171]
    s_add_u32 m0, s34, 62464
    v_mfma_f32_16x16x32_bf16 v[172:175], v[48:51], v[76:79], v[172:175]
    buffer_load_dwordx4 v11, s[28:31], s32 offen lds
    s_waitcnt lgkmcnt(4)
    v_mfma_f32_16x16x32_bf16 v[176:179], v[52:55], v[64:67], v[176:179]
    ds_read_b64_tr_b16 v[48:49], v38 offset:128
    v_mfma_f32_16x16x32_bf16 v[180:183], v[52:55], v[68:71], v[180:183]
    ds_read_b64_tr_b16 v[50:51], v38 offset:2688
    v_mfma_f32_16x16x32_bf16 v[184:187], v[52:55], v[72:75], v[184:187]
    v_mfma_f32_16x16x32_bf16 v[188:191], v[52:55], v[76:79], v[188:191]
    s_waitcnt lgkmcnt(4)
    v_mfma_f32_16x16x32_bf16 v[192:195], v[56:59], v[64:67], v[192:195]
    ds_read_b64_tr_b16 v[52:53], v38 offset:5248
    v_mfma_f32_16x16x32_bf16 v[196:199], v[56:59], v[68:71], v[196:199]
    ds_read_b64_tr_b16 v[54:55], v38 offset:7808
    v_mfma_f32_16x16x32_bf16 v[200:203], v[56:59], v[72:75], v[200:203]
    v_mfma_f32_16x16x32_bf16 v[204:207], v[56:59], v[76:79], v[204:207]
    s_waitcnt lgkmcnt(4)
    v_mfma_f32_16x16x32_bf16 v[208:211], v[60:63], v[64:67], v[208:211]
    ds_read_b64_tr_b16 v[56:57], v38 offset:10240
    v_mfma_f32_16x16x32_bf16 v[212:215], v[60:63], v[68:71], v[212:215]
    ds_read_b64_tr_b16 v[58:59], v38 offset:12800
    v_mfma_f32_16x16x32_bf16 v[216:219], v[60:63], v[72:75], v[216:219]
    v_mfma_f32_16x16x32_bf16 v[220:223], v[60:63], v[76:79], v[220:223]
    s_waitcnt lgkmcnt(4)
    v_mfma_f32_16x16x32_bf16 v[224:227], v[48:51], v[64:67], v[224:227]
    ds_read_b64_tr_b16 v[60:61], v38 offset:15360
    v_mfma_f32_16x16x32_bf16 v[228:231], v[48:51], v[68:71], v[228:231]
    ds_read_b64_tr_b16 v[62:63], v38 offset:17920
    v_mfma_f32_16x16x32_bf16 v[232:235], v[48:51], v[72:75], v[232:235]
    s_add_u32 m0, s34, 63488
    v_mfma_f32_16x16x32_bf16 v[236:239], v[48:51], v[76:79], v[236:239]
    buffer_load_dwordx4 v12, s[28:31], s32 offen lds
    s_waitcnt lgkmcnt(4)
    v_mfma_f32_16x16x32_bf16 v[240:243], v[52:55], v[64:67], v[240:243]
    ds_read_b64_tr_b16 v[48:49], v38 offset:10272
    v_mfma_f32_16x16x32_bf16 v[244:247], v[52:55], v[68:71], v[244:247]
    ds_read_b64_tr_b16 v[50:51], v38 offset:12832
    v_mfma_f32_16x16x32_bf16 v[248:251], v[52:55], v[72:75], v[248:251]
    v_mfma_f32_16x16x32_bf16 v[252:255], v[52:55], v[76:79], v[252:255]
    s_waitcnt lgkmcnt(4)
    v_mfma_f32_16x16x32_bf16 v[96:99], v[56:59], v[80:83], v[96:99]
    ds_read_b64_tr_b16 v[52:53], v38 offset:15392
    v_mfma_f32_16x16x32_bf16 v[100:103], v[56:59], v[84:87], v[100:103]
    ds_read_b64_tr_b16 v[54:55], v38 offset:17952
    v_mfma_f32_16x16x32_bf16 v[104:107], v[56:59], v[88:91], v[104:107]
    v_mfma_f32_16x16x32_bf16 v[108:111], v[56:59], v[92:95], v[108:111]
    s_waitcnt lgkmcnt(4)
    v_mfma_f32_16x16x32_bf16 v[112:115], v[60:63], v[80:83], v[112:115]
    ds_read_b64_tr_b16 v[56:57], v38 offset:10304
    v_mfma_f32_16x16x32_bf16 v[116:119], v[60:63], v[84:87], v[116:119]
    ds_read_b64_tr_b16 v[58:59], v38 offset:12864
    v_mfma_f32_16x16x32_bf16 v[120:123], v[60:63], v[88:91], v[120:123]
    s_add_u32 m0, s34, 64512
    v_mfma_f32_16x16x32_bf16 v[124:127], v[60:63], v[92:95], v[124:127]
    buffer_load_dwordx4 v13, s[28:31], s32 offen lds
    s_waitcnt lgkmcnt(4)
    v_mfma_f32_16x16x32_bf16 v[128:131], v[48:51], v[80:83], v[128:131]
    ds_read_b64_tr_b16 v[60:61], v38 offset:15424
    v_mfma_f32_16x16x32_bf16 v[132:135], v[48:51], v[84:87], v[132:135]
    ds_read_b64_tr_b16 v[62:63], v38 offset:17984
    v_mfma_f32_16x16x32_bf16 v[136:139], v[48:51], v[88:91], v[136:139]
    v_mfma_f32_16x16x32_bf16 v[140:143], v[48:51], v[92:95], v[140:143]
    s_waitcnt lgkmcnt(4)
    v_mfma_f32_16x16x32_bf16 v[144:147], v[52:55], v[80:83], v[144:147]
    ds_read_b64_tr_b16 v[48:49], v38 offset:10336
    v_mfma_f32_16x16x32_bf16 v[148:151], v[52:55], v[84:87], v[148:151]
    ds_read_b64_tr_b16 v[50:51], v38 offset:12896
    v_mfma_f32_16x16x32_bf16 v[152:155], v[52:55], v[88:91], v[152:155]
    v_mfma_f32_16x16x32_bf16 v[156:159], v[52:55], v[92:95], v[156:159]
    s_waitcnt lgkmcnt(4)
    v_mfma_f32_16x16x32_bf16 v[160:163], v[56:59], v[80:83], v[160:163]
    ds_read_b64_tr_b16 v[52:53], v38 offset:15456
    v_mfma_f32_16x16x32_bf16 v[164:167], v[56:59], v[84:87], v[164:167]
    ds_read_b64_tr_b16 v[54:55], v38 offset:18016
    v_mfma_f32_16x16x32_bf16 v[168:171], v[56:59], v[88:91], v[168:171]
    v_mfma_f32_16x16x32_bf16 v[172:175], v[56:59], v[92:95], v[172:175]
    s_waitcnt lgkmcnt(4)
    v_mfma_f32_16x16x32_bf16 v[176:179], v[60:63], v[80:83], v[176:179]
    ds_read_b64_tr_b16 v[56:57], v38 offset:10368
    v_mfma_f32_16x16x32_bf16 v[180:183], v[60:63], v[84:87], v[180:183]
    ds_read_b64_tr_b16 v[58:59], v38 offset:12928
    v_mfma_f32_16x16x32_bf16 v[184:187], v[60:63], v[88:91], v[184:187]
    s_add_u32 m0, s34, 65536
    v_mfma_f32_16x16x32_bf16 v[188:191], v[60:63], v[92:95], v[188:191]
    buffer_load_dwordx4 v14, s[28:31], s32 offen lds
    s_waitcnt lgkmcnt(4)
    v_mfma_f32_16x16x32_bf16 v[192:195], v[48:51], v[80:83], v[192:195]
    ds_read_b64_tr_b16 v[60:61], v38 offset:15488
    v_mfma_f32_16x16x32_bf16 v[196:199], v[48:51], v[84:87], v[196:199]
    ds_read_b64_tr_b16 v[62:63], v38 offset:18048
    v_mfma_f32_16x16x32_bf16 v[200:203], v[48:51], v[88:91], v[200:203]
    v_mfma_f32_16x16x32_bf16 v[204:207], v[48:51], v[92:95], v[204:207]
    s_waitcnt lgkmcnt(4)
    v_mfma_f32_16x16x32_bf16 v[208:211], v[52:55], v[80:83], v[208:211]
    v_mfma_f32_16x16x32_bf16 v[212:215], v[52:55], v[84:87], v[212:215]
    v_mfma_f32_16x16x32_bf16 v[216:219], v[52:55], v[88:91], v[216:219]
    v_mfma_f32_16x16x32_bf16 v[220:223], v[52:55], v[92:95], v[220:223]
    s_waitcnt lgkmcnt(2)
    v_mfma_f32_16x16x32_bf16 v[224:227], v[56:59], v[80:83], v[224:227]
    v_mfma_f32_16x16x32_bf16 v[228:231], v[56:59], v[84:87], v[228:231]
    v_mfma_f32_16x16x32_bf16 v[232:235], v[56:59], v[88:91], v[232:235]
    v_mfma_f32_16x16x32_bf16 v[236:239], v[56:59], v[92:95], v[236:239]
    s_waitcnt lgkmcnt(0)
    v_mfma_f32_16x16x32_bf16 v[240:243], v[60:63], v[80:83], v[240:243]
    v_mfma_f32_16x16x32_bf16 v[244:247], v[60:63], v[84:87], v[244:247]
    v_mfma_f32_16x16x32_bf16 v[248:251], v[60:63], v[88:91], v[248:251]
    v_mfma_f32_16x16x32_bf16 v[252:255], v[60:63], v[92:95], v[252:255]
    s_nop 7
    s_lshl_b32 s46, s40, 3
    s_add_u32 s46, s46, s41
    s_lshl_b32 s46, s46, 7
    s_add_u32 s46, s46, 20480
    v_min_u32 v6, 3, v0
    v_lshlrev_b32 v6, 2, v6
    v_add_u32 v6, s46, v6
    buffer_load_dword v7, v6, s[76:79], 0 offen sc1
    s_cmp_eq_u32 s59, 1
    s_cbranch_scc0 FKE_hs1
    s_lshl_b32 s45, s40, 4
    s_lshl_b32 s46, s3, 2
    s_add_u32 s45, s45, s46
    s_mul_i32 s50, s45, 147456
    s_mul_i32 s46, s41, 18432
    s_add_u32 s50, s50, s46
    s_lshl_b32 s46, s42, 11
    s_add_u32 s51, s50, s46
    s_add_u32 s51, s51, 8192
    s_lshr_b32 s46, s42, 1
    s_add_u32 s46, s46, 16
    s_lshl_b32 s46, s46, 10
    s_add_u32 s52, s50, s46
    s_and_b32 s46, s42, 1
    s_lshl_b32 s46, s46, 3
    s_add_u32 s52, s52, s46
    v_lshlrev_b32 v2, 4, v0
    v_pk_mul_f32 v[96:97], v[96:97], v[112:113]
    v_pk_mul_f32 v[98:99], v[98:99], v[114:115]
    v_cvt_pk_bf16_f32 v40, v96, v97
    v_cvt_pk_bf16_f32 v41, v98, v99
    v_pk_mul_f32 v[128:129], v[128:129], v[144:145]
    v_pk_mul_f32 v[130:131], v[130:131], v[146:147]
    v_cvt_pk_bf16_f32 v42, v128, v129
    v_cvt_pk_bf16_f32 v43, v130, v131
    buffer_store_dwordx4 v[40:43], v2, s[16:19], s51 offen offset:0
    v_pk_mul_f32 v[160:161], v[160:161], v[176:177]
    v_pk_mul_f32 v[162:163], v[162:163], v[178:179]
    v_cvt_pk_bf16_f32 v44, v160, v161
    v_cvt_pk_bf16_f32 v45, v162, v163
    v_pk_mul_f32 v[192:193], v[192:193], v[208:209]
    v_pk_mul_f32 v[194:195], v[194:195], v[210:211]
    v_cvt_pk_bf16_f32 v46, v192, v193
    v_cvt_pk_bf16_f32 v47, v194, v195
    buffer_store_dwordx4 v[44:47], v2, s[16:19], s51 offen offset:1024
    v_pk_mul_f32 v[224:225], v[224:225], v[240:241]
    v_pk_mul_f32 v[226:227], v[226:227], v[242:243]
    v_cvt_pk_bf16_f32 v40, v224, v225
    v_cvt_pk_bf16_f32 v41, v226, v227
    buffer_store_dwordx2 v[40:41], v2, s[16:19], s52 offen
    s_add_u32 s51, s51, 147456
    s_add_u32 s52, s52, 147456
    v_pk_mul_f32 v[100:101], v[100:101], v[116:117]
    v_pk_mul_f32 v[102:103], v[102:103], v[118:119]
    v_cvt_pk_bf16_f32 v44, v100, v101
    v_cvt_pk_bf16_f32 v45, v102, v103
    v_pk_mul_f32 v[132:133], v[132:133], v[148:149]
    v_pk_mul_f32 v[134:135], v[134:135], v[150:151]
    v_cvt_pk_bf16_f32 v46, v132, v133
    v_cvt_pk_bf16_f32 v47, v134, v135
    buffer_store_dwordx4 v[44:47], v2, s[16:19], s51 offen offset:0
    v_pk_mul_f32 v[164:165], v[164:165], v[180:181]
    v_pk_mul_f32 v[166:167], v[166:167], v[182:183]
    v_cvt_pk_bf16_f32 v40, v164, v165
    v_cvt_pk_bf16_f32 v41, v166, v167
    v_pk_mul_f32 v[196:197], v[196:197], v[212:213]
    v_pk_mul_f32 v[198:199], v[198:199], v[214:215]
    v_cvt_pk_bf16_f32 v42, v196, v197
    v_cvt_pk_bf16_f32 v43, v198, v199
    buffer_store_dwordx4 v[40:43], v2, s[16:19], s51 offen offset:1024
    v_pk_mul_f32 v[228:229], v[228:229], v[244:245]
    v_pk_mul_f32 v[230:231], v[230:231], v[246:247]
    v_cvt_pk_bf16_f32 v44, v228, v229
    v_cvt_pk_bf16_f32 v45, v230, v231
    buffer_store_dwordx2 v[44:45], v2, s[16:19], s52 offen
    s_add_u32 s51, s51, 147456
    s_add_u32 s52, s52, 147456
    v_pk_mul_f32 v[104:105], v[104:105], v[120:121]
    v_pk_mul_f32 v[106:107], v[106:107], v[122:123]
    v_cvt_pk_bf16_f32 v40, v104, v105
    v_cvt_pk_bf16_f32 v41, v106, v107
    v_pk_mul_f32 v[136:137], v[136:137], v[152:153]
    v_pk_mul_f32 v[138:139], v[138:139], v[154:155]
    v_cvt_pk_bf16_f32 v42, v136, v137
    v_cvt_pk_bf16_f32 v43, v138, v139
    buffer_store_dwordx4 v[40:43], v2, s[16:19], s51 offen offset:0
    v_pk_mul_f32 v[168:169], v[168:169], v[184:185]
    v_pk_mul_f32 v[170:171], v[170:171], v[186:187]
    v_cvt_pk_bf16_f32 v44, v168, v169
    v_cvt_pk_bf16_f32 v45, v170, v171
    v_pk_mul_f32 v[200:201], v[200:201], v[216:217]
    v_pk_mul_f32 v[202:203], v[202:203], v[218:219]
    v_cvt_pk_bf16_f32 v46, v200, v201
    v_cvt_pk_bf16_f32 v47, v202, v203
    buffer_store_dwordx4 v[44:47], v2, s[16:19], s51 offen offset:1024
    v_pk_mul_f32 v[232:233], v[232:233], v[248:249]
    v_pk_mul_f32 v[234:235], v[234:235], v[250:251]
    v_cvt_pk_bf16_f32 v40, v232, v233
    v_cvt_pk_bf16_f32 v41, v234, v235
    buffer_store_dwordx2 v[40:41], v2, s[16:19], s52 offen
    s_add_u32 s51, s51, 147456
    s_add_u32 s52, s52, 147456
    v_pk_mul_f32 v[108:109], v[108:109], v[124:125]
    v_pk_mul_f32 v[110:111], v[110:111], v[126:127]
    v_cvt_pk_bf16_f32 v44, v108, v109
    v_cvt_pk_bf16_f32 v45, v110, v111
    v_pk_mul_f32 v[140:141], v[140:141], v[156:157]
    v_pk_mul_f32 v[142:143], v[142:143], v[158:159]
    v_cvt_pk_bf16_f32 v46, v140, v141
    v_cvt_pk_bf16_f32 v47, v142, v143
    buffer_store_dwordx4 v[44:47], v2, s[16:19], s51 offen offset:0
    v_pk_mul_f32 v[172:173], v[172:173], v[188:189]
    v_pk_mul_f32 v[174:175], v[174:175], v[190:191]
    v_cvt_pk_bf16_f32 v40, v172, v173
    v_cvt_pk_bf16_f32 v41, v174, v175
    v_pk_mul_f32 v[204:205], v[204:205], v[220:221]
    v_pk_mul_f32 v[206:207], v[206:207], v[222:223]
    v_cvt_pk_bf16_f32 v42, v204, v205
    v_cvt_pk_bf16_f32 v43, v206, v207
    buffer_store_dwordx4 v[40:43], v2, s[16:19], s51 offen offset:1024
    v_pk_mul_f32 v[236:237], v[236:237], v[252:253]
    v_pk_mul_f32 v[238:239], v[238:239], v[254:255]
    v_cvt_pk_bf16_f32 v44, v236, v237
    v_cvt_pk_bf16_f32 v45, v238, v239
    buffer_store_dwordx2 v[44:45], v2, s[16:19], s52 offen
    s_branch FKE_hd1
FKE_hs1:
    s_lshl_b32 s45, s40, 4
    s_lshl_b32 s46, s3, 2
    s_add_u32 s45, s45, s46
    s_mul_i32 s50, s45, 147456
    s_mul_i32 s46, s41, 18432
    s_add_u32 s50, s50, s46
    s_lshl_b32 s46, s42, 11
    s_add_u32 s51, s50, s46
    s_add_u32 s51, s51, 8192
    s_lshr_b32 s46, s42, 1
    s_add_u32 s46, s46, 16
    s_lshl_b32 s46, s46, 10
    s_add_u32 s52, s50, s46
    s_and_b32 s46, s42, 1
    s_lshl_b32 s46, s46, 3
    s_add_u32 s52, s52, s46
    v_lshlrev_b32 v2, 4, v0
    v_pk_mul_f32 v[96:97], v[96:97], v[112:113]
    v_pk_mul_f32 v[98:99], v[98:99], v[114:115]
    v_cvt_pk_bf16_f32 v40, v96, v97
    v_cvt_pk_bf16_f32 v41, v98, v99
    v_pk_mul_f32 v[128:129], v[128:129], v[144:145]
    v_pk_mul_f32 v[130:131], v[130:131], v[146:147]
    v_cvt_pk_bf16_f32 v42, v128, v129
    v_cvt_pk_bf16_f32 v43, v130, v131
    buffer_store_dwordx4 v[40:43], v2, s[16:19], s51 offen offset:0 sc1
    v_pk_mul_f32 v[160:161], v[160:161], v[176:177]
    v_pk_mul_f32 v[162:163], v[162:163], v[178:179]
    v_cvt_pk_bf16_f32 v44, v160, v161
    v_cvt_pk_bf16_f32 v45, v162, v163
    v_pk_mul_f32 v[192:193], v[192:193], v[208:209]
    v_pk_mul_f32 v[194:195], v[194:195], v[210:211]
    v_cvt_pk_bf16_f32 v46, v192, v193
    v_cvt_pk_bf16_f32 v47, v194, v195
    buffer_store_dwordx4 v[44:47], v2, s[16:19], s51 offen offset:1024 sc1
    v_pk_mul_f32 v[224:225], v[224:225], v[240:241]
    v_pk_mul_f32 v[226:227], v[226:227], v[242:243]
    v_cvt_pk_bf16_f32 v40, v224, v225
    v_cvt_pk_bf16_f32 v41, v226, v227
    buffer_store_dwordx2 v[40:41], v2, s[16:19], s52 offen sc1
    s_add_u32 s51, s51, 147456
    s_add_u32 s52, s52, 147456
    v_pk_mul_f32 v[100:101], v[100:101], v[116:117]
    v_pk_mul_f32 v[102:103], v[102:103], v[118:119]
    v_cvt_pk_bf16_f32 v44, v100, v101
    v_cvt_pk_bf16_f32 v45, v102, v103
    v_pk_mul_f32 v[132:133], v[132:133], v[148:149]
    v_pk_mul_f32 v[134:135], v[134:135], v[150:151]
    v_cvt_pk_bf16_f32 v46, v132, v133
    v_cvt_pk_bf16_f32 v47, v134, v135
    buffer_store_dwordx4 v[44:47], v2, s[16:19], s51 offen offset:0 sc1
    v_pk_mul_f32 v[164:165], v[164:165], v[180:181]
    v_pk_mul_f32 v[166:167], v[166:167], v[182:183]
    v_cvt_pk_bf16_f32 v40, v164, v165
    v_cvt_pk_bf16_f32 v41, v166, v167
    v_pk_mul_f32 v[196:197], v[196:197], v[212:213]
    v_pk_mul_f32 v[198:199], v[198:199], v[214:215]
    v_cvt_pk_bf16_f32 v42, v196, v197
    v_cvt_pk_bf16_f32 v43, v198, v199
    buffer_store_dwordx4 v[40:43], v2, s[16:19], s51 offen offset:1024 sc1
    v_pk_mul_f32 v[228:229], v[228:229], v[244:245]
    v_pk_mul_f32 v[230:231], v[230:231], v[246:247]
    v_cvt_pk_bf16_f32 v44, v228, v229
    v_cvt_pk_bf16_f32 v45, v230, v231
    buffer_store_dwordx2 v[44:45], v2, s[16:19], s52 offen sc1
    s_add_u32 s51, s51, 147456
    s_add_u32 s52, s52, 147456
    v_pk_mul_f32 v[104:105], v[104:105], v[120:121]
    v_pk_mul_f32 v[106:107], v[106:107], v[122:123]
    v_cvt_pk_bf16_f32 v40, v104, v105
    v_cvt_pk_bf16_f32 v41, v106, v107
    v_pk_mul_f32 v[136:137], v[136:137], v[152:153]
    v_pk_mul_f32 v[138:139], v[138:139], v[154:155]
    v_cvt_pk_bf16_f32 v42, v136, v137
    v_cvt_pk_bf16_f32 v43, v138, v139
    buffer_store_dwordx4 v[40:43], v2, s[16:19], s51 offen offset:0 sc1
    v_pk_mul_f32 v[168:169], v[168:169], v[184:185]
    v_pk_mul_f32 v[170:171], v[170:171], v[186:187]
    v_cvt_pk_bf16_f32 v44, v168, v169
    v_cvt_pk_bf16_f32 v45, v170, v171
    v_pk_mul_f32 v[200:201], v[200:201], v[216:217]
    v_pk_mul_f32 v[202:203], v[202:203], v[218:219]
    v_cvt_pk_bf16_f32 v46, v200, v201
    v_cvt_pk_bf16_f32 v47, v202, v203
    buffer_store_dwordx4 v[44:47], v2, s[16:19], s51 offen offset:1024 sc1
    v_pk_mul_f32 v[232:233], v[232:233], v[248:249]
    v_pk_mul_f32 v[234:235], v[234:235], v[250:251]
    v_cvt_pk_bf16_f32 v40, v232, v233
    v_cvt_pk_bf16_f32 v41, v234, v235
    buffer_store_dwordx2 v[40:41], v2, s[16:19], s52 offen sc1
    s_add_u32 s51, s51, 147456
    s_add_u32 s52, s52, 147456
    v_pk_mul_f32 v[108:109], v[108:109], v[124:125]
    v_pk_mul_f32 v[110:111], v[110:111], v[126:127]
    v_cvt_pk_bf16_f32 v44, v108, v109
    v_cvt_pk_bf16_f32 v45, v110, v111
    v_pk_mul_f32 v[140:141], v[140:141], v[156:157]
    v_pk_mul_f32 v[142:143], v[142:143], v[158:159]
    v_cvt_pk_bf16_f32 v46, v140, v141
    v_cvt_pk_bf16_f32 v47, v142, v143
    buffer_store_dwordx4 v[44:47], v2, s[16:19], s51 offen offset:0 sc1
    v_pk_mul_f32 v[172:173], v[172:173], v[188:189]
    v_pk_mul_f32 v[174:175], v[174:175], v[190:191]
    v_cvt_pk_bf16_f32 v40, v172, v173
    v_cvt_pk_bf16_f32 v41, v174, v175
    v_pk_mul_f32 v[204:205], v[204:205], v[220:221]
    v_pk_mul_f32 v[206:207], v[206:207], v[222:223]
    v_cvt_pk_bf16_f32 v42, v204, v205
    v_cvt_pk_bf16_f32 v43, v206, v207
    buffer_store_dwordx4 v[40:43], v2, s[16:19], s51 offen offset:1024 sc1
    v_pk_mul_f32 v[236:237], v[236:237], v[252:253]
    v_pk_mul_f32 v[238:239], v[238:239], v[254:255]
    v_cvt_pk_bf16_f32 v44, v236, v237
    v_cvt_pk_bf16_f32 v45, v238, v239
    buffer_store_dwordx2 v[44:45], v2, s[16:19], s52 offen sc1
FKE_hd1:
    s_branch FK_g1d
FK_noE:
    buffer_load_dwordx4 a[0:3], v16, s[20:23], s33 offen offset:0 sc1
    buffer_load_dwordx4 a[16:19], v16, s[20:23], s33 offen offset:1024 sc1
    buffer_load_dwordx4 a[4:7], v17, s[20:23], s33 offen offset:0 sc1
    buffer_load_dwordx4 a[20:23], v17, s[20:23], s33 offen offset:1024 sc1
    buffer_load_dwordx4 a[8:11], v18, s[20:23], s33 offen offset:0 sc1
    buffer_load_dwordx4 a[24:27], v18, s[20:23], s33 offen offset:1024 sc1
    buffer_load_dwordx4 a[12:15], v19, s[20:23], s33 offen offset:0 sc1
    buffer_load_dwordx4 a[28:31], v19, s[20:23], s33 offen offset:1024 sc1
    s_add_u32 s33, s33, 2048
    buffer_load_dwordx4 a[32:35], v16, s[20:23], s33 offen offset:0 sc1
    buffer_load_dwordx4 a[48:51], v16, s[20:23], s33 offen offset:1024 sc1
    buffer_load_dwordx4 a[36:39], v17, s[20:23], s33 offen offset:0 sc1
    buffer_load_dwordx4 a[52:55], v17, s[20:23], s33 offen offset:1024 sc1
    buffer_load_dwordx4 a[40:43], v18, s[20:23], s33 offen offset:0 sc1
    buffer_load_dwordx4 a[56:59], v18, s[20:23], s33 offen offset:1024 sc1
    buffer_load_dwordx4 a[44:47], v19, s[20:23], s33 offen offset:0 sc1
    buffer_load_dwordx4 a[60:63], v19, s[20:23], s33 offen offset:1024 sc1
    s_add_u32 s33, s33, 2048
    s_waitcnt vmcnt(8)
    s_barrier
    ds_read_b64_tr_b16 v[48:49], v28 offset:0
    ds_read_b64_tr_b16 v[50:51], v28 offset:2048
    ds_read_b64_tr_b16 v[52:53], v28 offset:4096
    ds_read_b64_tr_b16 v[54:55], v28 offset:6144
    ds_read_b64_tr_b16 v[56:57], v29 offset:0
    ds_read_b64_tr_b16 v[58:59], v29 offset:2048
    s_waitcnt vmcnt(8) lgkmcnt(4)
    v_mfma_f32_16x16x32_bf16 v[96:99], v[48:51], a[0:3], 0
    ds_read_b64_tr_b16 v[60:61], v29 offset:4096
    v_mfma_f32_16x16x32_bf16 v[100:103], v[48:51], a[4:7], 0
    ds_read_b64_tr_b16 v[62:63], v29 offset:6144
    v_mfma_f32_16x16x32_bf16 v[104:107], v[48:51], a[8:11], 0
    v_mfma_f32_16x16x32_bf16 v[108:111], v[48:51], a[12:15], 0
    s_barrier
    s_waitcnt lgkmcnt(4)
    v_mfma_f32_16x16x32_bf16 v[112:115], v[52:55], a[0:3], 0
    ds_read_b64_tr_b16 v[48:49], v30 offset:0
    v_mfma_f32_16x16x32_bf16 v[116:119], v[52:55], a[4:7], 0
    ds_read_b64_tr_b16 v[50:51], v30 offset:2048
    v_mfma_f32_16x16x32_bf16 v[120:123], v[52:55], a[8:11], 0
    buffer_load_dwordx4 a[64:67], v16, s[20:23], s33 offen offset:0 sc1
    v_mfma_f32_16x16x32_bf16 v[124:127], v[52:55], a[12:15], 0
    s_waitcnt lgkmcnt(4)
    v_mfma_f32_16x16x32_bf16 v[128:131], v[56:59], a[0:3], 0
    ds_read_b64_tr_b16 v[52:53], v30 offset:4096
    v_mfma_f32_16x16x32_bf16 v[132:135], v[56:59], a[4:7], 0
    ds_read_b64_tr_b16 v[54:55], v30 offset:6144
    v_mfma_f32_16x16x32_bf16 v[136:139], v[56:59], a[8:11], 0
    buffer_load_dwordx4 a[80:83], v16, s[20:23], s33 offen offset:1024 sc1
    v_mfma_f32_16x16x32_bf16 v[140:143], v[56:59], a[12:15], 0
    s_waitcnt lgkmcnt(4)
    v_mfma_f32_16x16x32_bf16 v[144:147], v[60:63], a[0:3], 0
    ds_read_b64_tr_b16 v[56:57], v31 offset:0
    v_mfma_f32_16x16x32_bf16 v[148:151], v[60:63], a[4:7], 0
    ds_read_b64_tr_b16 v[58:59], v31 offset:2048
    v_mfma_f32_16x16x32_bf16 v[152:155], v[60:63], a[8:11], 0
    buffer_load_dwordx4 a[68:71], v17, s[20:23], s33 offen offset:0 sc1
    v_mfma_f32_16x16x32_bf16 v[156:159], v[60:63], a[12:15], 0
    s_waitcnt lgkmcnt(4)
    v_mfma_f32_16x16x32_bf16 v[160:163], v[48:51], a[0:3], 0
    ds_read_b64_tr_b16 v[60:61], v31 offset:4096
    v_mfma_f32_16x16x32_bf16 v[164:167], v[48:51], a[4:7], 0
    ds_read_b64_tr_b16 v[62:63], v31 offset:6144
    v_mfma_f32_16x16x32_bf16 v[168:171], v[48:51], a[8:11], 0
    buffer_load_dwordx4 a[84:87], v17, s[20:23], s33 offen offset:1024 sc1
    v_mfma_f32_16x16x32_bf16 v[172:175], v[48:51], a[12:15], 0
    s_waitcnt lgkmcnt(4)
    v_mfma_f32_16x16x32_bf16 v[176:179], v[52:55], a[0:3], 0
    ds_read_b64_tr_b16 v[48:49], v28 offset:8192
    v_mfma_f32_16x16x32_bf16 v[180:183], v[52:55], a[4:7], 0
    ds_read_b64_tr_b16 v[50:51], v28 offset:10240
    v_mfma_f32_16x16x32_bf16 v[184:187], v[52:55], a[8:11], 0
    buffer_load_dwordx4 a[72:75], v18, s[20:23], s33 offen offset:0 sc1
    v_mfma_f32_16x16x32_bf16 v[188:191], v[52:55], a[12:15], 0
    s_waitcnt lgkmcnt(4)
    v_mfma_f32_16x16x32_bf16 v[192:195], v[56:59], a[0:3], 0
    ds_read_b64_tr_b16 v[52:53], v28 offset:12288
    v_mfma_f32_16x16x32_bf16 v[196:199], v[56:59], a[4:7], 0
    ds_read_b64_tr_b16 v[54:55], v28 offset:14336
    v_mfma_f32_16x16x32_bf16 v[200:203], v[56:59], a[8:11], 0
    buffer_load_dwordx4 a[88:91], v18, s[20:23], s33 offen offset:1024 sc1
    v_mfma_f32_16x16x32_bf16 v[204:207], v[56:59], a[12:15], 0
    s_waitcnt lgkmcnt(4)
    v_mfma_f32_16x16x32_bf16 v[208:211], v[60:63], a[0:3], 0
    ds_read_b64_tr_b16 v[56:57], v29 offset:8192
    v_mfma_f32_16x16x32_bf16 v[212:215], v[60:63], a[4:7], 0
    ds_read_b64_tr_b16 v[58:59], v29 offset:10240
    v_mfma_f32_16x16x32_bf16 v[216:219], v[60:63], a[8:11], 0
    buffer_load_dwordx4 a[76:79], v19, s[20:23], s33 offen offset:0 sc1
    v_mfma_f32_16x16x32_bf16 v[220:223], v[60:63], a[12:15], 0
    s_waitcnt lgkmcnt(4)
    v_mfma_f32_16x16x32_bf16 v[96:99], v[48:51], a[16:19], v[96:99]
    ds_read_b64_tr_b16 v[60:61], v29 offset:12288
    v_mfma_f32_16x16x32_bf16 v[100:103], v[48:51], a[20:23], v[100:103]
    ds_read_b64_tr_b16 v[62:63], v29 offset:14336
    v_mfma_f32_16x16x32_bf16 v[104:107], v[48:51], a[24:27], v[104:107]
    buffer_load_dwordx4 a[92:95], v19, s[20:23], s33 offen offset:1024 sc1
    s_add_u32 s33, s33, 2048
    v_mfma_f32_16x16x32_bf16 v[108:111], v[48:51], a[28:31], v[108:111]
    s_waitcnt lgkmcnt(4)
    v_mfma_f32_16x16x32_bf16 v[112:115], v[52:55], a[16:19], v[112:115]
    ds_read_b64_tr_b16 v[48:49], v30 offset:8192
    v_mfma_f32_16x16x32_bf16 v[116:119], v[52:55], a[20:23], v[116:119]
    ds_read_b64_tr_b16 v[50:51], v30 offset:10240
    v_mfma_f32_16x16x32_bf16 v[120:123], v[52:55], a[24:27], v[120:123]
    s_and_b32 s44, s41, 1
    s_lshl_b32 s44, s44, 2
    v_mfma_f32_16x16x32_bf16 v[124:127], v[52:55], a[28:31], v[124:127]
    s_add_u32 s44, s44, s42
    s_waitcnt lgkmcnt(4)
    v_mfma_f32_16x16x32_bf16 v[128:131], v[56:59], a[16:19], v[128:131]
    ds_read_b64_tr_b16 v[52:53], v30 offset:12288
    v_mfma_f32_16x16x32_bf16 v[132:135], v[56:59], a[20:23], v[132:135]
    ds_read_b64_tr_b16 v[54:55], v30 offset:14336
    v_mfma_f32_16x16x32_bf16 v[136:139], v[56:59], a[24:27], v[136:139]
    s_lshl_b32 s44, s44, 1
    s_and_b32 s45, s3, 1
    v_mfma_f32_16x16x32_bf16 v[140:143], v[56:59], a[28:31], v[140:143]
    s_add_u32 s44, s44, s45
    s_waitcnt lgkmcnt(4)
    v_mfma_f32_16x16x32_bf16 v[144:147], v[60:63], a[16:19], v[144:147]
    ds_read_b64_tr_b16 v[56:57], v31 offset:8192
    v_mfma_f32_16x16x32_bf16 v[148:151], v[60:63], a[20:23], v[148:151]
    ds_read_b64_tr_b16 v[58:59], v31 offset:10240
    v_mfma_f32_16x16x32_bf16 v[152:155], v[60:63], a[24:27], v[152:155]
    s_lshl_b32 s45, s40, 4
    s_add_u32 s44, s44, s45
    v_mfma_f32_16x16x32_bf16 v[156:159], v[60:63], a[28:31], v[156:159]
    s_mul_i32 s44, s44, 18432
    s_waitcnt lgkmcnt(4)
    v_mfma_f32_16x16x32_bf16 v[160:163], v[48:51], a[16:19], v[160:163]
    ds_read_b64_tr_b16 v[60:61], v31 offset:12288
    v_mfma_f32_16x16x32_bf16 v[164:167], v[48:51], a[20:23], v[164:167]
    ds_read_b64_tr_b16 v[62:63], v31 offset:14336
    v_mfma_f32_16x16x32_bf16 v[168:171], v[48:51], a[24:27], v[168:171]
    s_lshr_b32 s45, s3, 1
    s_add_u32 s45, s45, 8
    v_mfma_f32_16x16x32_bf16 v[172:175], v[48:51], a[28:31], v[172:175]
    s_lshl_b32 s45, s45, 10
    s_waitcnt lgkmcnt(4)
    v_mfma_f32_16x16x32_bf16 v[176:179], v[52:55], a[16:19], v[176:179]
    ds_read_b64_tr_b16 v[48:49], v28 offset:20480
    v_mfma_f32_16x16x32_bf16 v[180:183], v[52:55], a[20:23], v[180:183]
    ds_read_b64_tr_b16 v[50:51], v28 offset:22528
    v_mfma_f32_16x16x32_bf16 v[184:187], v[52:55], a[24:27], v[184:187]
    s_add_u32 s89, s44, s45
    v_lshrrev_b32 v21, 3, v0
    v_mfma_f32_16x16x32_bf16 v[188:191], v[52:55], a[28:31], v[188:191]
    v_lshlrev_b32 v21, 7, v21
    s_waitcnt lgkmcnt(4)
    v_mfma_f32_16x16x32_bf16 v[192:195], v[56:59], a[16:19], v[192:195]
    ds_read_b64_tr_b16 v[52:53], v28 offset:24576
    v_mfma_f32_16x16x32_bf16 v[196:199], v[56:59], a[20:23], v[196:199]
    ds_read_b64_tr_b16 v[54:55], v28 offset:26624
    v_mfma_f32_16x16x32_bf16 v[200:203], v[56:59], a[24:27], v[200:203]
    buffer_load_dword v27, v21, s[20:23], s89 offen sc1
    s_add_u32 s89, s89, 2048
    v_mfma_f32_16x16x32_bf16 v[204:207], v[56:59], a[28:31], v[204:207]
    s_add_u32 m0, s34, 81920
    s_waitcnt lgkmcnt(4)
    v_mfma_f32_16x16x32_bf16 v[208:211], v[60:63], a[16:19], v[208:211]
    ds_read_b64_tr_b16 v[56:57], v29 offset:20480
    v_mfma_f32_16x16x32_bf16 v[212:215], v[60:63], a[20:23], v[212:215]
    ds_read_b64_tr_b16 v[58:59], v29 offset:22528
    v_mfma_f32_16x16x32_bf16 v[216:219], v[60:63], a[24:27], v[216:219]
    buffer_load_dwordx4 v10, s[12:15], s32 offen lds
    s_add_u32 m0, s34, 82944
    v_mfma_f32_16x16x32_bf16 v[220:223], v[60:63], a[28:31], v[220:223]
    buffer_load_dwordx4 v11, s[12:15], s32 offen lds
    s_add_u32 m0, s34, 83968
    s_nop 0
    buffer_load_dwordx4 v12, s[12:15], s32 offen lds
    s_add_u32 m0, s34, 84992
    s_nop 0
    buffer_load_dwordx4 v13, s[12:15], s32 offen lds
    s_add_u32 s32, s32, 589824
    s_waitcnt vmcnt(13) lgkmcnt(4)
    v_mfma_f32_16x16x32_bf16 v[96:99], v[48:51], a[32:35], v[96:99]
    ds_read_b64_tr_b16 v[60:61], v29 offset:24576
    v_mfma_f32_16x16x32_bf16 v[100:103], v[48:51], a[36:39], v[100:103]
    ds_read_b64_tr_b16 v[62:63], v29 offset:26624
    v_mfma_f32_16x16x32_bf16 v[104:107], v[48:51], a[40:43], v[104:107]
    v_mfma_f32_16x16x32_bf16 v[108:111], v[48:51], a[44:47], v[108:111]
    s_barrier
    s_waitcnt lgkmcnt(4)
    v_mfma_f32_16x16x32_bf16 v[112:115], v[52:55], a[32:35], v[112:115]
    ds_read_b64_tr_b16 v[48:49], v30 offset:20480
    v_mfma_f32_16x16x32_bf16 v[116:119], v[52:55], a[36:39], v[116:119]
    ds_read_b64_tr_b16 v[50:51], v30 offset:22528
    v_mfma_f32_16x16x32_bf16 v[120:123], v[52:55], a[40:43], v[120:123]
    buffer_load_dwordx4 a[96:99], v16, s[20:23], s33 offen offset:0 sc1
    v_mfma_f32_16x16x32_bf16 v[124:127], v[52:55], a[44:47], v[124:127]
    s_waitcnt lgkmcnt(4)
    v_mfma_f32_16x16x32_bf16 v[128:131], v[56:59], a[32:35], v[128:131]
    ds_read_b64_tr_b16 v[52:53], v30 offset:24576
    v_mfma_f32_16x16x32_bf16 v[132:135], v[56:59], a[36:39], v[132:135]
    ds_read_b64_tr_b16 v[54:55], v30 offset:26624
    v_mfma_f32_16x16x32_bf16 v[136:139], v[56:59], a[40:43], v[136:139]
    buffer_load_dwordx4 a[112:115], v16, s[20:23], s33 offen offset:1024 sc1
    v_mfma_f32_16x16x32_bf16 v[140:143], v[56:59], a[44:47], v[140:143]
    s_waitcnt lgkmcnt(4)
    v_mfma_f32_16x16x32_bf16 v[144:147], v[60:63], a[32:35], v[144:147]
    ds_read_b64_tr_b16 v[56:57], v31 offset:20480
    v_mfma_f32_16x16x32_bf16 v[148:151], v[60:63], a[36:39], v[148:151]
    ds_read_b64_tr_b16 v[58:59], v31 offset:22528
    v_mfma_f32_16x16x32_bf16 v[152:155], v[60:63], a[40:43], v[152:155]
    buffer_load_dwordx4 a[100:103], v17, s[20:23], s33 offen offset:0 sc1
    v_mfma_f32_16x16x32_bf16 v[156:159], v[60:63], a[44:47], v[156:159]
    s_waitcnt lgkmcnt(4)
    v_mfma_f32_16x16x32_bf16 v[160:163], v[48:51], a[32:35], v[160:163]
    ds_read_b64_tr_b16 v[60:61], v31 offset:24576
    v_mfma_f32_16x16x32_bf16 v[164:167], v[48:51], a[36:39], v[164:167]
    ds_read_b64_tr_b16 v[62:63], v31 offset:26624
    v_mfma_f32_16x16x32_bf16 v[168:171], v[48:51], a[40:43], v[168:171]
    buffer_load_dwordx4 a[116:119], v17, s[20:23], s33 offen offset:1024 sc1
    v_mfma_f32_16x16x32_bf16 v[172:175], v[48:51], a[44:47], v[172:175]
    s_waitcnt lgkmcnt(4)
    v_mfma_f32_16x16x32_bf16 v[176:179], v[52:55], a[32:35], v[176:179]
    ds_read_b64_tr_b16 v[48:49], v28 offset:28672
    v_mfma_f32_16x16x32_bf16 v[180:183], v[52:55], a[36:39], v[180:183]
    ds_read_b64_tr_b16 v[50:51], v28 offset:30720
    v_mfma_f32_16x16x32_bf16 v[184:187], v[52:55], a[40:43], v[184:187]
    buffer_load_dwordx4 a[104:107], v18, s[20:23], s33 offen offset:0 sc1
    v_mfma_f32_16x16x32_bf16 v[188:191], v[52:55], a[44:47], v[188:191]
    s_waitcnt lgkmcnt(4)
    v_mfma_f32_16x16x32_bf16 v[192:195], v[56:59], a[32:35], v[192:195]
    ds_read_b64_tr_b16 v[52:53], v28 offset:32768
    v_mfma_f32_16x16x32_bf16 v[196:199], v[56:59], a[36:39], v[196:199]
    ds_read_b64_tr_b16 v[54:55], v28 offset:34816
    v_mfma_f32_16x16x32_bf16 v[200:203], v[56:59], a[40:43], v[200:203]
    buffer_load_dwordx4 a[120:123], v18, s[20:23], s33 offen offset:1024 sc1
    v_mfma_f32_16x16x32_bf16 v[204:207], v[56:59], a[44:47], v[204:207]
    s_waitcnt lgkmcnt(4)
    v_mfma_f32_16x16x32_bf16 v[208:211], v[60:63], a[32:35], v[208:211]
    ds_read_b64_tr_b16 v[56:57], v29 offset:28672
    v_mfma_f32_16x16x32_bf16 v[212:215], v[60:63], a[36:39], v[212:215]
    ds_read_b64_tr_b16 v[58:59], v29 offset:30720
    v_mfma_f32_16x16x32_bf16 v[216:219], v[60:63], a[40:43], v[216:219]
    buffer_load_dwordx4 a[108:111], v19, s[20:23], s33 offen offset:0 sc1
    v_mfma_f32_16x16x32_bf16 v[220:223], v[60:63], a[44:47], v[220:223]
    s_waitcnt lgkmcnt(4)
    v_mfma_f32_16x16x32_bf16 v[96:99], v[48:51], a[48:51], v[96:99]
    ds_read_b64_tr_b16 v[60:61], v29 offset:32768
    v_mfma_f32_16x16x32_bf16 v[100:103], v[48:51], a[52:55], v[100:103]
    ds_read_b64_tr_b16 v[62:63], v29 offset:34816
    v_mfma_f32_16x16x32_bf16 v[104:107], v[48:51], a[56:59], v[104:107]
    buffer_load_dwordx4 a[124:127], v19, s[20:23], s33 offen offset:1024 sc1
    s_add_u32 s33, s33, 2048
    v_mfma_f32_16x16x32_bf16 v[108:111], v[48:51], a[60:63], v[108:111]
    s_waitcnt lgkmcnt(4)
    v_mfma_f32_16x16x32_bf16 v[112:115], v[52:55], a[48:51], v[112:115]
    ds_read_b64_tr_b16 v[48:49], v30 offset:28672
    v_mfma_f32_16x16x32_bf16 v[116:119], v[52:55], a[52:55], v[116:119]
    ds_read_b64_tr_b16 v[50:51], v30 offset:30720
    v_mfma_f32_16x16x32_bf16 v[120:123], v[52:55], a[56:59], v[120:123]
    buffer_load_dword v27, v21, s[20:23], s89 offen sc1
    s_add_u32 s89, s89, 2048
    v_mfma_f32_16x16x32_bf16 v[124:127], v[52:55], a[60:63], v[124:127]
    s_waitcnt lgkmcnt(4)
    v_mfma_f32_16x16x32_bf16 v[128:131], v[56:59], a[48:51], v[128:131]
    ds_read_b64_tr_b16 v[52:53], v30 offset:32768
    v_mfma_f32_16x16x32_bf16 v[132:135], v[56:59], a[52:55], v[132:135]
    ds_read_b64_tr_b16 v[54:55], v30 offset:34816
    v_mfma_f32_16x16x32_bf16 v[136:139], v[56:59], a[56:59], v[136:139]
    s_add_u32 m0, s34, 0
    v_mfma_f32_16x16x32_bf16 v[140:143], v[56:59], a[60:63], v[140:143]
    buffer_load_dwordx4 v10, s[12:15], s32 offen lds
    s_waitcnt lgkmcnt(4)
    v_mfma_f32_16x16x32_bf16 v[144:147], v[60:63], a[48:51], v[144:147]
    ds_read_b64_tr_b16 v[56:57], v31 offset:28672
    v_mfma_f32_16x16x32_bf16 v[148:151], v[60:63], a[52:55], v[148:151]
    ds_read_b64_tr_b16 v[58:59], v31 offset:30720
    v_mfma_f32_16x16x32_bf16 v[152:155], v[60:63], a[56:59], v[152:155]
    s_add_u32 m0, s34, 1024
    v_mfma_f32_16x16x32_bf16 v[156:159], v[60:63], a[60:63], v[156:159]
    buffer_load_dwordx4 v11, s[12:15], s32 offen lds
    s_waitcnt lgkmcnt(4)
    v_mfma_f32_16x16x32_bf16 v[160:163], v[48:51], a[48:51], v[160:163]
    ds_read_b64_tr_b16 v[60:61], v31 offset:32768
    v_mfma_f32_16x16x32_bf16 v[164:167], v[48:51], a[52:55], v[164:167]
    ds_read_b64_tr_b16 v[62:63], v31 offset:34816
    v_mfma_f32_16x16x32_bf16 v[168:171], v[48:51], a[56:59], v[168:171]
    s_add_u32 m0, s34, 2048
    v_mfma_f32_16x16x32_bf16 v[172:175], v[48:51], a[60:63], v[172:175]
    buffer_load_dwordx4 v12, s[12:15], s32 offen lds
    s_waitcnt lgkmcnt(4)
    v_mfma_f32_16x16x32_bf16 v[176:179], v[52:55], a[48:51], v[176:179]
    ds_read_b64_tr_b16 v[48:49], v28 offset:40960
    v_mfma_f32_16x16x32_bf16 v[180:183], v[52:55], a[52:55], v[180:183]
    ds_read_b64_tr_b16 v[50:51], v28 offset:43008
    v_mfma_f32_16x16x32_bf16 v[184:187], v[52:55], a[56:59], v[184:187]
    s_add_u32 m0, s34, 3072
    v_mfma_f32_16x16x32_bf16 v[188:191], v[52:55], a[60:63], v[188:191]
    buffer_load_dwordx4 v13, s[12:15], s32 offen lds
    s_waitcnt lgkmcnt(4)
    v_mfma_f32_16x16x32_bf16 v[192:195], v[56:59], a[48:51], v[192:195]
    ds_read_b64_tr_b16 v[52:53], v28 offset:45056
    v_mfma_f32_16x16x32_bf16 v[196:199], v[56:59], a[52:55], v[196:199]
    ds_read_b64_tr_b16 v[54:55], v28 offset:47104
    v_mfma_f32_16x16x32_bf16 v[200:203], v[56:59], a[56:59], v[200:203]
    s_add_u32 s32, s32, 589824
    v_mfma_f32_16x16x32_bf16 v[204:207], v[56:59], a[60:63], v[204:207]
    s_waitcnt lgkmcnt(4)
    v_mfma_f32_16x16x32_bf16 v[208:211], v[60:63], a[48:51], v[208:211]
    ds_read_b64_tr_b16 v[56:57], v29 offset:40960
    v_mfma_f32_16x16x32_bf16 v[212:215], v[60:63], a[52:55], v[212:215]
    ds_read_b64_tr_b16 v[58:59], v29 offset:43008
    v_mfma_f32_16x16x32_bf16 v[216:219], v[60:63], a[56:59], v[216:219]
    v_mfma_f32_16x16x32_bf16 v[220:223], v[60:63], a[60:63], v[220:223]
    s_waitcnt vmcnt(18) lgkmcnt(4)
    v_mfma_f32_16x16x32_bf16 v[96:99], v[48:51], a[64:67], v[96:99]
    ds_read_b64_tr_b16 v[60:61], v29 offset:45056
    v_mfma_f32_16x16x32_bf16 v[100:103], v[48:51], a[68:71], v[100:103]
    ds_read_b64_tr_b16 v[62:63], v29 offset:47104
    v_mfma_f32_16x16x32_bf16 v[104:107], v[48:51], a[72:75], v[104:107]
    v_mfma_f32_16x16x32_bf16 v[108:111], v[48:51], a[76:79], v[108:111]
    s_barrier
    s_waitcnt lgkmcnt(4)
    v_mfma_f32_16x16x32_bf16 v[112:115], v[52:55], a[64:67], v[112:115]
    ds_read_b64_tr_b16 v[48:49], v30 offset:40960
    v_mfma_f32_16x16x32_bf16 v[116:119], v[52:55], a[68:71], v[116:119]
    ds_read_b64_tr_b16 v[50:51], v30 offset:43008
    v_mfma_f32_16x16x32_bf16 v[120:123], v[52:55], a[72:75], v[120:123]
    buffer_load_dwordx4 a[128:131], v16, s[20:23], s33 offen offset:0 sc1
    v_mfma_f32_16x16x32_bf16 v[124:127], v[52:55], a[76:79], v[124:127]
    s_waitcnt lgkmcnt(4)
    v_mfma_f32_16x16x32_bf16 v[128:131], v[56:59], a[64:67], v[128:131]
    ds_read_b64_tr_b16 v[52:53], v30 offset:45056
    v_mfma_f32_16x16x32_bf16 v[132:135], v[56:59], a[68:71], v[132:135]
    ds_read_b64_tr_b16 v[54:55], v30 offset:47104
    v_mfma_f32_16x16x32_bf16 v[136:139], v[56:59], a[72:75], v[136:139]
    buffer_load_dwordx4 a[144:147], v16, s[20:23], s33 offen offset:1024 sc1
    v_mfma_f32_16x16x32_bf16 v[140:143], v[56:59], a[76:79], v[140:143]
    s_waitcnt lgkmcnt(4)
    v_mfma_f32_16x16x32_bf16 v[144:147], v[60:63], a[64:67], v[144:147]
    ds_read_b64_tr_b16 v[56:57], v31 offset:40960
    v_mfma_f32_16x16x32_bf16 v[148:151], v[60:63], a[68:71], v[148:151]
    ds_read_b64_tr_b16 v[58:59], v31 offset:43008
    v_mfma_f32_16x16x32_bf16 v[152:155], v[60:63], a[72:75], v[152:155]
    buffer_load_dwordx4 a[132:135], v17, s[20:23], s33 offen offset:0 sc1
    v_mfma_f32_16x16x32_bf16 v[156:159], v[60:63], a[76:79], v[156:159]
    s_waitcnt lgkmcnt(4)
    v_mfma_f32_16x16x32_bf16 v[160:163], v[48:51], a[64:67], v[160:163]
    ds_read_b64_tr_b16 v[60:61], v31 offset:45056
    v_mfma_f32_16x16x32_bf16 v[164:167], v[48:51], a[68:71], v[164:167]
    ds_read_b64_tr_b16 v[62:63], v31 offset:47104
    v_mfma_f32_16x16x32_bf16 v[168:171], v[48:51], a[72:75], v[168:171]
    buffer_load_dwordx4 a[148:151], v17, s[20:23], s33 offen offset:1024 sc1
    v_mfma_f32_16x16x32_bf16 v[172:175], v[48:51], a[76:79], v[172:175]
    s_waitcnt lgkmcnt(4)
    v_mfma_f32_16x16x32_bf16 v[176:179], v[52:55], a[64:67], v[176:179]
    ds_read_b64_tr_b16 v[48:49], v28 offset:49152
    v_mfma_f32_16x16x32_bf16 v[180:183], v[52:55], a[68:71], v[180:183]
    ds_read_b64_tr_b16 v[50:51], v28 offset:51200
    v_mfma_f32_16x16x32_bf16 v[184:187], v[52:55], a[72:75], v[184:187]
    buffer_load_dwordx4 a[136:139], v18, s[20:23], s33 offen offset:0 sc1
    v_mfma_f32_16x16x32_bf16 v[188:191], v[52:55], a[76:79], v[188:191]
    s_waitcnt lgkmcnt(4)
    v_mfma_f32_16x16x32_bf16 v[192:195], v[56:59], a[64:67], v[192:195]
    ds_read_b64_tr_b16 v[52:53], v28 offset:53248
    v_mfma_f32_16x16x32_bf16 v[196:199], v[56:59], a[68:71], v[196:199]
    ds_read_b64_tr_b16 v[54:55], v28 offset:55296
    v_mfma_f32_16x16x32_bf16 v[200:203], v[56:59], a[72:75], v[200:203]
    buffer_load_dwordx4 a[152:155], v18, s[20:23], s33 offen offset:1024 sc1
    v_mfma_f32_16x16x32_bf16 v[204:207], v[56:59], a[76:79], v[204:207]
    s_waitcnt lgkmcnt(4)
    v_mfma_f32_16x16x32_bf16 v[208:211], v[60:63], a[64:67], v[208:211]
    ds_read_b64_tr_b16 v[56:57], v29 offset:49152
    v_mfma_f32_16x16x32_bf16 v[212:215], v[60:63], a[68:71], v[212:215]
    ds_read_b64_tr_b16 v[58:59], v29 offset:51200
    v_mfma_f32_16x16x32_bf16 v[216:219], v[60:63], a[72:75], v[216:219]
    buffer_load_dwordx4 a[140:143], v19, s[20:23], s33 offen offset:0 sc1
    v_mfma_f32_16x16x32_bf16 v[220:223], v[60:63], a[76:79], v[220:223]
    s_waitcnt lgkmcnt(4)
    v_mfma_f32_16x16x32_bf16 v[96:99], v[48:51], a[80:83], v[96:99]
    ds_read_b64_tr_b16 v[60:61], v29 offset:53248
    v_mfma_f32_16x16x32_bf16 v[100:103], v[48:51], a[84:87], v[100:103]
    ds_read_b64_tr_b16 v[62:63], v29 offset:55296
    v_mfma_f32_16x16x32_bf16 v[104:107], v[48:51], a[88:91], v[104:107]
    buffer_load_dwordx4 a[156:159], v19, s[20:23], s33 offen offset:1024 sc1
    s_add_u32 s33, s33, 2048
    v_mfma_f32_16x16x32_bf16 v[108:111], v[48:51], a[92:95], v[108:111]
    s_waitcnt lgkmcnt(4)
    v_mfma_f32_16x16x32_bf16 v[112:115], v[52:55], a[80:83], v[112:115]
    ds_read_b64_tr_b16 v[48:49], v30 offset:49152
    v_mfma_f32_16x16x32_bf16 v[116:119], v[52:55], a[84:87], v[116:119]
    ds_read_b64_tr_b16 v[50:51], v30 offset:51200
    v_mfma_f32_16x16x32_bf16 v[120:123], v[52:55], a[88:91], v[120:123]
    buffer_load_dword v27, v21, s[20:23], s89 offen sc1
    s_add_u32 s89, s89, 2048
    v_mfma_f32_16x16x32_bf16 v[124:127], v[52:55], a[92:95], v[124:127]
    s_waitcnt lgkmcnt(4)
    v_mfma_f32_16x16x32_bf16 v[128:131], v[56:59], a[80:83], v[128:131]
    ds_read_b64_tr_b16 v[52:53], v30 offset:53248
    v_mfma_f32_16x16x32_bf16 v[132:135], v[56:59], a[84:87], v[132:135]
    ds_read_b64_tr_b16 v[54:55], v30 offset:55296
    v_mfma_f32_16x16x32_bf16 v[136:139], v[56:59], a[88:91], v[136:139]
    s_add_u32 m0, s34, 20480
    v_mfma_f32_16x16x32_bf16 v[140:143], v[56:59], a[92:95], v[140:143]
    buffer_load_dwordx4 v10, s[12:15], s32 offen lds
    s_waitcnt lgkmcnt(4)
    v_mfma_f32_16x16x32_bf16 v[144:147], v[60:63], a[80:83], v[144:147]
    ds_read_b64_tr_b16 v[56:57], v31 offset:49152
    v_mfma_f32_16x16x32_bf16 v[148:151], v[60:63], a[84:87], v[148:151]
    ds_read_b64_tr_b16 v[58:59], v31 offset:51200
    v_mfma_f32_16x16x32_bf16 v[152:155], v[60:63], a[88:91], v[152:155]
    s_add_u32 m0, s34, 21504
    v_mfma_f32_16x16x32_bf16 v[156:159], v[60:63], a[92:95], v[156:159]
    buffer_load_dwordx4 v11, s[12:15], s32 offen lds
    s_waitcnt lgkmcnt(4)
    v_mfma_f32_16x16x32_bf16 v[160:163], v[48:51], a[80:83], v[160:163]
    ds_read_b64_tr_b16 v[60:61], v31 offset:53248
    v_mfma_f32_16x16x32_bf16 v[164:167], v[48:51], a[84:87], v[164:167]
    ds_read_b64_tr_b16 v[62:63], v31 offset:55296
    v_mfma_f32_16x16x32_bf16 v[168:171], v[48:51], a[88:91], v[168:171]
    s_add_u32 m0, s34, 22528
    v_mfma_f32_16x16x32_bf16 v[172:175], v[48:51], a[92:95], v[172:175]
    buffer_load_dwordx4 v12, s[12:15], s32 offen lds
    s_waitcnt lgkmcnt(4)
    v_mfma_f32_16x16x32_bf16 v[176:179], v[52:55], a[80:83], v[176:179]
    ds_read_b64_tr_b16 v[48:49], v32 offset:0
    v_mfma_f32_16x16x32_bf16 v[180:183], v[52:55], a[84:87], v[180:183]
    ds_read_b64_tr_b16 v[50:51], v32 offset:2048
    v_mfma_f32_16x16x32_bf16 v[184:187], v[52:55], a[88:91], v[184:187]
    s_add_u32 m0, s34, 23552
    v_mfma_f32_16x16x32_bf16 v[188:191], v[52:55], a[92:95], v[188:191]
    buffer_load_dwordx4 v13, s[12:15], s32 offen lds
    s_waitcnt lgkmcnt(4)
    v_mfma_f32_16x16x32_bf16 v[192:195], v[56:59], a[80:83], v[192:195]
    ds_read_b64_tr_b16 v[52:53], v32 offset:4096
    v_mfma_f32_16x16x32_bf16 v[196:199], v[56:59], a[84:87], v[196:199]
    ds_read_b64_tr_b16 v[54:55], v32 offset:6144
    v_mfma_f32_16x16x32_bf16 v[200:203], v[56:59], a[88:91], v[200:203]
    s_add_u32 s32, s32, 589824
    v_mfma_f32_16x16x32_bf16 v[204:207], v[56:59], a[92:95], v[204:207]
    s_waitcnt lgkmcnt(4)
    v_mfma_f32_16x16x32_bf16 v[208:211], v[60:63], a[80:83], v[208:211]
    ds_read_b64_tr_b16 v[56:57], v33 offset:0
    v_mfma_f32_16x16x32_bf16 v[212:215], v[60:63], a[84:87], v[212:215]
    ds_read_b64_tr_b16 v[58:59], v33 offset:2048
    v_mfma_f32_16x16x32_bf16 v[216:219], v[60:63], a[88:91], v[216:219]
    v_mfma_f32_16x16x32_bf16 v[220:223], v[60:63], a[92:95], v[220:223]
    s_waitcnt vmcnt(18) lgkmcnt(4)
    v_mfma_f32_16x16x32_bf16 v[96:99], v[48:51], a[96:99], v[96:99]
    ds_read_b64_tr_b16 v[60:61], v33 offset:4096
    v_mfma_f32_16x16x32_bf16 v[100:103], v[48:51], a[100:103], v[100:103]
    ds_read_b64_tr_b16 v[62:63], v33 offset:6144
    v_mfma_f32_16x16x32_bf16 v[104:107], v[48:51], a[104:107], v[104:107]
    v_mfma_f32_16x16x32_bf16 v[108:111], v[48:51], a[108:111], v[108:111]
    s_waitcnt vmcnt(26)
    s_barrier
    s_waitcnt lgkmcnt(4)
    v_mfma_f32_16x16x32_bf16 v[112:115], v[52:55], a[96:99], v[112:115]
    ds_read_b64_tr_b16 v[48:49], v34 offset:0
    v_mfma_f32_16x16x32_bf16 v[116:119], v[52:55], a[100:103], v[116:119]
    ds_read_b64_tr_b16 v[50:51], v34 offset:2048
    v_mfma_f32_16x16x32_bf16 v[120:123], v[52:55], a[104:107], v[120:123]
    buffer_load_dwordx4 a[160:163], v16, s[20:23], s33 offen offset:0 sc1
    v_mfma_f32_16x16x32_bf16 v[124:127], v[52:55], a[108:111], v[124:127]
    s_waitcnt lgkmcnt(4)
    v_mfma_f32_16x16x32_bf16 v[128:131], v[56:59], a[96:99], v[128:131]
    ds_read_b64_tr_b16 v[52:53], v34 offset:4096
    v_mfma_f32_16x16x32_bf16 v[132:135], v[56:59], a[100:103], v[132:135]
    ds_read_b64_tr_b16 v[54:55], v34 offset:6144
    v_mfma_f32_16x16x32_bf16 v[136:139], v[56:59], a[104:107], v[136:139]
    buffer_load_dwordx4 a[176:179], v16, s[20:23], s33 offen offset:1024 sc1
    v_mfma_f32_16x16x32_bf16 v[140:143], v[56:59], a[108:111], v[140:143]
    s_waitcnt lgkmcnt(4)
    v_mfma_f32_16x16x32_bf16 v[144:147], v[60:63], a[96:99], v[144:147]
    ds_read_b64_tr_b16 v[56:57], v35 offset:0
    v_mfma_f32_16x16x32_bf16 v[148:151], v[60:63], a[100:103], v[148:151]
    ds_read_b64_tr_b16 v[58:59], v35 offset:2048
    v_mfma_f32_16x16x32_bf16 v[152:155], v[60:63], a[104:107], v[152:155]
    buffer_load_dwordx4 a[164:167], v17, s[20:23], s33 offen offset:0 sc1
    v_mfma_f32_16x16x32_bf16 v[156:159], v[60:63], a[108:111], v[156:159]
    s_waitcnt lgkmcnt(4)
    v_mfma_f32_16x16x32_bf16 v[160:163], v[48:51], a[96:99], v[160:163]
    ds_read_b64_tr_b16 v[60:61], v35 offset:4096
    v_mfma_f32_16x16x32_bf16 v[164:167], v[48:51], a[100:103], v[164:167]
    ds_read_b64_tr_b16 v[62:63], v35 offset:6144
    v_mfma_f32_16x16x32_bf16 v[168:171], v[48:51], a[104:107], v[168:171]
    buffer_load_dwordx4 a[180:183], v17, s[20:23], s33 offen offset:1024 sc1
    v_mfma_f32_16x16x32_bf16 v[172:175], v[48:51], a[108:111], v[172:175]
    s_waitcnt lgkmcnt(4)
    v_mfma_f32_16x16x32_bf16 v[176:179], v[52:55], a[96:99], v[176:179]
    ds_read_b64_tr_b16 v[48:49], v32 offset:8192
    v_mfma_f32_16x16x32_bf16 v[180:183], v[52:55], a[100:103], v[180:183]
    ds_read_b64_tr_b16 v[50:51], v32 offset:10240
    v_mfma_f32_16x16x32_bf16 v[184:187], v[52:55], a[104:107], v[184:187]
    buffer_load_dwordx4 a[168:171], v18, s[20:23], s33 offen offset:0 sc1
    v_mfma_f32_16x16x32_bf16 v[188:191], v[52:55], a[108:111], v[188:191]
    s_waitcnt lgkmcnt(4)
    v_mfma_f32_16x16x32_bf16 v[192:195], v[56:59], a[96:99], v[192:195]
    ds_read_b64_tr_b16 v[52:53], v32 offset:12288
    v_mfma_f32_16x16x32_bf16 v[196:199], v[56:59], a[100:103], v[196:199]
    ds_read_b64_tr_b16 v[54:55], v32 offset:14336
    v_mfma_f32_16x16x32_bf16 v[200:203], v[56:59], a[104:107], v[200:203]
    buffer_load_dwordx4 a[184:187], v18, s[20:23], s33 offen offset:1024 sc1
    v_mfma_f32_16x16x32_bf16 v[204:207], v[56:59], a[108:111], v[204:207]
    s_waitcnt lgkmcnt(4)
    v_mfma_f32_16x16x32_bf16 v[208:211], v[60:63], a[96:99], v[208:211]
    ds_read_b64_tr_b16 v[56:57], v33 offset:8192
    v_mfma_f32_16x16x32_bf16 v[212:215], v[60:63], a[100:103], v[212:215]
    ds_read_b64_tr_b16 v[58:59], v33 offset:10240
    v_mfma_f32_16x16x32_bf16 v[216:219], v[60:63], a[104:107], v[216:219]
    buffer_load_dwordx4 a[172:175], v19, s[20:23], s33 offen offset:0 sc1
    v_mfma_f32_16x16x32_bf16 v[220:223], v[60:63], a[108:111], v[220:223]
    s_waitcnt lgkmcnt(4)
    v_mfma_f32_16x16x32_bf16 v[96:99], v[48:51], a[112:115], v[96:99]
    ds_read_b64_tr_b16 v[60:61], v33 offset:12288
    v_mfma_f32_16x16x32_bf16 v[100:103], v[48:51], a[116:119], v[100:103]
    ds_read_b64_tr_b16 v[62:63], v33 offset:14336
    v_mfma_f32_16x16x32_bf16 v[104:107], v[48:51], a[120:123], v[104:107]
    buffer_load_dwordx4 a[188:191], v19, s[20:23], s33 offen offset:1024 sc1
    s_add_u32 s33, s33, 2048
    v_mfma_f32_16x16x32_bf16 v[108:111], v[48:51], a[124:127], v[108:111]
    s_waitcnt lgkmcnt(4)
    v_mfma_f32_16x16x32_bf16 v[112:115], v[52:55], a[112:115], v[112:115]
    ds_read_b64_tr_b16 v[48:49], v34 offset:8192
    v_mfma_f32_16x16x32_bf16 v[116:119], v[52:55], a[116:119], v[116:119]
    ds_read_b64_tr_b16 v[50:51], v34 offset:10240
    v_mfma_f32_16x16x32_bf16 v[120:123], v[52:55], a[120:123], v[120:123]
    buffer_load_dword v27, v21, s[20:23], s89 offen sc1
    s_add_u32 s89, s89, 2048
    v_mfma_f32_16x16x32_bf16 v[124:127], v[52:55], a[124:127], v[124:127]
    s_waitcnt lgkmcnt(4)
    v_mfma_f32_16x16x32_bf16 v[128:131], v[56:59], a[112:115], v[128:131]
    ds_read_b64_tr_b16 v[52:53], v34 offset:12288
    v_mfma_f32_16x16x32_bf16 v[132:135], v[56:59], a[116:119], v[132:135]
    ds_read_b64_tr_b16 v[54:55], v34 offset:14336
    v_mfma_f32_16x16x32_bf16 v[136:139], v[56:59], a[120:123], v[136:139]
    s_add_u32 m0, s34, 40960
    v_mfma_f32_16x16x32_bf16 v[140:143], v[56:59], a[124:127], v[140:143]
    buffer_load_dwordx4 v10, s[12:15], s32 offen lds
    s_waitcnt lgkmcnt(4)
    v_mfma_f32_16x16x32_bf16 v[144:147], v[60:63], a[112:115], v[144:147]
    ds_read_b64_tr_b16 v[56:57], v35 offset:8192
    v_mfma_f32_16x16x32_bf16 v[148:151], v[60:63], a[116:119], v[148:151]
    ds_read_b64_tr_b16 v[58:59], v35 offset:10240
    v_mfma_f32_16x16x32_bf16 v[152:155], v[60:63], a[120:123], v[152:155]
    s_add_u32 m0, s34, 41984
    v_mfma_f32_16x16x32_bf16 v[156:159], v[60:63], a[124:127], v[156:159]
    buffer_load_dwordx4 v11, s[12:15], s32 offen lds
    s_waitcnt lgkmcnt(4)
    v_mfma_f32_16x16x32_bf16 v[160:163], v[48:51], a[112:115], v[160:163]
    ds_read_b64_tr_b16 v[60:61], v35 offset:12288
    v_mfma_f32_16x16x32_bf16 v[164:167], v[48:51], a[116:119], v[164:167]
    ds_read_b64_tr_b16 v[62:63], v35 offset:14336
    v_mfma_f32_16x16x32_bf16 v[168:171], v[48:51], a[120:123], v[168:171]
    s_add_u32 m0, s34, 43008
    v_mfma_f32_16x16x32_bf16 v[172:175], v[48:51], a[124:127], v[172:175]
    buffer_load_dwordx4 v12, s[12:15], s32 offen lds
    s_waitcnt lgkmcnt(4)
    v_mfma_f32_16x16x32_bf16 v[176:179], v[52:55], a[112:115], v[176:179]
    ds_read_b64_tr_b16 v[48:49], v32 offset:20480
    v_mfma_f32_16x16x32_bf16 v[180:183], v[52:55], a[116:119], v[180:183]
    ds_read_b64_tr_b16 v[50:51], v32 offset:22528
    v_mfma_f32_16x16x32_bf16 v[184:187], v[52:55], a[120:123], v[184:187]
    s_add_u32 m0, s34, 44032
    v_mfma_f32_16x16x32_bf16 v[188:191], v[52:55], a[124:127], v[188:191]
    buffer_load_dwordx4 v13, s[12:15], s32 offen lds
    s_waitcnt lgkmcnt(4)
    v_mfma_f32_16x16x32_bf16 v[192:195], v[56:59], a[112:115], v[192:195]
    ds_read_b64_tr_b16 v[52:53], v32 offset:24576
    v_mfma_f32_16x16x32_bf16 v[196:199], v[56:59], a[116:119], v[196:199]
    ds_read_b64_tr_b16 v[54:55], v32 offset:26624
    v_mfma_f32_16x16x32_bf16 v[200:203], v[56:59], a[120:123], v[200:203]
    s_add_u32 s32, s32, 589824
    v_mfma_f32_16x16x32_bf16 v[204:207], v[56:59], a[124:127], v[204:207]
    s_waitcnt lgkmcnt(4)
    v_mfma_f32_16x16x32_bf16 v[208:211], v[60:63], a[112:115], v[208:211]
    ds_read_b64_tr_b16 v[56:57], v33 offset:20480
    v_mfma_f32_16x16x32_bf16 v[212:215], v[60:63], a[116:119], v[212:215]
    ds_read_b64_tr_b16 v[58:59], v33 offset:22528
    v_mfma_f32_16x16x32_bf16 v[216:219], v[60:63], a[120:123], v[216:219]
    v_mfma_f32_16x16x32_bf16 v[220:223], v[60:63], a[124:127], v[220:223]
    s_waitcnt vmcnt(18) lgkmcnt(4)
    v_mfma_f32_16x16x32_bf16 v[96:99], v[48:51], a[128:131], v[96:99]
    ds_read_b64_tr_b16 v[60:61], v33 offset:24576
    v_mfma_f32_16x16x32_bf16 v[100:103], v[48:51], a[132:135], v[100:103]
    ds_read_b64_tr_b16 v[62:63], v33 offset:26624
    v_mfma_f32_16x16x32_bf16 v[104:107], v[48:51], a[136:139], v[104:107]
    v_mfma_f32_16x16x32_bf16 v[108:111], v[48:51], a[140:143], v[108:111]
    s_waitcnt vmcnt(26)
    s_barrier
    s_waitcnt lgkmcnt(4)
    v_mfma_f32_16x16x32_bf16 v[112:115], v[52:55], a[128:131], v[112:115]
    ds_read_b64_tr_b16 v[48:49], v34 offset:20480
    v_mfma_f32_16x16x32_bf16 v[116:119], v[52:55], a[132:135], v[116:119]
    ds_read_b64_tr_b16 v[50:51], v34 offset:22528
    v_mfma_f32_16x16x32_bf16 v[120:123], v[52:55], a[136:139], v[120:123]
    buffer_load_dwordx4 a[192:195], v16, s[20:23], s33 offen offset:0 sc1
    v_mfma_f32_16x16x32_bf16 v[124:127], v[52:55], a[140:143], v[124:127]
    s_waitcnt lgkmcnt(4)
    v_mfma_f32_16x16x32_bf16 v[128:131], v[56:59], a[128:131], v[128:131]
    ds_read_b64_tr_b16 v[52:53], v34 offset:24576
    v_mfma_f32_16x16x32_bf16 v[132:135], v[56:59], a[132:135], v[132:135]
    ds_read_b64_tr_b16 v[54:55], v34 offset:26624
    v_mfma_f32_16x16x32_bf16 v[136:139], v[56:59], a[136:139], v[136:139]
    buffer_load_dwordx4 a[208:211], v16, s[20:23], s33 offen offset:1024 sc1
    v_mfma_f32_16x16x32_bf16 v[140:143], v[56:59], a[140:143], v[140:143]
    s_waitcnt lgkmcnt(4)
    v_mfma_f32_16x16x32_bf16 v[144:147], v[60:63], a[128:131], v[144:147]
    ds_read_b64_tr_b16 v[56:57], v35 offset:20480
    v_mfma_f32_16x16x32_bf16 v[148:151], v[60:63], a[132:135], v[148:151]
    ds_read_b64_tr_b16 v[58:59], v35 offset:22528
    v_mfma_f32_16x16x32_bf16 v[152:155], v[60:63], a[136:139], v[152:155]
    buffer_load_dwordx4 a[196:199], v17, s[20:23], s33 offen offset:0 sc1
    v_mfma_f32_16x16x32_bf16 v[156:159], v[60:63], a[140:143], v[156:159]
    s_waitcnt lgkmcnt(4)
    v_mfma_f32_16x16x32_bf16 v[160:163], v[48:51], a[128:131], v[160:163]
    ds_read_b64_tr_b16 v[60:61], v35 offset:24576
    v_mfma_f32_16x16x32_bf16 v[164:167], v[48:51], a[132:135], v[164:167]
    ds_read_b64_tr_b16 v[62:63], v35 offset:26624
    v_mfma_f32_16x16x32_bf16 v[168:171], v[48:51], a[136:139], v[168:171]
    buffer_load_dwordx4 a[212:215], v17, s[20:23], s33 offen offset:1024 sc1
    v_mfma_f32_16x16x32_bf16 v[172:175], v[48:51], a[140:143], v[172:175]
    s_waitcnt lgkmcnt(4)
    v_mfma_f32_16x16x32_bf16 v[176:179], v[52:55], a[128:131], v[176:179]
    ds_read_b64_tr_b16 v[48:49], v32 offset:28672
    v_mfma_f32_16x16x32_bf16 v[180:183], v[52:55], a[132:135], v[180:183]
    ds_read_b64_tr_b16 v[50:51], v32 offset:30720
    v_mfma_f32_16x16x32_bf16 v[184:187], v[52:55], a[136:139], v[184:187]
    buffer_load_dwordx4 a[200:203], v18, s[20:23], s33 offen offset:0 sc1
    v_mfma_f32_16x16x32_bf16 v[188:191], v[52:55], a[140:143], v[188:191]
    s_waitcnt lgkmcnt(4)
    v_mfma_f32_16x16x32_bf16 v[192:195], v[56:59], a[128:131], v[192:195]
    ds_read_b64_tr_b16 v[52:53], v32 offset:32768
    v_mfma_f32_16x16x32_bf16 v[196:199], v[56:59], a[132:135], v[196:199]
    ds_read_b64_tr_b16 v[54:55], v32 offset:34816
    v_mfma_f32_16x16x32_bf16 v[200:203], v[56:59], a[136:139], v[200:203]
    buffer_load_dwordx4 a[216:219], v18, s[20:23], s33 offen offset:1024 sc1
    v_mfma_f32_16x16x32_bf16 v[204:207], v[56:59], a[140:143], v[204:207]
    s_waitcnt lgkmcnt(4)
    v_mfma_f32_16x16x32_bf16 v[208:211], v[60:63], a[128:131], v[208:211]
    ds_read_b64_tr_b16 v[56:57], v33 offset:28672
    v_mfma_f32_16x16x32_bf16 v[212:215], v[60:63], a[132:135], v[212:215]
    ds_read_b64_tr_b16 v[58:59], v33 offset:30720
    v_mfma_f32_16x16x32_bf16 v[216:219], v[60:63], a[136:139], v[216:219]
    buffer_load_dwordx4 a[204:207], v19, s[20:23], s33 offen offset:0 sc1
    v_mfma_f32_16x16x32_bf16 v[220:223], v[60:63], a[140:143], v[220:223]
    s_waitcnt lgkmcnt(4)
    v_mfma_f32_16x16x32_bf16 v[96:99], v[48:51], a[144:147], v[96:99]
    ds_read_b64_tr_b16 v[60:61], v33 offset:32768
    v_mfma_f32_16x16x32_bf16 v[100:103], v[48:51], a[148:151], v[100:103]
    ds_read_b64_tr_b16 v[62:63], v33 offset:34816
    v_mfma_f32_16x16x32_bf16 v[104:107], v[48:51], a[152:155], v[104:107]
    buffer_load_dwordx4 a[220:223], v19, s[20:23], s33 offen offset:1024 sc1
    s_add_u32 s33, s33, 2048
    v_mfma_f32_16x16x32_bf16 v[108:111], v[48:51], a[156:159], v[108:111]
    s_waitcnt lgkmcnt(4)
    v_mfma_f32_16x16x32_bf16 v[112:115], v[52:55], a[144:147], v[112:115]
    ds_read_b64_tr_b16 v[48:49], v34 offset:28672
    v_mfma_f32_16x16x32_bf16 v[116:119], v[52:55], a[148:151], v[116:119]
    ds_read_b64_tr_b16 v[50:51], v34 offset:30720
    v_mfma_f32_16x16x32_bf16 v[120:123], v[52:55], a[152:155], v[120:123]
    buffer_load_dword v27, v21, s[20:23], s89 offen sc1
    s_add_u32 s89, s89, 2048
    v_mfma_f32_16x16x32_bf16 v[124:127], v[52:55], a[156:159], v[124:127]
    s_waitcnt lgkmcnt(4)
    v_mfma_f32_16x16x32_bf16 v[128:131], v[56:59], a[144:147], v[128:131]
    ds_read_b64_tr_b16 v[52:53], v34 offset:32768
    v_mfma_f32_16x16x32_bf16 v[132:135], v[56:59], a[148:151], v[132:135]
    ds_read_b64_tr_b16 v[54:55], v34 offset:34816
    v_mfma_f32_16x16x32_bf16 v[136:139], v[56:59], a[152:155], v[136:139]
    s_add_u32 m0, s34, 61440
    v_mfma_f32_16x16x32_bf16 v[140:143], v[56:59], a[156:159], v[140:143]
    buffer_load_dwordx4 v10, s[12:15], s32 offen lds
    s_waitcnt lgkmcnt(4)
    v_mfma_f32_16x16x32_bf16 v[144:147], v[60:63], a[144:147], v[144:147]
    ds_read_b64_tr_b16 v[56:57], v35 offset:28672
    v_mfma_f32_16x16x32_bf16 v[148:151], v[60:63], a[148:151], v[148:151]
    ds_read_b64_tr_b16 v[58:59], v35 offset:30720
    v_mfma_f32_16x16x32_bf16 v[152:155], v[60:63], a[152:155], v[152:155]
    s_add_u32 m0, s34, 62464
    v_mfma_f32_16x16x32_bf16 v[156:159], v[60:63], a[156:159], v[156:159]
    buffer_load_dwordx4 v11, s[12:15], s32 offen lds
    s_waitcnt lgkmcnt(4)
    v_mfma_f32_16x16x32_bf16 v[160:163], v[48:51], a[144:147], v[160:163]
    ds_read_b64_tr_b16 v[60:61], v35 offset:32768
    v_mfma_f32_16x16x32_bf16 v[164:167], v[48:51], a[148:151], v[164:167]
    ds_read_b64_tr_b16 v[62:63], v35 offset:34816
    v_mfma_f32_16x16x32_bf16 v[168:171], v[48:51], a[152:155], v[168:171]
    s_add_u32 m0, s34, 63488
    v_mfma_f32_16x16x32_bf16 v[172:175], v[48:51], a[156:159], v[172:175]
    buffer_load_dwordx4 v12, s[12:15], s32 offen lds
    s_waitcnt lgkmcnt(4)
    v_mfma_f32_16x16x32_bf16 v[176:179], v[52:55], a[144:147], v[176:179]
    ds_read_b64_tr_b16 v[48:49], v28 offset:0
    v_mfma_f32_16x16x32_bf16 v[180:183], v[52:55], a[148:151], v[180:183]
    ds_read_b64_tr_b16 v[50:51], v28 offset:2048
    v_mfma_f32_16x16x32_bf16 v[184:187], v[52:55], a[152:155], v[184:187]
    s_add_u32 m0, s34, 64512
    v_mfma_f32_16x16x32_bf16 v[188:191], v[52:55], a[156:159], v[188:191]
    buffer_load_dwordx4 v13, s[12:15], s32 offen lds
    s_waitcnt lgkmcnt(4)
    v_mfma_f32_16x16x32_bf16 v[192:195], v[56:59], a[144:147], v[192:195]
    ds_read_b64_tr_b16 v[52:53], v28 offset:4096
    v_mfma_f32_16x16x32_bf16 v[196:199], v[56:59], a[148:151], v[196:199]
    ds_read_b64_tr_b16 v[54:55], v28 offset:6144
    v_mfma_f32_16x16x32_bf16 v[200:203], v[56:59], a[152:155], v[200:203]
    s_sub_u32 s32, s32, s38
    v_lshrrev_b32 v3, 2, v0
    v_mfma_f32_16x16x32_bf16 v[204:207], v[56:59], a[156:159], v[204:207]
    v_min_u32 v3, 9, v3
    s_waitcnt lgkmcnt(4)
    v_mfma_f32_16x16x32_bf16 v[208:211], v[60:63], a[144:147], v[208:211]
    ds_read_b64_tr_b16 v[56:57], v29 offset:0
    v_mfma_f32_16x16x32_bf16 v[212:215], v[60:63], a[148:151], v[212:215]
    ds_read_b64_tr_b16 v[58:59], v29 offset:2048
    v_mfma_f32_16x16x32_bf16 v[216:219], v[60:63], a[152:155], v[216:219]
    v_and_b32 v2, 1, v3
    v_mul_u32_u24 v6, 9216, v2
    v_mfma_f32_16x16x32_bf16 v[220:223], v[60:63], a[156:159], v[220:223]
    v_lshrrev_b32 v2, 1, v3
    v_lshl_add_u32 v6, v2, 7, v6
    s_and_b32 s90, s40, 3
    s_lshl_b32 s90, s90, 2
    s_add_u32 s90, s90, s42
    s_lshl_b32 s90, s90, 1
    s_lshr_b32 s49, s3, 1
    s_lshl_b32 s49, s49, 5
    s_add_u32 s90, s90, s49
    s_mul_i32 s90, s90, 9216
    s_mul_i32 s49, s41, 1152
    s_add_u32 s49, s49, 512
    s_add_u32 s49, s49, s90
    buffer_load_dword v27, v6, s[12:15], s49 offen
    s_add_u32 s49, s49, 589824
    s_waitcnt vmcnt(19) lgkmcnt(4)
    v_mfma_f32_16x16x32_bf16 v[96:99], v[48:51], a[160:163], v[96:99]
    ds_read_b64_tr_b16 v[60:61], v29 offset:4096
    v_mfma_f32_16x16x32_bf16 v[100:103], v[48:51], a[164:167], v[100:103]
    ds_read_b64_tr_b16 v[62:63], v29 offset:6144
    v_mfma_f32_16x16x32_bf16 v[104:107], v[48:51], a[168:171], v[104:107]
    v_mfma_f32_16x16x32_bf16 v[108:111], v[48:51], a[172:175], v[108:111]
    s_waitcnt vmcnt(27)
    s_barrier
    s_waitcnt lgkmcnt(4)
    v_mfma_f32_16x16x32_bf16 v[112:115], v[52:55], a[160:163], v[112:115]
    ds_read_b64_tr_b16 v[48:49], v30 offset:0
    v_mfma_f32_16x16x32_bf16 v[116:119], v[52:55], a[164:167], v[116:119]
    ds_read_b64_tr_b16 v[50:51], v30 offset:2048
    v_mfma_f32_16x16x32_bf16 v[120:123], v[52:55], a[168:171], v[120:123]
    buffer_load_dwordx4 a[224:227], v16, s[20:23], s33 offen offset:0 sc1
    v_mfma_f32_16x16x32_bf16 v[124:127], v[52:55], a[172:175], v[124:127]
    s_waitcnt lgkmcnt(4)
    v_mfma_f32_16x16x32_bf16 v[128:131], v[56:59], a[160:163], v[128:131]
    ds_read_b64_tr_b16 v[52:53], v30 offset:4096
    v_mfma_f32_16x16x32_bf16 v[132:135], v[56:59], a[164:167], v[132:135]
    ds_read_b64_tr_b16 v[54:55], v30 offset:6144
    v_mfma_f32_16x16x32_bf16 v[136:139], v[56:59], a[168:171], v[136:139]
    buffer_load_dwordx4 a[240:243], v16, s[20:23], s33 offen offset:1024 sc1
    v_mfma_f32_16x16x32_bf16 v[140:143], v[56:59], a[172:175], v[140:143]
    s_waitcnt lgkmcnt(4)
    v_mfma_f32_16x16x32_bf16 v[144:147], v[60:63], a[160:163], v[144:147]
    ds_read_b64_tr_b16 v[56:57], v31 offset:0
    v_mfma_f32_16x16x32_bf16 v[148:151], v[60:63], a[164:167], v[148:151]
    ds_read_b64_tr_b16 v[58:59], v31 offset:2048
    v_mfma_f32_16x16x32_bf16 v[152:155], v[60:63], a[168:171], v[152:155]
    v_mfma_f32_16x16x32_bf16 v[156:159], v[60:63], a[172:175], v[156:159]
    s_waitcnt lgkmcnt(4)
    v_mfma_f32_16x16x32_bf16 v[160:163], v[48:51], a[160:163], v[160:163]
    ds_read_b64_tr_b16 v[60:61], v31 offset:4096
    v_mfma_f32_16x16x32_bf16 v[164:167], v[48:51], a[164:167], v[164:167]
    ds_read_b64_tr_b16 v[62:63], v31 offset:6144
    v_mfma_f32_16x16x32_bf16 v[168:171], v[48:51], a[168:171], v[168:171]
    buffer_load_dwordx4 a[228:231], v17, s[20:23], s33 offen offset:0 sc1
    v_mfma_f32_16x16x32_bf16 v[172:175], v[48:51], a[172:175], v[172:175]
    s_waitcnt lgkmcnt(4)
    v_mfma_f32_16x16x32_bf16 v[176:179], v[52:55], a[160:163], v[176:179]
    ds_read_b64_tr_b16 v[48:49], v28 offset:8192
    v_mfma_f32_16x16x32_bf16 v[180:183], v[52:55], a[164:167], v[180:183]
    ds_read_b64_tr_b16 v[50:51], v28 offset:10240
    v_mfma_f32_16x16x32_bf16 v[184:187], v[52:55], a[168:171], v[184:187]
    buffer_load_dwordx4 a[244:247], v17, s[20:23], s33 offen offset:1024 sc1
    v_mfma_f32_16x16x32_bf16 v[188:191], v[52:55], a[172:175], v[188:191]
    s_waitcnt lgkmcnt(4)
    v_mfma_f32_16x16x32_bf16 v[192:195], v[56:59], a[160:163], v[192:195]
    ds_read_b64_tr_b16 v[52:53], v28 offset:12288
    v_mfma_f32_16x16x32_bf16 v[196:199], v[56:59], a[164:167], v[196:199]
    ds_read_b64_tr_b16 v[54:55], v28 offset:14336
    v_mfma_f32_16x16x32_bf16 v[200:203], v[56:59], a[168:171], v[200:203]
    v_mfma_f32_16x16x32_bf16 v[204:207], v[56:59], a[172:175], v[204:207]
    s_waitcnt lgkmcnt(4)
    v_mfma_f32_16x16x32_bf16 v[208:211], v[60:63], a[160:163], v[208:211]
    ds_read_b64_tr_b16 v[56:57], v29 offset:8192
    v_mfma_f32_16x16x32_bf16 v[212:215], v[60:63], a[164:167], v[212:215]
    ds_read_b64_tr_b16 v[58:59], v29 offset:10240
    v_mfma_f32_16x16x32_bf16 v[216:219], v[60:63], a[168:171], v[216:219]
    buffer_load_dwordx4 a[232:235], v18, s[20:23], s33 offen offset:0 sc1
    v_mfma_f32_16x16x32_bf16 v[220:223], v[60:63], a[172:175], v[220:223]
    s_waitcnt lgkmcnt(4)
    v_mfma_f32_16x16x32_bf16 v[96:99], v[48:51], a[176:179], v[96:99]
    ds_read_b64_tr_b16 v[60:61], v29 offset:12288
    v_mfma_f32_16x16x32_bf16 v[100:103], v[48:51], a[180:183], v[100:103]
    ds_read_b64_tr_b16 v[62:63], v29 offset:14336
    v_mfma_f32_16x16x32_bf16 v[104:107], v[48:51], a[184:187], v[104:107]
    buffer_load_dwordx4 a[248:251], v18, s[20:23], s33 offen offset:1024 sc1
    v_mfma_f32_16x16x32_bf16 v[108:111], v[48:51], a[188:191], v[108:111]
    s_waitcnt lgkmcnt(4)
    v_mfma_f32_16x16x32_bf16 v[112:115], v[52:55], a[176:179], v[112:115]
    ds_read_b64_tr_b16 v[48:49], v30 offset:8192
    v_mfma_f32_16x16x32_bf16 v[116:119], v[52:55], a[180:183], v[116:119]
    ds_read_b64_tr_b16 v[50:51], v30 offset:10240
    v_mfma_f32_16x16x32_bf16 v[120:123], v[52:55], a[184:187], v[120:123]
    v_mfma_f32_16x16x32_bf16 v[124:127], v[52:55], a[188:191], v[124:127]
    s_waitcnt lgkmcnt(4)
    v_mfma_f32_16x16x32_bf16 v[128:131], v[56:59], a[176:179], v[128:131]
    ds_read_b64_tr_b16 v[52:53], v30 offset:12288
    v_mfma_f32_16x16x32_bf16 v[132:135], v[56:59], a[180:183], v[132:135]
    ds_read_b64_tr_b16 v[54:55], v30 offset:14336
    v_mfma_f32_16x16x32_bf16 v[136:139], v[56:59], a[184:187], v[136:139]
    buffer_load_dwordx4 a[236:239], v19, s[20:23], s33 offen offset:0 sc1
    v_mfma_f32_16x16x32_bf16 v[140:143], v[56:59], a[188:191], v[140:143]
    s_waitcnt lgkmcnt(4)
    v_mfma_f32_16x16x32_bf16 v[144:147], v[60:63], a[176:179], v[144:147]
    ds_read_b64_tr_b16 v[56:57], v31 offset:8192
    v_mfma_f32_16x16x32_bf16 v[148:151], v[60:63], a[180:183], v[148:151]
    ds_read_b64_tr_b16 v[58:59], v31 offset:10240
    v_mfma_f32_16x16x32_bf16 v[152:155], v[60:63], a[184:187], v[152:155]
    buffer_load_dwordx4 a[252:255], v19, s[20:23], s33 offen offset:1024 sc1
    s_add_u32 s33, s33, 2048
    v_mfma_f32_16x16x32_bf16 v[156:159], v[60:63], a[188:191], v[156:159]
    s_waitcnt lgkmcnt(4)
    v_mfma_f32_16x16x32_bf16 v[160:163], v[48:51], a[176:179], v[160:163]
    ds_read_b64_tr_b16 v[60:61], v31 offset:12288
    v_mfma_f32_16x16x32_bf16 v[164:167], v[48:51], a[180:183], v[164:167]
    ds_read_b64_tr_b16 v[62:63], v31 offset:14336
    v_mfma_f32_16x16x32_bf16 v[168:171], v[48:51], a[184:187], v[168:171]
    v_mfma_f32_16x16x32_bf16 v[172:175], v[48:51], a[188:191], v[172:175]
    s_waitcnt lgkmcnt(4)
    v_mfma_f32_16x16x32_bf16 v[176:179], v[52:55], a[176:179], v[176:179]
    ds_read_b64_tr_b16 v[48:49], v28 offset:20480
    v_mfma_f32_16x16x32_bf16 v[180:183], v[52:55], a[180:183], v[180:183]
    ds_read_b64_tr_b16 v[50:51], v28 offset:22528
    v_mfma_f32_16x16x32_bf16 v[184:187], v[52:55], a[184:187], v[184:187]
    buffer_load_dword v27, v6, s[12:15], s49 offen
    s_add_u32 s49, s49, 589824
    v_mfma_f32_16x16x32_bf16 v[188:191], v[52:55], a[188:191], v[188:191]
    s_waitcnt lgkmcnt(4)
    v_mfma_f32_16x16x32_bf16 v[192:195], v[56:59], a[176:179], v[192:195]
    ds_read_b64_tr_b16 v[52:53], v28 offset:24576
    v_mfma_f32_16x16x32_bf16 v[196:199], v[56:59], a[180:183], v[196:199]
    ds_read_b64_tr_b16 v[54:55], v28 offset:26624
    v_mfma_f32_16x16x32_bf16 v[200:203], v[56:59], a[184:187], v[200:203]
    v_mfma_f32_16x16x32_bf16 v[204:207], v[56:59], a[188:191], v[204:207]
    s_waitcnt lgkmcnt(4)
    v_mfma_f32_16x16x32_bf16 v[208:211], v[60:63], a[176:179], v[208:211]
    ds_read_b64_tr_b16 v[56:57], v29 offset:20480
    v_mfma_f32_16x16x32_bf16 v[212:215], v[60:63], a[180:183], v[212:215]
    ds_read_b64_tr_b16 v[58:59], v29 offset:22528
    v_mfma_f32_16x16x32_bf16 v[216:219], v[60:63], a[184:187], v[216:219]
    v_mfma_f32_16x16x32_bf16 v[220:223], v[60:63], a[188:191], v[220:223]
    s_waitcnt vmcnt(15) lgkmcnt(4)
    v_mfma_f32_16x16x32_bf16 v[96:99], v[48:51], a[192:195], v[96:99]
    ds_read_b64_tr_b16 v[60:61], v29 offset:24576
    v_mfma_f32_16x16x32_bf16 v[100:103], v[48:51], a[196:199], v[100:103]
    ds_read_b64_tr_b16 v[62:63], v29 offset:26624
    v_mfma_f32_16x16x32_bf16 v[104:107], v[48:51], a[200:203], v[104:107]
    v_mfma_f32_16x16x32_bf16 v[108:111], v[48:51], a[204:207], v[108:111]
    s_waitcnt vmcnt(23)
    s_barrier
    s_waitcnt lgkmcnt(4)
    v_mfma_f32_16x16x32_bf16 v[112:115], v[52:55], a[192:195], v[112:115]
    ds_read_b64_tr_b16 v[48:49], v30 offset:20480
    v_mfma_f32_16x16x32_bf16 v[116:119], v[52:55], a[196:199], v[116:119]
    ds_read_b64_tr_b16 v[50:51], v30 offset:22528
    v_mfma_f32_16x16x32_bf16 v[120:123], v[52:55], a[200:203], v[120:123]
    buffer_load_dwordx4 v[64:67], v16, s[20:23], s33 offen offset:0 sc1
    v_mfma_f32_16x16x32_bf16 v[124:127], v[52:55], a[204:207], v[124:127]
    s_waitcnt lgkmcnt(4)
    v_mfma_f32_16x16x32_bf16 v[128:131], v[56:59], a[192:195], v[128:131]
    ds_read_b64_tr_b16 v[52:53], v30 offset:24576
    v_mfma_f32_16x16x32_bf16 v[132:135], v[56:59], a[196:199], v[132:135]
    ds_read_b64_tr_b16 v[54:55], v30 offset:26624
    v_mfma_f32_16x16x32_bf16 v[136:139], v[56:59], a[200:203], v[136:139]
    buffer_load_dwordx4 v[80:83], v16, s[20:23], s33 offen offset:1024 sc1
    v_mfma_f32_16x16x32_bf16 v[140:143], v[56:59], a[204:207], v[140:143]
    s_waitcnt lgkmcnt(4)
    v_mfma_f32_16x16x32_bf16 v[144:147], v[60:63], a[192:195], v[144:147]
    ds_read_b64_tr_b16 v[56:57], v31 offset:20480
    v_mfma_f32_16x16x32_bf16 v[148:151], v[60:63], a[196:199], v[148:151]
    ds_read_b64_tr_b16 v[58:59], v31 offset:22528
    v_mfma_f32_16x16x32_bf16 v[152:155], v[60:63], a[200:203], v[152:155]
    buffer_load_dwordx4 v[68:71], v17, s[20:23], s33 offen offset:0 sc1
    v_mfma_f32_16x16x32_bf16 v[156:159], v[60:63], a[204:207], v[156:159]
    s_waitcnt lgkmcnt(4)
    v_mfma_f32_16x16x32_bf16 v[160:163], v[48:51], a[192:195], v[160:163]
    ds_read_b64_tr_b16 v[60:61], v31 offset:24576
    v_mfma_f32_16x16x32_bf16 v[164:167], v[48:51], a[196:199], v[164:167]
    ds_read_b64_tr_b16 v[62:63], v31 offset:26624
    v_mfma_f32_16x16x32_bf16 v[168:171], v[48:51], a[200:203], v[168:171]
    buffer_load_dwordx4 v[84:87], v17, s[20:23], s33 offen offset:1024 sc1
    v_mfma_f32_16x16x32_bf16 v[172:175], v[48:51], a[204:207], v[172:175]
    s_waitcnt lgkmcnt(4)
    v_mfma_f32_16x16x32_bf16 v[176:179], v[52:55], a[192:195], v[176:179]
    ds_read_b64_tr_b16 v[48:49], v28 offset:28672
    v_mfma_f32_16x16x32_bf16 v[180:183], v[52:55], a[196:199], v[180:183]
    ds_read_b64_tr_b16 v[50:51], v28 offset:30720
    v_mfma_f32_16x16x32_bf16 v[184:187], v[52:55], a[200:203], v[184:187]
    buffer_load_dwordx4 v[72:75], v18, s[20:23], s33 offen offset:0 sc1
    v_mfma_f32_16x16x32_bf16 v[188:191], v[52:55], a[204:207], v[188:191]
    s_waitcnt lgkmcnt(4)
    v_mfma_f32_16x16x32_bf16 v[192:195], v[56:59], a[192:195], v[192:195]
    ds_read_b64_tr_b16 v[52:53], v28 offset:32768
    v_mfma_f32_16x16x32_bf16 v[196:199], v[56:59], a[196:199], v[196:199]
    ds_read_b64_tr_b16 v[54:55], v28 offset:34816
    v_mfma_f32_16x16x32_bf16 v[200:203], v[56:59], a[200:203], v[200:203]
    buffer_load_dwordx4 v[88:91], v18, s[20:23], s33 offen offset:1024 sc1
    v_mfma_f32_16x16x32_bf16 v[204:207], v[56:59], a[204:207], v[204:207]
    s_waitcnt lgkmcnt(4)
    v_mfma_f32_16x16x32_bf16 v[208:211], v[60:63], a[192:195], v[208:211]
    ds_read_b64_tr_b16 v[56:57], v29 offset:28672
    v_mfma_f32_16x16x32_bf16 v[212:215], v[60:63], a[196:199], v[212:215]
    ds_read_b64_tr_b16 v[58:59], v29 offset:30720
    v_mfma_f32_16x16x32_bf16 v[216:219], v[60:63], a[200:203], v[216:219]
    buffer_load_dwordx4 v[76:79], v19, s[20:23], s33 offen offset:0 sc1
    v_mfma_f32_16x16x32_bf16 v[220:223], v[60:63], a[204:207], v[220:223]
    s_waitcnt lgkmcnt(4)
    v_mfma_f32_16x16x32_bf16 v[96:99], v[48:51], a[208:211], v[96:99]
    ds_read_b64_tr_b16 v[60:61], v29 offset:32768
    v_mfma_f32_16x16x32_bf16 v[100:103], v[48:51], a[212:215], v[100:103]
    ds_read_b64_tr_b16 v[62:63], v29 offset:34816
    v_mfma_f32_16x16x32_bf16 v[104:107], v[48:51], a[216:219], v[104:107]
    buffer_load_dwordx4 v[92:95], v19, s[20:23], s33 offen offset:1024 sc1
    s_add_u32 s33, s33, 2048
    v_mfma_f32_16x16x32_bf16 v[108:111], v[48:51], a[220:223], v[108:111]
    s_waitcnt lgkmcnt(4)
    v_mfma_f32_16x16x32_bf16 v[112:115], v[52:55], a[208:211], v[112:115]
    ds_read_b64_tr_b16 v[48:49], v30 offset:28672
    v_mfma_f32_16x16x32_bf16 v[116:119], v[52:55], a[212:215], v[116:119]
    ds_read_b64_tr_b16 v[50:51], v30 offset:30720
    v_mfma_f32_16x16x32_bf16 v[120:123], v[52:55], a[216:219], v[120:123]
    s_add_u32 m0, s37, 0
    v_mfma_f32_16x16x32_bf16 v[124:127], v[52:55], a[220:223], v[124:127]
    buffer_load_dwordx4 v22, s[12:15], s32 offen lds
    s_waitcnt lgkmcnt(4)
    v_mfma_f32_16x16x32_bf16 v[128:131], v[56:59], a[208:211], v[128:131]
    ds_read_b64_tr_b16 v[52:53], v30 offset:32768
    v_mfma_f32_16x16x32_bf16 v[132:135], v[56:59], a[212:215], v[132:135]
    ds_read_b64_tr_b16 v[54:55], v30 offset:34816
    v_mfma_f32_16x16x32_bf16 v[136:139], v[56:59], a[216:219], v[136:139]
    s_add_u32 m0, s37, 1024
    v_mfma_f32_16x16x32_bf16 v[140:143], v[56:59], a[220:223], v[140:143]
    buffer_load_dwordx4 v23, s[12:15], s32 offen lds
    s_waitcnt lgkmcnt(4)
    v_mfma_f32_16x16x32_bf16 v[144:147], v[60:63], a[208:211], v[144:147]
    ds_read_b64_tr_b16 v[56:57], v31 offset:28672
    v_mfma_f32_16x16x32_bf16 v[148:151], v[60:63], a[212:215], v[148:151]
    ds_read_b64_tr_b16 v[58:59], v31 offset:30720
    v_mfma_f32_16x16x32_bf16 v[152:155], v[60:63], a[216:219], v[152:155]
    s_add_u32 m0, s37, 2048
    v_mfma_f32_16x16x32_bf16 v[156:159], v[60:63], a[220:223], v[156:159]
    buffer_load_dwordx4 v24, s[12:15], s32 offen lds
    s_waitcnt lgkmcnt(4)
    v_mfma_f32_16x16x32_bf16 v[160:163], v[48:51], a[208:211], v[160:163]
    ds_read_b64_tr_b16 v[60:61], v31 offset:32768
    v_mfma_f32_16x16x32_bf16 v[164:167], v[48:51], a[212:215], v[164:167]
    ds_read_b64_tr_b16 v[62:63], v31 offset:34816
    v_mfma_f32_16x16x32_bf16 v[168:171], v[48:51], a[216:219], v[168:171]
    s_add_u32 m0, s37, 3072
    v_mfma_f32_16x16x32_bf16 v[172:175], v[48:51], a[220:223], v[172:175]
    buffer_load_dwordx4 v25, s[12:15], s32 offen lds
    s_waitcnt lgkmcnt(4)
    v_mfma_f32_16x16x32_bf16 v[176:179], v[52:55], a[208:211], v[176:179]
    ds_read_b64_tr_b16 v[48:49], v28 offset:40960
    v_mfma_f32_16x16x32_bf16 v[180:183], v[52:55], a[212:215], v[180:183]
    ds_read_b64_tr_b16 v[50:51], v28 offset:43008
    v_mfma_f32_16x16x32_bf16 v[184:187], v[52:55], a[216:219], v[184:187]
    s_add_u32 m0, s37, 4096
    v_mfma_f32_16x16x32_bf16 v[188:191], v[52:55], a[220:223], v[188:191]
    buffer_load_dwordx4 v26, s[12:15], s32 offen lds
    s_waitcnt lgkmcnt(4)
    v_mfma_f32_16x16x32_bf16 v[192:195], v[56:59], a[208:211], v[192:195]
    ds_read_b64_tr_b16 v[52:53], v28 offset:45056
    v_mfma_f32_16x16x32_bf16 v[196:199], v[56:59], a[212:215], v[196:199]
    ds_read_b64_tr_b16 v[54:55], v28 offset:47104
    v_mfma_f32_16x16x32_bf16 v[200:203], v[56:59], a[216:219], v[200:203]
    s_add_u32 s32, s32, 589824
    v_mfma_f32_16x16x32_bf16 v[204:207], v[56:59], a[220:223], v[204:207]
    buffer_load_dword v27, v6, s[12:15], s49 offen
    s_waitcnt lgkmcnt(4)
    v_mfma_f32_16x16x32_bf16 v[208:211], v[60:63], a[208:211], v[208:211]
    ds_read_b64_tr_b16 v[56:57], v29 offset:40960
    v_mfma_f32_16x16x32_bf16 v[212:215], v[60:63], a[212:215], v[212:215]
    ds_read_b64_tr_b16 v[58:59], v29 offset:43008
    v_mfma_f32_16x16x32_bf16 v[216:219], v[60:63], a[216:219], v[216:219]
    s_add_u32 s49, s49, 589824
    v_mfma_f32_16x16x32_bf16 v[220:223], v[60:63], a[220:223], v[220:223]
    s_waitcnt vmcnt(15) lgkmcnt(4)
    v_mfma_f32_16x16x32_bf16 v[96:99], v[48:51], a[224:227], v[96:99]
    ds_read_b64_tr_b16 v[60:61], v29 offset:45056
    v_mfma_f32_16x16x32_bf16 v[100:103], v[48:51], a[228:231], v[100:103]
    ds_read_b64_tr_b16 v[62:63], v29 offset:47104
    v_mfma_f32_16x16x32_bf16 v[104:107], v[48:51], a[232:235], v[104:107]
    v_mfma_f32_16x16x32_bf16 v[108:111], v[48:51], a[236:239], v[108:111]
    s_waitcnt vmcnt(24)
    s_barrier
    s_waitcnt lgkmcnt(4)
    v_mfma_f32_16x16x32_bf16 v[112:115], v[52:55], a[224:227], v[112:115]
    ds_read_b64_tr_b16 v[48:49], v30 offset:40960
    v_mfma_f32_16x16x32_bf16 v[116:119], v[52:55], a[228:231], v[116:119]
    ds_read_b64_tr_b16 v[50:51], v30 offset:43008
    v_mfma_f32_16x16x32_bf16 v[120:123], v[52:55], a[232:235], v[120:123]
    s_add_u32 m0, s37, 20480
    v_mfma_f32_16x16x32_bf16 v[124:127], v[52:55], a[236:239], v[124:127]
    buffer_load_dwordx4 v22, s[12:15], s32 offen lds
    s_waitcnt lgkmcnt(4)
    v_mfma_f32_16x16x32_bf16 v[128:131], v[56:59], a[224:227], v[128:131]
    ds_read_b64_tr_b16 v[52:53], v30 offset:45056
    v_mfma_f32_16x16x32_bf16 v[132:135], v[56:59], a[228:231], v[132:135]
    ds_read_b64_tr_b16 v[54:55], v30 offset:47104
    v_mfma_f32_16x16x32_bf16 v[136:139], v[56:59], a[232:235], v[136:139]
    v_mfma_f32_16x16x32_bf16 v[140:143], v[56:59], a[236:239], v[140:143]
    s_waitcnt lgkmcnt(4)
    v_mfma_f32_16x16x32_bf16 v[144:147], v[60:63], a[224:227], v[144:147]
    ds_read_b64_tr_b16 v[56:57], v31 offset:40960
    v_mfma_f32_16x16x32_bf16 v[148:151], v[60:63], a[228:231], v[148:151]
    ds_read_b64_tr_b16 v[58:59], v31 offset:43008
    v_mfma_f32_16x16x32_bf16 v[152:155], v[60:63], a[232:235], v[152:155]
    s_add_u32 m0, s37, 21504
    v_mfma_f32_16x16x32_bf16 v[156:159], v[60:63], a[236:239], v[156:159]
    buffer_load_dwordx4 v23, s[12:15], s32 offen lds
    s_waitcnt lgkmcnt(4)
    v_mfma_f32_16x16x32_bf16 v[160:163], v[48:51], a[224:227], v[160:163]
    ds_read_b64_tr_b16 v[60:61], v31 offset:45056
    v_mfma_f32_16x16x32_bf16 v[164:167], v[48:51], a[228:231], v[164:167]
    ds_read_b64_tr_b16 v[62:63], v31 offset:47104
    v_mfma_f32_16x16x32_bf16 v[168:171], v[48:51], a[232:235], v[168:171]
    v_mfma_f32_16x16x32_bf16 v[172:175], v[48:51], a[236:239], v[172:175]
    s_waitcnt lgkmcnt(4)
    v_mfma_f32_16x16x32_bf16 v[176:179], v[52:55], a[224:227], v[176:179]
    ds_read_b64_tr_b16 v[48:49], v28 offset:49152
    v_mfma_f32_16x16x32_bf16 v[180:183], v[52:55], a[228:231], v[180:183]
    ds_read_b64_tr_b16 v[50:51], v28 offset:51200
    v_mfma_f32_16x16x32_bf16 v[184:187], v[52:55], a[232:235], v[184:187]
    s_add_u32 m0, s37, 22528
    v_mfma_f32_16x16x32_bf16 v[188:191], v[52:55], a[236:239], v[188:191]
    buffer_load_dwordx4 v24, s[12:15], s32 offen lds
    s_waitcnt lgkmcnt(4)
    v_mfma_f32_16x16x32_bf16 v[192:195], v[56:59], a[224:227], v[192:195]
    ds_read_b64_tr_b16 v[52:53], v28 offset:53248
    v_mfma_f32_16x16x32_bf16 v[196:199], v[56:59], a[228:231], v[196:199]
    ds_read_b64_tr_b16 v[54:55], v28 offset:55296
    v_mfma_f32_16x16x32_bf16 v[200:203], v[56:59], a[232:235], v[200:203]
    v_mfma_f32_16x16x32_bf16 v[204:207], v[56:59], a[236:239], v[204:207]
    s_waitcnt lgkmcnt(4)
    v_mfma_f32_16x16x32_bf16 v[208:211], v[60:63], a[224:227], v[208:211]
    ds_read_b64_tr_b16 v[56:57], v29 offset:49152
    v_mfma_f32_16x16x32_bf16 v[212:215], v[60:63], a[228:231], v[212:215]
    ds_read_b64_tr_b16 v[58:59], v29 offset:51200
    v_mfma_f32_16x16x32_bf16 v[216:219], v[60:63], a[232:235], v[216:219]
    v_mfma_f32_16x16x32_bf16 v[220:223], v[60:63], a[236:239], v[220:223]
    s_waitcnt lgkmcnt(4)
    v_mfma_f32_16x16x32_bf16 v[96:99], v[48:51], a[240:243], v[96:99]
    ds_read_b64_tr_b16 v[60:61], v29 offset:53248
    v_mfma_f32_16x16x32_bf16 v[100:103], v[48:51], a[244:247], v[100:103]
    ds_read_b64_tr_b16 v[62:63], v29 offset:55296
    v_mfma_f32_16x16x32_bf16 v[104:107], v[48:51], a[248:251], v[104:107]
    s_add_u32 m0, s37, 23552
    v_mfma_f32_16x16x32_bf16 v[108:111], v[48:51], a[252:255], v[108:111]
    buffer_load_dwordx4 v25, s[12:15], s32 offen lds
    s_waitcnt lgkmcnt(4)
    v_mfma_f32_16x16x32_bf16 v[112:115], v[52:55], a[240:243], v[112:115]
    ds_read_b64_tr_b16 v[48:49], v30 offset:49152
    v_mfma_f32_16x16x32_bf16 v[116:119], v[52:55], a[244:247], v[116:119]
    ds_read_b64_tr_b16 v[50:51], v30 offset:51200
    v_mfma_f32_16x16x32_bf16 v[120:123], v[52:55], a[248:251], v[120:123]
    v_mfma_f32_16x16x32_bf16 v[124:127], v[52:55], a[252:255], v[124:127]
    s_waitcnt lgkmcnt(4)
    v_mfma_f32_16x16x32_bf16 v[128:131], v[56:59], a[240:243], v[128:131]
    ds_read_b64_tr_b16 v[52:53], v30 offset:53248
    v_mfma_f32_16x16x32_bf16 v[132:135], v[56:59], a[244:247], v[132:135]
    ds_read_b64_tr_b16 v[54:55], v30 offset:55296
    v_mfma_f32_16x16x32_bf16 v[136:139], v[56:59], a[248:251], v[136:139]
    s_add_u32 m0, s37, 24576
    v_mfma_f32_16x16x32_bf16 v[140:143], v[56:59], a[252:255], v[140:143]
    buffer_load_dwordx4 v26, s[12:15], s32 offen lds
    s_waitcnt lgkmcnt(4)
    v_mfma_f32_16x16x32_bf16 v[144:147], v[60:63], a[240:243], v[144:147]
    ds_read_b64_tr_b16 v[56:57], v31 offset:49152
    v_mfma_f32_16x16x32_bf16 v[148:151], v[60:63], a[244:247], v[148:151]
    ds_read_b64_tr_b16 v[58:59], v31 offset:51200
    v_mfma_f32_16x16x32_bf16 v[152:155], v[60:63], a[248:251], v[152:155]
    s_add_u32 s32, s32, 589824
    v_mfma_f32_16x16x32_bf16 v[156:159], v[60:63], a[252:255], v[156:159]
    s_waitcnt lgkmcnt(4)
    v_mfma_f32_16x16x32_bf16 v[160:163], v[48:51], a[240:243], v[160:163]
    ds_read_b64_tr_b16 v[60:61], v31 offset:53248
    v_mfma_f32_16x16x32_bf16 v[164:167], v[48:51], a[244:247], v[164:167]
    ds_read_b64_tr_b16 v[62:63], v31 offset:55296
    v_mfma_f32_16x16x32_bf16 v[168:171], v[48:51], a[248:251], v[168:171]
    buffer_load_dword v27, v6, s[12:15], s49 offen
    s_add_u32 s49, s49, 589824
    v_mfma_f32_16x16x32_bf16 v[172:175], v[48:51], a[252:255], v[172:175]
    s_waitcnt lgkmcnt(4)
    v_mfma_f32_16x16x32_bf16 v[176:179], v[52:55], a[240:243], v[176:179]
    ds_read_b64_tr_b16 v[48:49], v32 offset:0
    v_mfma_f32_16x16x32_bf16 v[180:183], v[52:55], a[244:247], v[180:183]
    ds_read_b64_tr_b16 v[50:51], v32 offset:2048
    v_mfma_f32_16x16x32_bf16 v[184:187], v[52:55], a[248:251], v[184:187]
    v_mfma_f32_16x16x32_bf16 v[188:191], v[52:55], a[252:255], v[188:191]
    s_waitcnt lgkmcnt(4)
    v_mfma_f32_16x16x32_bf16 v[192:195], v[56:59], a[240:243], v[192:195]
    ds_read_b64_tr_b16 v[52:53], v32 offset:4096
    v_mfma_f32_16x16x32_bf16 v[196:199], v[56:59], a[244:247], v[196:199]
    ds_read_b64_tr_b16 v[54:55], v32 offset:6144
    v_mfma_f32_16x16x32_bf16 v[200:203], v[56:59], a[248:251], v[200:203]
    v_mfma_f32_16x16x32_bf16 v[204:207], v[56:59], a[252:255], v[204:207]
    s_waitcnt lgkmcnt(4)
    v_mfma_f32_16x16x32_bf16 v[208:211], v[60:63], a[240:243], v[208:211]
    ds_read_b64_tr_b16 v[56:57], v33 offset:0
    v_mfma_f32_16x16x32_bf16 v[212:215], v[60:63], a[244:247], v[212:215]
    ds_read_b64_tr_b16 v[58:59], v33 offset:2048
    v_mfma_f32_16x16x32_bf16 v[216:219], v[60:63], a[248:251], v[216:219]
    v_mfma_f32_16x16x32_bf16 v[220:223], v[60:63], a[252:255], v[220:223]
    s_waitcnt vmcnt(12) lgkmcnt(4)
    v_mfma_f32_16x16x32_bf16 v[96:99], v[48:51], v[64:67], v[96:99]
    ds_read_b64_tr_b16 v[60:61], v33 offset:4096
    v_mfma_f32_16x16x32_bf16 v[100:103], v[48:51], v[68:71], v[100:103]
    ds_read_b64_tr_b16 v[62:63], v33 offset:6144
    v_mfma_f32_16x16x32_bf16 v[104:107], v[48:51], v[72:75], v[104:107]
    v_mfma_f32_16x16x32_bf16 v[108:111], v[48:51], v[76:79], v[108:111]
    s_waitcnt vmcnt(7)
    s_barrier
    s_waitcnt lgkmcnt(4)
    v_mfma_f32_16x16x32_bf16 v[112:115], v[52:55], v[64:67], v[112:115]
    ds_read_b64_tr_b16 v[48:49], v34 offset:0
    v_mfma_f32_16x16x32_bf16 v[116:119], v[52:55], v[68:71], v[116:119]
    ds_read_b64_tr_b16 v[50:51], v34 offset:2048
    v_mfma_f32_16x16x32_bf16 v[120:123], v[52:55], v[72:75], v[120:123]
    s_add_u32 m0, s37, 40960
    v_mfma_f32_16x16x32_bf16 v[124:127], v[52:55], v[76:79], v[124:127]
    buffer_load_dwordx4 v22, s[12:15], s32 offen lds
    s_waitcnt lgkmcnt(4)
    v_mfma_f32_16x16x32_bf16 v[128:131], v[56:59], v[64:67], v[128:131]
    ds_read_b64_tr_b16 v[52:53], v34 offset:4096
    v_mfma_f32_16x16x32_bf16 v[132:135], v[56:59], v[68:71], v[132:135]
    ds_read_b64_tr_b16 v[54:55], v34 offset:6144
    v_mfma_f32_16x16x32_bf16 v[136:139], v[56:59], v[72:75], v[136:139]
    v_mfma_f32_16x16x32_bf16 v[140:143], v[56:59], v[76:79], v[140:143]
    s_waitcnt lgkmcnt(4)
    v_mfma_f32_16x16x32_bf16 v[144:147], v[60:63], v[64:67], v[144:147]
    ds_read_b64_tr_b16 v[56:57], v35 offset:0
    v_mfma_f32_16x16x32_bf16 v[148:151], v[60:63], v[68:71], v[148:151]
    ds_read_b64_tr_b16 v[58:59], v35 offset:2048
    v_mfma_f32_16x16x32_bf16 v[152:155], v[60:63], v[72:75], v[152:155]
    s_add_u32 m0, s37, 41984
    v_mfma_f32_16x16x32_bf16 v[156:159], v[60:63], v[76:79], v[156:159]
    buffer_load_dwordx4 v23, s[12:15], s32 offen lds
    s_waitcnt lgkmcnt(4)
    v_mfma_f32_16x16x32_bf16 v[160:163], v[48:51], v[64:67], v[160:163]
    ds_read_b64_tr_b16 v[60:61], v35 offset:4096
    v_mfma_f32_16x16x32_bf16 v[164:167], v[48:51], v[68:71], v[164:167]
    ds_read_b64_tr_b16 v[62:63], v35 offset:6144
    v_mfma_f32_16x16x32_bf16 v[168:171], v[48:51], v[72:75], v[168:171]
    v_mfma_f32_16x16x32_bf16 v[172:175], v[48:51], v[76:79], v[172:175]
    s_waitcnt lgkmcnt(4)
    v_mfma_f32_16x16x32_bf16 v[176:179], v[52:55], v[64:67], v[176:179]
    ds_read_b64_tr_b16 v[48:49], v32 offset:8192
    v_mfma_f32_16x16x32_bf16 v[180:183], v[52:55], v[68:71], v[180:183]
    ds_read_b64_tr_b16 v[50:51], v32 offset:10240
    v_mfma_f32_16x16x32_bf16 v[184:187], v[52:55], v[72:75], v[184:187]
    s_add_u32 m0, s37, 43008
    v_mfma_f32_16x16x32_bf16 v[188:191], v[52:55], v[76:79], v[188:191]
    buffer_load_dwordx4 v24, s[12:15], s32 offen lds
    s_waitcnt lgkmcnt(4)
    v_mfma_f32_16x16x32_bf16 v[192:195], v[56:59], v[64:67], v[192:195]
    ds_read_b64_tr_b16 v[52:53], v32 offset:12288
    v_mfma_f32_16x16x32_bf16 v[196:199], v[56:59], v[68:71], v[196:199]
    ds_read_b64_tr_b16 v[54:55], v32 offset:14336
    v_mfma_f32_16x16x32_bf16 v[200:203], v[56:59], v[72:75], v[200:203]
    v_mfma_f32_16x16x32_bf16 v[204:207], v[56:59], v[76:79], v[204:207]
    s_waitcnt lgkmcnt(4)
    v_mfma_f32_16x16x32_bf16 v[208:211], v[60:63], v[64:67], v[208:211]
    ds_read_b64_tr_b16 v[56:57], v33 offset:8192
    v_mfma_f32_16x16x32_bf16 v[212:215], v[60:63], v[68:71], v[212:215]
    ds_read_b64_tr_b16 v[58:59], v33 offset:10240
    v_mfma_f32_16x16x32_bf16 v[216:219], v[60:63], v[72:75], v[216:219]
    s_add_u32 m0, s37, 44032
    v_mfma_f32_16x16x32_bf16 v[220:223], v[60:63], v[76:79], v[220:223]
    buffer_load_dwordx4 v25, s[12:15], s32 offen lds
    s_waitcnt lgkmcnt(4)
    v_mfma_f32_16x16x32_bf16 v[96:99], v[48:51], v[80:83], v[96:99]
    ds_read_b64_tr_b16 v[60:61], v33 offset:12288
    v_mfma_f32_16x16x32_bf16 v[100:103], v[48:51], v[84:87], v[100:103]
    ds_read_b64_tr_b16 v[62:63], v33 offset:14336
    v_mfma_f32_16x16x32_bf16 v[104:107], v[48:51], v[88:91], v[104:107]
    v_mfma_f32_16x16x32_bf16 v[108:111], v[48:51], v[92:95], v[108:111]
    s_waitcnt lgkmcnt(4)
    v_mfma_f32_16x16x32_bf16 v[112:115], v[52:55], v[80:83], v[112:115]
    ds_read_b64_tr_b16 v[48:49], v34 offset:8192
    v_mfma_f32_16x16x32_bf16 v[116:119], v[52:55], v[84:87], v[116:119]
    ds_read_b64_tr_b16 v[50:51], v34 offset:10240
    v_mfma_f32_16x16x32_bf16 v[120:123], v[52:55], v[88:91], v[120:123]
    s_add_u32 m0, s37, 45056
    v_mfma_f32_16x16x32_bf16 v[124:127], v[52:55], v[92:95], v[124:127]
    buffer_load_dwordx4 v26, s[12:15], s32 offen lds
    s_waitcnt lgkmcnt(4)
    v_mfma_f32_16x16x32_bf16 v[128:131], v[56:59], v[80:83], v[128:131]
    ds_read_b64_tr_b16 v[52:53], v34 offset:12288
    v_mfma_f32_16x16x32_bf16 v[132:135], v[56:59], v[84:87], v[132:135]
    ds_read_b64_tr_b16 v[54:55], v34 offset:14336
    v_mfma_f32_16x16x32_bf16 v[136:139], v[56:59], v[88:91], v[136:139]
    s_add_u32 s32, s32, 589824
    v_mfma_f32_16x16x32_bf16 v[140:143], v[56:59], v[92:95], v[140:143]
    s_waitcnt lgkmcnt(4)
    v_mfma_f32_16x16x32_bf16 v[144:147], v[60:63], v[80:83], v[144:147]
    ds_read_b64_tr_b16 v[56:57], v35 offset:8192
    v_mfma_f32_16x16x32_bf16 v[148:151], v[60:63], v[84:87], v[148:151]
    ds_read_b64_tr_b16 v[58:59], v35 offset:10240
    v_mfma_f32_16x16x32_bf16 v[152:155], v[60:63], v[88:91], v[152:155]
    buffer_load_dword v27, v6, s[12:15], s49 offen
    s_add_u32 s49, s49, 589824
    v_mfma_f32_16x16x32_bf16 v[156:159], v[60:63], v[92:95], v[156:159]
    s_waitcnt lgkmcnt(4)
    v_mfma_f32_16x16x32_bf16 v[160:163], v[48:51], v[80:83], v[160:163]
    ds_read_b64_tr_b16 v[60:61], v35 offset:12288
    v_mfma_f32_16x16x32_bf16 v[164:167], v[48:51], v[84:87], v[164:167]
    ds_read_b64_tr_b16 v[62:63], v35 offset:14336
    v_mfma_f32_16x16x32_bf16 v[168:171], v[48:51], v[88:91], v[168:171]
    v_mfma_f32_16x16x32_bf16 v[172:175], v[48:51], v[92:95], v[172:175]
    s_waitcnt lgkmcnt(4)
    v_mfma_f32_16x16x32_bf16 v[176:179], v[52:55], v[80:83], v[176:179]
    s_mov_b32 s92, s72
    v_mfma_f32_16x16x32_bf16 v[180:183], v[52:55], v[84:87], v[180:183]
    s_mov_b32 s93, s73
    v_mfma_f32_16x16x32_bf16 v[184:187], v[52:55], v[88:91], v[184:187]
    s_mov_b32 s94, 0x510000
    s_mov_b32 s95, 0x20000
    v_mfma_f32_16x16x32_bf16 v[188:191], v[52:55], v[92:95], v[188:191]
    v_lshrrev_b32 v5, 2, v0
    s_waitcnt lgkmcnt(2)
    v_mfma_f32_16x16x32_bf16 v[192:195], v[56:59], v[80:83], v[192:195]
    v_min_u32 v5, 11, v5
    v_mfma_f32_16x16x32_bf16 v[196:199], v[56:59], v[84:87], v[196:199]
    v_and_b32 v1, 3, v5
    v_mfma_f32_16x16x32_bf16 v[200:203], v[56:59], v[88:91], v[200:203]
    v_mul_u32_u24 v1, 1152, v1
    s_mul_i32 s90, s42, 160
    v_mfma_f32_16x16x32_bf16 v[204:207], v[56:59], v[92:95], v[204:207]
    s_add_u32 s90, s90, 512
    s_waitcnt lgkmcnt(0)
    v_mfma_f32_16x16x32_bf16 v[208:211], v[60:63], v[80:83], v[208:211]
    s_and_b32 s90, s90, 0xffffff80
    v_mfma_f32_16x16x32_bf16 v[212:215], v[60:63], v[84:87], v[212:215]
    v_lshrrev_b32 v2, 2, v5
    v_mfma_f32_16x16x32_bf16 v[216:219], v[60:63], v[88:91], v[216:219]
    v_lshlrev_b32 v3, 7, v2
    v_add_u32 v3, s90, v3
    v_mfma_f32_16x16x32_bf16 v[220:223], v[60:63], v[92:95], v[220:223]
    s_lshl_b32 s90, s42, 7
    v_mov_b32 v4, s90
    v_cmp_le_u32 vcc, 2, v2
    s_nop 1
    v_cndmask_b32 v3, v3, v4, vcc
    v_add_u32 v1, v1, v3
    s_mul_i32 s100, s41, 576
    s_and_b32 s90, s40, 3
    s_lshl_b32 s90, s90, 4
    s_add_u32 s100, s100, s90
    s_lshl_b32 s90, s3, 2
    s_add_u32 s100, s100, s90
    s_mul_i32 s100, s100, 1152
    buffer_load_dword v27, v1, s[92:95], s100 offen
    s_add_u32 s100, s100, 73728
    s_nop 7
    s_mul_i32 s101, s40, 14
    s_add_u32 s101, s101, s43
    s_sub_u32 s101, s101, 18
    s_mul_i32 s45, s3, 112
    s_add_u32 s101, s101, s45
    v_min_u32 v8, 15, v0
    v_lshlrev_b32 v8, 2, v8
    v_add_u32 v8, 12288, v8
    buffer_load_dword v7, v8, s[76:79], 0 offen sc1
    v_min_u32 v21, 31, v0
    v_lshlrev_b32 v21, 4, v21
    v_add_u32 v21, 45056, v21
    buffer_load_dwordx4 v[16:19], v21, s[76:79], 0 offen sc1
    s_cmp_eq_u32 s59, 1
    s_cbranch_scc0 FKN_hs0
    s_lshl_b32 s45, s40, 4
    s_lshl_b32 s46, s3, 2
    s_add_u32 s45, s45, s46
    s_mul_i32 s50, s45, 147456
    s_mul_i32 s46, s41, 18432
    s_add_u32 s50, s50, s46
    s_lshl_b32 s46, s42, 11
    s_add_u32 s51, s50, s46
    v_lshlrev_b32 v2, 4, v0
    v_pk_mul_f32 v[96:97], v[96:97], v[112:113]
    v_pk_mul_f32 v[98:99], v[98:99], v[114:115]
    v_cvt_pk_bf16_f32 v40, v96, v97
    v_cvt_pk_bf16_f32 v41, v98, v99
    v_pk_mul_f32 v[128:129], v[128:129], v[144:145]
    v_pk_mul_f32 v[130:131], v[130:131], v[146:147]
    v_cvt_pk_bf16_f32 v42, v128, v129
    v_cvt_pk_bf16_f32 v43, v130, v131
    buffer_store_dwordx4 v[40:43], v2, s[16:19], s51 offen offset:0
    v_pk_mul_f32 v[160:161], v[160:161], v[176:177]
    v_pk_mul_f32 v[162:163], v[162:163], v[178:179]
    v_cvt_pk_bf16_f32 v44, v160, v161
    v_cvt_pk_bf16_f32 v45, v162, v163
    v_pk_mul_f32 v[192:193], v[192:193], v[208:209]
    v_pk_mul_f32 v[194:195], v[194:195], v[210:211]
    v_cvt_pk_bf16_f32 v46, v192, v193
    v_cvt_pk_bf16_f32 v47, v194, v195
    buffer_store_dwordx4 v[44:47], v2, s[16:19], s51 offen offset:1024
    s_add_u32 s51, s51, 147456
    v_pk_mul_f32 v[100:101], v[100:101], v[116:117]
    v_pk_mul_f32 v[102:103], v[102:103], v[118:119]
    v_cvt_pk_bf16_f32 v40, v100, v101
    v_cvt_pk_bf16_f32 v41, v102, v103
    v_pk_mul_f32 v[132:133], v[132:133], v[148:149]
    v_pk_mul_f32 v[134:135], v[134:135], v[150:151]
    v_cvt_pk_bf16_f32 v42, v132, v133
    v_cvt_pk_bf16_f32 v43, v134, v135
    buffer_store_dwordx4 v[40:43], v2, s[16:19], s51 offen offset:0
    v_pk_mul_f32 v[164:165], v[164:165], v[180:181]
    v_pk_mul_f32 v[166:167], v[166:167], v[182:183]
    v_cvt_pk_bf16_f32 v44, v164, v165
    v_cvt_pk_bf16_f32 v45, v166, v167
    v_pk_mul_f32 v[196:197], v[196:197], v[212:213]
    v_pk_mul_f32 v[198:199], v[198:199], v[214:215]
    v_cvt_pk_bf16_f32 v46, v196, v197
    v_cvt_pk_bf16_f32 v47, v198, v199
    buffer_store_dwordx4 v[44:47], v2, s[16:19], s51 offen offset:1024
    s_add_u32 s51, s51, 147456
    v_pk_mul_f32 v[104:105], v[104:105], v[120:121]
    v_pk_mul_f32 v[106:107], v[106:107], v[122:123]
    v_cvt_pk_bf16_f32 v40, v104, v105
    v_cvt_pk_bf16_f32 v41, v106, v107
    v_pk_mul_f32 v[136:137], v[136:137], v[152:153]
    v_pk_mul_f32 v[138:139], v[138:139], v[154:155]
    v_cvt_pk_bf16_f32 v42, v136, v137
    v_cvt_pk_bf16_f32 v43, v138, v139
    buffer_store_dwordx4 v[40:43], v2, s[16:19], s51 offen offset:0
    v_pk_mul_f32 v[168:169], v[168:169], v[184:185]
    v_pk_mul_f32 v[170:171], v[170:171], v[186:187]
    v_cvt_pk_bf16_f32 v44, v168, v169
    v_cvt_pk_bf16_f32 v45, v170, v171
    v_pk_mul_f32 v[200:201], v[200:201], v[216:217]
    v_pk_mul_f32 v[202:203], v[202:203], v[218:219]
    v_cvt_pk_bf16_f32 v46, v200, v201
    v_cvt_pk_bf16_f32 v47, v202, v203
    buffer_store_dwordx4 v[44:47], v2, s[16:19], s51 offen offset:1024
    s_add_u32 s51, s51, 147456
    v_pk_mul_f32 v[108:109], v[108:109], v[124:125]
    v_pk_mul_f32 v[110:111], v[110:111], v[126:127]
    v_cvt_pk_bf16_f32 v40, v108, v109
    v_cvt_pk_bf16_f32 v41, v110, v111
    v_pk_mul_f32 v[140:141], v[140:141], v[156:157]
    v_pk_mul_f32 v[142:143], v[142:143], v[158:159]
    v_cvt_pk_bf16_f32 v42, v140, v141
    v_cvt_pk_bf16_f32 v43, v142, v143
    buffer_store_dwordx4 v[40:43], v2, s[16:19], s51 offen offset:0
    v_pk_mul_f32 v[172:173], v[172:173], v[188:189]
    v_pk_mul_f32 v[174:175], v[174:175], v[190:191]
    v_cvt_pk_bf16_f32 v44, v172, v173
    v_cvt_pk_bf16_f32 v45, v174, v175
    v_pk_mul_f32 v[204:205], v[204:205], v[220:221]
    v_pk_mul_f32 v[206:207], v[206:207], v[222:223]
    v_cvt_pk_bf16_f32 v46, v204, v205
    v_cvt_pk_bf16_f32 v47, v206, v207
    buffer_store_dwordx4 v[44:47], v2, s[16:19], s51 offen offset:1024
    s_branch FKN_hd0
FKN_hs0:
    s_lshl_b32 s45, s40, 4
    s_lshl_b32 s46, s3, 2
    s_add_u32 s45, s45, s46
    s_mul_i32 s50, s45, 147456
    s_mul_i32 s46, s41, 18432
    s_add_u32 s50, s50, s46
    s_lshl_b32 s46, s42, 11
    s_add_u32 s51, s50, s46
    v_lshlrev_b32 v2, 4, v0
    v_pk_mul_f32 v[96:97], v[96:97], v[112:113]
    v_pk_mul_f32 v[98:99], v[98:99], v[114:115]
    v_cvt_pk_bf16_f32 v40, v96, v97
    v_cvt_pk_bf16_f32 v41, v98, v99
    v_pk_mul_f32 v[128:129], v[128:129], v[144:145]
    v_pk_mul_f32 v[130:131], v[130:131], v[146:147]
    v_cvt_pk_bf16_f32 v42, v128, v129
    v_cvt_pk_bf16_f32 v43, v130, v131
    buffer_store_dwordx4 v[40:43], v2, s[16:19], s51 offen offset:0 sc1
    v_pk_mul_f32 v[160:161], v[160:161], v[176:177]
    v_pk_mul_f32 v[162:163], v[162:163], v[178:179]
    v_cvt_pk_bf16_f32 v44, v160, v161
    v_cvt_pk_bf16_f32 v45, v162, v163
    v_pk_mul_f32 v[192:193], v[192:193], v[208:209]
    v_pk_mul_f32 v[194:195], v[194:195], v[210:211]
    v_cvt_pk_bf16_f32 v46, v192, v193
    v_cvt_pk_bf16_f32 v47, v194, v195
    buffer_store_dwordx4 v[44:47], v2, s[16:19], s51 offen offset:1024 sc1
    s_add_u32 s51, s51, 147456
    v_pk_mul_f32 v[100:101], v[100:101], v[116:117]
    v_pk_mul_f32 v[102:103], v[102:103], v[118:119]
    v_cvt_pk_bf16_f32 v40, v100, v101
    v_cvt_pk_bf16_f32 v41, v102, v103
    v_pk_mul_f32 v[132:133], v[132:133], v[148:149]
    v_pk_mul_f32 v[134:135], v[134:135], v[150:151]
    v_cvt_pk_bf16_f32 v42, v132, v133
    v_cvt_pk_bf16_f32 v43, v134, v135
    buffer_store_dwordx4 v[40:43], v2, s[16:19], s51 offen offset:0 sc1
    v_pk_mul_f32 v[164:165], v[164:165], v[180:181]
    v_pk_mul_f32 v[166:167], v[166:167], v[182:183]
    v_cvt_pk_bf16_f32 v44, v164, v165
    v_cvt_pk_bf16_f32 v45, v166, v167
    v_pk_mul_f32 v[196:197], v[196:197], v[212:213]
    v_pk_mul_f32 v[198:199], v[198:199], v[214:215]
    v_cvt_pk_bf16_f32 v46, v196, v197
    v_cvt_pk_bf16_f32 v47, v198, v199
    buffer_store_dwordx4 v[44:47], v2, s[16:19], s51 offen offset:1024 sc1
    s_add_u32 s51, s51, 147456
    v_pk_mul_f32 v[104:105], v[104:105], v[120:121]
    v_pk_mul_f32 v[106:107], v[106:107], v[122:123]
    v_cvt_pk_bf16_f32 v40, v104, v105
    v_cvt_pk_bf16_f32 v41, v106, v107
    v_pk_mul_f32 v[136:137], v[136:137], v[152:153]
    v_pk_mul_f32 v[138:139], v[138:139], v[154:155]
    v_cvt_pk_bf16_f32 v42, v136, v137
    v_cvt_pk_bf16_f32 v43, v138, v139
    buffer_store_dwordx4 v[40:43], v2, s[16:19], s51 offen offset:0 sc1
    v_pk_mul_f32 v[168:169], v[168:169], v[184:185]
    v_pk_mul_f32 v[170:171], v[170:171], v[186:187]
    v_cvt_pk_bf16_f32 v44, v168, v169
    v_cvt_pk_bf16_f32 v45, v170, v171
    v_pk_mul_f32 v[200:201], v[200:201], v[216:217]
    v_pk_mul_f32 v[202:203], v[202:203], v[218:219]
    v_cvt_pk_bf16_f32 v46, v200, v201
    v_cvt_pk_bf16_f32 v47, v202, v203
    buffer_store_dwordx4 v[44:47], v2, s[16:19], s51 offen offset:1024 sc1
    s_add_u32 s51, s51, 147456
    v_pk_mul_f32 v[108:109], v[108:109], v[124:125]
    v_pk_mul_f32 v[110:111], v[110:111], v[126:127]
    v_cvt_pk_bf16_f32 v40, v108, v109
    v_cvt_pk_bf16_f32 v41, v110, v111
    v_pk_mul_f32 v[140:141], v[140:141], v[156:157]
    v_pk_mul_f32 v[142:143], v[142:143], v[158:159]
    v_cvt_pk_bf16_f32 v42, v140, v141
    v_cvt_pk_bf16_f32 v43, v142, v143
    buffer_store_dwordx4 v[40:43], v2, s[16:19], s51 offen offset:0 sc1
    v_pk_mul_f32 v[172:173], v[172:173], v[188:189]
    v_pk_mul_f32 v[174:175], v[174:175], v[190:191]
    v_cvt_pk_bf16_f32 v44, v172, v173
    v_cvt_pk_bf16_f32 v45, v174, v175
    v_pk_mul_f32 v[204:205], v[204:205], v[220:221]
    v_pk_mul_f32 v[206:207], v[206:207], v[222:223]
    v_cvt_pk_bf16_f32 v46, v204, v205
    v_cvt_pk_bf16_f32 v47, v206, v207
    buffer_store_dwordx4 v[44:47], v2, s[16:19], s51 offen offset:1024 sc1
FKN_hd0:
    ds_read_b64_tr_b16 v[48:49], v38 offset:0
    ds_read_b64_tr_b16 v[50:51], v38 offset:2560
    ds_read_b64_tr_b16 v[52:53], v38 offset:5120
    ds_read_b64_tr_b16 v[54:55], v38 offset:7680
    ds_read_b64_tr_b16 v[56:57], v38 offset:32
    ds_read_b64_tr_b16 v[58:59], v38 offset:2592
    s_waitcnt lgkmcnt(4)
    v_mfma_f32_16x16x32_bf16 v[96:99], v[48:51], a[0:3], 0
    ds_read_b64_tr_b16 v[60:61], v38 offset:5152
    v_mfma_f32_16x16x32_bf16 v[100:103], v[48:51], a[4:7], 0
    ds_read_b64_tr_b16 v[62:63], v38 offset:7712
    v_mfma_f32_16x16x32_bf16 v[104:107], v[48:51], a[8:11], 0
    v_mfma_f32_16x16x32_bf16 v[108:111], v[48:51], a[12:15], 0
    s_waitcnt vmcnt(18)
    s_barrier
    s_cmp_eq_u32 s3, 0
    s_cbranch_scc0 FKN_tb0
    s_waitcnt vmcnt(8)
    s_mov_b32 s5, 0
    s_branch FKN_sb_c
FKN_sb_l:
    buffer_load_dword v7, v8, s[76:79], 0 offen sc1
    buffer_load_dwordx4 v[16:19], v21, s[76:79], 0 offen sc1
    s_waitcnt vmcnt(0)
FKN_sb_c:
    v_xor_b32 v5, s39, v7
    v_xor_b32 v16, s39, v16
    v_or_b32 v5, v5, v16
    v_xor_b32 v17, s39, v17
    v_or_b32 v5, v5, v17
    v_xor_b32 v18, s39, v18
    v_or_b32 v5, v5, v18
    v_xor_b32 v19, s39, v19
    v_or_b32 v5, v5, v19
    v_cmp_ne_u32 vcc, 0, v5
    s_add_u32 s5, s5, 1
    s_cmp_ge_u32 s5, 20000
    s_cbranch_scc1 FKN_sb_x
    s_nop 0
    s_cmp_eq_u64 vcc, 0
    s_cbranch_scc1 FKN_sb_x
    s_sleep 1
    s_branch FKN_sb_l
FKN_sb_x:
FKN_tb0:
    s_waitcnt lgkmcnt(4)
    v_mfma_f32_16x16x32_bf16 v[112:115], v[52:55], a[0:3], 0
    ds_read_b64_tr_b16 v[48:49], v38 offset:64
    v_mfma_f32_16x16x32_bf16 v[116:119], v[52:55], a[4:7], 0
    ds_read_b64_tr_b16 v[50:51], v38 offset:2624
    v_mfma_f32_16x16x32_bf16 v[120:123], v[52:55], a[8:11], 0
    s_add_u32 m0, s37, 61440
    v_mfma_f32_16x16x32_bf16 v[124:127], v[52:55], a[12:15], 0
    buffer_load_dwordx4 v22, s[12:15], s32 offen lds
    s_waitcnt lgkmcnt(4)
    v_mfma_f32_16x16x32_bf16 v[128:131], v[56:59], a[0:3], 0
    ds_read_b64_tr_b16 v[52:53], v38 offset:5184
    v_mfma_f32_16x16x32_bf16 v[132:135], v[56:59], a[4:7], 0
    ds_read_b64_tr_b16 v[54:55], v38 offset:7744
    v_mfma_f32_16x16x32_bf16 v[136:139], v[56:59], a[8:11], 0
    s_mov_b32 s28, s72
    s_mov_b32 s29, s73
    v_mfma_f32_16x16x32_bf16 v[140:143], v[56:59], a[12:15], 0
    s_mov_b32 s30, 0x510000
    s_waitcnt lgkmcnt(4)
    v_mfma_f32_16x16x32_bf16 v[144:147], v[60:63], a[0:3], 0
    ds_read_b64_tr_b16 v[56:57], v38 offset:96
    v_mfma_f32_16x16x32_bf16 v[148:151], v[60:63], a[4:7], 0
    ds_read_b64_tr_b16 v[58:59], v38 offset:2656
    v_mfma_f32_16x16x32_bf16 v[152:155], v[60:63], a[8:11], 0
    s_mov_b32 s31, 0x20000
    s_mul_i32 s44, s41, 576
    v_mfma_f32_16x16x32_bf16 v[156:159], v[60:63], a[12:15], 0
    s_lshl_b32 s45, s3, 5
    s_waitcnt lgkmcnt(4)
    v_mfma_f32_16x16x32_bf16 v[160:163], v[48:51], a[0:3], 0
    ds_read_b64_tr_b16 v[60:61], v38 offset:5216
    v_mfma_f32_16x16x32_bf16 v[164:167], v[48:51], a[4:7], 0
    ds_read_b64_tr_b16 v[62:63], v38 offset:7776
    v_mfma_f32_16x16x32_bf16 v[168:171], v[48:51], a[8:11], 0
    s_add_u32 s52, s44, s45
    s_add_u32 s53, s52, 128
    v_mfma_f32_16x16x32_bf16 v[172:175], v[48:51], a[12:15], 0
    s_lshr_b32 s46, s3, 1
    s_waitcnt lgkmcnt(4)
    v_mfma_f32_16x16x32_bf16 v[176:179], v[52:55], a[0:3], 0
    ds_read_b64_tr_b16 v[48:49], v38 offset:128
    v_mfma_f32_16x16x32_bf16 v[180:183], v[52:55], a[4:7], 0
    ds_read_b64_tr_b16 v[50:51], v38 offset:2688
    v_mfma_f32_16x16x32_bf16 v[184:187], v[52:55], a[8:11], 0
    s_mul_i32 s46, s46, 80
    s_and_b32 s47, s3, 1
    v_mfma_f32_16x16x32_bf16 v[188:191], v[52:55], a[12:15], 0
    s_lshl_b32 s47, s47, 5
    s_waitcnt lgkmcnt(4)
    v_mfma_f32_16x16x32_bf16 v[192:195], v[56:59], a[0:3], 0
    ds_read_b64_tr_b16 v[52:53], v38 offset:5248
    v_mfma_f32_16x16x32_bf16 v[196:199], v[56:59], a[4:7], 0
    ds_read_b64_tr_b16 v[54:55], v38 offset:7808
    v_mfma_f32_16x16x32_bf16 v[200:203], v[56:59], a[8:11], 0
    s_add_u32 m0, s37, 62464
    v_mfma_f32_16x16x32_bf16 v[204:207], v[56:59], a[12:15], 0
    buffer_load_dwordx4 v23, s[12:15], s32 offen lds
    s_waitcnt lgkmcnt(4)
    v_mfma_f32_16x16x32_bf16 v[208:211], v[60:63], a[0:3], 0
    ds_read_b64_tr_b16 v[56:57], v38 offset:10240
    v_mfma_f32_16x16x32_bf16 v[212:215], v[60:63], a[4:7], 0
    ds_read_b64_tr_b16 v[58:59], v38 offset:12800
    v_mfma_f32_16x16x32_bf16 v[216:219], v[60:63], a[8:11], 0
    s_add_u32 s54, s44, s46
    s_add_u32 s54, s54, s47
    v_mfma_f32_16x16x32_bf16 v[220:223], v[60:63], a[12:15], 0
    s_add_u32 s54, s54, 256
    s_waitcnt lgkmcnt(4)
    v_mfma_f32_16x16x32_bf16 v[224:227], v[48:51], a[0:3], 0
    ds_read_b64_tr_b16 v[60:61], v38 offset:15360
    v_mfma_f32_16x16x32_bf16 v[228:231], v[48:51], a[4:7], 0
    ds_read_b64_tr_b16 v[62:63], v38 offset:17920
    v_mfma_f32_16x16x32_bf16 v[232:235], v[48:51], a[8:11], 0
    s_add_u32 s55, s54, 160
    s_mul_i32 s46, s3, 160
    v_mfma_f32_16x16x32_bf16 v[236:239], v[48:51], a[12:15], 0
    s_add_u32 s56, s44, s46
    s_waitcnt lgkmcnt(4)
    v_mfma_f32_16x16x32_bf16 v[240:243], v[52:55], a[0:3], 0
    ds_read_b64_tr_b16 v[48:49], v38 offset:10272
    v_mfma_f32_16x16x32_bf16 v[244:247], v[52:55], a[4:7], 0
    ds_read_b64_tr_b16 v[50:51], v38 offset:12832
    v_mfma_f32_16x16x32_bf16 v[248:251], v[52:55], a[8:11], 0
    s_add_u32 s56, s56, 320
    s_mul_i32 s52, s52, 1152
    v_mfma_f32_16x16x32_bf16 v[252:255], v[52:55], a[12:15], 0
    s_mul_i32 s53, s53, 1152
    s_waitcnt lgkmcnt(4)
    v_mfma_f32_16x16x32_bf16 v[96:99], v[56:59], a[16:19], v[96:99]
    ds_read_b64_tr_b16 v[52:53], v38 offset:15392
    v_mfma_f32_16x16x32_bf16 v[100:103], v[56:59], a[20:23], v[100:103]
    ds_read_b64_tr_b16 v[54:55], v38 offset:17952
    v_mfma_f32_16x16x32_bf16 v[104:107], v[56:59], a[24:27], v[104:107]
    s_mul_i32 s54, s54, 1152
    s_mul_i32 s55, s55, 1152
    v_mfma_f32_16x16x32_bf16 v[108:111], v[56:59], a[28:31], v[108:111]
    s_mul_i32 s56, s56, 1152
    s_waitcnt lgkmcnt(4)
    v_mfma_f32_16x16x32_bf16 v[112:115], v[60:63], a[16:19], v[112:115]
    ds_read_b64_tr_b16 v[56:57], v38 offset:10304
    v_mfma_f32_16x16x32_bf16 v[116:119], v[60:63], a[20:23], v[116:119]
    ds_read_b64_tr_b16 v[58:59], v38 offset:12864
    v_mfma_f32_16x16x32_bf16 v[120:123], v[60:63], a[24:27], v[120:123]
    s_mul_i32 s57, s42, 160
    s_add_u32 s57, s57, 512
    v_mfma_f32_16x16x32_bf16 v[124:127], v[60:63], a[28:31], v[124:127]
    s_lshl_b32 s58, s42, 7
    s_waitcnt lgkmcnt(4)
    v_mfma_f32_16x16x32_bf16 v[128:131], v[48:51], a[16:19], v[128:131]
    ds_read_b64_tr_b16 v[60:61], v38 offset:15424
    v_mfma_f32_16x16x32_bf16 v[132:135], v[48:51], a[20:23], v[132:135]
    ds_read_b64_tr_b16 v[62:63], v38 offset:17984
    v_mfma_f32_16x16x32_bf16 v[136:139], v[48:51], a[24:27], v[136:139]
    v_add_u32 v2, 0, v0
    v_mul_u32_u24 v3, 6554, v2
    v_mfma_f32_16x16x32_bf16 v[140:143], v[48:51], a[28:31], v[140:143]
    v_lshrrev_b32 v3, 16, v3
    s_waitcnt lgkmcnt(4)
    v_mfma_f32_16x16x32_bf16 v[144:147], v[52:55], a[16:19], v[144:147]
    ds_read_b64_tr_b16 v[48:49], v38 offset:10336
    v_mfma_f32_16x16x32_bf16 v[148:151], v[52:55], a[20:23], v[148:151]
    ds_read_b64_tr_b16 v[50:51], v38 offset:12896
    v_mfma_f32_16x16x32_bf16 v[152:155], v[52:55], a[24:27], v[152:155]
    s_add_u32 m0, s37, 63488
    v_mfma_f32_16x16x32_bf16 v[156:159], v[52:55], a[28:31], v[156:159]
    buffer_load_dwordx4 v24, s[12:15], s32 offen lds
    s_waitcnt lgkmcnt(4)
    v_mfma_f32_16x16x32_bf16 v[160:163], v[56:59], a[16:19], v[160:163]
    ds_read_b64_tr_b16 v[52:53], v38 offset:15456
    v_mfma_f32_16x16x32_bf16 v[164:167], v[56:59], a[20:23], v[164:167]
    ds_read_b64_tr_b16 v[54:55], v38 offset:18016
    v_mfma_f32_16x16x32_bf16 v[168:171], v[56:59], a[24:27], v[168:171]
    v_mul_u32_u24 v4, 10, v3
    v_sub_u32 v4, v2, v4
    v_mfma_f32_16x16x32_bf16 v[172:175], v[56:59], a[28:31], v[172:175]
    v_mul_u32_u24 v5, 1152, v3
    s_waitcnt lgkmcnt(4)
    v_mfma_f32_16x16x32_bf16 v[176:179], v[60:63], a[16:19], v[176:179]
    ds_read_b64_tr_b16 v[56:57], v38 offset:10368
    v_mfma_f32_16x16x32_bf16 v[180:183], v[60:63], a[20:23], v[180:183]
    ds_read_b64_tr_b16 v[58:59], v38 offset:12928
    v_mfma_f32_16x16x32_bf16 v[184:187], v[60:63], a[24:27], v[184:187]
    v_lshl_add_u32 v10, v4, 4, v5
    v_add_u32 v2, 64, v0
    v_mfma_f32_16x16x32_bf16 v[188:191], v[60:63], a[28:31], v[188:191]
    v_mul_u32_u24 v3, 6554, v2
    s_waitcnt lgkmcnt(4)
    v_mfma_f32_16x16x32_bf16 v[192:195], v[48:51], a[16:19], v[192:195]
    ds_read_b64_tr_b16 v[60:61], v38 offset:15488
    v_mfma_f32_16x16x32_bf16 v[196:199], v[48:51], a[20:23], v[196:199]
    ds_read_b64_tr_b16 v[62:63], v38 offset:18048
    v_mfma_f32_16x16x32_bf16 v[200:203], v[48:51], a[24:27], v[200:203]
    v_lshrrev_b32 v3, 16, v3
    v_mul_u32_u24 v4, 10, v3
    v_mfma_f32_16x16x32_bf16 v[204:207], v[48:51], a[28:31], v[204:207]
    v_sub_u32 v4, v2, v4
    s_waitcnt lgkmcnt(4)
    v_mfma_f32_16x16x32_bf16 v[208:211], v[52:55], a[16:19], v[208:211]
    ds_read_b64_tr_b16 v[48:49], v38 offset:20480
    v_mfma_f32_16x16x32_bf16 v[212:215], v[52:55], a[20:23], v[212:215]
    ds_read_b64_tr_b16 v[50:51], v38 offset:23040
    v_mfma_f32_16x16x32_bf16 v[216:219], v[52:55], a[24:27], v[216:219]
    v_mul_u32_u24 v5, 1152, v3
    v_lshl_add_u32 v11, v4, 4, v5
    v_mfma_f32_16x16x32_bf16 v[220:223], v[52:55], a[28:31], v[220:223]
    v_add_u32 v2, 128, v0
    s_waitcnt lgkmcnt(4)
    v_mfma_f32_16x16x32_bf16 v[224:227], v[56:59], a[16:19], v[224:227]
    ds_read_b64_tr_b16 v[52:53], v38 offset:25600
    v_mfma_f32_16x16x32_bf16 v[228:231], v[56:59], a[20:23], v[228:231]
    ds_read_b64_tr_b16 v[54:55], v38 offset:28160
    v_mfma_f32_16x16x32_bf16 v[232:235], v[56:59], a[24:27], v[232:235]
    s_add_u32 m0, s37, 64512
    v_mfma_f32_16x16x32_bf16 v[236:239], v[56:59], a[28:31], v[236:239]
    buffer_load_dwordx4 v25, s[12:15], s32 offen lds
    s_waitcnt lgkmcnt(4)
    v_mfma_f32_16x16x32_bf16 v[240:243], v[60:63], a[16:19], v[240:243]
    ds_read_b64_tr_b16 v[56:57], v38 offset:20512
    v_mfma_f32_16x16x32_bf16 v[244:247], v[60:63], a[20:23], v[244:247]
    ds_read_b64_tr_b16 v[58:59], v38 offset:23072
    v_mfma_f32_16x16x32_bf16 v[248:251], v[60:63], a[24:27], v[248:251]
    v_mul_u32_u24 v3, 6554, v2
    v_lshrrev_b32 v3, 16, v3
    v_mfma_f32_16x16x32_bf16 v[252:255], v[60:63], a[28:31], v[252:255]
    v_mul_u32_u24 v4, 10, v3
    v_sub_u32 v4, v2, v4
    v_mul_u32_u24 v5, 1152, v3
    v_lshl_add_u32 v12, v4, 4, v5
    v_add_u32 v2, 192, v0
    v_mul_u32_u24 v3, 6554, v2
    v_lshrrev_b32 v3, 16, v3
    v_mul_u32_u24 v4, 10, v3
    v_sub_u32 v4, v2, v4
    v_mul_u32_u24 v5, 1152, v3
    v_lshl_add_u32 v13, v4, 4, v5
    v_add_u32 v2, 256, v0
    v_mul_u32_u24 v3, 6554, v2
    v_lshrrev_b32 v3, 16, v3
    v_mul_u32_u24 v4, 10, v3
    v_sub_u32 v4, v2, v4
    s_add_u32 m0, s37, 65536
    s_nop 0
    buffer_load_dwordx4 v26, s[12:15], s32 offen lds
    s_add_u32 s32, s32, 589824
    v_mul_u32_u24 v5, 1152, v3
    v_lshl_add_u32 v14, v4, 4, v5
    s_mul_i32 s34, s3, 5120
    s_add_u32 s20, s8, 0xd00000
    s_addc_u32 s21, s9, 0
    s_mov_b32 s22, 0x12000
    s_mov_b32 s23, 0x20000
    v_lshlrev_b32 v15, 4, v0
    s_mul_i32 s48, s3, 18432
    s_add_u32 s84, s8, 0x4000000
    s_addc_u32 s85, s9, 0
    s_mov_b32 s86, 0x242000
    buffer_load_dword v27, v6, s[12:15], s49 offen
    s_add_u32 s49, s49, 589824
    s_mov_b32 s87, 0x20000
    s_add_u32 s80, s8, 0x700000
    s_addc_u32 s81, s9, 0
    s_mov_b32 s82, 0x240000
    s_mov_b32 s83, 0x20000
    s_lshl_b32 s88, s101, 13
    v_lshrrev_b32 v20, 3, v0
    v_lshlrev_b32 v20, 7, v20
    buffer_load_dword v27, v1, s[92:95], s100 offen
    s_add_u32 s100, s100, 73728
    s_waitcnt lgkmcnt(4)
    v_mfma_f32_16x16x32_bf16 v[96:99], v[48:51], a[32:35], v[96:99]
    ds_read_b64_tr_b16 v[60:61], v38 offset:25632
    v_mfma_f32_16x16x32_bf16 v[100:103], v[48:51], a[36:39], v[100:103]
    ds_read_b64_tr_b16 v[62:63], v38 offset:28192
    v_mfma_f32_16x16x32_bf16 v[104:107], v[48:51], a[40:43], v[104:107]
    v_mfma_f32_16x16x32_bf16 v[108:111], v[48:51], a[44:47], v[108:111]
    s_waitcnt vmcnt(7)
    s_barrier
    s_cmp_eq_u32 s3, 0
    s_cbranch_scc0 FKN_fl1
    s_lshl_b32 s46, s40, 3
    s_add_u32 s46, s46, s41
    s_lshl_b32 s46, s46, 7
    s_lshl_b32 s47, s42, 2
    s_add_u32 s46, s46, s47
    s_add_u32 s46, s46, 20480
    s_mov_b64 s[6:7], exec
    s_mov_b64 exec, 1
    v_mov_b32 v4, s39
    v_mov_b32 v5, 0
    buffer_store_dword v4, v5, s[76:79], s46 offen sc1
    s_mov_b64 exec, s[6:7]
FKN_fl1:
    s_waitcnt lgkmcnt(4)
    v_mfma_f32_16x16x32_bf16 v[112:115], v[52:55], a[32:35], v[112:115]
    ds_read_b64_tr_b16 v[48:49], v38 offset:20544
    v_mfma_f32_16x16x32_bf16 v[116:119], v[52:55], a[36:39], v[116:119]
    ds_read_b64_tr_b16 v[50:51], v38 offset:23104
    v_mfma_f32_16x16x32_bf16 v[120:123], v[52:55], a[40:43], v[120:123]
    s_add_u32 m0, s37, 0
    v_mfma_f32_16x16x32_bf16 v[124:127], v[52:55], a[44:47], v[124:127]
    buffer_load_dwordx4 v22, s[12:15], s32 offen lds
    s_waitcnt lgkmcnt(4)
    v_mfma_f32_16x16x32_bf16 v[128:131], v[56:59], a[32:35], v[128:131]
    ds_read_b64_tr_b16 v[52:53], v38 offset:25664
    v_mfma_f32_16x16x32_bf16 v[132:135], v[56:59], a[36:39], v[132:135]
    ds_read_b64_tr_b16 v[54:55], v38 offset:28224
    v_mfma_f32_16x16x32_bf16 v[136:139], v[56:59], a[40:43], v[136:139]
    s_cmp_ge_u32 s101, 288
    s_cselect_b32 s45, 0, s101
    v_mfma_f32_16x16x32_bf16 v[140:143], v[56:59], a[44:47], v[140:143]
    s_lshr_b32 s45, s45, 4
    s_waitcnt lgkmcnt(4)
    v_mfma_f32_16x16x32_bf16 v[144:147], v[60:63], a[32:35], v[144:147]
    ds_read_b64_tr_b16 v[56:57], v38 offset:20576
    v_mfma_f32_16x16x32_bf16 v[148:151], v[60:63], a[36:39], v[148:151]
    ds_read_b64_tr_b16 v[58:59], v38 offset:23136
    v_mfma_f32_16x16x32_bf16 v[152:155], v[60:63], a[40:43], v[152:155]
    s_lshl_b32 s45, s45, 7
    s_add_u32 s45, s45, 16384
    v_mfma_f32_16x16x32_bf16 v[156:159], v[60:63], a[44:47], v[156:159]
    v_min_u32 v8, 7, v0
    s_waitcnt lgkmcnt(4)
    v_mfma_f32_16x16x32_bf16 v[160:163], v[48:51], a[32:35], v[160:163]
    ds_read_b64_tr_b16 v[60:61], v38 offset:25696
    v_mfma_f32_16x16x32_bf16 v[164:167], v[48:51], a[36:39], v[164:167]
    ds_read_b64_tr_b16 v[62:63], v38 offset:28256
    v_mfma_f32_16x16x32_bf16 v[168:171], v[48:51], a[40:43], v[168:171]
    v_lshlrev_b32 v8, 2, v8
    v_add_u32 v8, s45, v8
    v_mfma_f32_16x16x32_bf16 v[172:175], v[48:51], a[44:47], v[172:175]
    s_add_u32 m0, s37, 1024
    s_waitcnt lgkmcnt(4)
    v_mfma_f32_16x16x32_bf16 v[176:179], v[52:55], a[32:35], v[176:179]
    ds_read_b64_tr_b16 v[48:49], v38 offset:20608
    v_mfma_f32_16x16x32_bf16 v[180:183], v[52:55], a[36:39], v[180:183]
    ds_read_b64_tr_b16 v[50:51], v38 offset:23168
    v_mfma_f32_16x16x32_bf16 v[184:187], v[52:55], a[40:43], v[184:187]
    buffer_load_dwordx4 v23, s[12:15], s32 offen lds
    s_add_u32 m0, s37, 2048
    v_mfma_f32_16x16x32_bf16 v[188:191], v[52:55], a[44:47], v[188:191]
    buffer_load_dwordx4 v24, s[12:15], s32 offen lds
    s_waitcnt lgkmcnt(4)
    v_mfma_f32_16x16x32_bf16 v[192:195], v[56:59], a[32:35], v[192:195]
    ds_read_b64_tr_b16 v[52:53], v38 offset:25728
    v_mfma_f32_16x16x32_bf16 v[196:199], v[56:59], a[36:39], v[196:199]
    ds_read_b64_tr_b16 v[54:55], v38 offset:28288
    v_mfma_f32_16x16x32_bf16 v[200:203], v[56:59], a[40:43], v[200:203]
    s_add_u32 m0, s37, 3072
    v_mfma_f32_16x16x32_bf16 v[204:207], v[56:59], a[44:47], v[204:207]
    buffer_load_dwordx4 v25, s[12:15], s32 offen lds
    s_waitcnt lgkmcnt(4)
    v_mfma_f32_16x16x32_bf16 v[208:211], v[60:63], a[32:35], v[208:211]
    ds_read_b64_tr_b16 v[56:57], v38 offset:30720
    v_mfma_f32_16x16x32_bf16 v[212:215], v[60:63], a[36:39], v[212:215]
    ds_read_b64_tr_b16 v[58:59], v38 offset:33280
    v_mfma_f32_16x16x32_bf16 v[216:219], v[60:63], a[40:43], v[216:219]
    s_add_u32 m0, s37, 4096
    v_mfma_f32_16x16x32_bf16 v[220:223], v[60:63], a[44:47], v[220:223]
    buffer_load_dwordx4 v26, s[12:15], s32 offen lds
    s_waitcnt lgkmcnt(4)
    v_mfma_f32_16x16x32_bf16 v[224:227], v[48:51], a[32:35], v[224:227]
    ds_read_b64_tr_b16 v[60:61], v38 offset:35840
    v_mfma_f32_16x16x32_bf16 v[228:231], v[48:51], a[36:39], v[228:231]
    ds_read_b64_tr_b16 v[62:63], v38 offset:38400
    v_mfma_f32_16x16x32_bf16 v[232:235], v[48:51], a[40:43], v[232:235]
    s_add_u32 s32, s32, 589824
    v_mfma_f32_16x16x32_bf16 v[236:239], v[48:51], a[44:47], v[236:239]
    s_waitcnt lgkmcnt(4)
    v_mfma_f32_16x16x32_bf16 v[240:243], v[52:55], a[32:35], v[240:243]
    ds_read_b64_tr_b16 v[48:49], v38 offset:30752
    v_mfma_f32_16x16x32_bf16 v[244:247], v[52:55], a[36:39], v[244:247]
    ds_read_b64_tr_b16 v[50:51], v38 offset:33312
    v_mfma_f32_16x16x32_bf16 v[248:251], v[52:55], a[40:43], v[248:251]
    buffer_load_dword v27, v6, s[12:15], s49 offen
    s_add_u32 s49, s49, 589824
    v_mfma_f32_16x16x32_bf16 v[252:255], v[52:55], a[44:47], v[252:255]
    s_waitcnt lgkmcnt(4)
    v_mfma_f32_16x16x32_bf16 v[96:99], v[56:59], a[48:51], v[96:99]
    ds_read_b64_tr_b16 v[52:53], v38 offset:35872
    v_mfma_f32_16x16x32_bf16 v[100:103], v[56:59], a[52:55], v[100:103]
    ds_read_b64_tr_b16 v[54:55], v38 offset:38432
    v_mfma_f32_16x16x32_bf16 v[104:107], v[56:59], a[56:59], v[104:107]
    buffer_load_dword v27, v1, s[92:95], s100 offen
    s_add_u32 s100, s100, 73728
    v_mfma_f32_16x16x32_bf16 v[108:111], v[56:59], a[60:63], v[108:111]
    s_waitcnt lgkmcnt(4)
    v_mfma_f32_16x16x32_bf16 v[112:115], v[60:63], a[48:51], v[112:115]
    ds_read_b64_tr_b16 v[56:57], v38 offset:30784
    v_mfma_f32_16x16x32_bf16 v[116:119], v[60:63], a[52:55], v[116:119]
    ds_read_b64_tr_b16 v[58:59], v38 offset:33344
    v_mfma_f32_16x16x32_bf16 v[120:123], v[60:63], a[56:59], v[120:123]
    v_mfma_f32_16x16x32_bf16 v[124:127], v[60:63], a[60:63], v[124:127]
    s_waitcnt lgkmcnt(4)
    v_mfma_f32_16x16x32_bf16 v[128:131], v[48:51], a[48:51], v[128:131]
    ds_read_b64_tr_b16 v[60:61], v38 offset:35904
    v_mfma_f32_16x16x32_bf16 v[132:135], v[48:51], a[52:55], v[132:135]
    ds_read_b64_tr_b16 v[62:63], v38 offset:38464
    v_mfma_f32_16x16x32_bf16 v[136:139], v[48:51], a[56:59], v[136:139]
    s_add_u32 m0, s48, 81920
    v_mfma_f32_16x16x32_bf16 v[140:143], v[48:51], a[60:63], v[140:143]
    buffer_load_dwordx4 v15, s[20:23], s48 offen lds
    s_waitcnt lgkmcnt(4)
    v_mfma_f32_16x16x32_bf16 v[144:147], v[52:55], a[48:51], v[144:147]
    ds_read_b64_tr_b16 v[48:49], v38 offset:30816
    v_mfma_f32_16x16x32_bf16 v[148:151], v[52:55], a[52:55], v[148:151]
    ds_read_b64_tr_b16 v[50:51], v38 offset:33376
    v_mfma_f32_16x16x32_bf16 v[152:155], v[52:55], a[56:59], v[152:155]
    s_add_u32 s48, s48, 1024
    v_mfma_f32_16x16x32_bf16 v[156:159], v[52:55], a[60:63], v[156:159]
    s_waitcnt lgkmcnt(4)
    v_mfma_f32_16x16x32_bf16 v[160:163], v[56:59], a[48:51], v[160:163]
    ds_read_b64_tr_b16 v[52:53], v38 offset:35936
    v_mfma_f32_16x16x32_bf16 v[164:167], v[56:59], a[52:55], v[164:167]
    ds_read_b64_tr_b16 v[54:55], v38 offset:38496
    v_mfma_f32_16x16x32_bf16 v[168:171], v[56:59], a[56:59], v[168:171]
    s_add_u32 m0, s48, 81920
    v_mfma_f32_16x16x32_bf16 v[172:175], v[56:59], a[60:63], v[172:175]
    buffer_load_dwordx4 v15, s[20:23], s48 offen lds
    s_waitcnt lgkmcnt(4)
    v_mfma_f32_16x16x32_bf16 v[176:179], v[60:63], a[48:51], v[176:179]
    ds_read_b64_tr_b16 v[56:57], v38 offset:30848
    v_mfma_f32_16x16x32_bf16 v[180:183], v[60:63], a[52:55], v[180:183]
    ds_read_b64_tr_b16 v[58:59], v38 offset:33408
    v_mfma_f32_16x16x32_bf16 v[184:187], v[60:63], a[56:59], v[184:187]
    s_add_u32 s48, s48, 1024
    s_add_u32 m0, s48, 81920
    v_mfma_f32_16x16x32_bf16 v[188:191], v[60:63], a[60:63], v[188:191]
    buffer_load_dwordx4 v15, s[20:23], s48 offen lds
    s_waitcnt lgkmcnt(4)
    v_mfma_f32_16x16x32_bf16 v[192:195], v[48:51], a[48:51], v[192:195]
    ds_read_b64_tr_b16 v[60:61], v38 offset:35968
    v_mfma_f32_16x16x32_bf16 v[196:199], v[48:51], a[52:55], v[196:199]
    ds_read_b64_tr_b16 v[62:63], v38 offset:38528
    v_mfma_f32_16x16x32_bf16 v[200:203], v[48:51], a[56:59], v[200:203]
    s_add_u32 s48, s48, 1024
    v_mfma_f32_16x16x32_bf16 v[204:207], v[48:51], a[60:63], v[204:207]
    s_waitcnt lgkmcnt(4)
    v_mfma_f32_16x16x32_bf16 v[208:211], v[52:55], a[48:51], v[208:211]
    ds_read_b64_tr_b16 v[48:49], v38 offset:40960
    v_mfma_f32_16x16x32_bf16 v[212:215], v[52:55], a[52:55], v[212:215]
    ds_read_b64_tr_b16 v[50:51], v38 offset:43520
    v_mfma_f32_16x16x32_bf16 v[216:219], v[52:55], a[56:59], v[216:219]
    buffer_load_dword v27, v20, s[84:87], s88 offen
    s_add_u32 s88, s88, 1024
    v_mfma_f32_16x16x32_bf16 v[220:223], v[52:55], a[60:63], v[220:223]
    s_waitcnt lgkmcnt(4)
    v_mfma_f32_16x16x32_bf16 v[224:227], v[56:59], a[48:51], v[224:227]
    ds_read_b64_tr_b16 v[52:53], v38 offset:46080
    v_mfma_f32_16x16x32_bf16 v[228:231], v[56:59], a[52:55], v[228:231]
    ds_read_b64_tr_b16 v[54:55], v38 offset:48640
    v_mfma_f32_16x16x32_bf16 v[232:235], v[56:59], a[56:59], v[232:235]
    v_mfma_f32_16x16x32_bf16 v[236:239], v[56:59], a[60:63], v[236:239]
    s_waitcnt lgkmcnt(4)
    v_mfma_f32_16x16x32_bf16 v[240:243], v[60:63], a[48:51], v[240:243]
    ds_read_b64_tr_b16 v[56:57], v38 offset:40992
    v_mfma_f32_16x16x32_bf16 v[244:247], v[60:63], a[52:55], v[244:247]
    ds_read_b64_tr_b16 v[58:59], v38 offset:43552
    v_mfma_f32_16x16x32_bf16 v[248:251], v[60:63], a[56:59], v[248:251]
    v_mfma_f32_16x16x32_bf16 v[252:255], v[60:63], a[60:63], v[252:255]
    s_waitcnt lgkmcnt(4)
    v_mfma_f32_16x16x32_bf16 v[96:99], v[48:51], a[64:67], v[96:99]
    ds_read_b64_tr_b16 v[60:61], v38 offset:46112
    v_mfma_f32_16x16x32_bf16 v[100:103], v[48:51], a[68:71], v[100:103]
    ds_read_b64_tr_b16 v[62:63], v38 offset:48672
    v_mfma_f32_16x16x32_bf16 v[104:107], v[48:51], a[72:75], v[104:107]
    v_mfma_f32_16x16x32_bf16 v[108:111], v[48:51], a[76:79], v[108:111]
    s_waitcnt vmcnt(13)
    s_barrier
    s_waitcnt lgkmcnt(4)
    v_mfma_f32_16x16x32_bf16 v[112:115], v[52:55], a[64:67], v[112:115]
    ds_read_b64_tr_b16 v[48:49], v38 offset:41024
    v_mfma_f32_16x16x32_bf16 v[116:119], v[52:55], a[68:71], v[116:119]
    ds_read_b64_tr_b16 v[50:51], v38 offset:43584
    v_mfma_f32_16x16x32_bf16 v[120:123], v[52:55], a[72:75], v[120:123]
    s_add_u32 m0, s37, 20480
    v_mfma_f32_16x16x32_bf16 v[124:127], v[52:55], a[76:79], v[124:127]
    buffer_load_dwordx4 v22, s[12:15], s32 offen lds
    s_waitcnt lgkmcnt(4)
    v_mfma_f32_16x16x32_bf16 v[128:131], v[56:59], a[64:67], v[128:131]
    ds_read_b64_tr_b16 v[52:53], v38 offset:46144
    v_mfma_f32_16x16x32_bf16 v[132:135], v[56:59], a[68:71], v[132:135]
    ds_read_b64_tr_b16 v[54:55], v38 offset:48704
    v_mfma_f32_16x16x32_bf16 v[136:139], v[56:59], a[72:75], v[136:139]
    s_add_u32 m0, s37, 21504
    v_mfma_f32_16x16x32_bf16 v[140:143], v[56:59], a[76:79], v[140:143]
    buffer_load_dwordx4 v23, s[12:15], s32 offen lds
    s_waitcnt lgkmcnt(4)
    v_mfma_f32_16x16x32_bf16 v[144:147], v[60:63], a[64:67], v[144:147]
    ds_read_b64_tr_b16 v[56:57], v38 offset:41056
    v_mfma_f32_16x16x32_bf16 v[148:151], v[60:63], a[68:71], v[148:151]
    ds_read_b64_tr_b16 v[58:59], v38 offset:43616
    v_mfma_f32_16x16x32_bf16 v[152:155], v[60:63], a[72:75], v[152:155]
    v_mfma_f32_16x16x32_bf16 v[156:159], v[60:63], a[76:79], v[156:159]
    s_waitcnt lgkmcnt(4)
    v_mfma_f32_16x16x32_bf16 v[160:163], v[48:51], a[64:67], v[160:163]
    ds_read_b64_tr_b16 v[60:61], v38 offset:46176
    v_mfma_f32_16x16x32_bf16 v[164:167], v[48:51], a[68:71], v[164:167]
    ds_read_b64_tr_b16 v[62:63], v38 offset:48736
    v_mfma_f32_16x16x32_bf16 v[168:171], v[48:51], a[72:75], v[168:171]
    s_add_u32 m0, s37, 22528
    v_mfma_f32_16x16x32_bf16 v[172:175], v[48:51], a[76:79], v[172:175]
    buffer_load_dwordx4 v24, s[12:15], s32 offen lds
    s_waitcnt lgkmcnt(4)
    v_mfma_f32_16x16x32_bf16 v[176:179], v[52:55], a[64:67], v[176:179]
    ds_read_b64_tr_b16 v[48:49], v38 offset:41088
    v_mfma_f32_16x16x32_bf16 v[180:183], v[52:55], a[68:71], v[180:183]
    ds_read_b64_tr_b16 v[50:51], v38 offset:43648
    v_mfma_f32_16x16x32_bf16 v[184:187], v[52:55], a[72:75], v[184:187]
    s_add_u32 m0, s37, 23552
    v_mfma_f32_16x16x32_bf16 v[188:191], v[52:55], a[76:79], v[188:191]
    buffer_load_dwordx4 v25, s[12:15], s32 offen lds
    s_waitcnt lgkmcnt(4)
    v_mfma_f32_16x16x32_bf16 v[192:195], v[56:59], a[64:67], v[192:195]
    ds_read_b64_tr_b16 v[52:53], v38 offset:46208
    v_mfma_f32_16x16x32_bf16 v[196:199], v[56:59], a[68:71], v[196:199]
    ds_read_b64_tr_b16 v[54:55], v38 offset:48768
    v_mfma_f32_16x16x32_bf16 v[200:203], v[56:59], a[72:75], v[200:203]
    v_mfma_f32_16x16x32_bf16 v[204:207], v[56:59], a[76:79], v[204:207]
    s_waitcnt lgkmcnt(4)
    v_mfma_f32_16x16x32_bf16 v[208:211], v[60:63], a[64:67], v[208:211]
    ds_read_b64_tr_b16 v[56:57], v38 offset:51200
    v_mfma_f32_16x16x32_bf16 v[212:215], v[60:63], a[68:71], v[212:215]
    ds_read_b64_tr_b16 v[58:59], v38 offset:53760
    v_mfma_f32_16x16x32_bf16 v[216:219], v[60:63], a[72:75], v[216:219]
    s_add_u32 m0, s37, 24576
    v_mfma_f32_16x16x32_bf16 v[220:223], v[60:63], a[76:79], v[220:223]
    buffer_load_dwordx4 v26, s[12:15], s32 offen lds
    s_waitcnt lgkmcnt(4)
    v_mfma_f32_16x16x32_bf16 v[224:227], v[48:51], a[64:67], v[224:227]
    ds_read_b64_tr_b16 v[60:61], v38 offset:56320
    v_mfma_f32_16x16x32_bf16 v[228:231], v[48:51], a[68:71], v[228:231]
    ds_read_b64_tr_b16 v[62:63], v38 offset:58880
    v_mfma_f32_16x16x32_bf16 v[232:235], v[48:51], a[72:75], v[232:235]
    s_add_u32 s32, s32, 589824
    v_mfma_f32_16x16x32_bf16 v[236:239], v[48:51], a[76:79], v[236:239]
    s_waitcnt lgkmcnt(4)
    v_mfma_f32_16x16x32_bf16 v[240:243], v[52:55], a[64:67], v[240:243]
    ds_read_b64_tr_b16 v[48:49], v38 offset:51232
    v_mfma_f32_16x16x32_bf16 v[244:247], v[52:55], a[68:71], v[244:247]
    ds_read_b64_tr_b16 v[50:51], v38 offset:53792
    v_mfma_f32_16x16x32_bf16 v[248:251], v[52:55], a[72:75], v[248:251]
    buffer_load_dword v27, v6, s[12:15], s49 offen
    s_add_u32 s49, s49, 589824
    v_mfma_f32_16x16x32_bf16 v[252:255], v[52:55], a[76:79], v[252:255]
    s_waitcnt lgkmcnt(4)
    v_mfma_f32_16x16x32_bf16 v[96:99], v[56:59], a[80:83], v[96:99]
    ds_read_b64_tr_b16 v[52:53], v38 offset:56352
    v_mfma_f32_16x16x32_bf16 v[100:103], v[56:59], a[84:87], v[100:103]
    ds_read_b64_tr_b16 v[54:55], v38 offset:58912
    v_mfma_f32_16x16x32_bf16 v[104:107], v[56:59], a[88:91], v[104:107]
    buffer_load_dword v27, v1, s[92:95], s100 offen
    s_add_u32 s100, s100, 73728
    v_mfma_f32_16x16x32_bf16 v[108:111], v[56:59], a[92:95], v[108:111]
    s_waitcnt lgkmcnt(4)
    v_mfma_f32_16x16x32_bf16 v[112:115], v[60:63], a[80:83], v[112:115]
    ds_read_b64_tr_b16 v[56:57], v38 offset:51264
    v_mfma_f32_16x16x32_bf16 v[116:119], v[60:63], a[84:87], v[116:119]
    ds_read_b64_tr_b16 v[58:59], v38 offset:53824
    v_mfma_f32_16x16x32_bf16 v[120:123], v[60:63], a[88:91], v[120:123]
    v_mfma_f32_16x16x32_bf16 v[124:127], v[60:63], a[92:95], v[124:127]
    s_waitcnt lgkmcnt(4)
    v_mfma_f32_16x16x32_bf16 v[128:131], v[48:51], a[80:83], v[128:131]
    ds_read_b64_tr_b16 v[60:61], v38 offset:56384
    v_mfma_f32_16x16x32_bf16 v[132:135], v[48:51], a[84:87], v[132:135]
    ds_read_b64_tr_b16 v[62:63], v38 offset:58944
    v_mfma_f32_16x16x32_bf16 v[136:139], v[48:51], a[88:91], v[136:139]
    s_add_u32 m0, s48, 81920
    v_mfma_f32_16x16x32_bf16 v[140:143], v[48:51], a[92:95], v[140:143]
    buffer_load_dwordx4 v15, s[20:23], s48 offen lds
    s_waitcnt lgkmcnt(4)
    v_mfma_f32_16x16x32_bf16 v[144:147], v[52:55], a[80:83], v[144:147]
    ds_read_b64_tr_b16 v[48:49], v38 offset:51296
    v_mfma_f32_16x16x32_bf16 v[148:151], v[52:55], a[84:87], v[148:151]
    ds_read_b64_tr_b16 v[50:51], v38 offset:53856
    v_mfma_f32_16x16x32_bf16 v[152:155], v[52:55], a[88:91], v[152:155]
    s_add_u32 s48, s48, 1024
    v_mfma_f32_16x16x32_bf16 v[156:159], v[52:55], a[92:95], v[156:159]
    s_waitcnt lgkmcnt(4)
    v_mfma_f32_16x16x32_bf16 v[160:163], v[56:59], a[80:83], v[160:163]
    ds_read_b64_tr_b16 v[52:53], v38 offset:56416
    v_mfma_f32_16x16x32_bf16 v[164:167], v[56:59], a[84:87], v[164:167]
    ds_read_b64_tr_b16 v[54:55], v38 offset:58976
    v_mfma_f32_16x16x32_bf16 v[168:171], v[56:59], a[88:91], v[168:171]
    s_add_u32 m0, s48, 81920
    v_mfma_f32_16x16x32_bf16 v[172:175], v[56:59], a[92:95], v[172:175]
    buffer_load_dwordx4 v15, s[20:23], s48 offen lds
    s_waitcnt lgkmcnt(4)
    v_mfma_f32_16x16x32_bf16 v[176:179], v[60:63], a[80:83], v[176:179]
    ds_read_b64_tr_b16 v[56:57], v38 offset:51328
    v_mfma_f32_16x16x32_bf16 v[180:183], v[60:63], a[84:87], v[180:183]
    ds_read_b64_tr_b16 v[58:59], v38 offset:53888
    v_mfma_f32_16x16x32_bf16 v[184:187], v[60:63], a[88:91], v[184:187]
    s_add_u32 s48, s48, 1024
    s_add_u32 m0, s48, 81920
    v_mfma_f32_16x16x32_bf16 v[188:191], v[60:63], a[92:95], v[188:191]
    buffer_load_dwordx4 v15, s[20:23], s48 offen lds
    s_waitcnt lgkmcnt(4)
    v_mfma_f32_16x16x32_bf16 v[192:195], v[48:51], a[80:83], v[192:195]
    ds_read_b64_tr_b16 v[60:61], v38 offset:56448
    v_mfma_f32_16x16x32_bf16 v[196:199], v[48:51], a[84:87], v[196:199]
    ds_read_b64_tr_b16 v[62:63], v38 offset:59008
    v_mfma_f32_16x16x32_bf16 v[200:203], v[48:51], a[88:91], v[200:203]
    s_add_u32 s48, s48, 1024
    v_mfma_f32_16x16x32_bf16 v[204:207], v[48:51], a[92:95], v[204:207]
    s_waitcnt lgkmcnt(4)
    v_mfma_f32_16x16x32_bf16 v[208:211], v[52:55], a[80:83], v[208:211]
    ds_read_b64_tr_b16 v[48:49], v39 offset:0
    v_mfma_f32_16x16x32_bf16 v[212:215], v[52:55], a[84:87], v[212:215]
    ds_read_b64_tr_b16 v[50:51], v39 offset:2560
    v_mfma_f32_16x16x32_bf16 v[216:219], v[52:55], a[88:91], v[216:219]
    buffer_load_dword v27, v20, s[84:87], s88 offen
    s_add_u32 s88, s88, 1024
    v_mfma_f32_16x16x32_bf16 v[220:223], v[52:55], a[92:95], v[220:223]
    s_waitcnt lgkmcnt(4)
    v_mfma_f32_16x16x32_bf16 v[224:227], v[56:59], a[80:83], v[224:227]
    ds_read_b64_tr_b16 v[52:53], v39 offset:5120
    v_mfma_f32_16x16x32_bf16 v[228:231], v[56:59], a[84:87], v[228:231]
    ds_read_b64_tr_b16 v[54:55], v39 offset:7680
    v_mfma_f32_16x16x32_bf16 v[232:235], v[56:59], a[88:91], v[232:235]
    v_mfma_f32_16x16x32_bf16 v[236:239], v[56:59], a[92:95], v[236:239]
    s_waitcnt lgkmcnt(4)
    v_mfma_f32_16x16x32_bf16 v[240:243], v[60:63], a[80:83], v[240:243]
    ds_read_b64_tr_b16 v[56:57], v39 offset:32
    v_mfma_f32_16x16x32_bf16 v[244:247], v[60:63], a[84:87], v[244:247]
    ds_read_b64_tr_b16 v[58:59], v39 offset:2592
    v_mfma_f32_16x16x32_bf16 v[248:251], v[60:63], a[88:91], v[248:251]
    v_mfma_f32_16x16x32_bf16 v[252:255], v[60:63], a[92:95], v[252:255]
    s_waitcnt lgkmcnt(4)
    v_mfma_f32_16x16x32_bf16 v[96:99], v[48:51], a[96:99], v[96:99]
    ds_read_b64_tr_b16 v[60:61], v39 offset:5152
    v_mfma_f32_16x16x32_bf16 v[100:103], v[48:51], a[100:103], v[100:103]
    ds_read_b64_tr_b16 v[62:63], v39 offset:7712
    v_mfma_f32_16x16x32_bf16 v[104:107], v[48:51], a[104:107], v[104:107]
    v_mfma_f32_16x16x32_bf16 v[108:111], v[48:51], a[108:111], v[108:111]
    s_waitcnt vmcnt(17)
    s_barrier
    s_waitcnt lgkmcnt(4)
    v_mfma_f32_16x16x32_bf16 v[112:115], v[52:55], a[96:99], v[112:115]
    ds_read_b64_tr_b16 v[48:49], v39 offset:64
    v_mfma_f32_16x16x32_bf16 v[116:119], v[52:55], a[100:103], v[116:119]
    ds_read_b64_tr_b16 v[50:51], v39 offset:2624
    v_mfma_f32_16x16x32_bf16 v[120:123], v[52:55], a[104:107], v[120:123]
    s_add_u32 m0, s37, 40960
    v_mfma_f32_16x16x32_bf16 v[124:127], v[52:55], a[108:111], v[124:127]
    buffer_load_dwordx4 v22, s[12:15], s32 offen lds
    s_waitcnt lgkmcnt(4)
    v_mfma_f32_16x16x32_bf16 v[128:131], v[56:59], a[96:99], v[128:131]
    ds_read_b64_tr_b16 v[52:53], v39 offset:5184
    v_mfma_f32_16x16x32_bf16 v[132:135], v[56:59], a[100:103], v[132:135]
    ds_read_b64_tr_b16 v[54:55], v39 offset:7744
    v_mfma_f32_16x16x32_bf16 v[136:139], v[56:59], a[104:107], v[136:139]
    s_add_u32 m0, s37, 41984
    v_mfma_f32_16x16x32_bf16 v[140:143], v[56:59], a[108:111], v[140:143]
    buffer_load_dwordx4 v23, s[12:15], s32 offen lds
    s_waitcnt lgkmcnt(4)
    v_mfma_f32_16x16x32_bf16 v[144:147], v[60:63], a[96:99], v[144:147]
    ds_read_b64_tr_b16 v[56:57], v39 offset:96
    v_mfma_f32_16x16x32_bf16 v[148:151], v[60:63], a[100:103], v[148:151]
    ds_read_b64_tr_b16 v[58:59], v39 offset:2656
    v_mfma_f32_16x16x32_bf16 v[152:155], v[60:63], a[104:107], v[152:155]
    v_mfma_f32_16x16x32_bf16 v[156:159], v[60:63], a[108:111], v[156:159]
    s_waitcnt lgkmcnt(4)
    v_mfma_f32_16x16x32_bf16 v[160:163], v[48:51], a[96:99], v[160:163]
    ds_read_b64_tr_b16 v[60:61], v39 offset:5216
    v_mfma_f32_16x16x32_bf16 v[164:167], v[48:51], a[100:103], v[164:167]
    ds_read_b64_tr_b16 v[62:63], v39 offset:7776
    v_mfma_f32_16x16x32_bf16 v[168:171], v[48:51], a[104:107], v[168:171]
    s_add_u32 m0, s37, 43008
    v_mfma_f32_16x16x32_bf16 v[172:175], v[48:51], a[108:111], v[172:175]
    buffer_load_dwordx4 v24, s[12:15], s32 offen lds
    s_waitcnt lgkmcnt(4)
    v_mfma_f32_16x16x32_bf16 v[176:179], v[52:55], a[96:99], v[176:179]
    ds_read_b64_tr_b16 v[48:49], v39 offset:128
    v_mfma_f32_16x16x32_bf16 v[180:183], v[52:55], a[100:103], v[180:183]
    ds_read_b64_tr_b16 v[50:51], v39 offset:2688
    v_mfma_f32_16x16x32_bf16 v[184:187], v[52:55], a[104:107], v[184:187]
    s_add_u32 m0, s37, 44032
    v_mfma_f32_16x16x32_bf16 v[188:191], v[52:55], a[108:111], v[188:191]
    buffer_load_dwordx4 v25, s[12:15], s32 offen lds
    s_waitcnt lgkmcnt(4)
    v_mfma_f32_16x16x32_bf16 v[192:195], v[56:59], a[96:99], v[192:195]
    ds_read_b64_tr_b16 v[52:53], v39 offset:5248
    v_mfma_f32_16x16x32_bf16 v[196:199], v[56:59], a[100:103], v[196:199]
    ds_read_b64_tr_b16 v[54:55], v39 offset:7808
    v_mfma_f32_16x16x32_bf16 v[200:203], v[56:59], a[104:107], v[200:203]
    v_mfma_f32_16x16x32_bf16 v[204:207], v[56:59], a[108:111], v[204:207]
    s_waitcnt lgkmcnt(4)
    v_mfma_f32_16x16x32_bf16 v[208:211], v[60:63], a[96:99], v[208:211]
    ds_read_b64_tr_b16 v[56:57], v39 offset:10240
    v_mfma_f32_16x16x32_bf16 v[212:215], v[60:63], a[100:103], v[212:215]
    ds_read_b64_tr_b16 v[58:59], v39 offset:12800
    v_mfma_f32_16x16x32_bf16 v[216:219], v[60:63], a[104:107], v[216:219]
    s_add_u32 m0, s37, 45056
    v_mfma_f32_16x16x32_bf16 v[220:223], v[60:63], a[108:111], v[220:223]
    buffer_load_dwordx4 v26, s[12:15], s32 offen lds
    s_waitcnt lgkmcnt(4)
    v_mfma_f32_16x16x32_bf16 v[224:227], v[48:51], a[96:99], v[224:227]
    ds_read_b64_tr_b16 v[60:61], v39 offset:15360
    v_mfma_f32_16x16x32_bf16 v[228:231], v[48:51], a[100:103], v[228:231]
    ds_read_b64_tr_b16 v[62:63], v39 offset:17920
    v_mfma_f32_16x16x32_bf16 v[232:235], v[48:51], a[104:107], v[232:235]
    s_add_u32 s32, s32, 589824
    v_mfma_f32_16x16x32_bf16 v[236:239], v[48:51], a[108:111], v[236:239]
    s_waitcnt lgkmcnt(4)
    v_mfma_f32_16x16x32_bf16 v[240:243], v[52:55], a[96:99], v[240:243]
    ds_read_b64_tr_b16 v[48:49], v39 offset:10272
    v_mfma_f32_16x16x32_bf16 v[244:247], v[52:55], a[100:103], v[244:247]
    ds_read_b64_tr_b16 v[50:51], v39 offset:12832
    v_mfma_f32_16x16x32_bf16 v[248:251], v[52:55], a[104:107], v[248:251]
    buffer_load_dword v27, v6, s[12:15], s49 offen
    s_add_u32 s49, s49, 589824
    v_mfma_f32_16x16x32_bf16 v[252:255], v[52:55], a[108:111], v[252:255]
    s_waitcnt lgkmcnt(4)
    v_mfma_f32_16x16x32_bf16 v[96:99], v[56:59], a[112:115], v[96:99]
    ds_read_b64_tr_b16 v[52:53], v39 offset:15392
    v_mfma_f32_16x16x32_bf16 v[100:103], v[56:59], a[116:119], v[100:103]
    ds_read_b64_tr_b16 v[54:55], v39 offset:17952
    v_mfma_f32_16x16x32_bf16 v[104:107], v[56:59], a[120:123], v[104:107]
    buffer_load_dword v27, v1, s[92:95], s100 offen
    s_add_u32 s100, s100, 73728
    v_mfma_f32_16x16x32_bf16 v[108:111], v[56:59], a[124:127], v[108:111]
    s_waitcnt lgkmcnt(4)
    v_mfma_f32_16x16x32_bf16 v[112:115], v[60:63], a[112:115], v[112:115]
    ds_read_b64_tr_b16 v[56:57], v39 offset:10304
    v_mfma_f32_16x16x32_bf16 v[116:119], v[60:63], a[116:119], v[116:119]
    ds_read_b64_tr_b16 v[58:59], v39 offset:12864
    v_mfma_f32_16x16x32_bf16 v[120:123], v[60:63], a[120:123], v[120:123]
    v_mfma_f32_16x16x32_bf16 v[124:127], v[60:63], a[124:127], v[124:127]
    s_waitcnt lgkmcnt(4)
    v_mfma_f32_16x16x32_bf16 v[128:131], v[48:51], a[112:115], v[128:131]
    ds_read_b64_tr_b16 v[60:61], v39 offset:15424
    v_mfma_f32_16x16x32_bf16 v[132:135], v[48:51], a[116:119], v[132:135]
    ds_read_b64_tr_b16 v[62:63], v39 offset:17984
    v_mfma_f32_16x16x32_bf16 v[136:139], v[48:51], a[120:123], v[136:139]
    s_add_u32 m0, s48, 81920
    v_mfma_f32_16x16x32_bf16 v[140:143], v[48:51], a[124:127], v[140:143]
    buffer_load_dwordx4 v15, s[20:23], s48 offen lds
    s_waitcnt lgkmcnt(4)
    v_mfma_f32_16x16x32_bf16 v[144:147], v[52:55], a[112:115], v[144:147]
    ds_read_b64_tr_b16 v[48:49], v39 offset:10336
    v_mfma_f32_16x16x32_bf16 v[148:151], v[52:55], a[116:119], v[148:151]
    ds_read_b64_tr_b16 v[50:51], v39 offset:12896
    v_mfma_f32_16x16x32_bf16 v[152:155], v[52:55], a[120:123], v[152:155]
    s_add_u32 s48, s48, 1024
    v_mfma_f32_16x16x32_bf16 v[156:159], v[52:55], a[124:127], v[156:159]
    s_waitcnt lgkmcnt(4)
    v_mfma_f32_16x16x32_bf16 v[160:163], v[56:59], a[112:115], v[160:163]
    ds_read_b64_tr_b16 v[52:53], v39 offset:15456
    v_mfma_f32_16x16x32_bf16 v[164:167], v[56:59], a[116:119], v[164:167]
    ds_read_b64_tr_b16 v[54:55], v39 offset:18016
    v_mfma_f32_16x16x32_bf16 v[168:171], v[56:59], a[120:123], v[168:171]
    s_add_u32 m0, s48, 81920
    v_mfma_f32_16x16x32_bf16 v[172:175], v[56:59], a[124:127], v[172:175]
    buffer_load_dwordx4 v15, s[20:23], s48 offen lds
    s_waitcnt lgkmcnt(4)
    v_mfma_f32_16x16x32_bf16 v[176:179], v[60:63], a[112:115], v[176:179]
    ds_read_b64_tr_b16 v[56:57], v39 offset:10368
    v_mfma_f32_16x16x32_bf16 v[180:183], v[60:63], a[116:119], v[180:183]
    ds_read_b64_tr_b16 v[58:59], v39 offset:12928
    v_mfma_f32_16x16x32_bf16 v[184:187], v[60:63], a[120:123], v[184:187]
    s_add_u32 s48, s48, 1024
    s_add_u32 m0, s48, 81920
    v_mfma_f32_16x16x32_bf16 v[188:191], v[60:63], a[124:127], v[188:191]
    buffer_load_dwordx4 v15, s[20:23], s48 offen lds
    s_waitcnt lgkmcnt(4)
    v_mfma_f32_16x16x32_bf16 v[192:195], v[48:51], a[112:115], v[192:195]
    ds_read_b64_tr_b16 v[60:61], v39 offset:15488
    v_mfma_f32_16x16x32_bf16 v[196:199], v[48:51], a[116:119], v[196:199]
    ds_read_b64_tr_b16 v[62:63], v39 offset:18048
    v_mfma_f32_16x16x32_bf16 v[200:203], v[48:51], a[120:123], v[200:203]
    s_add_u32 s48, s48, 1024
    v_mfma_f32_16x16x32_bf16 v[204:207], v[48:51], a[124:127], v[204:207]
    s_waitcnt lgkmcnt(4)
    v_mfma_f32_16x16x32_bf16 v[208:211], v[52:55], a[112:115], v[208:211]
    ds_read_b64_tr_b16 v[48:49], v38 offset:0
    v_mfma_f32_16x16x32_bf16 v[212:215], v[52:55], a[116:119], v[212:215]
    ds_read_b64_tr_b16 v[50:51], v38 offset:2560
    v_mfma_f32_16x16x32_bf16 v[216:219], v[52:55], a[120:123], v[216:219]
    buffer_load_dword v27, v20, s[84:87], s88 offen
    s_add_u32 s88, s88, 1024
    v_mfma_f32_16x16x32_bf16 v[220:223], v[52:55], a[124:127], v[220:223]
    s_waitcnt lgkmcnt(4)
    v_mfma_f32_16x16x32_bf16 v[224:227], v[56:59], a[112:115], v[224:227]
    ds_read_b64_tr_b16 v[52:53], v38 offset:5120
    v_mfma_f32_16x16x32_bf16 v[228:231], v[56:59], a[116:119], v[228:231]
    ds_read_b64_tr_b16 v[54:55], v38 offset:7680
    v_mfma_f32_16x16x32_bf16 v[232:235], v[56:59], a[120:123], v[232:235]
    v_mfma_f32_16x16x32_bf16 v[236:239], v[56:59], a[124:127], v[236:239]
    s_waitcnt lgkmcnt(4)
    v_mfma_f32_16x16x32_bf16 v[240:243], v[60:63], a[112:115], v[240:243]
    ds_read_b64_tr_b16 v[56:57], v38 offset:32
    v_mfma_f32_16x16x32_bf16 v[244:247], v[60:63], a[116:119], v[244:247]
    ds_read_b64_tr_b16 v[58:59], v38 offset:2592
    v_mfma_f32_16x16x32_bf16 v[248:251], v[60:63], a[120:123], v[248:251]
    v_mfma_f32_16x16x32_bf16 v[252:255], v[60:63], a[124:127], v[252:255]
    s_waitcnt lgkmcnt(4)
    v_mfma_f32_16x16x32_bf16 v[96:99], v[48:51], a[128:131], v[96:99]
    ds_read_b64_tr_b16 v[60:61], v38 offset:5152
    v_mfma_f32_16x16x32_bf16 v[100:103], v[48:51], a[132:135], v[100:103]
    ds_read_b64_tr_b16 v[62:63], v38 offset:7712
    v_mfma_f32_16x16x32_bf16 v[104:107], v[48:51], a[136:139], v[104:107]
    v_mfma_f32_16x16x32_bf16 v[108:111], v[48:51], a[140:143], v[108:111]
    s_waitcnt vmcnt(17)
    s_barrier
    s_waitcnt lgkmcnt(4)
    v_mfma_f32_16x16x32_bf16 v[112:115], v[52:55], a[128:131], v[112:115]
    ds_read_b64_tr_b16 v[48:49], v38 offset:64
    v_mfma_f32_16x16x32_bf16 v[116:119], v[52:55], a[132:135], v[116:119]
    ds_read_b64_tr_b16 v[50:51], v38 offset:2624
    v_mfma_f32_16x16x32_bf16 v[120:123], v[52:55], a[136:139], v[120:123]
    buffer_load_dword v7, v8, s[76:79], 0 offen sc1
    v_mfma_f32_16x16x32_bf16 v[124:127], v[52:55], a[140:143], v[124:127]
    s_waitcnt lgkmcnt(4)
    v_mfma_f32_16x16x32_bf16 v[128:131], v[56:59], a[128:131], v[128:131]
    ds_read_b64_tr_b16 v[52:53], v38 offset:5184
    v_mfma_f32_16x16x32_bf16 v[132:135], v[56:59], a[132:135], v[132:135]
    ds_read_b64_tr_b16 v[54:55], v38 offset:7744
    v_mfma_f32_16x16x32_bf16 v[136:139], v[56:59], a[136:139], v[136:139]
    s_add_u32 m0, s37, 61440
    v_mfma_f32_16x16x32_bf16 v[140:143], v[56:59], a[140:143], v[140:143]
    buffer_load_dwordx4 v22, s[12:15], s32 offen lds
    s_waitcnt lgkmcnt(4)
    v_mfma_f32_16x16x32_bf16 v[144:147], v[60:63], a[128:131], v[144:147]
    ds_read_b64_tr_b16 v[56:57], v38 offset:96
    v_mfma_f32_16x16x32_bf16 v[148:151], v[60:63], a[132:135], v[148:151]
    ds_read_b64_tr_b16 v[58:59], v38 offset:2656
    v_mfma_f32_16x16x32_bf16 v[152:155], v[60:63], a[136:139], v[152:155]
    v_mfma_f32_16x16x32_bf16 v[156:159], v[60:63], a[140:143], v[156:159]
    s_waitcnt lgkmcnt(4)
    v_mfma_f32_16x16x32_bf16 v[160:163], v[48:51], a[128:131], v[160:163]
    ds_read_b64_tr_b16 v[60:61], v38 offset:5216
    v_mfma_f32_16x16x32_bf16 v[164:167], v[48:51], a[132:135], v[164:167]
    ds_read_b64_tr_b16 v[62:63], v38 offset:7776
    v_mfma_f32_16x16x32_bf16 v[168:171], v[48:51], a[136:139], v[168:171]
    s_add_u32 m0, s37, 62464
    v_mfma_f32_16x16x32_bf16 v[172:175], v[48:51], a[140:143], v[172:175]
    buffer_load_dwordx4 v23, s[12:15], s32 offen lds
    s_waitcnt lgkmcnt(4)
    v_mfma_f32_16x16x32_bf16 v[176:179], v[52:55], a[128:131], v[176:179]
    ds_read_b64_tr_b16 v[48:49], v38 offset:128
    v_mfma_f32_16x16x32_bf16 v[180:183], v[52:55], a[132:135], v[180:183]
    ds_read_b64_tr_b16 v[50:51], v38 offset:2688
    v_mfma_f32_16x16x32_bf16 v[184:187], v[52:55], a[136:139], v[184:187]
    s_add_u32 m0, s37, 63488
    v_mfma_f32_16x16x32_bf16 v[188:191], v[52:55], a[140:143], v[188:191]
    buffer_load_dwordx4 v24, s[12:15], s32 offen lds
    s_waitcnt lgkmcnt(4)
    v_mfma_f32_16x16x32_bf16 v[192:195], v[56:59], a[128:131], v[192:195]
    ds_read_b64_tr_b16 v[52:53], v38 offset:5248
    v_mfma_f32_16x16x32_bf16 v[196:199], v[56:59], a[132:135], v[196:199]
    ds_read_b64_tr_b16 v[54:55], v38 offset:7808
    v_mfma_f32_16x16x32_bf16 v[200:203], v[56:59], a[136:139], v[200:203]
    v_mfma_f32_16x16x32_bf16 v[204:207], v[56:59], a[140:143], v[204:207]
    s_waitcnt lgkmcnt(4)
    v_mfma_f32_16x16x32_bf16 v[208:211], v[60:63], a[128:131], v[208:211]
    ds_read_b64_tr_b16 v[56:57], v38 offset:10240
    v_mfma_f32_16x16x32_bf16 v[212:215], v[60:63], a[132:135], v[212:215]
    ds_read_b64_tr_b16 v[58:59], v38 offset:12800
    v_mfma_f32_16x16x32_bf16 v[216:219], v[60:63], a[136:139], v[216:219]
    s_add_u32 m0, s37, 64512
    v_mfma_f32_16x16x32_bf16 v[220:223], v[60:63], a[140:143], v[220:223]
    buffer_load_dwordx4 v25, s[12:15], s32 offen lds
    s_waitcnt lgkmcnt(4)
    v_mfma_f32_16x16x32_bf16 v[224:227], v[48:51], a[128:131], v[224:227]
    ds_read_b64_tr_b16 v[60:61], v38 offset:15360
    v_mfma_f32_16x16x32_bf16 v[228:231], v[48:51], a[132:135], v[228:231]
    ds_read_b64_tr_b16 v[62:63], v38 offset:17920
    v_mfma_f32_16x16x32_bf16 v[232:235], v[48:51], a[136:139], v[232:235]
    v_mfma_f32_16x16x32_bf16 v[236:239], v[48:51], a[140:143], v[236:239]
    s_waitcnt lgkmcnt(4)
    v_mfma_f32_16x16x32_bf16 v[240:243], v[52:55], a[128:131], v[240:243]
    ds_read_b64_tr_b16 v[48:49], v38 offset:10272
    v_mfma_f32_16x16x32_bf16 v[244:247], v[52:55], a[132:135], v[244:247]
    ds_read_b64_tr_b16 v[50:51], v38 offset:12832
    v_mfma_f32_16x16x32_bf16 v[248:251], v[52:55], a[136:139], v[248:251]
    s_add_u32 m0, s37, 65536
    v_mfma_f32_16x16x32_bf16 v[252:255], v[52:55], a[140:143], v[252:255]
    buffer_load_dwordx4 v26, s[12:15], s32 offen lds
    s_waitcnt lgkmcnt(4)
    v_mfma_f32_16x16x32_bf16 v[96:99], v[56:59], a[144:147], v[96:99]
    ds_read_b64_tr_b16 v[52:53], v38 offset:15392
    v_mfma_f32_16x16x32_bf16 v[100:103], v[56:59], a[148:151], v[100:103]
    ds_read_b64_tr_b16 v[54:55], v38 offset:17952
    v_mfma_f32_16x16x32_bf16 v[104:107], v[56:59], a[152:155], v[104:107]
    s_add_u32 s32, s32, 589824
    v_mfma_f32_16x16x32_bf16 v[108:111], v[56:59], a[156:159], v[108:111]
    buffer_load_dword v27, v1, s[92:95], s100 offen
    s_waitcnt lgkmcnt(4)
    v_mfma_f32_16x16x32_bf16 v[112:115], v[60:63], a[144:147], v[112:115]
    ds_read_b64_tr_b16 v[56:57], v38 offset:10304
    v_mfma_f32_16x16x32_bf16 v[116:119], v[60:63], a[148:151], v[116:119]
    ds_read_b64_tr_b16 v[58:59], v38 offset:12864
    v_mfma_f32_16x16x32_bf16 v[120:123], v[60:63], a[152:155], v[120:123]
    s_add_u32 s100, s100, 73728
    v_mfma_f32_16x16x32_bf16 v[124:127], v[60:63], a[156:159], v[124:127]
    s_waitcnt lgkmcnt(4)
    v_mfma_f32_16x16x32_bf16 v[128:131], v[48:51], a[144:147], v[128:131]
    ds_read_b64_tr_b16 v[60:61], v38 offset:15424
    v_mfma_f32_16x16x32_bf16 v[132:135], v[48:51], a[148:151], v[132:135]
    ds_read_b64_tr_b16 v[62:63], v38 offset:17984
    v_mfma_f32_16x16x32_bf16 v[136:139], v[48:51], a[152:155], v[136:139]
    s_add_u32 m0, s48, 81920
    v_mfma_f32_16x16x32_bf16 v[140:143], v[48:51], a[156:159], v[140:143]
    buffer_load_dwordx4 v15, s[20:23], s48 offen lds
    s_waitcnt lgkmcnt(4)
    v_mfma_f32_16x16x32_bf16 v[144:147], v[52:55], a[144:147], v[144:147]
    ds_read_b64_tr_b16 v[48:49], v38 offset:10336
    v_mfma_f32_16x16x32_bf16 v[148:151], v[52:55], a[148:151], v[148:151]
    ds_read_b64_tr_b16 v[50:51], v38 offset:12896
    v_mfma_f32_16x16x32_bf16 v[152:155], v[52:55], a[152:155], v[152:155]
    s_add_u32 s48, s48, 1024
    v_mfma_f32_16x16x32_bf16 v[156:159], v[52:55], a[156:159], v[156:159]
    s_waitcnt lgkmcnt(4)
    v_mfma_f32_16x16x32_bf16 v[160:163], v[56:59], a[144:147], v[160:163]
    ds_read_b64_tr_b16 v[52:53], v38 offset:15456
    v_mfma_f32_16x16x32_bf16 v[164:167], v[56:59], a[148:151], v[164:167]
    ds_read_b64_tr_b16 v[54:55], v38 offset:18016
    v_mfma_f32_16x16x32_bf16 v[168:171], v[56:59], a[152:155], v[168:171]
    s_add_u32 m0, s48, 81920
    v_mfma_f32_16x16x32_bf16 v[172:175], v[56:59], a[156:159], v[172:175]
    buffer_load_dwordx4 v15, s[20:23], s48 offen lds
    s_waitcnt lgkmcnt(4)
    v_mfma_f32_16x16x32_bf16 v[176:179], v[60:63], a[144:147], v[176:179]
    ds_read_b64_tr_b16 v[56:57], v38 offset:10368
    v_mfma_f32_16x16x32_bf16 v[180:183], v[60:63], a[148:151], v[180:183]
    ds_read_b64_tr_b16 v[58:59], v38 offset:12928
    v_mfma_f32_16x16x32_bf16 v[184:187], v[60:63], a[152:155], v[184:187]
    s_add_u32 s48, s48, 1024
    s_add_u32 m0, s48, 81920
    v_mfma_f32_16x16x32_bf16 v[188:191], v[60:63], a[156:159], v[188:191]
    buffer_load_dwordx4 v15, s[20:23], s48 offen lds
    s_waitcnt lgkmcnt(4)
    v_mfma_f32_16x16x32_bf16 v[192:195], v[48:51], a[144:147], v[192:195]
    ds_read_b64_tr_b16 v[60:61], v38 offset:15488
    v_mfma_f32_16x16x32_bf16 v[196:199], v[48:51], a[148:151], v[196:199]
    ds_read_b64_tr_b16 v[62:63], v38 offset:18048
    v_mfma_f32_16x16x32_bf16 v[200:203], v[48:51], a[152:155], v[200:203]
    s_add_u32 s48, s48, 1024
    v_mfma_f32_16x16x32_bf16 v[204:207], v[48:51], a[156:159], v[204:207]
    s_waitcnt lgkmcnt(4)
    v_mfma_f32_16x16x32_bf16 v[208:211], v[52:55], a[144:147], v[208:211]
    ds_read_b64_tr_b16 v[48:49], v38 offset:20480
    v_mfma_f32_16x16x32_bf16 v[212:215], v[52:55], a[148:151], v[212:215]
    ds_read_b64_tr_b16 v[50:51], v38 offset:23040
    v_mfma_f32_16x16x32_bf16 v[216:219], v[52:55], a[152:155], v[216:219]
    buffer_load_dword v27, v20, s[84:87], s88 offen
    s_add_u32 s88, s88, 1024
    v_mfma_f32_16x16x32_bf16 v[220:223], v[52:55], a[156:159], v[220:223]
    s_waitcnt lgkmcnt(4)
    v_mfma_f32_16x16x32_bf16 v[224:227], v[56:59], a[144:147], v[224:227]
    ds_read_b64_tr_b16 v[52:53], v38 offset:25600
    v_mfma_f32_16x16x32_bf16 v[228:231], v[56:59], a[148:151], v[228:231]
    ds_read_b64_tr_b16 v[54:55], v38 offset:28160
    v_mfma_f32_16x16x32_bf16 v[232:235], v[56:59], a[152:155], v[232:235]
    v_mfma_f32_16x16x32_bf16 v[236:239], v[56:59], a[156:159], v[236:239]
    s_waitcnt lgkmcnt(4)
    v_mfma_f32_16x16x32_bf16 v[240:243], v[60:63], a[144:147], v[240:243]
    ds_read_b64_tr_b16 v[56:57], v38 offset:20512
    v_mfma_f32_16x16x32_bf16 v[244:247], v[60:63], a[148:151], v[244:247]
    ds_read_b64_tr_b16 v[58:59], v38 offset:23072
    v_mfma_f32_16x16x32_bf16 v[248:251], v[60:63], a[152:155], v[248:251]
    v_mfma_f32_16x16x32_bf16 v[252:255], v[60:63], a[156:159], v[252:255]
    s_waitcnt lgkmcnt(4)
    v_mfma_f32_16x16x32_bf16 v[96:99], v[48:51], a[160:163], v[96:99]
    ds_read_b64_tr_b16 v[60:61], v38 offset:25632
    v_mfma_f32_16x16x32_bf16 v[100:103], v[48:51], a[164:167], v[100:103]
    ds_read_b64_tr_b16 v[62:63], v38 offset:28192
    v_mfma_f32_16x16x32_bf16 v[104:107], v[48:51], a[168:171], v[104:107]
    v_mfma_f32_16x16x32_bf16 v[108:111], v[48:51], a[172:175], v[108:111]
    s_waitcnt vmcnt(17)
    s_barrier
    s_waitcnt lgkmcnt(4)
    v_mfma_f32_16x16x32_bf16 v[112:115], v[52:55], a[160:163], v[112:115]
    ds_read_b64_tr_b16 v[48:49], v38 offset:20544
    v_mfma_f32_16x16x32_bf16 v[116:119], v[52:55], a[164:167], v[116:119]
    ds_read_b64_tr_b16 v[50:51], v38 offset:23104
    v_mfma_f32_16x16x32_bf16 v[120:123], v[52:55], a[168:171], v[120:123]
    s_add_u32 m0, s37, 0
    v_mfma_f32_16x16x32_bf16 v[124:127], v[52:55], a[172:175], v[124:127]
    buffer_load_dwordx4 v22, s[12:15], s32 offen lds
    s_waitcnt lgkmcnt(4)
    v_mfma_f32_16x16x32_bf16 v[128:131], v[56:59], a[160:163], v[128:131]
    ds_read_b64_tr_b16 v[52:53], v38 offset:25664
    v_mfma_f32_16x16x32_bf16 v[132:135], v[56:59], a[164:167], v[132:135]
    ds_read_b64_tr_b16 v[54:55], v38 offset:28224
    v_mfma_f32_16x16x32_bf16 v[136:139], v[56:59], a[168:171], v[136:139]
    s_add_u32 m0, s37, 1024
    v_mfma_f32_16x16x32_bf16 v[140:143], v[56:59], a[172:175], v[140:143]
    buffer_load_dwordx4 v23, s[12:15], s32 offen lds
    s_waitcnt lgkmcnt(4)
    v_mfma_f32_16x16x32_bf16 v[144:147], v[60:63], a[160:163], v[144:147]
    ds_read_b64_tr_b16 v[56:57], v38 offset:20576
    v_mfma_f32_16x16x32_bf16 v[148:151], v[60:63], a[164:167], v[148:151]
    ds_read_b64_tr_b16 v[58:59], v38 offset:23136
    v_mfma_f32_16x16x32_bf16 v[152:155], v[60:63], a[168:171], v[152:155]
    v_mfma_f32_16x16x32_bf16 v[156:159], v[60:63], a[172:175], v[156:159]
    s_waitcnt lgkmcnt(4)
    v_mfma_f32_16x16x32_bf16 v[160:163], v[48:51], a[160:163], v[160:163]
    ds_read_b64_tr_b16 v[60:61], v38 offset:25696
    v_mfma_f32_16x16x32_bf16 v[164:167], v[48:51], a[164:167], v[164:167]
    ds_read_b64_tr_b16 v[62:63], v38 offset:28256
    v_mfma_f32_16x16x32_bf16 v[168:171], v[48:51], a[168:171], v[168:171]
    s_add_u32 m0, s37, 2048
    v_mfma_f32_16x16x32_bf16 v[172:175], v[48:51], a[172:175], v[172:175]
    buffer_load_dwordx4 v24, s[12:15], s32 offen lds
    s_waitcnt lgkmcnt(4)
    v_mfma_f32_16x16x32_bf16 v[176:179], v[52:55], a[160:163], v[176:179]
    ds_read_b64_tr_b16 v[48:49], v38 offset:20608
    v_mfma_f32_16x16x32_bf16 v[180:183], v[52:55], a[164:167], v[180:183]
    ds_read_b64_tr_b16 v[50:51], v38 offset:23168
    v_mfma_f32_16x16x32_bf16 v[184:187], v[52:55], a[168:171], v[184:187]
    v_mfma_f32_16x16x32_bf16 v[188:191], v[52:55], a[172:175], v[188:191]
    s_waitcnt lgkmcnt(4)
    v_mfma_f32_16x16x32_bf16 v[192:195], v[56:59], a[160:163], v[192:195]
    ds_read_b64_tr_b16 v[52:53], v38 offset:25728
    v_mfma_f32_16x16x32_bf16 v[196:199], v[56:59], a[164:167], v[196:199]
    ds_read_b64_tr_b16 v[54:55], v38 offset:28288
    v_mfma_f32_16x16x32_bf16 v[200:203], v[56:59], a[168:171], v[200:203]
    s_add_u32 m0, s37, 3072
    v_mfma_f32_16x16x32_bf16 v[204:207], v[56:59], a[172:175], v[204:207]
    buffer_load_dwordx4 v25, s[12:15], s32 offen lds
    s_waitcnt lgkmcnt(4)
    v_mfma_f32_16x16x32_bf16 v[208:211], v[60:63], a[160:163], v[208:211]
    ds_read_b64_tr_b16 v[56:57], v38 offset:30720
    v_mfma_f32_16x16x32_bf16 v[212:215], v[60:63], a[164:167], v[212:215]
    ds_read_b64_tr_b16 v[58:59], v38 offset:33280
    v_mfma_f32_16x16x32_bf16 v[216:219], v[60:63], a[168:171], v[216:219]
    v_mfma_f32_16x16x32_bf16 v[220:223], v[60:63], a[172:175], v[220:223]
    s_waitcnt lgkmcnt(4)
    v_mfma_f32_16x16x32_bf16 v[224:227], v[48:51], a[160:163], v[224:227]
    ds_read_b64_tr_b16 v[60:61], v38 offset:35840
    v_mfma_f32_16x16x32_bf16 v[228:231], v[48:51], a[164:167], v[228:231]
    ds_read_b64_tr_b16 v[62:63], v38 offset:38400
    v_mfma_f32_16x16x32_bf16 v[232:235], v[48:51], a[168:171], v[232:235]
    s_add_u32 m0, s37, 4096
    v_mfma_f32_16x16x32_bf16 v[236:239], v[48:51], a[172:175], v[236:239]
    buffer_load_dwordx4 v26, s[12:15], s32 offen lds
    s_waitcnt lgkmcnt(4)
    v_mfma_f32_16x16x32_bf16 v[240:243], v[52:55], a[160:163], v[240:243]
    ds_read_b64_tr_b16 v[48:49], v38 offset:30752
    v_mfma_f32_16x16x32_bf16 v[244:247], v[52:55], a[164:167], v[244:247]
    ds_read_b64_tr_b16 v[50:51], v38 offset:33312
    v_mfma_f32_16x16x32_bf16 v[248:251], v[52:55], a[168:171], v[248:251]
    s_add_u32 s32, s32, 589824
    v_mfma_f32_16x16x32_bf16 v[252:255], v[52:55], a[172:175], v[252:255]
    s_waitcnt lgkmcnt(4)
    v_mfma_f32_16x16x32_bf16 v[96:99], v[56:59], a[176:179], v[96:99]
    ds_read_b64_tr_b16 v[52:53], v38 offset:35872
    v_mfma_f32_16x16x32_bf16 v[100:103], v[56:59], a[180:183], v[100:103]
    ds_read_b64_tr_b16 v[54:55], v38 offset:38432
    v_mfma_f32_16x16x32_bf16 v[104:107], v[56:59], a[184:187], v[104:107]
    buffer_load_dword v27, v1, s[92:95], s100 offen
    s_add_u32 s100, s100, 73728
    v_mfma_f32_16x16x32_bf16 v[108:111], v[56:59], a[188:191], v[108:111]
    s_waitcnt lgkmcnt(4)
    v_mfma_f32_16x16x32_bf16 v[112:115], v[60:63], a[176:179], v[112:115]
    ds_read_b64_tr_b16 v[56:57], v38 offset:30784
    v_mfma_f32_16x16x32_bf16 v[116:119], v[60:63], a[180:183], v[116:119]
    ds_read_b64_tr_b16 v[58:59], v38 offset:33344
    v_mfma_f32_16x16x32_bf16 v[120:123], v[60:63], a[184:187], v[120:123]
    s_add_u32 m0, s48, 81920
    v_mfma_f32_16x16x32_bf16 v[124:127], v[60:63], a[188:191], v[124:127]
    buffer_load_dwordx4 v15, s[20:23], s48 offen lds
    s_waitcnt lgkmcnt(4)
    v_mfma_f32_16x16x32_bf16 v[128:131], v[48:51], a[176:179], v[128:131]
    ds_read_b64_tr_b16 v[60:61], v38 offset:35904
    v_mfma_f32_16x16x32_bf16 v[132:135], v[48:51], a[180:183], v[132:135]
    ds_read_b64_tr_b16 v[62:63], v38 offset:38464
    v_mfma_f32_16x16x32_bf16 v[136:139], v[48:51], a[184:187], v[136:139]
    s_add_u32 s48, s48, 1024
    v_mfma_f32_16x16x32_bf16 v[140:143], v[48:51], a[188:191], v[140:143]
    s_waitcnt lgkmcnt(4)
    v_mfma_f32_16x16x32_bf16 v[144:147], v[52:55], a[176:179], v[144:147]
    ds_read_b64_tr_b16 v[48:49], v38 offset:30816
    v_mfma_f32_16x16x32_bf16 v[148:151], v[52:55], a[180:183], v[148:151]
    ds_read_b64_tr_b16 v[50:51], v38 offset:33376
    v_mfma_f32_16x16x32_bf16 v[152:155], v[52:55], a[184:187], v[152:155]
    s_add_u32 m0, s48, 81920
    v_mfma_f32_16x16x32_bf16 v[156:159], v[52:55], a[188:191], v[156:159]
    buffer_load_dwordx4 v15, s[20:23], s48 offen lds
    s_waitcnt lgkmcnt(4)
    v_mfma_f32_16x16x32_bf16 v[160:163], v[56:59], a[176:179], v[160:163]
    ds_read_b64_tr_b16 v[52:53], v38 offset:35936
    v_mfma_f32_16x16x32_bf16 v[164:167], v[56:59], a[180:183], v[164:167]
    ds_read_b64_tr_b16 v[54:55], v38 offset:38496
    v_mfma_f32_16x16x32_bf16 v[168:171], v[56:59], a[184:187], v[168:171]
    s_add_u32 s48, s48, 1024
    v_mfma_f32_16x16x32_bf16 v[172:175], v[56:59], a[188:191], v[172:175]
    s_waitcnt lgkmcnt(4)
    v_mfma_f32_16x16x32_bf16 v[176:179], v[60:63], a[176:179], v[176:179]
    ds_read_b64_tr_b16 v[56:57], v38 offset:30848
    v_mfma_f32_16x16x32_bf16 v[180:183], v[60:63], a[180:183], v[180:183]
    ds_read_b64_tr_b16 v[58:59], v38 offset:33408
    v_mfma_f32_16x16x32_bf16 v[184:187], v[60:63], a[184:187], v[184:187]
    s_add_u32 m0, s48, 81920
    v_mfma_f32_16x16x32_bf16 v[188:191], v[60:63], a[188:191], v[188:191]
    buffer_load_dwordx4 v15, s[20:23], s48 offen lds
    s_waitcnt lgkmcnt(4)
    v_mfma_f32_16x16x32_bf16 v[192:195], v[48:51], a[176:179], v[192:195]
    ds_read_b64_tr_b16 v[60:61], v38 offset:35968
    v_mfma_f32_16x16x32_bf16 v[196:199], v[48:51], a[180:183], v[196:199]
    ds_read_b64_tr_b16 v[62:63], v38 offset:38528
    v_mfma_f32_16x16x32_bf16 v[200:203], v[48:51], a[184:187], v[200:203]
    s_add_u32 s48, s48, 1024
    v_mfma_f32_16x16x32_bf16 v[204:207], v[48:51], a[188:191], v[204:207]
    s_waitcnt lgkmcnt(4)
    v_mfma_f32_16x16x32_bf16 v[208:211], v[52:55], a[176:179], v[208:211]
    ds_read_b64_tr_b16 v[48:49], v38 offset:40960
    v_mfma_f32_16x16x32_bf16 v[212:215], v[52:55], a[180:183], v[212:215]
    ds_read_b64_tr_b16 v[50:51], v38 offset:43520
    v_mfma_f32_16x16x32_bf16 v[216:219], v[52:55], a[184:187], v[216:219]
    buffer_load_dword v27, v20, s[84:87], s88 offen
    s_add_u32 s88, s88, 1024
    v_mfma_f32_16x16x32_bf16 v[220:223], v[52:55], a[188:191], v[220:223]
    s_waitcnt lgkmcnt(4)
    v_mfma_f32_16x16x32_bf16 v[224:227], v[56:59], a[176:179], v[224:227]
    ds_read_b64_tr_b16 v[52:53], v38 offset:46080
    v_mfma_f32_16x16x32_bf16 v[228:231], v[56:59], a[180:183], v[228:231]
    ds_read_b64_tr_b16 v[54:55], v38 offset:48640
    v_mfma_f32_16x16x32_bf16 v[232:235], v[56:59], a[184:187], v[232:235]
    v_mfma_f32_16x16x32_bf16 v[236:239], v[56:59], a[188:191], v[236:239]
    s_waitcnt lgkmcnt(4)
    v_mfma_f32_16x16x32_bf16 v[240:243], v[60:63], a[176:179], v[240:243]
    ds_read_b64_tr_b16 v[56:57], v38 offset:40992
    v_mfma_f32_16x16x32_bf16 v[244:247], v[60:63], a[180:183], v[244:247]
    ds_read_b64_tr_b16 v[58:59], v38 offset:43552
    v_mfma_f32_16x16x32_bf16 v[248:251], v[60:63], a[184:187], v[248:251]
    v_mfma_f32_16x16x32_bf16 v[252:255], v[60:63], a[188:191], v[252:255]
    s_waitcnt lgkmcnt(4)
    v_mfma_f32_16x16x32_bf16 v[96:99], v[48:51], a[192:195], v[96:99]
    ds_read_b64_tr_b16 v[60:61], v38 offset:46112
    v_mfma_f32_16x16x32_bf16 v[100:103], v[48:51], a[196:199], v[100:103]
    ds_read_b64_tr_b16 v[62:63], v38 offset:48672
    v_mfma_f32_16x16x32_bf16 v[104:107], v[48:51], a[200:203], v[104:107]
    v_mfma_f32_16x16x32_bf16 v[108:111], v[48:51], a[204:207], v[108:111]
    s_waitcnt vmcnt(15)
    s_barrier
    s_waitcnt vmcnt(20)
    v_cmp_ne_u32 vcc, s39, v7
    s_cmp_eq_u32 s101, 288
    s_cselect_b32 s89, 0, s101
    s_lshl_b32 s89, s89, 13
    s_nop 0
    s_cmp_eq_u64 vcc, 0
    s_cselect_b32 s89, s89, 0x240000
    v_lshrrev_b32 v21, 1, v0
    v_lshlrev_b32 v21, 7, v21
    s_waitcnt lgkmcnt(4)
    v_mfma_f32_16x16x32_bf16 v[112:115], v[52:55], a[192:195], v[112:115]
    ds_read_b64_tr_b16 v[48:49], v38 offset:41024
    v_mfma_f32_16x16x32_bf16 v[116:119], v[52:55], a[196:199], v[116:119]
    ds_read_b64_tr_b16 v[50:51], v38 offset:43584
    v_mfma_f32_16x16x32_bf16 v[120:123], v[52:55], a[200:203], v[120:123]
    s_add_u32 s32, s52, s57
    s_add_u32 m0, s34, 20480
    v_mfma_f32_16x16x32_bf16 v[124:127], v[52:55], a[204:207], v[124:127]
    buffer_load_dwordx4 v10, s[28:31], s32 offen lds
    s_waitcnt lgkmcnt(4)
    v_mfma_f32_16x16x32_bf16 v[128:131], v[56:59], a[192:195], v[128:131]
    ds_read_b64_tr_b16 v[52:53], v38 offset:46144
    v_mfma_f32_16x16x32_bf16 v[132:135], v[56:59], a[196:199], v[132:135]
    ds_read_b64_tr_b16 v[54:55], v38 offset:48704
    v_mfma_f32_16x16x32_bf16 v[136:139], v[56:59], a[200:203], v[136:139]
    s_add_u32 m0, s34, 21504
    v_mfma_f32_16x16x32_bf16 v[140:143], v[56:59], a[204:207], v[140:143]
    buffer_load_dwordx4 v11, s[28:31], s32 offen lds
    s_waitcnt lgkmcnt(4)
    v_mfma_f32_16x16x32_bf16 v[144:147], v[60:63], a[192:195], v[144:147]
    ds_read_b64_tr_b16 v[56:57], v38 offset:41056
    v_mfma_f32_16x16x32_bf16 v[148:151], v[60:63], a[196:199], v[148:151]
    ds_read_b64_tr_b16 v[58:59], v38 offset:43616
    v_mfma_f32_16x16x32_bf16 v[152:155], v[60:63], a[200:203], v[152:155]
    v_mfma_f32_16x16x32_bf16 v[156:159], v[60:63], a[204:207], v[156:159]
    s_waitcnt lgkmcnt(4)
    v_mfma_f32_16x16x32_bf16 v[160:163], v[48:51], a[192:195], v[160:163]
    ds_read_b64_tr_b16 v[60:61], v38 offset:46176
    v_mfma_f32_16x16x32_bf16 v[164:167], v[48:51], a[196:199], v[164:167]
    ds_read_b64_tr_b16 v[62:63], v38 offset:48736
    v_mfma_f32_16x16x32_bf16 v[168:171], v[48:51], a[200:203], v[168:171]
    s_add_u32 m0, s34, 22528
    v_mfma_f32_16x16x32_bf16 v[172:175], v[48:51], a[204:207], v[172:175]
    buffer_load_dwordx4 v12, s[28:31], s32 offen lds
    s_waitcnt lgkmcnt(4)
    v_mfma_f32_16x16x32_bf16 v[176:179], v[52:55], a[192:195], v[176:179]
    ds_read_b64_tr_b16 v[48:49], v38 offset:41088
    v_mfma_f32_16x16x32_bf16 v[180:183], v[52:55], a[196:199], v[180:183]
    ds_read_b64_tr_b16 v[50:51], v38 offset:43648
    v_mfma_f32_16x16x32_bf16 v[184:187], v[52:55], a[200:203], v[184:187]
    v_mfma_f32_16x16x32_bf16 v[188:191], v[52:55], a[204:207], v[188:191]
    s_waitcnt lgkmcnt(4)
    v_mfma_f32_16x16x32_bf16 v[192:195], v[56:59], a[192:195], v[192:195]
    ds_read_b64_tr_b16 v[52:53], v38 offset:46208
    v_mfma_f32_16x16x32_bf16 v[196:199], v[56:59], a[196:199], v[196:199]
    ds_read_b64_tr_b16 v[54:55], v38 offset:48768
    v_mfma_f32_16x16x32_bf16 v[200:203], v[56:59], a[200:203], v[200:203]
    s_add_u32 m0, s34, 23552
    v_mfma_f32_16x16x32_bf16 v[204:207], v[56:59], a[204:207], v[204:207]
    buffer_load_dwordx4 v13, s[28:31], s32 offen lds
    s_waitcnt lgkmcnt(4)
    v_mfma_f32_16x16x32_bf16 v[208:211], v[60:63], a[192:195], v[208:211]
    ds_read_b64_tr_b16 v[56:57], v38 offset:51200
    v_mfma_f32_16x16x32_bf16 v[212:215], v[60:63], a[196:199], v[212:215]
    ds_read_b64_tr_b16 v[58:59], v38 offset:53760
    v_mfma_f32_16x16x32_bf16 v[216:219], v[60:63], a[200:203], v[216:219]
    v_mfma_f32_16x16x32_bf16 v[220:223], v[60:63], a[204:207], v[220:223]
    s_waitcnt lgkmcnt(4)
    v_mfma_f32_16x16x32_bf16 v[224:227], v[48:51], a[192:195], v[224:227]
    ds_read_b64_tr_b16 v[60:61], v38 offset:56320
    v_mfma_f32_16x16x32_bf16 v[228:231], v[48:51], a[196:199], v[228:231]
    ds_read_b64_tr_b16 v[62:63], v38 offset:58880
    v_mfma_f32_16x16x32_bf16 v[232:235], v[48:51], a[200:203], v[232:235]
    s_add_u32 m0, s34, 24576
    v_mfma_f32_16x16x32_bf16 v[236:239], v[48:51], a[204:207], v[236:239]
    buffer_load_dwordx4 v14, s[28:31], s32 offen lds
    s_waitcnt lgkmcnt(4)
    v_mfma_f32_16x16x32_bf16 v[240:243], v[52:55], a[192:195], v[240:243]
    ds_read_b64_tr_b16 v[48:49], v38 offset:51232
    v_mfma_f32_16x16x32_bf16 v[244:247], v[52:55], a[196:199], v[244:247]
    ds_read_b64_tr_b16 v[50:51], v38 offset:53792
    v_mfma_f32_16x16x32_bf16 v[248:251], v[52:55], a[200:203], v[248:251]
    v_mfma_f32_16x16x32_bf16 v[252:255], v[52:55], a[204:207], v[252:255]
    s_waitcnt lgkmcnt(4)
    v_mfma_f32_16x16x32_bf16 v[96:99], v[56:59], a[208:211], v[96:99]
    ds_read_b64_tr_b16 v[52:53], v38 offset:56352
    v_mfma_f32_16x16x32_bf16 v[100:103], v[56:59], a[212:215], v[100:103]
    ds_read_b64_tr_b16 v[54:55], v38 offset:58912
    v_mfma_f32_16x16x32_bf16 v[104:107], v[56:59], a[216:219], v[104:107]
    buffer_load_dword v27, v1, s[92:95], s100 offen
    s_add_u32 s100, s100, 73728
    v_mfma_f32_16x16x32_bf16 v[108:111], v[56:59], a[220:223], v[108:111]
    s_waitcnt lgkmcnt(4)
    v_mfma_f32_16x16x32_bf16 v[112:115], v[60:63], a[208:211], v[112:115]
    ds_read_b64_tr_b16 v[56:57], v38 offset:51264
    v_mfma_f32_16x16x32_bf16 v[116:119], v[60:63], a[212:215], v[116:119]
    ds_read_b64_tr_b16 v[58:59], v38 offset:53824
    v_mfma_f32_16x16x32_bf16 v[120:123], v[60:63], a[216:219], v[120:123]
    s_add_u32 m0, s48, 81920
    v_mfma_f32_16x16x32_bf16 v[124:127], v[60:63], a[220:223], v[124:127]
    buffer_load_dwordx4 v15, s[20:23], s48 offen lds
    s_waitcnt lgkmcnt(4)
    v_mfma_f32_16x16x32_bf16 v[128:131], v[48:51], a[208:211], v[128:131]
    ds_read_b64_tr_b16 v[60:61], v38 offset:56384
    v_mfma_f32_16x16x32_bf16 v[132:135], v[48:51], a[212:215], v[132:135]
    ds_read_b64_tr_b16 v[62:63], v38 offset:58944
    v_mfma_f32_16x16x32_bf16 v[136:139], v[48:51], a[216:219], v[136:139]
    s_add_u32 s48, s48, 1024
    v_mfma_f32_16x16x32_bf16 v[140:143], v[48:51], a[220:223], v[140:143]
    s_waitcnt lgkmcnt(4)
    v_mfma_f32_16x16x32_bf16 v[144:147], v[52:55], a[208:211], v[144:147]
    ds_read_b64_tr_b16 v[48:49], v38 offset:51296
    v_mfma_f32_16x16x32_bf16 v[148:151], v[52:55], a[212:215], v[148:151]
    ds_read_b64_tr_b16 v[50:51], v38 offset:53856
    v_mfma_f32_16x16x32_bf16 v[152:155], v[52:55], a[216:219], v[152:155]
    s_add_u32 m0, s48, 81920
    v_mfma_f32_16x16x32_bf16 v[156:159], v[52:55], a[220:223], v[156:159]
    buffer_load_dwordx4 v15, s[20:23], s48 offen lds
    s_waitcnt lgkmcnt(4)
    v_mfma_f32_16x16x32_bf16 v[160:163], v[56:59], a[208:211], v[160:163]
    ds_read_b64_tr_b16 v[52:53], v38 offset:56416
    v_mfma_f32_16x16x32_bf16 v[164:167], v[56:59], a[212:215], v[164:167]
    ds_read_b64_tr_b16 v[54:55], v38 offset:58976
    v_mfma_f32_16x16x32_bf16 v[168:171], v[56:59], a[216:219], v[168:171]
    s_add_u32 s48, s48, 1024
    v_mfma_f32_16x16x32_bf16 v[172:175], v[56:59], a[220:223], v[172:175]
    s_waitcnt lgkmcnt(4)
    v_mfma_f32_16x16x32_bf16 v[176:179], v[60:63], a[208:211], v[176:179]
    ds_read_b64_tr_b16 v[56:57], v38 offset:51328
    v_mfma_f32_16x16x32_bf16 v[180:183], v[60:63], a[212:215], v[180:183]
    ds_read_b64_tr_b16 v[58:59], v38 offset:53888
    v_mfma_f32_16x16x32_bf16 v[184:187], v[60:63], a[216:219], v[184:187]
    s_add_u32 m0, s48, 81920
    v_mfma_f32_16x16x32_bf16 v[188:191], v[60:63], a[220:223], v[188:191]
    buffer_load_dwordx4 v15, s[20:23], s48 offen lds
    s_waitcnt lgkmcnt(4)
    v_mfma_f32_16x16x32_bf16 v[192:195], v[48:51], a[208:211], v[192:195]
    ds_read_b64_tr_b16 v[60:61], v38 offset:56448
    v_mfma_f32_16x16x32_bf16 v[196:199], v[48:51], a[212:215], v[196:199]
    ds_read_b64_tr_b16 v[62:63], v38 offset:59008
    v_mfma_f32_16x16x32_bf16 v[200:203], v[48:51], a[216:219], v[200:203]
    s_add_u32 s48, s48, 1024
    v_mfma_f32_16x16x32_bf16 v[204:207], v[48:51], a[220:223], v[204:207]
    s_waitcnt lgkmcnt(4)
    v_mfma_f32_16x16x32_bf16 v[208:211], v[52:55], a[208:211], v[208:211]
    ds_read_b64_tr_b16 v[48:49], v39 offset:0
    v_mfma_f32_16x16x32_bf16 v[212:215], v[52:55], a[212:215], v[212:215]
    ds_read_b64_tr_b16 v[50:51], v39 offset:2560
    v_mfma_f32_16x16x32_bf16 v[216:219], v[52:55], a[216:219], v[216:219]
    buffer_load_dword v27, v20, s[84:87], s88 offen
    s_add_u32 s88, s88, 1024
    v_mfma_f32_16x16x32_bf16 v[220:223], v[52:55], a[220:223], v[220:223]
    s_waitcnt lgkmcnt(4)
    v_mfma_f32_16x16x32_bf16 v[224:227], v[56:59], a[208:211], v[224:227]
    ds_read_b64_tr_b16 v[52:53], v39 offset:5120
    v_mfma_f32_16x16x32_bf16 v[228:231], v[56:59], a[212:215], v[228:231]
    ds_read_b64_tr_b16 v[54:55], v39 offset:7680
    v_mfma_f32_16x16x32_bf16 v[232:235], v[56:59], a[216:219], v[232:235]
    v_mfma_f32_16x16x32_bf16 v[236:239], v[56:59], a[220:223], v[236:239]
    s_waitcnt lgkmcnt(4)
    v_mfma_f32_16x16x32_bf16 v[240:243], v[60:63], a[208:211], v[240:243]
    ds_read_b64_tr_b16 v[56:57], v39 offset:32
    v_mfma_f32_16x16x32_bf16 v[244:247], v[60:63], a[212:215], v[244:247]
    ds_read_b64_tr_b16 v[58:59], v39 offset:2592
    v_mfma_f32_16x16x32_bf16 v[248:251], v[60:63], a[216:219], v[248:251]
    v_mfma_f32_16x16x32_bf16 v[252:255], v[60:63], a[220:223], v[252:255]
    s_waitcnt lgkmcnt(4)
    v_mfma_f32_16x16x32_bf16 v[96:99], v[48:51], a[224:227], v[96:99]
    ds_read_b64_tr_b16 v[60:61], v39 offset:5152
    v_mfma_f32_16x16x32_bf16 v[100:103], v[48:51], a[228:231], v[100:103]
    ds_read_b64_tr_b16 v[62:63], v39 offset:7712
    v_mfma_f32_16x16x32_bf16 v[104:107], v[48:51], a[232:235], v[104:107]
    v_mfma_f32_16x16x32_bf16 v[108:111], v[48:51], a[236:239], v[108:111]
    s_waitcnt vmcnt(15)
    s_barrier
    s_waitcnt lgkmcnt(4)
    v_mfma_f32_16x16x32_bf16 v[112:115], v[52:55], a[224:227], v[112:115]
    ds_read_b64_tr_b16 v[48:49], v39 offset:64
    v_mfma_f32_16x16x32_bf16 v[116:119], v[52:55], a[228:231], v[116:119]
    ds_read_b64_tr_b16 v[50:51], v39 offset:2624
    v_mfma_f32_16x16x32_bf16 v[120:123], v[52:55], a[232:235], v[120:123]
    s_add_u32 s32, s53, s57
    s_add_u32 m0, s34, 40960
    v_mfma_f32_16x16x32_bf16 v[124:127], v[52:55], a[236:239], v[124:127]
    buffer_load_dwordx4 v10, s[28:31], s32 offen lds
    s_waitcnt lgkmcnt(4)
    v_mfma_f32_16x16x32_bf16 v[128:131], v[56:59], a[224:227], v[128:131]
    ds_read_b64_tr_b16 v[52:53], v39 offset:5184
    v_mfma_f32_16x16x32_bf16 v[132:135], v[56:59], a[228:231], v[132:135]
    ds_read_b64_tr_b16 v[54:55], v39 offset:7744
    v_mfma_f32_16x16x32_bf16 v[136:139], v[56:59], a[232:235], v[136:139]
    v_mfma_f32_16x16x32_bf16 v[140:143], v[56:59], a[236:239], v[140:143]
    s_waitcnt lgkmcnt(4)
    v_mfma_f32_16x16x32_bf16 v[144:147], v[60:63], a[224:227], v[144:147]
    ds_read_b64_tr_b16 v[56:57], v39 offset:96
    v_mfma_f32_16x16x32_bf16 v[148:151], v[60:63], a[228:231], v[148:151]
    ds_read_b64_tr_b16 v[58:59], v39 offset:2656
    v_mfma_f32_16x16x32_bf16 v[152:155], v[60:63], a[232:235], v[152:155]
    s_add_u32 m0, s34, 41984
    v_mfma_f32_16x16x32_bf16 v[156:159], v[60:63], a[236:239], v[156:159]
    buffer_load_dwordx4 v11, s[28:31], s32 offen lds
    s_waitcnt lgkmcnt(4)
    v_mfma_f32_16x16x32_bf16 v[160:163], v[48:51], a[224:227], v[160:163]
    ds_read_b64_tr_b16 v[60:61], v39 offset:5216
    v_mfma_f32_16x16x32_bf16 v[164:167], v[48:51], a[228:231], v[164:167]
    ds_read_b64_tr_b16 v[62:63], v39 offset:7776
    v_mfma_f32_16x16x32_bf16 v[168:171], v[48:51], a[232:235], v[168:171]
    v_mfma_f32_16x16x32_bf16 v[172:175], v[48:51], a[236:239], v[172:175]
    s_waitcnt lgkmcnt(4)
    v_mfma_f32_16x16x32_bf16 v[176:179], v[52:55], a[224:227], v[176:179]
    ds_read_b64_tr_b16 v[48:49], v39 offset:128
    v_mfma_f32_16x16x32_bf16 v[180:183], v[52:55], a[228:231], v[180:183]
    ds_read_b64_tr_b16 v[50:51], v39 offset:2688
    v_mfma_f32_16x16x32_bf16 v[184:187], v[52:55], a[232:235], v[184:187]
    s_add_u32 m0, s34, 43008
    v_mfma_f32_16x16x32_bf16 v[188:191], v[52:55], a[236:239], v[188:191]
    buffer_load_dwordx4 v12, s[28:31], s32 offen lds
    s_waitcnt lgkmcnt(4)
    v_mfma_f32_16x16x32_bf16 v[192:195], v[56:59], a[224:227], v[192:195]
    ds_read_b64_tr_b16 v[52:53], v39 offset:5248
    v_mfma_f32_16x16x32_bf16 v[196:199], v[56:59], a[228:231], v[196:199]
    ds_read_b64_tr_b16 v[54:55], v39 offset:7808
    v_mfma_f32_16x16x32_bf16 v[200:203], v[56:59], a[232:235], v[200:203]
    v_mfma_f32_16x16x32_bf16 v[204:207], v[56:59], a[236:239], v[204:207]
    s_waitcnt lgkmcnt(4)
    v_mfma_f32_16x16x32_bf16 v[208:211], v[60:63], a[224:227], v[208:211]
    ds_read_b64_tr_b16 v[56:57], v39 offset:10240
    v_mfma_f32_16x16x32_bf16 v[212:215], v[60:63], a[228:231], v[212:215]
    ds_read_b64_tr_b16 v[58:59], v39 offset:12800
    v_mfma_f32_16x16x32_bf16 v[216:219], v[60:63], a[232:235], v[216:219]
    s_add_u32 m0, s34, 44032
    v_mfma_f32_16x16x32_bf16 v[220:223], v[60:63], a[236:239], v[220:223]
    buffer_load_dwordx4 v13, s[28:31], s32 offen lds
    s_waitcnt lgkmcnt(4)
    v_mfma_f32_16x16x32_bf16 v[224:227], v[48:51], a[224:227], v[224:227]
    ds_read_b64_tr_b16 v[60:61], v39 offset:15360
    v_mfma_f32_16x16x32_bf16 v[228:231], v[48:51], a[228:231], v[228:231]
    ds_read_b64_tr_b16 v[62:63], v39 offset:17920
    v_mfma_f32_16x16x32_bf16 v[232:235], v[48:51], a[232:235], v[232:235]
    v_mfma_f32_16x16x32_bf16 v[236:239], v[48:51], a[236:239], v[236:239]
    s_waitcnt lgkmcnt(4)
    v_mfma_f32_16x16x32_bf16 v[240:243], v[52:55], a[224:227], v[240:243]
    ds_read_b64_tr_b16 v[48:49], v39 offset:10272
    v_mfma_f32_16x16x32_bf16 v[244:247], v[52:55], a[228:231], v[244:247]
    ds_read_b64_tr_b16 v[50:51], v39 offset:12832
    v_mfma_f32_16x16x32_bf16 v[248:251], v[52:55], a[232:235], v[248:251]
    v_mfma_f32_16x16x32_bf16 v[252:255], v[52:55], a[236:239], v[252:255]
    s_waitcnt lgkmcnt(4)
    v_mfma_f32_16x16x32_bf16 v[96:99], v[56:59], a[240:243], v[96:99]
    ds_read_b64_tr_b16 v[52:53], v39 offset:15392
    v_mfma_f32_16x16x32_bf16 v[100:103], v[56:59], a[244:247], v[100:103]
    ds_read_b64_tr_b16 v[54:55], v39 offset:17952
    v_mfma_f32_16x16x32_bf16 v[104:107], v[56:59], a[248:251], v[104:107]
    s_add_u32 m0, s34, 45056
    v_mfma_f32_16x16x32_bf16 v[108:111], v[56:59], a[252:255], v[108:111]
    buffer_load_dwordx4 v14, s[28:31], s32 offen lds
    s_waitcnt lgkmcnt(4)
    v_mfma_f32_16x16x32_bf16 v[112:115], v[60:63], a[240:243], v[112:115]
    ds_read_b64_tr_b16 v[56:57], v39 offset:10304
    v_mfma_f32_16x16x32_bf16 v[116:119], v[60:63], a[244:247], v[116:119]
    ds_read_b64_tr_b16 v[58:59], v39 offset:12864
    v_mfma_f32_16x16x32_bf16 v[120:123], v[60:63], a[248:251], v[120:123]
    v_mfma_f32_16x16x32_bf16 v[124:127], v[60:63], a[252:255], v[124:127]
    s_waitcnt lgkmcnt(4)
    v_mfma_f32_16x16x32_bf16 v[128:131], v[48:51], a[240:243], v[128:131]
    ds_read_b64_tr_b16 v[60:61], v39 offset:15424
    v_mfma_f32_16x16x32_bf16 v[132:135], v[48:51], a[244:247], v[132:135]
    ds_read_b64_tr_b16 v[62:63], v39 offset:17984
    v_mfma_f32_16x16x32_bf16 v[136:139], v[48:51], a[248:251], v[136:139]
    buffer_load_dword v27, v1, s[92:95], s100 offen
    s_add_u32 s100, s100, 73728
    v_mfma_f32_16x16x32_bf16 v[140:143], v[48:51], a[252:255], v[140:143]
    s_waitcnt lgkmcnt(4)
    v_mfma_f32_16x16x32_bf16 v[144:147], v[52:55], a[240:243], v[144:147]
    ds_read_b64_tr_b16 v[48:49], v39 offset:10336
    v_mfma_f32_16x16x32_bf16 v[148:151], v[52:55], a[244:247], v[148:151]
    ds_read_b64_tr_b16 v[50:51], v39 offset:12896
    v_mfma_f32_16x16x32_bf16 v[152:155], v[52:55], a[248:251], v[152:155]
    v_mfma_f32_16x16x32_bf16 v[156:159], v[52:55], a[252:255], v[156:159]
    s_waitcnt lgkmcnt(4)
    v_mfma_f32_16x16x32_bf16 v[160:163], v[56:59], a[240:243], v[160:163]
    ds_read_b64_tr_b16 v[52:53], v39 offset:15456
    v_mfma_f32_16x16x32_bf16 v[164:167], v[56:59], a[244:247], v[164:167]
    ds_read_b64_tr_b16 v[54:55], v39 offset:18016
    v_mfma_f32_16x16x32_bf16 v[168:171], v[56:59], a[248:251], v[168:171]
    buffer_load_dword v27, v20, s[84:87], s88 offen
    s_add_u32 s88, s88, 1024
    v_mfma_f32_16x16x32_bf16 v[172:175], v[56:59], a[252:255], v[172:175]
    s_waitcnt lgkmcnt(4)
    v_mfma_f32_16x16x32_bf16 v[176:179], v[60:63], a[240:243], v[176:179]
    ds_read_b64_tr_b16 v[56:57], v39 offset:10368
    v_mfma_f32_16x16x32_bf16 v[180:183], v[60:63], a[244:247], v[180:183]
    ds_read_b64_tr_b16 v[58:59], v39 offset:12928
    v_mfma_f32_16x16x32_bf16 v[184:187], v[60:63], a[248:251], v[184:187]
    v_mfma_f32_16x16x32_bf16 v[188:191], v[60:63], a[252:255], v[188:191]
    s_waitcnt lgkmcnt(4)
    v_mfma_f32_16x16x32_bf16 v[192:195], v[48:51], a[240:243], v[192:195]
    ds_read_b64_tr_b16 v[60:61], v39 offset:15488
    v_mfma_f32_16x16x32_bf16 v[196:199], v[48:51], a[244:247], v[196:199]
    ds_read_b64_tr_b16 v[62:63], v39 offset:18048
    v_mfma_f32_16x16x32_bf16 v[200:203], v[48:51], a[248:251], v[200:203]
    buffer_load_dword v27, v21, s[80:83], s89 offen sc1
    s_add_u32 s89, s89, 4096
    v_mfma_f32_16x16x32_bf16 v[204:207], v[48:51], a[252:255], v[204:207]
    s_waitcnt lgkmcnt(4)
    v_mfma_f32_16x16x32_bf16 v[208:211], v[52:55], a[240:243], v[208:211]
    ds_read_b64_tr_b16 v[48:49], v38 offset:0
    v_mfma_f32_16x16x32_bf16 v[212:215], v[52:55], a[244:247], v[212:215]
    ds_read_b64_tr_b16 v[50:51], v38 offset:2560
    v_mfma_f32_16x16x32_bf16 v[216:219], v[52:55], a[248:251], v[216:219]
    v_mfma_f32_16x16x32_bf16 v[220:223], v[52:55], a[252:255], v[220:223]
    s_waitcnt lgkmcnt(4)
    v_mfma_f32_16x16x32_bf16 v[224:227], v[56:59], a[240:243], v[224:227]
    ds_read_b64_tr_b16 v[52:53], v38 offset:5120
    v_mfma_f32_16x16x32_bf16 v[228:231], v[56:59], a[244:247], v[228:231]
    ds_read_b64_tr_b16 v[54:55], v38 offset:7680
    v_mfma_f32_16x16x32_bf16 v[232:235], v[56:59], a[248:251], v[232:235]
    v_mfma_f32_16x16x32_bf16 v[236:239], v[56:59], a[252:255], v[236:239]
    s_waitcnt lgkmcnt(4)
    v_mfma_f32_16x16x32_bf16 v[240:243], v[60:63], a[240:243], v[240:243]
    ds_read_b64_tr_b16 v[56:57], v38 offset:32
    v_mfma_f32_16x16x32_bf16 v[244:247], v[60:63], a[244:247], v[244:247]
    ds_read_b64_tr_b16 v[58:59], v38 offset:2592
    v_mfma_f32_16x16x32_bf16 v[248:251], v[60:63], a[248:251], v[248:251]
    v_mfma_f32_16x16x32_bf16 v[252:255], v[60:63], a[252:255], v[252:255]
    s_waitcnt lgkmcnt(4)
    v_mfma_f32_16x16x32_bf16 v[96:99], v[48:51], v[64:67], v[96:99]
    ds_read_b64_tr_b16 v[60:61], v38 offset:5152
    v_mfma_f32_16x16x32_bf16 v[100:103], v[48:51], v[68:71], v[100:103]
    ds_read_b64_tr_b16 v[62:63], v38 offset:7712
    v_mfma_f32_16x16x32_bf16 v[104:107], v[48:51], v[72:75], v[104:107]
    v_mfma_f32_16x16x32_bf16 v[108:111], v[48:51], v[76:79], v[108:111]
    s_barrier
    s_waitcnt lgkmcnt(4)
    v_mfma_f32_16x16x32_bf16 v[112:115], v[52:55], v[64:67], v[112:115]
    ds_read_b64_tr_b16 v[48:49], v38 offset:64
    v_mfma_f32_16x16x32_bf16 v[116:119], v[52:55], v[68:71], v[116:119]
    ds_read_b64_tr_b16 v[50:51], v38 offset:2624
    v_mfma_f32_16x16x32_bf16 v[120:123], v[52:55], v[72:75], v[120:123]
    s_add_u32 s32, s54, s57
    s_add_u32 m0, s34, 61440
    v_mfma_f32_16x16x32_bf16 v[124:127], v[52:55], v[76:79], v[124:127]
    buffer_load_dwordx4 v10, s[28:31], s32 offen lds
    s_waitcnt lgkmcnt(4)
    v_mfma_f32_16x16x32_bf16 v[128:131], v[56:59], v[64:67], v[128:131]
    ds_read_b64_tr_b16 v[52:53], v38 offset:5184
    v_mfma_f32_16x16x32_bf16 v[132:135], v[56:59], v[68:71], v[132:135]
    ds_read_b64_tr_b16 v[54:55], v38 offset:7744
    v_mfma_f32_16x16x32_bf16 v[136:139], v[56:59], v[72:75], v[136:139]
    v_mfma_f32_16x16x32_bf16 v[140:143], v[56:59], v[76:79], v[140:143]
    s_waitcnt lgkmcnt(4)
    v_mfma_f32_16x16x32_bf16 v[144:147], v[60:63], v[64:67], v[144:147]
    ds_read_b64_tr_b16 v[56:57], v38 offset:96
    v_mfma_f32_16x16x32_bf16 v[148:151], v[60:63], v[68:71], v[148:151]
    ds_read_b64_tr_b16 v[58:59], v38 offset:2656
    v_mfma_f32_16x16x32_bf16 v[152:155], v[60:63], v[72:75], v[152:155]
    s_add_u32 m0, s34, 62464
    v_mfma_f32_16x16x32_bf16 v[156:159], v[60:63], v[76:79], v[156:159]
    buffer_load_dwordx4 v11, s[28:31], s32 offen lds
    s_waitcnt lgkmcnt(4)
    v_mfma_f32_16x16x32_bf16 v[160:163], v[48:51], v[64:67], v[160:163]
    ds_read_b64_tr_b16 v[60:61], v38 offset:5216
    v_mfma_f32_16x16x32_bf16 v[164:167], v[48:51], v[68:71], v[164:167]
    ds_read_b64_tr_b16 v[62:63], v38 offset:7776
    v_mfma_f32_16x16x32_bf16 v[168:171], v[48:51], v[72:75], v[168:171]
    v_mfma_f32_16x16x32_bf16 v[172:175], v[48:51], v[76:79], v[172:175]
    s_waitcnt lgkmcnt(4)
    v_mfma_f32_16x16x32_bf16 v[176:179], v[52:55], v[64:67], v[176:179]
    ds_read_b64_tr_b16 v[48:49], v38 offset:128
    v_mfma_f32_16x16x32_bf16 v[180:183], v[52:55], v[68:71], v[180:183]
    ds_read_b64_tr_b16 v[50:51], v38 offset:2688
    v_mfma_f32_16x16x32_bf16 v[184:187], v[52:55], v[72:75], v[184:187]
    v_mfma_f32_16x16x32_bf16 v[188:191], v[52:55], v[76:79], v[188:191]
    s_waitcnt lgkmcnt(4)
    v_mfma_f32_16x16x32_bf16 v[192:195], v[56:59], v[64:67], v[192:195]
    ds_read_b64_tr_b16 v[52:53], v38 offset:5248
    v_mfma_f32_16x16x32_bf16 v[196:199], v[56:59], v[68:71], v[196:199]
    ds_read_b64_tr_b16 v[54:55], v38 offset:7808
    v_mfma_f32_16x16x32_bf16 v[200:203], v[56:59], v[72:75], v[200:203]
    s_add_u32 m0, s34, 63488
    v_mfma_f32_16x16x32_bf16 v[204:207], v[56:59], v[76:79], v[204:207]
    buffer_load_dwordx4 v12, s[28:31], s32 offen lds
    s_waitcnt lgkmcnt(4)
    v_mfma_f32_16x16x32_bf16 v[208:211], v[60:63], v[64:67], v[208:211]
    ds_read_b64_tr_b16 v[56:57], v38 offset:10240
    v_mfma_f32_16x16x32_bf16 v[212:215], v[60:63], v[68:71], v[212:215]
    ds_read_b64_tr_b16 v[58:59], v38 offset:12800
    v_mfma_f32_16x16x32_bf16 v[216:219], v[60:63], v[72:75], v[216:219]
    v_mfma_f32_16x16x32_bf16 v[220:223], v[60:63], v[76:79], v[220:223]
    s_waitcnt lgkmcnt(4)
    v_mfma_f32_16x16x32_bf16 v[224:227], v[48:51], v[64:67], v[224:227]
    ds_read_b64_tr_b16 v[60:61], v38 offset:15360
    v_mfma_f32_16x16x32_bf16 v[228:231], v[48:51], v[68:71], v[228:231]
    ds_read_b64_tr_b16 v[62:63], v38 offset:17920
    v_mfma_f32_16x16x32_bf16 v[232:235], v[48:51], v[72:75], v[232:235]
    s_add_u32 m0, s34, 64512
    v_mfma_f32_16x16x32_bf16 v[236:239], v[48:51], v[76:79], v[236:239]
    buffer_load_dwordx4 v13, s[28:31], s32 offen lds
    s_waitcnt lgkmcnt(4)
    v_mfma_f32_16x16x32_bf16 v[240:243], v[52:55], v[64:67], v[240:243]
    ds_read_b64_tr_b16 v[48:49], v38 offset:10272
    v_mfma_f32_16x16x32_bf16 v[244:247], v[52:55], v[68:71], v[244:247]
    ds_read_b64_tr_b16 v[50:51], v38 offset:12832
    v_mfma_f32_16x16x32_bf16 v[248:251], v[52:55], v[72:75], v[248:251]
    v_mfma_f32_16x16x32_bf16 v[252:255], v[52:55], v[76:79], v[252:255]
    s_waitcnt lgkmcnt(4)
    v_mfma_f32_16x16x32_bf16 v[96:99], v[56:59], v[80:83], v[96:99]
    ds_read_b64_tr_b16 v[52:53], v38 offset:15392
    v_mfma_f32_16x16x32_bf16 v[100:103], v[56:59], v[84:87], v[100:103]
    ds_read_b64_tr_b16 v[54:55], v38 offset:17952
    v_mfma_f32_16x16x32_bf16 v[104:107], v[56:59], v[88:91], v[104:107]
    v_mfma_f32_16x16x32_bf16 v[108:111], v[56:59], v[92:95], v[108:111]
    s_waitcnt lgkmcnt(4)
    v_mfma_f32_16x16x32_bf16 v[112:115], v[60:63], v[80:83], v[112:115]
    ds_read_b64_tr_b16 v[56:57], v38 offset:10304
    v_mfma_f32_16x16x32_bf16 v[116:119], v[60:63], v[84:87], v[116:119]
    ds_read_b64_tr_b16 v[58:59], v38 offset:12864
    v_mfma_f32_16x16x32_bf16 v[120:123], v[60:63], v[88:91], v[120:123]
    s_add_u32 m0, s34, 65536
    v_mfma_f32_16x16x32_bf16 v[124:127], v[60:63], v[92:95], v[124:127]
    buffer_load_dwordx4 v14, s[28:31], s32 offen lds
    s_waitcnt lgkmcnt(4)
    v_mfma_f32_16x16x32_bf16 v[128:131], v[48:51], v[80:83], v[128:131]
    ds_read_b64_tr_b16 v[60:61], v38 offset:15424
    v_mfma_f32_16x16x32_bf16 v[132:135], v[48:51], v[84:87], v[132:135]
    ds_read_b64_tr_b16 v[62:63], v38 offset:17984
    v_mfma_f32_16x16x32_bf16 v[136:139], v[48:51], v[88:91], v[136:139]
    v_mfma_f32_16x16x32_bf16 v[140:143], v[48:51], v[92:95], v[140:143]
    s_waitcnt lgkmcnt(4)
    v_mfma_f32_16x16x32_bf16 v[144:147], v[52:55], v[80:83], v[144:147]
    ds_read_b64_tr_b16 v[48:49], v38 offset:10336
    v_mfma_f32_16x16x32_bf16 v[148:151], v[52:55], v[84:87], v[148:151]
    ds_read_b64_tr_b16 v[50:51], v38 offset:12896
    v_mfma_f32_16x16x32_bf16 v[152:155], v[52:55], v[88:91], v[152:155]
    buffer_load_dword v27, v20, s[84:87], s88 offen
    s_add_u32 s88, s88, 1024
    v_mfma_f32_16x16x32_bf16 v[156:159], v[52:55], v[92:95], v[156:159]
    s_waitcnt lgkmcnt(4)
    v_mfma_f32_16x16x32_bf16 v[160:163], v[56:59], v[80:83], v[160:163]
    ds_read_b64_tr_b16 v[52:53], v38 offset:15456
    v_mfma_f32_16x16x32_bf16 v[164:167], v[56:59], v[84:87], v[164:167]
    ds_read_b64_tr_b16 v[54:55], v38 offset:18016
    v_mfma_f32_16x16x32_bf16 v[168:171], v[56:59], v[88:91], v[168:171]
    v_mfma_f32_16x16x32_bf16 v[172:175], v[56:59], v[92:95], v[172:175]
    s_waitcnt lgkmcnt(4)
    v_mfma_f32_16x16x32_bf16 v[176:179], v[60:63], v[80:83], v[176:179]
    ds_read_b64_tr_b16 v[56:57], v38 offset:10368
    v_mfma_f32_16x16x32_bf16 v[180:183], v[60:63], v[84:87], v[180:183]
    ds_read_b64_tr_b16 v[58:59], v38 offset:12928
    v_mfma_f32_16x16x32_bf16 v[184:187], v[60:63], v[88:91], v[184:187]
    v_mfma_f32_16x16x32_bf16 v[188:191], v[60:63], v[92:95], v[188:191]
    s_waitcnt lgkmcnt(4)
    v_mfma_f32_16x16x32_bf16 v[192:195], v[48:51], v[80:83], v[192:195]
    ds_read_b64_tr_b16 v[60:61], v38 offset:15488
    v_mfma_f32_16x16x32_bf16 v[196:199], v[48:51], v[84:87], v[196:199]
    ds_read_b64_tr_b16 v[62:63], v38 offset:18048
    v_mfma_f32_16x16x32_bf16 v[200:203], v[48:51], v[88:91], v[200:203]
    buffer_load_dword v27, v21, s[80:83], s89 offen sc1
    s_add_u32 s89, s89, 4096
    v_mfma_f32_16x16x32_bf16 v[204:207], v[48:51], v[92:95], v[204:207]
    s_waitcnt lgkmcnt(4)
    v_mfma_f32_16x16x32_bf16 v[208:211], v[52:55], v[80:83], v[208:211]
    v_mfma_f32_16x16x32_bf16 v[212:215], v[52:55], v[84:87], v[212:215]
    v_mfma_f32_16x16x32_bf16 v[216:219], v[52:55], v[88:91], v[216:219]
    v_mfma_f32_16x16x32_bf16 v[220:223], v[52:55], v[92:95], v[220:223]
    s_waitcnt lgkmcnt(2)
    v_mfma_f32_16x16x32_bf16 v[224:227], v[56:59], v[80:83], v[224:227]
    v_mfma_f32_16x16x32_bf16 v[228:231], v[56:59], v[84:87], v[228:231]
    v_mfma_f32_16x16x32_bf16 v[232:235], v[56:59], v[88:91], v[232:235]
    v_mfma_f32_16x16x32_bf16 v[236:239], v[56:59], v[92:95], v[236:239]
    s_waitcnt lgkmcnt(0)
    v_mfma_f32_16x16x32_bf16 v[240:243], v[60:63], v[80:83], v[240:243]
    v_mfma_f32_16x16x32_bf16 v[244:247], v[60:63], v[84:87], v[244:247]
    v_mfma_f32_16x16x32_bf16 v[248:251], v[60:63], v[88:91], v[248:251]
    v_mfma_f32_16x16x32_bf16 v[252:255], v[60:63], v[92:95], v[252:255]
    s_nop 7
    s_lshl_b32 s46, s40, 3
    s_add_u32 s46, s46, s41
    s_lshl_b32 s46, s46, 7
    s_add_u32 s46, s46, 20480
    v_min_u32 v6, 3, v0
    v_lshlrev_b32 v6, 2, v6
    v_add_u32 v6, s46, v6
    buffer_load_dword v7, v6, s[76:79], 0 offen sc1
    buffer_load_dword v4, v8, s[76:79], 0 offen sc1
    s_cmp_eq_u32 s59, 1
    s_cbranch_scc0 FKN_hs1
    s_lshl_b32 s45, s40, 4
    s_lshl_b32 s46, s3, 2
    s_add_u32 s45, s45, s46
    s_mul_i32 s50, s45, 147456
    s_mul_i32 s46, s41, 18432
    s_add_u32 s50, s50, s46
    s_lshl_b32 s46, s42, 11
    s_add_u32 s51, s50, s46
    s_add_u32 s51, s51, 8192
    s_lshr_b32 s46, s42, 1
    s_add_u32 s46, s46, 16
    s_lshl_b32 s46, s46, 10
    s_add_u32 s52, s50, s46
    s_and_b32 s46, s42, 1
    s_lshl_b32 s46, s46, 3
    s_add_u32 s52, s52, s46
    v_lshlrev_b32 v2, 4, v0
    v_pk_mul_f32 v[96:97], v[96:97], v[112:113]
    v_pk_mul_f32 v[98:99], v[98:99], v[114:115]
    v_cvt_pk_bf16_f32 v40, v96, v97
    v_cvt_pk_bf16_f32 v41, v98, v99
    v_pk_mul_f32 v[128:129], v[128:129], v[144:145]
    v_pk_mul_f32 v[130:131], v[130:131], v[146:147]
    v_cvt_pk_bf16_f32 v42, v128, v129
    v_cvt_pk_bf16_f32 v43, v130, v131
    buffer_store_dwordx4 v[40:43], v2, s[16:19], s51 offen offset:0
    v_pk_mul_f32 v[160:161], v[160:161], v[176:177]
    v_pk_mul_f32 v[162:163], v[162:163], v[178:179]
    v_cvt_pk_bf16_f32 v44, v160, v161
    v_cvt_pk_bf16_f32 v45, v162, v163
    v_pk_mul_f32 v[192:193], v[192:193], v[208:209]
    v_pk_mul_f32 v[194:195], v[194:195], v[210:211]
    v_cvt_pk_bf16_f32 v46, v192, v193
    v_cvt_pk_bf16_f32 v47, v194, v195
    buffer_store_dwordx4 v[44:47], v2, s[16:19], s51 offen offset:1024
    v_pk_mul_f32 v[224:225], v[224:225], v[240:241]
    v_pk_mul_f32 v[226:227], v[226:227], v[242:243]
    v_cvt_pk_bf16_f32 v40, v224, v225
    v_cvt_pk_bf16_f32 v41, v226, v227
    buffer_store_dwordx2 v[40:41], v2, s[16:19], s52 offen
    s_add_u32 s51, s51, 147456
    s_add_u32 s52, s52, 147456
    v_pk_mul_f32 v[100:101], v[100:101], v[116:117]
    v_pk_mul_f32 v[102:103], v[102:103], v[118:119]
    v_cvt_pk_bf16_f32 v44, v100, v101
    v_cvt_pk_bf16_f32 v45, v102, v103
    v_pk_mul_f32 v[132:133], v[132:133], v[148:149]
    v_pk_mul_f32 v[134:135], v[134:135], v[150:151]
    v_cvt_pk_bf16_f32 v46, v132, v133
    v_cvt_pk_bf16_f32 v47, v134, v135
    buffer_store_dwordx4 v[44:47], v2, s[16:19], s51 offen offset:0
    v_pk_mul_f32 v[164:165], v[164:165], v[180:181]
    v_pk_mul_f32 v[166:167], v[166:167], v[182:183]
    v_cvt_pk_bf16_f32 v40, v164, v165
    v_cvt_pk_bf16_f32 v41, v166, v167
    v_pk_mul_f32 v[196:197], v[196:197], v[212:213]
    v_pk_mul_f32 v[198:199], v[198:199], v[214:215]
    v_cvt_pk_bf16_f32 v42, v196, v197
    v_cvt_pk_bf16_f32 v43, v198, v199
    buffer_store_dwordx4 v[40:43], v2, s[16:19], s51 offen offset:1024
    v_pk_mul_f32 v[228:229], v[228:229], v[244:245]
    v_pk_mul_f32 v[230:231], v[230:231], v[246:247]
    v_cvt_pk_bf16_f32 v44, v228, v229
    v_cvt_pk_bf16_f32 v45, v230, v231
    buffer_store_dwordx2 v[44:45], v2, s[16:19], s52 offen
    s_add_u32 s51, s51, 147456
    s_add_u32 s52, s52, 147456
    v_pk_mul_f32 v[104:105], v[104:105], v[120:121]
    v_pk_mul_f32 v[106:107], v[106:107], v[122:123]
    v_cvt_pk_bf16_f32 v40, v104, v105
    v_cvt_pk_bf16_f32 v41, v106, v107
    v_pk_mul_f32 v[136:137], v[136:137], v[152:153]
    v_pk_mul_f32 v[138:139], v[138:139], v[154:155]
    v_cvt_pk_bf16_f32 v42, v136, v137
    v_cvt_pk_bf16_f32 v43, v138, v139
    buffer_store_dwordx4 v[40:43], v2, s[16:19], s51 offen offset:0
    v_pk_mul_f32 v[168:169], v[168:169], v[184:185]
    v_pk_mul_f32 v[170:171], v[170:171], v[186:187]
    v_cvt_pk_bf16_f32 v44, v168, v169
    v_cvt_pk_bf16_f32 v45, v170, v171
    v_pk_mul_f32 v[200:201], v[200:201], v[216:217]
    v_pk_mul_f32 v[202:203], v[202:203], v[218:219]
    v_cvt_pk_bf16_f32 v46, v200, v201
    v_cvt_pk_bf16_f32 v47, v202, v203
    buffer_store_dwordx4 v[44:47], v2, s[16:19], s51 offen offset:1024
    v_pk_mul_f32 v[232:233], v[232:233], v[248:249]
    v_pk_mul_f32 v[234:235], v[234:235], v[250:251]
    v_cvt_pk_bf16_f32 v40, v232, v233
    v_cvt_pk_bf16_f32 v41, v234, v235
    buffer_store_dwordx2 v[40:41], v2, s[16:19], s52 offen
    s_add_u32 s51, s51, 147456
    s_add_u32 s52, s52, 147456
    v_pk_mul_f32 v[108:109], v[108:109], v[124:125]
    v_pk_mul_f32 v[110:111], v[110:111], v[126:127]
    v_cvt_pk_bf16_f32 v44, v108, v109
    v_cvt_pk_bf16_f32 v45, v110, v111
    v_pk_mul_f32 v[140:141], v[140:141], v[156:157]
    v_pk_mul_f32 v[142:143], v[142:143], v[158:159]
    v_cvt_pk_bf16_f32 v46, v140, v141
    v_cvt_pk_bf16_f32 v47, v142, v143
    buffer_store_dwordx4 v[44:47], v2, s[16:19], s51 offen offset:0
    v_pk_mul_f32 v[172:173], v[172:173], v[188:189]
    v_pk_mul_f32 v[174:175], v[174:175], v[190:191]
    v_cvt_pk_bf16_f32 v40, v172, v173
    v_cvt_pk_bf16_f32 v41, v174, v175
    v_pk_mul_f32 v[204:205], v[204:205], v[220:221]
    v_pk_mul_f32 v[206:207], v[206:207], v[222:223]
    v_cvt_pk_bf16_f32 v42, v204, v205
    v_cvt_pk_bf16_f32 v43, v206, v207
    buffer_store_dwordx4 v[40:43], v2, s[16:19], s51 offen offset:1024
    v_pk_mul_f32 v[236:237], v[236:237], v[252:253]
    v_pk_mul_f32 v[238:239], v[238:239], v[254:255]
    v_cvt_pk_bf16_f32 v44, v236, v237
    v_cvt_pk_bf16_f32 v45, v238, v239
    buffer_store_dwordx2 v[44:45], v2, s[16:19], s52 offen
    s_branch FKN_hd1
FKN_hs1:
    s_lshl_b32 s45, s40, 4
    s_lshl_b32 s46, s3, 2
    s_add_u32 s45, s45, s46
    s_mul_i32 s50, s45, 147456
    s_mul_i32 s46, s41, 18432
    s_add_u32 s50, s50, s46
    s_lshl_b32 s46, s42, 11
    s_add_u32 s51, s50, s46
    s_add_u32 s51, s51, 8192
    s_lshr_b32 s46, s42, 1
    s_add_u32 s46, s46, 16
    s_lshl_b32 s46, s46, 10
    s_add_u32 s52, s50, s46
    s_and_b32 s46, s42, 1
    s_lshl_b32 s46, s46, 3
    s_add_u32 s52, s52, s46
    v_lshlrev_b32 v2, 4, v0
    v_pk_mul_f32 v[96:97], v[96:97], v[112:113]
    v_pk_mul_f32 v[98:99], v[98:99], v[114:115]
    v_cvt_pk_bf16_f32 v40, v96, v97
    v_cvt_pk_bf16_f32 v41, v98, v99
    v_pk_mul_f32 v[128:129], v[128:129], v[144:145]
    v_pk_mul_f32 v[130:131], v[130:131], v[146:147]
    v_cvt_pk_bf16_f32 v42, v128, v129
    v_cvt_pk_bf16_f32 v43, v130, v131
    buffer_store_dwordx4 v[40:43], v2, s[16:19], s51 offen offset:0 sc1
    v_pk_mul_f32 v[160:161], v[160:161], v[176:177]
    v_pk_mul_f32 v[162:163], v[162:163], v[178:179]
    v_cvt_pk_bf16_f32 v44, v160, v161
    v_cvt_pk_bf16_f32 v45, v162, v163
    v_pk_mul_f32 v[192:193], v[192:193], v[208:209]
    v_pk_mul_f32 v[194:195], v[194:195], v[210:211]
    v_cvt_pk_bf16_f32 v46, v192, v193
    v_cvt_pk_bf16_f32 v47, v194, v195
    buffer_store_dwordx4 v[44:47], v2, s[16:19], s51 offen offset:1024 sc1
    v_pk_mul_f32 v[224:225], v[224:225], v[240:241]
    v_pk_mul_f32 v[226:227], v[226:227], v[242:243]
    v_cvt_pk_bf16_f32 v40, v224, v225
    v_cvt_pk_bf16_f32 v41, v226, v227
    buffer_store_dwordx2 v[40:41], v2, s[16:19], s52 offen sc1
    s_add_u32 s51, s51, 147456
    s_add_u32 s52, s52, 147456
    v_pk_mul_f32 v[100:101], v[100:101], v[116:117]
    v_pk_mul_f32 v[102:103], v[102:103], v[118:119]
    v_cvt_pk_bf16_f32 v44, v100, v101
    v_cvt_pk_bf16_f32 v45, v102, v103
    v_pk_mul_f32 v[132:133], v[132:133], v[148:149]
    v_pk_mul_f32 v[134:135], v[134:135], v[150:151]
    v_cvt_pk_bf16_f32 v46, v132, v133
    v_cvt_pk_bf16_f32 v47, v134, v135
    buffer_store_dwordx4 v[44:47], v2, s[16:19], s51 offen offset:0 sc1
    v_pk_mul_f32 v[164:165], v[164:165], v[180:181]
    v_pk_mul_f32 v[166:167], v[166:167], v[182:183]
    v_cvt_pk_bf16_f32 v40, v164, v165
    v_cvt_pk_bf16_f32 v41, v166, v167
    v_pk_mul_f32 v[196:197], v[196:197], v[212:213]
    v_pk_mul_f32 v[198:199], v[198:199], v[214:215]
    v_cvt_pk_bf16_f32 v42, v196, v197
    v_cvt_pk_bf16_f32 v43, v198, v199
    buffer_store_dwordx4 v[40:43], v2, s[16:19], s51 offen offset:1024 sc1
    v_pk_mul_f32 v[228:229], v[228:229], v[244:245]
    v_pk_mul_f32 v[230:231], v[230:231], v[246:247]
    v_cvt_pk_bf16_f32 v44, v228, v229
    v_cvt_pk_bf16_f32 v45, v230, v231
    buffer_store_dwordx2 v[44:45], v2, s[16:19], s52 offen sc1
    s_add_u32 s51, s51, 147456
    s_add_u32 s52, s52, 147456
    v_pk_mul_f32 v[104:105], v[104:105], v[120:121]
    v_pk_mul_f32 v[106:107], v[106:107], v[122:123]
    v_cvt_pk_bf16_f32 v40, v104, v105
    v_cvt_pk_bf16_f32 v41, v106, v107
    v_pk_mul_f32 v[136:137], v[136:137], v[152:153]
    v_pk_mul_f32 v[138:139], v[138:139], v[154:155]
    v_cvt_pk_bf16_f32 v42, v136, v137
    v_cvt_pk_bf16_f32 v43, v138, v139
    buffer_store_dwordx4 v[40:43], v2, s[16:19], s51 offen offset:0 sc1
    v_pk_mul_f32 v[168:169], v[168:169], v[184:185]
    v_pk_mul_f32 v[170:171], v[170:171], v[186:187]
    v_cvt_pk_bf16_f32 v44, v168, v169
    v_cvt_pk_bf16_f32 v45, v170, v171
    v_pk_mul_f32 v[200:201], v[200:201], v[216:217]
    v_pk_mul_f32 v[202:203], v[202:203], v[218:219]
    v_cvt_pk_bf16_f32 v46, v200, v201
    v_cvt_pk_bf16_f32 v47, v202, v203
    buffer_store_dwordx4 v[44:47], v2, s[16:19], s51 offen offset:1024 sc1
    v_pk_mul_f32 v[232:233], v[232:233], v[248:249]
    v_pk_mul_f32 v[234:235], v[234:235], v[250:251]
    v_cvt_pk_bf16_f32 v40, v232, v233
    v_cvt_pk_bf16_f32 v41, v234, v235
    buffer_store_dwordx2 v[40:41], v2, s[16:19], s52 offen sc1
    s_add_u32 s51, s51, 147456
    s_add_u32 s52, s52, 147456
    v_pk_mul_f32 v[108:109], v[108:109], v[124:125]
    v_pk_mul_f32 v[110:111], v[110:111], v[126:127]
    v_cvt_pk_bf16_f32 v44, v108, v109
    v_cvt_pk_bf16_f32 v45, v110, v111
    v_pk_mul_f32 v[140:141], v[140:141], v[156:157]
    v_pk_mul_f32 v[142:143], v[142:143], v[158:159]
    v_cvt_pk_bf16_f32 v46, v140, v141
    v_cvt_pk_bf16_f32 v47, v142, v143
    buffer_store_dwordx4 v[44:47], v2, s[16:19], s51 offen offset:0 sc1
    v_pk_mul_f32 v[172:173], v[172:173], v[188:189]
    v_pk_mul_f32 v[174:175], v[174:175], v[190:191]
    v_cvt_pk_bf16_f32 v40, v172, v173
    v_cvt_pk_bf16_f32 v41, v174, v175
    v_pk_mul_f32 v[204:205], v[204:205], v[220:221]
    v_pk_mul_f32 v[206:207], v[206:207], v[222:223]
    v_cvt_pk_bf16_f32 v42, v204, v205
    v_cvt_pk_bf16_f32 v43, v206, v207
    buffer_store_dwordx4 v[40:43], v2, s[16:19], s51 offen offset:1024 sc1
    v_pk_mul_f32 v[236:237], v[236:237], v[252:253]
    v_pk_mul_f32 v[238:239], v[238:239], v[254:255]
    v_cvt_pk_bf16_f32 v44, v236, v237
    v_cvt_pk_bf16_f32 v45, v238, v239
    buffer_store_dwordx2 v[44:45], v2, s[16:19], s52 offen sc1
FKN_hd1:
FK_g1d:
    s_waitcnt vmcnt(0)
    s_barrier
    s_cmp_eq_u32 s3, 0
    s_cbranch_scc0 FK_fh2
    s_lshl_b32 s46, s40, 3
    s_add_u32 s46, s46, s41
    s_lshl_b32 s46, s46, 7
    s_lshl_b32 s47, s42, 2
    s_add_u32 s46, s46, s47
    s_add_u32 s46, s46, 20496
    v_mov_b32 v21, v4
    s_mov_b64 s[6:7], exec
    s_mov_b64 exec, 1
    v_mov_b32 v4, s39
    v_mov_b32 v5, 0
    buffer_store_dword v4, v5, s[76:79], s46 offen sc1
    s_mov_b64 exec, s[6:7]
    v_mov_b32 v4, v21
FK_fh2:
    s_mov_b32 s5, 0
    s_branch FK_sh0_c
FK_sh0_l:
    buffer_load_dword v7, v6, s[76:79], 0 offen sc1
    s_waitcnt vmcnt(0)
FK_sh0_c:
    v_xor_b32 v2, s39, v7
    v_cmp_ne_u32 vcc, 0, v2
    s_add_u32 s5, s5, 1
    s_cmp_ge_u32 s5, 20000
    s_cbranch_scc1 FK_sh0_x
    s_nop 0
    s_cmp_eq_u64 vcc, 0
    s_cbranch_scc1 FK_sh0_x
    s_sleep 1
    s_branch FK_sh0_l
FK_sh0_x:
    s_add_u32 s96, s8, 0x1000000
    s_addc_u32 s97, s9, 0
    s_mov_b32 s98, 0x1200000
    s_mov_b32 s99, 0x20000
    v_lshlrev_b32 v6, 4, v0
    s_mul_i32 s45, s3, 589824
    v_add_u32 v88, s45, v6
    v_add_u32 v89, 147456, v88
    v_add_u32 v90, 147456, v89
    v_add_u32 v91, 147456, v90
    s_mul_i32 s33, s40, 2359296
    s_mul_i32 s45, s41, 18432
    s_add_u32 s33, s33, s45
    s_cmp_ge_u32 s43, 18
    s_cbranch_scc0 FK_nofft
    s_mul_i32 s44, s40, 14
    s_add_u32 s44, s44, s43
    s_sub_u32 s44, s44, 18
    s_mul_i32 s45, s3, 112
    s_add_u32 s44, s44, s45
    s_mov_b32 s91, -1
    s_cmp_gt_u32 s44, 288
    s_cbranch_scc0 FK_fw
    buffer_load_dwordx4 a[0:3], v88, s[96:99], s33 offen offset:0 sc1
    buffer_load_dwordx4 a[4:7], v89, s[96:99], s33 offen offset:0 sc1
    buffer_load_dwordx4 a[8:11], v90, s[96:99], s33 offen offset:0 sc1
    buffer_load_dwordx4 a[12:15], v91, s[96:99], s33 offen offset:0 sc1
    buffer_load_dwordx4 a[16:19], v88, s[96:99], s33 offen offset:1024 sc1
    buffer_load_dwordx4 a[20:23], v89, s[96:99], s33 offen offset:1024 sc1
    buffer_load_dwordx4 a[24:27], v90, s[96:99], s33 offen offset:1024 sc1
    buffer_load_dwordx4 a[28:31], v91, s[96:99], s33 offen offset:1024 sc1
    buffer_load_dwordx4 a[32:35], v88, s[96:99], s33 offen offset:2048 sc1
    buffer_load_dwordx4 a[36:39], v89, s[96:99], s33 offen offset:2048 sc1
    buffer_load_dwordx4 a[40:43], v90, s[96:99], s33 offen offset:2048 sc1
    buffer_load_dwordx4 a[44:47], v91, s[96:99], s33 offen offset:2048 sc1
    buffer_load_dwordx4 a[48:51], v88, s[96:99], s33 offen offset:3072 sc1
    buffer_load_dwordx4 a[52:55], v89, s[96:99], s33 offen offset:3072 sc1
    buffer_load_dwordx4 a[56:59], v90, s[96:99], s33 offen offset:3072 sc1
    buffer_load_dwordx4 a[60:63], v91, s[96:99], s33 offen offset:3072 sc1
    s_add_u32 s33, s33, 4096
    buffer_load_dwordx4 a[64:67], v88, s[96:99], s33 offen offset:0 sc1
    buffer_load_dwordx4 a[68:71], v89, s[96:99], s33 offen offset:0 sc1
    buffer_load_dwordx4 a[72:75], v90, s[96:99], s33 offen offset:0 sc1
    buffer_load_dwordx4 a[76:79], v91, s[96:99], s33 offen offset:0 sc1
    buffer_load_dwordx4 a[80:83], v88, s[96:99], s33 offen offset:1024 sc1
    buffer_load_dwordx4 a[84:87], v89, s[96:99], s33 offen offset:1024 sc1
    buffer_load_dwordx4 a[88:91], v90, s[96:99], s33 offen offset:1024 sc1
    buffer_load_dwordx4 a[92:95], v91, s[96:99], s33 offen offset:1024 sc1
    buffer_load_dwordx4 a[96:99], v88, s[96:99], s33 offen offset:2048 sc1
    buffer_load_dwordx4 a[100:103], v89, s[96:99], s33 offen offset:2048 sc1
    buffer_load_dwordx4 a[104:107], v90, s[96:99], s33 offen offset:2048 sc1
    buffer_load_dwordx4 a[108:111], v91, s[96:99], s33 offen offset:2048 sc1
    buffer_load_dwordx4 a[112:115], v88, s[96:99], s33 offen offset:3072 sc1
    buffer_load_dwordx4 a[116:119], v89, s[96:99], s33 offen offset:3072 sc1
    buffer_load_dwordx4 a[120:123], v90, s[96:99], s33 offen offset:3072 sc1
    buffer_load_dwordx4 a[124:127], v91, s[96:99], s33 offen offset:3072 sc1
    s_add_u32 s33, s33, 4096
    s_branch FK_fftd
FK_fw:
    s_cmp_ge_u32 s44, 288
    s_cselect_b32 s45, 0, s44
    s_lshr_b32 s45, s45, 4
    s_lshl_b32 s45, s45, 7
    s_add_u32 s45, s45, 16384
    v_min_u32 v8, 7, v0
    v_lshlrev_b32 v8, 2, v8
    v_add_u32 v8, s45, v8
    s_mov_b32 s5, 0
    s_branch FK_sx_c
FK_sx_l:
    buffer_load_dword v4, v8, s[76:79], 0 offen sc1
    s_waitcnt vmcnt(0)
FK_sx_c:
    v_xor_b32 v2, s39, v4
    v_cmp_ne_u32 vcc, 0, v2
    s_add_u32 s5, s5, 1
    s_cmp_ge_u32 s5, 20000
    s_cbranch_scc1 FK_sx_x
    s_nop 0
    s_cmp_eq_u64 vcc, 0
    s_cbranch_scc1 FK_sx_x
    s_sleep 1
    s_branch FK_sx_l
FK_sx_x:
    s_add_u32 s12, s8, 0x700000
    s_addc_u32 s13, s9, 0
    s_mov_b32 s14, 0x240000
    s_mov_b32 s15, 0x20000
    s_add_u32 s20, s8, 0x4000000
    s_addc_u32 s21, s9, 0
    s_mov_b32 s22, 0x242000
    s_mov_b32 s23, 0x20000
    s_cmp_eq_u32 s44, 288
    s_cselect_b32 s45, 0, s44
    s_lshl_b32 s45, s45, 13
    s_add_u32 s46, s45, 4096
    s_lshl_b32 s47, s44, 13
    v_lshlrev_b32 v6, 3, v0
    v_and_b32 v1, 31, v0
    v_lshrrev_b32 v2, 5, v0
    v_lshlrev_b32 v1, 2, v1
    v_lshl_add_u32 v1, v2, 9, v1
    v_lshlrev_b32 v3, 4, v0
    buffer_load_dword v96, v1, s[12:15], s45 offen offset:0 sc1
    buffer_load_dword v97, v1, s[12:15], s45 offen offset:128 sc1
    buffer_load_dword v98, v1, s[12:15], s45 offen offset:256 sc1
    buffer_load_dword v99, v1, s[12:15], s45 offen offset:384 sc1
    buffer_load_dword v100, v1, s[12:15], s45 offen offset:1024 sc1
    buffer_load_dword v101, v1, s[12:15], s45 offen offset:1152 sc1
    buffer_load_dword v102, v1, s[12:15], s45 offen offset:1280 sc1
    buffer_load_dword v103, v1, s[12:15], s45 offen offset:1408 sc1
    buffer_load_dword v104, v1, s[12:15], s45 offen offset:2048 sc1
    buffer_load_dword v105, v1, s[12:15], s45 offen offset:2176 sc1
    buffer_load_dword v106, v1, s[12:15], s45 offen offset:2304 sc1
    buffer_load_dword v107, v1, s[12:15], s45 offen offset:2432 sc1
    buffer_load_dword v108, v1, s[12:15], s45 offen offset:3072 sc1
    buffer_load_dword v109, v1, s[12:15], s45 offen offset:3200 sc1
    buffer_load_dword v110, v1, s[12:15], s45 offen offset:3328 sc1
    buffer_load_dword v111, v1, s[12:15], s45 offen offset:3456 sc1
    buffer_load_dword v112, v1, s[12:15], s46 offen offset:0 sc1
    buffer_load_dword v113, v1, s[12:15], s46 offen offset:128 sc1
    buffer_load_dword v114, v1, s[12:15], s46 offen offset:256 sc1
    buffer_load_dword v115, v1, s[12:15], s46 offen offset:384 sc1
    buffer_load_dword v116, v1, s[12:15], s46 offen offset:1024 sc1
    buffer_load_dword v117, v1, s[12:15], s46 offen offset:1152 sc1
    buffer_load_dword v118, v1, s[12:15], s46 offen offset:1280 sc1
    buffer_load_dword v119, v1, s[12:15], s46 offen offset:1408 sc1
    buffer_load_dword v120, v1, s[12:15], s46 offen offset:2048 sc1
    buffer_load_dword v121, v1, s[12:15], s46 offen offset:2176 sc1
    buffer_load_dword v122, v1, s[12:15], s46 offen offset:2304 sc1
    buffer_load_dword v123, v1, s[12:15], s46 offen offset:2432 sc1
    s_waitcnt vmcnt(54)
    buffer_load_dword v124, v1, s[12:15], s46 offen offset:3072 sc1
    buffer_load_dword v125, v1, s[12:15], s46 offen offset:3200 sc1
    buffer_load_dword v126, v1, s[12:15], s46 offen offset:3328 sc1
    buffer_load_dword v127, v1, s[12:15], s46 offen offset:3456 sc1
    s_add_u32 s48, s47, 0
    buffer_load_dwordx2 v[192:193], v6, s[20:23], s48 offen offset:0 sc1
    buffer_load_dwordx2 v[194:195], v6, s[20:23], s48 offen offset:512 sc1
    buffer_load_dwordx2 v[196:197], v6, s[20:23], s48 offen offset:1024 sc1
    s_waitcnt vmcnt(54)
    buffer_load_dwordx2 v[198:199], v6, s[20:23], s48 offen offset:1536 sc1
    buffer_load_dwordx2 v[200:201], v6, s[20:23], s48 offen offset:2048 sc1
    buffer_load_dwordx2 v[202:203], v6, s[20:23], s48 offen offset:2560 sc1
    buffer_load_dwordx2 v[204:205], v6, s[20:23], s48 offen offset:3072 sc1
    buffer_load_dwordx2 v[206:207], v6, s[20:23], s48 offen offset:3584 sc1
    s_add_u32 s48, s47, 4096
    buffer_load_dwordx2 v[56:57], v6, s[20:23], s48 offen offset:0 sc1
    buffer_load_dwordx2 v[58:59], v6, s[20:23], s48 offen offset:512 sc1
    s_waitcnt vmcnt(54)
    buffer_load_dwordx2 v[60:61], v6, s[20:23], s48 offen offset:1024 sc1
    buffer_load_dwordx2 v[62:63], v6, s[20:23], s48 offen offset:1536 sc1
    buffer_load_dwordx2 v[64:65], v6, s[20:23], s48 offen offset:2048 sc1
    buffer_load_dwordx2 v[66:67], v6, s[20:23], s48 offen offset:2560 sc1
    buffer_load_dwordx2 v[68:69], v6, s[20:23], s48 offen offset:3072 sc1
    buffer_load_dwordx2 v[70:71], v6, s[20:23], s48 offen offset:3584 sc1
    s_mov_b32 s49, 0xffff0000
    v_lshlrev_b32 v4, 4, v0
    v_add_u32 v4, 81920, v4
    v_add_u32 v5, 40960, v4
    ds_read_b128 a[224:227], v5 offset:0
    ds_read_b128 a[228:231], v5 offset:16384
    ds_read_b128 a[232:235], v5 offset:1024
    ds_read_b128 a[236:239], v5 offset:17408
    ds_read_b128 a[240:243], v5 offset:2048
    ds_read_b128 v[224:227], v4 offset:0
    ds_read_b128 v[228:231], v4 offset:1024
    ds_read_b128 v[232:235], v4 offset:2048
    ds_read_b128 v[236:239], v4 offset:3072
    ds_read_b128 v[240:243], v4 offset:4096
    ds_read_b128 v[244:247], v4 offset:5120
    ds_read_b128 v[248:251], v4 offset:6144
    ds_read_b128 v[252:255], v4 offset:7168
    ds_read_b128 a[192:195], v4 offset:32768
    s_waitcnt lgkmcnt(12)
    ds_read_b128 a[196:199], v4 offset:33792
    ds_read_b128 a[200:203], v4 offset:34816
    s_waitcnt lgkmcnt(12)
    ds_read_b128 a[204:207], v4 offset:35840
    ds_read_b128 a[208:211], v4 offset:36864
    s_waitcnt lgkmcnt(12)
    ds_read_b128 a[212:215], v4 offset:37888
    ds_read_b128 a[216:219], v4 offset:38912
    s_waitcnt lgkmcnt(12)
    ds_read_b128 a[220:223], v4 offset:39936
    s_waitcnt vmcnt(16)
    s_cmp_eq_u32 s44, 0
    s_cbranch_scc0 FKF_n0
    v_and_b32 v96, 0xffff, v96
    v_and_b32 v97, 0xffff, v97
    v_and_b32 v98, 0xffff, v98
    v_and_b32 v99, 0xffff, v99
    v_and_b32 v100, 0xffff, v100
    v_and_b32 v101, 0xffff, v101
    v_and_b32 v102, 0xffff, v102
    v_and_b32 v103, 0xffff, v103
    v_and_b32 v104, 0xffff, v104
    v_and_b32 v105, 0xffff, v105
    v_and_b32 v106, 0xffff, v106
    v_and_b32 v107, 0xffff, v107
    v_and_b32 v108, 0xffff, v108
    v_and_b32 v109, 0xffff, v109
    v_and_b32 v110, 0xffff, v110
    v_and_b32 v111, 0xffff, v111
    v_and_b32 v112, 0xffff, v112
    v_and_b32 v113, 0xffff, v113
    v_and_b32 v114, 0xffff, v114
    v_and_b32 v115, 0xffff, v115
    v_and_b32 v116, 0xffff, v116
    v_and_b32 v117, 0xffff, v117
    v_and_b32 v118, 0xffff, v118
    v_and_b32 v119, 0xffff, v119
    v_and_b32 v120, 0xffff, v120
    v_and_b32 v121, 0xffff, v121
    v_and_b32 v122, 0xffff, v122
    v_and_b32 v123, 0xffff, v123
    v_and_b32 v124, 0xffff, v124
    v_and_b32 v125, 0xffff, v125
    v_and_b32 v126, 0xffff, v126
    v_and_b32 v127, 0xffff, v127
FKF_n0:
    s_cmp_eq_u32 s44, 288
    s_cbranch_scc0 FKF_n1
    v_lshrrev_b32 v96, 16, v96
    v_lshrrev_b32 v97, 16, v97
    v_lshrrev_b32 v98, 16, v98
    v_lshrrev_b32 v99, 16, v99
    v_lshrrev_b32 v100, 16, v100
    v_lshrrev_b32 v101, 16, v101
    v_lshrrev_b32 v102, 16, v102
    v_lshrrev_b32 v103, 16, v103
    v_lshrrev_b32 v104, 16, v104
    v_lshrrev_b32 v105, 16, v105
    v_lshrrev_b32 v106, 16, v106
    v_lshrrev_b32 v107, 16, v107
    v_lshrrev_b32 v108, 16, v108
    v_lshrrev_b32 v109, 16, v109
    v_lshrrev_b32 v110, 16, v110
    v_lshrrev_b32 v111, 16, v111
    v_lshrrev_b32 v112, 16, v112
    v_lshrrev_b32 v113, 16, v113
    v_lshrrev_b32 v114, 16, v114
    v_lshrrev_b32 v115, 16, v115
    v_lshrrev_b32 v116, 16, v116
    v_lshrrev_b32 v117, 16, v117
    v_lshrrev_b32 v118, 16, v118
    v_lshrrev_b32 v119, 16, v119
    v_lshrrev_b32 v120, 16, v120
    v_lshrrev_b32 v121, 16, v121
    v_lshrrev_b32 v122, 16, v122
    v_lshrrev_b32 v123, 16, v123
    v_lshrrev_b32 v124, 16, v124
    v_lshrrev_b32 v125, 16, v125
    v_lshrrev_b32 v126, 16, v126
    v_lshrrev_b32 v127, 16, v127
FKF_n1:
    ds_read_b128 a[244:247], v5 offset:18432
    v_mfma_f32_32x32x16_bf16 v[128:143], v[96:99], a[224:227], 0
    buffer_load_dwordx4 a[0:3], v88, s[96:99], s33 offen offset:0 sc1
    s_waitcnt lgkmcnt(12)
    ds_read_b128 a[248:251], v5 offset:3072
    v_mfma_f32_32x32x16_bf16 v[144:159], v[96:99], a[228:231], 0
    buffer_load_dwordx4 a[4:7], v89, s[96:99], s33 offen offset:0 sc1
    ds_read_b128 a[252:255], v5 offset:19456
    v_mfma_f32_32x32x16_bf16 v[128:143], v[100:103], a[232:235], v[128:143]
    buffer_load_dwordx4 a[8:11], v90, s[96:99], s33 offen offset:0 sc1
    s_waitcnt lgkmcnt(12)
    ds_read_b128 a[224:227], v5 offset:4096
    v_mfma_f32_32x32x16_bf16 v[144:159], v[100:103], a[236:239], v[144:159]
    buffer_load_dwordx4 a[12:15], v91, s[96:99], s33 offen offset:0 sc1
    ds_read_b128 a[228:231], v5 offset:20480
    v_mfma_f32_32x32x16_bf16 v[128:143], v[104:107], a[240:243], v[128:143]
    buffer_load_dwordx4 a[16:19], v88, s[96:99], s33 offen offset:1024 sc1
    s_waitcnt lgkmcnt(12)
    ds_read_b128 a[232:235], v5 offset:5120
    s_waitcnt lgkmcnt(5)
    v_mfma_f32_32x32x16_bf16 v[144:159], v[104:107], a[244:247], v[144:159]
    buffer_load_dwordx4 a[20:23], v89, s[96:99], s33 offen offset:1024 sc1
    ds_read_b128 a[236:239], v5 offset:21504
    s_waitcnt lgkmcnt(5)
    v_mfma_f32_32x32x16_bf16 v[128:143], v[108:111], a[248:251], v[128:143]
    buffer_load_dwordx4 a[24:27], v90, s[96:99], s33 offen offset:1024 sc1
    ds_read_b128 a[240:243], v5 offset:6144
    s_waitcnt lgkmcnt(5)
    v_mfma_f32_32x32x16_bf16 v[144:159], v[108:111], a[252:255], v[144:159]
    buffer_load_dwordx4 a[28:31], v91, s[96:99], s33 offen offset:1024 sc1
    ds_read_b128 a[244:247], v5 offset:22528
    s_waitcnt lgkmcnt(5)
    v_mfma_f32_32x32x16_bf16 v[128:143], v[112:115], a[224:227], v[128:143]
    buffer_load_dwordx4 a[32:35], v88, s[96:99], s33 offen offset:2048 sc1
    ds_read_b128 a[248:251], v5 offset:7168
    s_waitcnt lgkmcnt(5)
    v_mfma_f32_32x32x16_bf16 v[144:159], v[112:115], a[228:231], v[144:159]
    buffer_load_dwordx4 a[36:39], v89, s[96:99], s33 offen offset:2048 sc1
    ds_read_b128 a[252:255], v5 offset:23552
    s_waitcnt lgkmcnt(5)
    v_mfma_f32_32x32x16_bf16 v[128:143], v[116:119], a[232:235], v[128:143]
    buffer_load_dwordx4 a[40:43], v90, s[96:99], s33 offen offset:2048 sc1
    ds_read_b128 a[224:227], v5 offset:8192
    s_waitcnt lgkmcnt(5)
    v_mfma_f32_32x32x16_bf16 v[144:159], v[116:119], a[236:239], v[144:159]
    buffer_load_dwordx4 a[44:47], v91, s[96:99], s33 offen offset:2048 sc1
    ds_read_b128 a[228:231], v5 offset:24576
    s_waitcnt lgkmcnt(5)
    v_mfma_f32_32x32x16_bf16 v[128:143], v[120:123], a[240:243], v[128:143]
    ds_read_b128 a[232:235], v5 offset:9216
    s_waitcnt lgkmcnt(5)
    v_mfma_f32_32x32x16_bf16 v[144:159], v[120:123], a[244:247], v[144:159]
    ds_read_b128 a[236:239], v5 offset:25600
    s_waitcnt lgkmcnt(5)
    v_mfma_f32_32x32x16_bf16 v[128:143], v[124:127], a[248:251], v[128:143]
    ds_read_b128 a[240:243], v5 offset:10240
    s_waitcnt lgkmcnt(5)
    v_mfma_f32_32x32x16_bf16 v[144:159], v[124:127], a[252:255], v[144:159]
    ds_read_b128 a[244:247], v5 offset:26624
    s_waitcnt lgkmcnt(5)
    v_mfma_f32_32x32x16_bf16 v[160:175], v[96:99], a[224:227], 0
    ds_read_b128 a[248:251], v5 offset:11264
    s_waitcnt lgkmcnt(5)
    v_mfma_f32_32x32x16_bf16 v[176:191], v[96:99], a[228:231], 0
    ds_read_b128 a[252:255], v5 offset:27648
    s_waitcnt lgkmcnt(5)
    v_mfma_f32_32x32x16_bf16 v[160:175], v[100:103], a[232:235], v[160:175]
    ds_read_b128 a[224:227], v5 offset:12288
    s_waitcnt lgkmcnt(5)
    v_mfma_f32_32x32x16_bf16 v[176:191], v[100:103], a[236:239], v[176:191]
    v_pk_mul_f32 v[48:49], v[128:129], v[224:225]
    v_pk_mul_f32 v[50:51], v[144:145], v[224:225]
    v_pk_mul_f32 v[52:53], v[130:131], v[228:229]
    v_pk_mul_f32 v[54:55], v[146:147], v[228:229]
    ds_read_b128 a[228:231], v5 offset:28672
    s_waitcnt lgkmcnt(5)
    v_mfma_f32_32x32x16_bf16 v[160:175], v[104:107], a[240:243], v[160:175]
    v_pk_fma_f32 v[48:49], v[144:145], v[226:227], v[48:49]
    v_pk_fma_f32 v[50:51], v[128:129], v[226:227], v[50:51] neg_lo:[1,0,0] neg_hi:[1,0,0]
    v_pk_fma_f32 v[52:53], v[146:147], v[230:231], v[52:53]
    v_pk_fma_f32 v[54:55], v[130:131], v[230:231], v[54:55] neg_lo:[1,0,0] neg_hi:[1,0,0]
    v_cvt_pk_bf16_f32 v16, v48, v50
    ds_read_b128 a[232:235], v5 offset:13312
    s_waitcnt lgkmcnt(5)
    v_mfma_f32_32x32x16_bf16 v[176:191], v[104:107], a[244:247], v[176:191]
    v_cvt_pk_bf16_f32 v17, v49, v51
    v_cvt_pk_bf16_f32 v18, v52, v54
    v_cvt_pk_bf16_f32 v19, v53, v55
    ds_read_b128 v[224:227], v4 offset:8192
    ds_read_b128 v[228:231], v4 offset:9216
    ds_read_b128 a[236:239], v5 offset:29696
    s_waitcnt lgkmcnt(7)
    v_mfma_f32_32x32x16_bf16 v[160:175], v[108:111], a[248:251], v[160:175]
    v_pk_mul_f32 v[48:49], v[132:133], v[232:233]
    v_pk_mul_f32 v[50:51], v[148:149], v[232:233]
    v_pk_mul_f32 v[52:53], v[134:135], v[236:237]
    v_pk_mul_f32 v[54:55], v[150:151], v[236:237]
    ds_read_b128 a[240:243], v5 offset:14336
    s_waitcnt lgkmcnt(7)
    v_mfma_f32_32x32x16_bf16 v[176:191], v[108:111], a[252:255], v[176:191]
    v_pk_fma_f32 v[48:49], v[148:149], v[234:235], v[48:49]
    v_pk_fma_f32 v[50:51], v[132:133], v[234:235], v[50:51] neg_lo:[1,0,0] neg_hi:[1,0,0]
    v_pk_fma_f32 v[52:53], v[150:151], v[238:239], v[52:53]
    v_pk_fma_f32 v[54:55], v[134:135], v[238:239], v[54:55] neg_lo:[1,0,0] neg_hi:[1,0,0]
    v_cvt_pk_bf16_f32 v20, v48, v50
    ds_read_b128 a[244:247], v5 offset:30720
    s_waitcnt lgkmcnt(7)
    v_mfma_f32_32x32x16_bf16 v[160:175], v[112:115], a[224:227], v[160:175]
    v_cvt_pk_bf16_f32 v21, v49, v51
    v_cvt_pk_bf16_f32 v22, v52, v54
    v_cvt_pk_bf16_f32 v23, v53, v55
    ds_read_b128 v[232:235], v4 offset:10240
    ds_read_b128 v[236:239], v4 offset:11264
    ds_read_b128 a[248:251], v5 offset:15360
    s_waitcnt lgkmcnt(9)
    v_mfma_f32_32x32x16_bf16 v[176:191], v[112:115], a[228:231], v[176:191]
    v_pk_mul_f32 v[48:49], v[136:137], v[240:241]
    v_pk_mul_f32 v[50:51], v[152:153], v[240:241]
    v_pk_mul_f32 v[52:53], v[138:139], v[244:245]
    v_pk_mul_f32 v[54:55], v[154:155], v[244:245]
    ds_read_b128 a[252:255], v5 offset:31744
    s_waitcnt lgkmcnt(9)
    v_mfma_f32_32x32x16_bf16 v[160:175], v[116:119], a[232:235], v[160:175]
    v_pk_fma_f32 v[48:49], v[152:153], v[242:243], v[48:49]
    v_pk_fma_f32 v[50:51], v[136:137], v[242:243], v[50:51] neg_lo:[1,0,0] neg_hi:[1,0,0]
    v_pk_fma_f32 v[52:53], v[154:155], v[246:247], v[52:53]
    v_pk_fma_f32 v[54:55], v[138:139], v[246:247], v[54:55] neg_lo:[1,0,0] neg_hi:[1,0,0]
    v_cvt_pk_bf16_f32 v24, v48, v50
    ds_read_b128 a[224:227], v5 offset:0
    s_waitcnt lgkmcnt(7)
    v_mfma_f32_32x32x16_bf16 v[176:191], v[116:119], a[236:239], v[176:191]
    v_cvt_pk_bf16_f32 v25, v49, v51
    v_cvt_pk_bf16_f32 v26, v52, v54
    v_cvt_pk_bf16_f32 v27, v53, v55
    ds_read_b128 v[240:243], v4 offset:12288
    ds_read_b128 a[228:231], v5 offset:16384
    s_waitcnt lgkmcnt(8)
    v_mfma_f32_32x32x16_bf16 v[160:175], v[120:123], a[240:243], v[160:175]
    ds_read_b128 v[244:247], v4 offset:13312
    v_pk_mul_f32 v[48:49], v[140:141], v[248:249]
    v_pk_mul_f32 v[50:51], v[156:157], v[248:249]
    ds_read_b128 a[232:235], v5 offset:1024
    s_waitcnt lgkmcnt(9)
    v_mfma_f32_32x32x16_bf16 v[176:191], v[120:123], a[244:247], v[176:191]
    v_pk_mul_f32 v[52:53], v[142:143], v[252:253]
    v_pk_mul_f32 v[54:55], v[158:159], v[252:253]
    v_pk_fma_f32 v[48:49], v[156:157], v[250:251], v[48:49]
    v_pk_fma_f32 v[50:51], v[140:141], v[250:251], v[50:51] neg_lo:[1,0,0] neg_hi:[1,0,0]
    ds_read_b128 a[236:239], v5 offset:17408
    s_waitcnt lgkmcnt(7)
    v_mfma_f32_32x32x16_bf16 v[160:175], v[124:127], a[248:251], v[160:175]
    v_pk_fma_f32 v[52:53], v[158:159], v[254:255], v[52:53]
    v_pk_fma_f32 v[54:55], v[142:143], v[254:255], v[54:55] neg_lo:[1,0,0] neg_hi:[1,0,0]
    v_cvt_pk_bf16_f32 v28, v48, v50
    v_cvt_pk_bf16_f32 v29, v49, v51
    ds_read_b128 a[240:243], v5 offset:2048
    s_waitcnt lgkmcnt(7)
    v_mfma_f32_32x32x16_bf16 v[176:191], v[124:127], a[252:255], v[176:191]
    v_cvt_pk_bf16_f32 v30, v52, v54
    v_cvt_pk_bf16_f32 v31, v53, v55
    ds_read_b128 v[248:251], v4 offset:14336
    ds_read_b128 v[252:255], v4 offset:15360
    s_waitcnt lgkmcnt(8)
    v_mfma_f32_32x32x16_bf16 v[128:143], a[192:195], v[16:19], 0
    v_pk_mul_f32 v[48:49], v[160:161], v[224:225]
    s_nop 4
    v_pk_mul_f32 v[50:51], v[176:177], v[224:225]
    v_pk_mul_f32 v[52:53], v[162:163], v[228:229]
    v_pk_mul_f32 v[54:55], v[178:179], v[228:229]
    v_pk_fma_f32 v[48:49], v[176:177], v[226:227], v[48:49]
    v_pk_fma_f32 v[50:51], v[160:161], v[226:227], v[50:51] neg_lo:[1,0,0] neg_hi:[1,0,0]
    v_pk_fma_f32 v[52:53], v[178:179], v[230:231], v[52:53]
    v_mfma_f32_32x32x16_bf16 v[144:159], a[208:211], v[16:19], 0
    v_pk_fma_f32 v[54:55], v[162:163], v[230:231], v[54:55] neg_lo:[1,0,0] neg_hi:[1,0,0]
    v_cvt_pk_bf16_f32 v32, v48, v50
    v_cvt_pk_bf16_f32 v33, v49, v51
    v_cvt_pk_bf16_f32 v34, v52, v54
    v_cvt_pk_bf16_f32 v35, v53, v55
    ds_read_b128 v[224:227], v4 offset:16384
    ds_read_b128 v[228:231], v4 offset:17408
    v_mfma_f32_32x32x16_bf16 v[128:143], a[196:199], v[20:23], v[128:143]
    v_pk_mul_f32 v[48:49], v[164:165], v[232:233]
    v_pk_mul_f32 v[50:51], v[180:181], v[232:233]
    v_pk_mul_f32 v[52:53], v[166:167], v[236:237]
    v_pk_mul_f32 v[54:55], v[182:183], v[236:237]
    v_pk_fma_f32 v[48:49], v[180:181], v[234:235], v[48:49]
    v_pk_fma_f32 v[50:51], v[164:165], v[234:235], v[50:51] neg_lo:[1,0,0] neg_hi:[1,0,0]
    v_pk_fma_f32 v[52:53], v[182:183], v[238:239], v[52:53]
    v_pk_fma_f32 v[54:55], v[166:167], v[238:239], v[54:55] neg_lo:[1,0,0] neg_hi:[1,0,0]
    v_mfma_f32_32x32x16_bf16 v[144:159], a[212:215], v[20:23], v[144:159]
    v_cvt_pk_bf16_f32 v36, v48, v50
    v_cvt_pk_bf16_f32 v37, v49, v51
    v_cvt_pk_bf16_f32 v38, v52, v54
    v_cvt_pk_bf16_f32 v39, v53, v55
    ds_read_b128 v[232:235], v4 offset:18432
    ds_read_b128 v[236:239], v4 offset:19456
    s_waitcnt lgkmcnt(9)
    v_pk_mul_f32 v[48:49], v[168:169], v[240:241]
    v_mfma_f32_32x32x16_bf16 v[128:143], a[200:203], v[24:27], v[128:143]
    v_pk_mul_f32 v[50:51], v[184:185], v[240:241]
    v_pk_mul_f32 v[52:53], v[170:171], v[244:245]
    v_pk_mul_f32 v[54:55], v[186:187], v[244:245]
    v_pk_fma_f32 v[48:49], v[184:185], v[242:243], v[48:49]
    v_pk_fma_f32 v[50:51], v[168:169], v[242:243], v[50:51] neg_lo:[1,0,0] neg_hi:[1,0,0]
    v_pk_fma_f32 v[52:53], v[186:187], v[246:247], v[52:53]
    v_pk_fma_f32 v[54:55], v[170:171], v[246:247], v[54:55] neg_lo:[1,0,0] neg_hi:[1,0,0]
    v_cvt_pk_bf16_f32 v40, v48, v50
    v_mfma_f32_32x32x16_bf16 v[144:159], a[216:219], v[24:27], v[144:159]
    v_cvt_pk_bf16_f32 v41, v49, v51
    v_cvt_pk_bf16_f32 v42, v52, v54
    v_cvt_pk_bf16_f32 v43, v53, v55
    ds_read_b128 v[240:243], v4 offset:20480
    ds_read_b128 v[244:247], v4 offset:21504
    s_waitcnt lgkmcnt(6)
    v_pk_mul_f32 v[48:49], v[172:173], v[248:249]
    v_pk_mul_f32 v[50:51], v[188:189], v[248:249]
    v_mfma_f32_32x32x16_bf16 v[128:143], a[204:207], v[28:31], v[128:143]
    v_pk_mul_f32 v[52:53], v[174:175], v[252:253]
    v_pk_mul_f32 v[54:55], v[190:191], v[252:253]
    v_pk_fma_f32 v[48:49], v[188:189], v[250:251], v[48:49]
    v_pk_fma_f32 v[50:51], v[172:173], v[250:251], v[50:51] neg_lo:[1,0,0] neg_hi:[1,0,0]
    v_pk_fma_f32 v[52:53], v[190:191], v[254:255], v[52:53]
    v_pk_fma_f32 v[54:55], v[174:175], v[254:255], v[54:55] neg_lo:[1,0,0] neg_hi:[1,0,0]
    v_cvt_pk_bf16_f32 v44, v48, v50
    v_cvt_pk_bf16_f32 v45, v49, v51
    v_mfma_f32_32x32x16_bf16 v[144:159], a[220:223], v[28:31], v[144:159]
    v_cvt_pk_bf16_f32 v46, v52, v54
    v_cvt_pk_bf16_f32 v47, v53, v55
    ds_read_b128 v[248:251], v4 offset:22528
    ds_read_b128 v[252:255], v4 offset:23552
    buffer_load_dwordx4 a[48:51], v88, s[96:99], s33 offen offset:3072 sc1
    buffer_load_dwordx4 a[52:55], v89, s[96:99], s33 offen offset:3072 sc1
    buffer_load_dwordx4 a[56:59], v90, s[96:99], s33 offen offset:3072 sc1
    s_waitcnt vmcnt(23)
    v_mfma_f32_32x32x16_bf16 v[160:175], a[192:195], v[32:35], 0
    v_mfma_f32_32x32x16_bf16 v[176:191], a[208:211], v[32:35], 0
    v_mfma_f32_32x32x16_bf16 v[160:175], a[196:199], v[36:39], v[160:175]
    v_lshlrev_b32 v10, 16, v192
    v_and_b32 v11, s49, v192
    v_lshlrev_b32 v12, 16, v193
    v_and_b32 v13, s49, v193
    v_lshlrev_b32 v92, 16, v194
    v_and_b32 v93, s49, v194
    v_lshlrev_b32 v94, 16, v195
    v_and_b32 v95, s49, v195
    v_pk_mul_f32 v[48:49], v[128:129], v[10:11]
    v_mfma_f32_32x32x16_bf16 v[176:191], a[212:215], v[36:39], v[176:191]
    v_pk_mul_f32 v[50:51], v[128:129], v[12:13]
    v_pk_mul_f32 v[52:53], v[130:131], v[92:93]
    v_pk_mul_f32 v[54:55], v[130:131], v[94:95]
    v_pk_fma_f32 v[48:49], v[144:145], v[12:13], v[48:49] neg_lo:[1,0,0] neg_hi:[1,0,0]
    v_pk_fma_f32 v[50:51], v[144:145], v[10:11], v[50:51]
    v_pk_fma_f32 v[52:53], v[146:147], v[94:95], v[52:53] neg_lo:[1,0,0] neg_hi:[1,0,0]
    v_pk_fma_f32 v[54:55], v[146:147], v[92:93], v[54:55]
    v_cvt_pk_bf16_f32 v96, v48, -v50
    v_cvt_pk_bf16_f32 v97, v49, -v51
    v_mfma_f32_32x32x16_bf16 v[160:175], a[200:203], v[40:43], v[160:175]
    v_cvt_pk_bf16_f32 v98, v52, -v54
    v_cvt_pk_bf16_f32 v99, v53, -v55
    v_lshlrev_b32 v10, 16, v196
    v_and_b32 v11, s49, v196
    v_lshlrev_b32 v12, 16, v197
    v_and_b32 v13, s49, v197
    v_lshlrev_b32 v92, 16, v198
    v_and_b32 v93, s49, v198
    v_lshlrev_b32 v94, 16, v199
    v_mfma_f32_32x32x16_bf16 v[176:191], a[216:219], v[40:43], v[176:191]
    v_and_b32 v95, s49, v199
    v_pk_mul_f32 v[48:49], v[132:133], v[10:11]
    v_pk_mul_f32 v[50:51], v[132:133], v[12:13]
    v_pk_mul_f32 v[52:53], v[134:135], v[92:93]
    v_pk_mul_f32 v[54:55], v[134:135], v[94:95]
    v_pk_fma_f32 v[48:49], v[148:149], v[12:13], v[48:49] neg_lo:[1,0,0] neg_hi:[1,0,0]
    v_pk_fma_f32 v[50:51], v[148:149], v[10:11], v[50:51]
    v_pk_fma_f32 v[52:53], v[150:151], v[94:95], v[52:53] neg_lo:[1,0,0] neg_hi:[1,0,0]
    v_pk_fma_f32 v[54:55], v[150:151], v[92:93], v[54:55]
    v_mfma_f32_32x32x16_bf16 v[160:175], a[204:207], v[44:47], v[160:175]
    v_cvt_pk_bf16_f32 v100, v48, -v50
    v_cvt_pk_bf16_f32 v101, v49, -v51
    v_cvt_pk_bf16_f32 v102, v52, -v54
    v_cvt_pk_bf16_f32 v103, v53, -v55
    v_lshlrev_b32 v10, 16, v200
    v_and_b32 v11, s49, v200
    v_lshlrev_b32 v12, 16, v201
    v_and_b32 v13, s49, v201
    v_lshlrev_b32 v92, 16, v202
    v_mfma_f32_32x32x16_bf16 v[176:191], a[220:223], v[44:47], v[176:191]
    v_and_b32 v93, s49, v202
    v_lshlrev_b32 v94, 16, v203
    v_and_b32 v95, s49, v203
    v_pk_mul_f32 v[48:49], v[136:137], v[10:11]
    v_pk_mul_f32 v[50:51], v[136:137], v[12:13]
    v_pk_mul_f32 v[52:53], v[138:139], v[92:93]
    v_pk_mul_f32 v[54:55], v[138:139], v[94:95]
    v_pk_fma_f32 v[48:49], v[152:153], v[12:13], v[48:49] neg_lo:[1,0,0] neg_hi:[1,0,0]
    v_pk_fma_f32 v[50:51], v[152:153], v[10:11], v[50:51]
    v_pk_fma_f32 v[52:53], v[154:155], v[94:95], v[52:53] neg_lo:[1,0,0] neg_hi:[1,0,0]
    v_pk_fma_f32 v[54:55], v[154:155], v[92:93], v[54:55]
    v_cvt_pk_bf16_f32 v104, v48, -v50
    v_cvt_pk_bf16_f32 v105, v49, -v51
    v_cvt_pk_bf16_f32 v106, v52, -v54
    v_cvt_pk_bf16_f32 v107, v53, -v55
    v_lshlrev_b32 v10, 16, v204
    v_and_b32 v11, s49, v204
    v_lshlrev_b32 v12, 16, v205
    v_and_b32 v13, s49, v205
    v_lshlrev_b32 v92, 16, v206
    v_and_b32 v93, s49, v206
    v_lshlrev_b32 v94, 16, v207
    v_and_b32 v95, s49, v207
    v_pk_mul_f32 v[48:49], v[140:141], v[10:11]
    v_pk_mul_f32 v[50:51], v[140:141], v[12:13]
    v_pk_mul_f32 v[52:53], v[142:143], v[92:93]
    v_pk_mul_f32 v[54:55], v[142:143], v[94:95]
    v_pk_fma_f32 v[48:49], v[156:157], v[12:13], v[48:49] neg_lo:[1,0,0] neg_hi:[1,0,0]
    v_pk_fma_f32 v[50:51], v[156:157], v[10:11], v[50:51]
    v_pk_fma_f32 v[52:53], v[158:159], v[94:95], v[52:53] neg_lo:[1,0,0] neg_hi:[1,0,0]
    v_pk_fma_f32 v[54:55], v[158:159], v[92:93], v[54:55]
    v_cvt_pk_bf16_f32 v108, v48, -v50
    v_cvt_pk_bf16_f32 v109, v49, -v51
    v_cvt_pk_bf16_f32 v110, v52, -v54
    v_cvt_pk_bf16_f32 v111, v53, -v55
    s_waitcnt vmcnt(15)
    v_mfma_f32_32x32x16_bf16 v[128:143], v[96:99], a[192:195], 0
    v_lshlrev_b32 v10, 16, v56
    v_and_b32 v11, s49, v56
    v_lshlrev_b32 v12, 16, v57
    v_and_b32 v13, s49, v57
    v_lshlrev_b32 v92, 16, v58
    v_and_b32 v93, s49, v58
    v_lshlrev_b32 v94, 16, v59
    v_and_b32 v95, s49, v59
    v_mfma_f32_32x32x16_bf16 v[144:159], v[96:99], a[208:211], 0
    v_pk_mul_f32 v[48:49], v[160:161], v[10:11]
    v_pk_mul_f32 v[50:51], v[160:161], v[12:13]
    v_pk_mul_f32 v[52:53], v[162:163], v[92:93]
    v_pk_mul_f32 v[54:55], v[162:163], v[94:95]
    v_pk_fma_f32 v[48:49], v[176:177], v[12:13], v[48:49] neg_lo:[1,0,0] neg_hi:[1,0,0]
    v_pk_fma_f32 v[50:51], v[176:177], v[10:11], v[50:51]
    v_pk_fma_f32 v[52:53], v[178:179], v[94:95], v[52:53] neg_lo:[1,0,0] neg_hi:[1,0,0]
    v_pk_fma_f32 v[54:55], v[178:179], v[92:93], v[54:55]
    v_mfma_f32_32x32x16_bf16 v[128:143], v[100:103], a[196:199], v[128:143]
    v_cvt_pk_bf16_f32 v112, v48, -v50
    v_cvt_pk_bf16_f32 v113, v49, -v51
    v_cvt_pk_bf16_f32 v114, v52, -v54
    v_cvt_pk_bf16_f32 v115, v53, -v55
    v_lshlrev_b32 v10, 16, v60
    v_and_b32 v11, s49, v60
    v_lshlrev_b32 v12, 16, v61
    v_and_b32 v13, s49, v61
    v_mfma_f32_32x32x16_bf16 v[144:159], v[100:103], a[212:215], v[144:159]
    v_lshlrev_b32 v92, 16, v62
    v_and_b32 v93, s49, v62
    v_lshlrev_b32 v94, 16, v63
    v_and_b32 v95, s49, v63
    v_pk_mul_f32 v[48:49], v[164:165], v[10:11]
    v_pk_mul_f32 v[50:51], v[164:165], v[12:13]
    v_pk_mul_f32 v[52:53], v[166:167], v[92:93]
    v_pk_mul_f32 v[54:55], v[166:167], v[94:95]
    v_mfma_f32_32x32x16_bf16 v[128:143], v[104:107], a[200:203], v[128:143]
    v_pk_fma_f32 v[48:49], v[180:181], v[12:13], v[48:49] neg_lo:[1,0,0] neg_hi:[1,0,0]
    v_pk_fma_f32 v[50:51], v[180:181], v[10:11], v[50:51]
    v_pk_fma_f32 v[52:53], v[182:183], v[94:95], v[52:53] neg_lo:[1,0,0] neg_hi:[1,0,0]
    v_pk_fma_f32 v[54:55], v[182:183], v[92:93], v[54:55]
    v_cvt_pk_bf16_f32 v116, v48, -v50
    v_cvt_pk_bf16_f32 v117, v49, -v51
    v_cvt_pk_bf16_f32 v118, v52, -v54
    v_cvt_pk_bf16_f32 v119, v53, -v55
    v_mfma_f32_32x32x16_bf16 v[144:159], v[104:107], a[216:219], v[144:159]
    v_lshlrev_b32 v10, 16, v64
    v_and_b32 v11, s49, v64
    v_lshlrev_b32 v12, 16, v65
    v_and_b32 v13, s49, v65
    v_lshlrev_b32 v92, 16, v66
    v_and_b32 v93, s49, v66
    v_lshlrev_b32 v94, 16, v67
    v_and_b32 v95, s49, v67
    v_mfma_f32_32x32x16_bf16 v[128:143], v[108:111], a[204:207], v[128:143]
    v_pk_mul_f32 v[48:49], v[168:169], v[10:11]
    v_pk_mul_f32 v[50:51], v[168:169], v[12:13]
    v_pk_mul_f32 v[52:53], v[170:171], v[92:93]
    v_pk_mul_f32 v[54:55], v[170:171], v[94:95]
    v_pk_fma_f32 v[48:49], v[184:185], v[12:13], v[48:49] neg_lo:[1,0,0] neg_hi:[1,0,0]
    v_pk_fma_f32 v[50:51], v[184:185], v[10:11], v[50:51]
    v_pk_fma_f32 v[52:53], v[186:187], v[94:95], v[52:53] neg_lo:[1,0,0] neg_hi:[1,0,0]
    v_pk_fma_f32 v[54:55], v[186:187], v[92:93], v[54:55]
    v_mfma_f32_32x32x16_bf16 v[144:159], v[108:111], a[220:223], v[144:159]
    v_cvt_pk_bf16_f32 v120, v48, -v50
    v_cvt_pk_bf16_f32 v121, v49, -v51
    v_cvt_pk_bf16_f32 v122, v52, -v54
    v_cvt_pk_bf16_f32 v123, v53, -v55
    v_lshlrev_b32 v10, 16, v68
    v_and_b32 v11, s49, v68
    v_lshlrev_b32 v12, 16, v69
    v_and_b32 v13, s49, v69
    v_lshlrev_b32 v92, 16, v70
    v_and_b32 v93, s49, v70
    v_lshlrev_b32 v94, 16, v71
    v_and_b32 v95, s49, v71
    v_pk_mul_f32 v[48:49], v[172:173], v[10:11]
    v_pk_mul_f32 v[50:51], v[172:173], v[12:13]
    v_pk_mul_f32 v[52:53], v[174:175], v[92:93]
    v_pk_mul_f32 v[54:55], v[174:175], v[94:95]
    v_pk_fma_f32 v[48:49], v[188:189], v[12:13], v[48:49] neg_lo:[1,0,0] neg_hi:[1,0,0]
    v_pk_fma_f32 v[50:51], v[188:189], v[10:11], v[50:51]
    v_pk_fma_f32 v[52:53], v[190:191], v[94:95], v[52:53] neg_lo:[1,0,0] neg_hi:[1,0,0]
    v_pk_fma_f32 v[54:55], v[190:191], v[92:93], v[54:55]
    v_cvt_pk_bf16_f32 v124, v48, -v50
    v_cvt_pk_bf16_f32 v125, v49, -v51
    v_cvt_pk_bf16_f32 v126, v52, -v54
    v_cvt_pk_bf16_f32 v127, v53, -v55
    buffer_load_dwordx4 a[60:63], v91, s[96:99], s33 offen offset:3072 sc1
    s_add_u32 s33, s33, 4096
    buffer_load_dwordx4 a[64:67], v88, s[96:99], s33 offen offset:0 sc1
    buffer_load_dwordx4 a[68:71], v89, s[96:99], s33 offen offset:0 sc1
    v_mfma_f32_32x32x16_bf16 v[160:175], v[112:115], a[192:195], 0
    v_mfma_f32_32x32x16_bf16 v[176:191], v[112:115], a[208:211], 0
    v_mfma_f32_32x32x16_bf16 v[160:175], v[116:119], a[196:199], v[160:175]
    s_waitcnt lgkmcnt(6)
    v_pk_mul_f32 v[48:49], v[128:129], v[224:225]
    v_pk_mul_f32 v[50:51], v[144:145], v[224:225]
    v_pk_mul_f32 v[52:53], v[130:131], v[228:229]
    v_pk_mul_f32 v[54:55], v[146:147], v[228:229]
    v_pk_fma_f32 v[48:49], v[144:145], v[226:227], v[48:49]
    v_pk_fma_f32 v[50:51], v[128:129], v[226:227], v[50:51] neg_lo:[1,0,0] neg_hi:[1,0,0]
    v_pk_fma_f32 v[52:53], v[146:147], v[230:231], v[52:53]
    v_pk_fma_f32 v[54:55], v[130:131], v[230:231], v[54:55] neg_lo:[1,0,0] neg_hi:[1,0,0]
    v_cvt_pk_bf16_f32 v16, v48, v50
    v_mfma_f32_32x32x16_bf16 v[176:191], v[116:119], a[212:215], v[176:191]
    v_cvt_pk_bf16_f32 v17, v49, v51
    v_cvt_pk_bf16_f32 v18, v52, v54
    v_cvt_pk_bf16_f32 v19, v53, v55
    ds_read_b128 v[224:227], v4 offset:24576
    ds_read_b128 v[228:231], v4 offset:25600
    s_waitcnt lgkmcnt(6)
    v_pk_mul_f32 v[48:49], v[132:133], v[232:233]
    v_pk_mul_f32 v[50:51], v[148:149], v[232:233]
    v_pk_mul_f32 v[52:53], v[134:135], v[236:237]
    v_pk_mul_f32 v[54:55], v[150:151], v[236:237]
    v_mfma_f32_32x32x16_bf16 v[160:175], v[120:123], a[200:203], v[160:175]
    v_pk_fma_f32 v[48:49], v[148:149], v[234:235], v[48:49]
    v_pk_fma_f32 v[50:51], v[132:133], v[234:235], v[50:51] neg_lo:[1,0,0] neg_hi:[1,0,0]
    v_pk_fma_f32 v[52:53], v[150:151], v[238:239], v[52:53]
    v_pk_fma_f32 v[54:55], v[134:135], v[238:239], v[54:55] neg_lo:[1,0,0] neg_hi:[1,0,0]
    v_cvt_pk_bf16_f32 v20, v48, v50
    v_cvt_pk_bf16_f32 v21, v49, v51
    v_cvt_pk_bf16_f32 v22, v52, v54
    v_cvt_pk_bf16_f32 v23, v53, v55
    ds_read_b128 v[232:235], v4 offset:26624
    ds_read_b128 v[236:239], v4 offset:27648
    v_mfma_f32_32x32x16_bf16 v[176:191], v[120:123], a[216:219], v[176:191]
    s_waitcnt lgkmcnt(6)
    v_pk_mul_f32 v[48:49], v[136:137], v[240:241]
    v_pk_mul_f32 v[50:51], v[152:153], v[240:241]
    v_pk_mul_f32 v[52:53], v[138:139], v[244:245]
    v_pk_mul_f32 v[54:55], v[154:155], v[244:245]
    v_pk_fma_f32 v[48:49], v[152:153], v[242:243], v[48:49]
    v_pk_fma_f32 v[50:51], v[136:137], v[242:243], v[50:51] neg_lo:[1,0,0] neg_hi:[1,0,0]
    v_pk_fma_f32 v[52:53], v[154:155], v[246:247], v[52:53]
    v_pk_fma_f32 v[54:55], v[138:139], v[246:247], v[54:55] neg_lo:[1,0,0] neg_hi:[1,0,0]
    v_cvt_pk_bf16_f32 v24, v48, v50
    v_mfma_f32_32x32x16_bf16 v[160:175], v[124:127], a[204:207], v[160:175]
    v_cvt_pk_bf16_f32 v25, v49, v51
    v_cvt_pk_bf16_f32 v26, v52, v54
    v_cvt_pk_bf16_f32 v27, v53, v55
    ds_read_b128 v[240:243], v4 offset:28672
    ds_read_b128 v[244:247], v4 offset:29696
    s_waitcnt lgkmcnt(6)
    v_pk_mul_f32 v[48:49], v[140:141], v[248:249]
    v_pk_mul_f32 v[50:51], v[156:157], v[248:249]
    v_pk_mul_f32 v[52:53], v[142:143], v[252:253]
    v_pk_mul_f32 v[54:55], v[158:159], v[252:253]
    v_mfma_f32_32x32x16_bf16 v[176:191], v[124:127], a[220:223], v[176:191]
    v_pk_fma_f32 v[48:49], v[156:157], v[250:251], v[48:49]
    v_pk_fma_f32 v[50:51], v[140:141], v[250:251], v[50:51] neg_lo:[1,0,0] neg_hi:[1,0,0]
    v_pk_fma_f32 v[52:53], v[158:159], v[254:255], v[52:53]
    v_pk_fma_f32 v[54:55], v[142:143], v[254:255], v[54:55] neg_lo:[1,0,0] neg_hi:[1,0,0]
    v_cvt_pk_bf16_f32 v28, v48, v50
    v_cvt_pk_bf16_f32 v29, v49, v51
    v_cvt_pk_bf16_f32 v30, v52, v54
    v_cvt_pk_bf16_f32 v31, v53, v55
    ds_read_b128 v[248:251], v4 offset:30720
    ds_read_b128 v[252:255], v4 offset:31744
    ds_read_b128 a[244:247], v5 offset:18432
    v_mfma_f32_32x32x16_bf16 v[56:71], a[224:227], v[16:19], 0
    s_waitcnt lgkmcnt(7)
    v_pk_mul_f32 v[48:49], v[160:161], v[224:225]
    v_pk_mul_f32 v[50:51], v[176:177], v[224:225]
    v_pk_mul_f32 v[52:53], v[162:163], v[228:229]
    ds_read_b128 a[248:251], v5 offset:3072
    v_mfma_f32_32x32x16_bf16 v[72:87], a[228:231], v[16:19], 0
    v_pk_mul_f32 v[54:55], v[178:179], v[228:229]
    v_pk_fma_f32 v[48:49], v[176:177], v[226:227], v[48:49]
    v_pk_fma_f32 v[50:51], v[160:161], v[226:227], v[50:51] neg_lo:[1,0,0] neg_hi:[1,0,0]
    v_pk_fma_f32 v[52:53], v[178:179], v[230:231], v[52:53]
    ds_read_b128 a[252:255], v5 offset:19456
    v_mfma_f32_32x32x16_bf16 v[56:71], a[232:235], v[20:23], v[56:71]
    v_pk_fma_f32 v[54:55], v[162:163], v[230:231], v[54:55] neg_lo:[1,0,0] neg_hi:[1,0,0]
    v_cvt_pk_bf16_f32 v32, v48, v50
    v_cvt_pk_bf16_f32 v33, v49, v51
    v_cvt_pk_bf16_f32 v34, v52, v54
    ds_read_b128 a[224:227], v5 offset:8192
    v_mfma_f32_32x32x16_bf16 v[72:87], a[236:239], v[20:23], v[72:87]
    v_cvt_pk_bf16_f32 v35, v53, v55
    s_waitcnt lgkmcnt(8)
    v_pk_mul_f32 v[48:49], v[164:165], v[232:233]
    v_pk_mul_f32 v[50:51], v[180:181], v[232:233]
    ds_read_b128 a[228:231], v5 offset:24576
    v_mfma_f32_32x32x16_bf16 v[56:71], a[240:243], v[24:27], v[56:71]
    v_pk_mul_f32 v[52:53], v[166:167], v[236:237]
    v_pk_mul_f32 v[54:55], v[182:183], v[236:237]
    v_pk_fma_f32 v[48:49], v[180:181], v[234:235], v[48:49]
    v_pk_fma_f32 v[50:51], v[164:165], v[234:235], v[50:51] neg_lo:[1,0,0] neg_hi:[1,0,0]
    ds_read_b128 a[232:235], v5 offset:9216
    s_waitcnt lgkmcnt(5)
    v_mfma_f32_32x32x16_bf16 v[72:87], a[244:247], v[24:27], v[72:87]
    v_pk_fma_f32 v[52:53], v[182:183], v[238:239], v[52:53]
    v_pk_fma_f32 v[54:55], v[166:167], v[238:239], v[54:55] neg_lo:[1,0,0] neg_hi:[1,0,0]
    v_cvt_pk_bf16_f32 v36, v48, v50
    v_cvt_pk_bf16_f32 v37, v49, v51
    ds_read_b128 a[236:239], v5 offset:25600
    s_waitcnt lgkmcnt(5)
    v_mfma_f32_32x32x16_bf16 v[56:71], a[248:251], v[28:31], v[56:71]
    v_cvt_pk_bf16_f32 v38, v52, v54
    v_cvt_pk_bf16_f32 v39, v53, v55
    v_pk_mul_f32 v[48:49], v[168:169], v[240:241]
    ds_read_b128 a[240:243], v5 offset:10240
    s_waitcnt lgkmcnt(5)
    v_mfma_f32_32x32x16_bf16 v[72:87], a[252:255], v[28:31], v[72:87]
    v_pk_mul_f32 v[50:51], v[184:185], v[240:241]
    v_pk_mul_f32 v[52:53], v[170:171], v[244:245]
    v_pk_mul_f32 v[54:55], v[186:187], v[244:245]
    v_pk_fma_f32 v[48:49], v[184:185], v[242:243], v[48:49]
    ds_read_b128 a[244:247], v5 offset:26624
    s_waitcnt lgkmcnt(5)
    v_mfma_f32_32x32x16_bf16 v[128:143], a[224:227], v[16:19], 0
    v_pk_fma_f32 v[50:51], v[168:169], v[242:243], v[50:51] neg_lo:[1,0,0] neg_hi:[1,0,0]
    v_pk_fma_f32 v[52:53], v[186:187], v[246:247], v[52:53]
    v_pk_fma_f32 v[54:55], v[170:171], v[246:247], v[54:55] neg_lo:[1,0,0] neg_hi:[1,0,0]
    v_cvt_pk_bf16_f32 v40, v48, v50
    ds_read_b128 a[248:251], v5 offset:11264
    s_waitcnt lgkmcnt(5)
    v_mfma_f32_32x32x16_bf16 v[144:159], a[228:231], v[16:19], 0
    v_cvt_pk_bf16_f32 v41, v49, v51
    v_cvt_pk_bf16_f32 v42, v52, v54
    v_cvt_pk_bf16_f32 v43, v53, v55
    ds_read_b128 a[252:255], v5 offset:27648
    s_waitcnt lgkmcnt(5)
    v_mfma_f32_32x32x16_bf16 v[128:143], a[232:235], v[20:23], v[128:143]
    v_pk_mul_f32 v[48:49], v[172:173], v[248:249]
    v_pk_mul_f32 v[50:51], v[188:189], v[248:249]
    v_pk_mul_f32 v[52:53], v[174:175], v[252:253]
    ds_read_b128 a[224:227], v5 offset:4096
    s_waitcnt lgkmcnt(5)
    v_mfma_f32_32x32x16_bf16 v[144:159], a[236:239], v[20:23], v[144:159]
    v_pk_mul_f32 v[54:55], v[190:191], v[252:253]
    v_pk_fma_f32 v[48:49], v[188:189], v[250:251], v[48:49]
    v_pk_fma_f32 v[50:51], v[172:173], v[250:251], v[50:51] neg_lo:[1,0,0] neg_hi:[1,0,0]
    ds_read_b128 a[228:231], v5 offset:20480
    s_waitcnt lgkmcnt(5)
    v_mfma_f32_32x32x16_bf16 v[128:143], a[240:243], v[24:27], v[128:143]
    v_pk_fma_f32 v[52:53], v[190:191], v[254:255], v[52:53]
    v_pk_fma_f32 v[54:55], v[174:175], v[254:255], v[54:55] neg_lo:[1,0,0] neg_hi:[1,0,0]
    v_cvt_pk_bf16_f32 v44, v48, v50
    ds_read_b128 a[232:235], v5 offset:5120
    s_waitcnt lgkmcnt(5)
    v_mfma_f32_32x32x16_bf16 v[144:159], a[244:247], v[24:27], v[144:159]
    v_cvt_pk_bf16_f32 v45, v49, v51
    v_cvt_pk_bf16_f32 v46, v52, v54
    v_cvt_pk_bf16_f32 v47, v53, v55
    ds_read_b128 a[236:239], v5 offset:21504
    s_waitcnt lgkmcnt(5)
    v_mfma_f32_32x32x16_bf16 v[128:143], a[248:251], v[28:31], v[128:143]
    buffer_load_dwordx4 a[72:75], v90, s[96:99], s33 offen offset:0 sc1
    buffer_load_dwordx4 a[76:79], v91, s[96:99], s33 offen offset:0 sc1
    buffer_load_dwordx4 a[80:83], v88, s[96:99], s33 offen offset:1024 sc1
    ds_read_b128 a[240:243], v5 offset:6144
    s_waitcnt lgkmcnt(5)
    v_mfma_f32_32x32x16_bf16 v[144:159], a[252:255], v[28:31], v[144:159]
    buffer_load_dwordx4 a[84:87], v89, s[96:99], s33 offen offset:1024 sc1
    buffer_load_dwordx4 a[88:91], v90, s[96:99], s33 offen offset:1024 sc1
    buffer_load_dwordx4 a[92:95], v91, s[96:99], s33 offen offset:1024 sc1
    ds_read_b128 a[244:247], v5 offset:22528
    s_waitcnt lgkmcnt(5)
    v_mfma_f32_32x32x16_bf16 v[56:71], a[224:227], v[32:35], v[56:71]
    buffer_load_dwordx4 a[96:99], v88, s[96:99], s33 offen offset:2048 sc1
    buffer_load_dwordx4 a[100:103], v89, s[96:99], s33 offen offset:2048 sc1
    ds_read_b128 a[248:251], v5 offset:7168
    s_waitcnt lgkmcnt(5)
    v_mfma_f32_32x32x16_bf16 v[72:87], a[228:231], v[32:35], v[72:87]
    buffer_load_dwordx4 a[104:107], v90, s[96:99], s33 offen offset:2048 sc1
    ds_read_b128 a[252:255], v5 offset:23552
    s_waitcnt lgkmcnt(5)
    v_mfma_f32_32x32x16_bf16 v[56:71], a[232:235], v[36:39], v[56:71]
    buffer_load_dwordx4 a[108:111], v91, s[96:99], s33 offen offset:2048 sc1
    ds_read_b128 a[224:227], v5 offset:12288
    s_waitcnt lgkmcnt(5)
    v_mfma_f32_32x32x16_bf16 v[72:87], a[236:239], v[36:39], v[72:87]
    buffer_load_dwordx4 a[112:115], v88, s[96:99], s33 offen offset:3072 sc1
    ds_read_b128 a[228:231], v5 offset:28672
    s_waitcnt lgkmcnt(5)
    v_mfma_f32_32x32x16_bf16 v[56:71], a[240:243], v[40:43], v[56:71]
    buffer_load_dwordx4 a[116:119], v89, s[96:99], s33 offen offset:3072 sc1
    ds_read_b128 a[232:235], v5 offset:13312
    s_waitcnt lgkmcnt(5)
    v_mfma_f32_32x32x16_bf16 v[72:87], a[244:247], v[40:43], v[72:87]
    buffer_load_dwordx4 a[120:123], v90, s[96:99], s33 offen offset:3072 sc1
    ds_read_b128 a[236:239], v5 offset:29696
    s_waitcnt lgkmcnt(5)
    v_mfma_f32_32x32x16_bf16 v[56:71], a[248:251], v[44:47], v[56:71]
    buffer_load_dwordx4 a[124:127], v91, s[96:99], s33 offen offset:3072 sc1
    ds_read_b128 a[240:243], v5 offset:14336
    s_waitcnt lgkmcnt(5)
    v_mfma_f32_32x32x16_bf16 v[72:87], a[252:255], v[44:47], v[72:87]
    s_add_u32 s33, s33, 4096
    s_add_u32 s16, s8, 0xa00000
    s_addc_u32 s17, s9, 0
    s_mov_b32 s18, 0x242000
    s_mov_b32 s19, 0x20000
    s_lshl_b32 s45, s44, 13
    s_add_u32 s46, s45, 4096
    ds_read_b128 a[244:247], v5 offset:30720
    s_waitcnt lgkmcnt(5)
    v_mfma_f32_32x32x16_bf16 v[128:143], a[224:227], v[32:35], v[128:143]
    ds_read_b128 a[248:251], v5 offset:15360
    s_waitcnt lgkmcnt(5)
    v_mfma_f32_32x32x16_bf16 v[144:159], a[228:231], v[32:35], v[144:159]
    ds_read_b128 a[252:255], v5 offset:31744
    s_waitcnt lgkmcnt(5)
    v_mfma_f32_32x32x16_bf16 v[128:143], a[232:235], v[36:39], v[128:143]
    s_waitcnt lgkmcnt(4)
    v_mfma_f32_32x32x16_bf16 v[144:159], a[236:239], v[36:39], v[144:159]
    v_cvt_pk_bf16_f32 v96, v56, -v72
    v_cvt_pk_bf16_f32 v97, v57, -v73
    v_cvt_pk_bf16_f32 v98, v58, -v74
    v_cvt_pk_bf16_f32 v99, v59, -v75
    v_cvt_pk_bf16_f32 v100, v60, -v76
    s_waitcnt lgkmcnt(3)
    v_mfma_f32_32x32x16_bf16 v[128:143], a[240:243], v[40:43], v[128:143]
    buffer_store_dword v96, v1, s[16:19], s45 offen offset:0 sc1
    v_cvt_pk_bf16_f32 v101, v61, -v77
    buffer_store_dword v97, v1, s[16:19], s45 offen offset:128 sc1
    v_cvt_pk_bf16_f32 v102, v62, -v78
    buffer_store_dword v98, v1, s[16:19], s45 offen offset:256 sc1
    s_waitcnt lgkmcnt(2)
    v_mfma_f32_32x32x16_bf16 v[144:159], a[244:247], v[40:43], v[144:159]
    v_cvt_pk_bf16_f32 v103, v63, -v79
    buffer_store_dword v99, v1, s[16:19], s45 offen offset:384 sc1
    v_cvt_pk_bf16_f32 v104, v64, -v80
    buffer_store_dword v100, v1, s[16:19], s45 offen offset:1024 sc1
    v_cvt_pk_bf16_f32 v105, v65, -v81
    s_waitcnt lgkmcnt(1)
    v_mfma_f32_32x32x16_bf16 v[128:143], a[248:251], v[44:47], v[128:143]
    buffer_store_dword v101, v1, s[16:19], s45 offen offset:1152 sc1
    v_cvt_pk_bf16_f32 v106, v66, -v82
    buffer_store_dword v102, v1, s[16:19], s45 offen offset:1280 sc1
    v_cvt_pk_bf16_f32 v107, v67, -v83
    buffer_store_dword v103, v1, s[16:19], s45 offen offset:1408 sc1
    s_waitcnt lgkmcnt(0)
    v_mfma_f32_32x32x16_bf16 v[144:159], a[252:255], v[44:47], v[144:159]
    v_cvt_pk_bf16_f32 v108, v68, -v84
    buffer_store_dword v104, v1, s[16:19], s45 offen offset:2048 sc1
    v_cvt_pk_bf16_f32 v109, v69, -v85
    buffer_store_dword v105, v1, s[16:19], s45 offen offset:2176 sc1
    v_cvt_pk_bf16_f32 v110, v70, -v86
    buffer_store_dword v106, v1, s[16:19], s45 offen offset:2304 sc1
    v_cvt_pk_bf16_f32 v111, v71, -v87
    buffer_store_dword v107, v1, s[16:19], s45 offen offset:2432 sc1
    buffer_store_dword v108, v1, s[16:19], s45 offen offset:3072 sc1
    buffer_store_dword v109, v1, s[16:19], s45 offen offset:3200 sc1
    buffer_store_dword v110, v1, s[16:19], s45 offen offset:3328 sc1
    buffer_store_dword v111, v1, s[16:19], s45 offen offset:3456 sc1
    v_cvt_pk_bf16_f32 v112, v128, -v144
    buffer_store_dword v112, v1, s[16:19], s46 offen offset:0 sc1
    v_cvt_pk_bf16_f32 v113, v129, -v145
    buffer_store_dword v113, v1, s[16:19], s46 offen offset:128 sc1
    v_cvt_pk_bf16_f32 v114, v130, -v146
    buffer_store_dword v114, v1, s[16:19], s46 offen offset:256 sc1
    v_cvt_pk_bf16_f32 v115, v131, -v147
    buffer_store_dword v115, v1, s[16:19], s46 offen offset:384 sc1
    v_cvt_pk_bf16_f32 v116, v132, -v148
    buffer_store_dword v116, v1, s[16:19], s46 offen offset:1024 sc1
    v_cvt_pk_bf16_f32 v117, v133, -v149
    buffer_store_dword v117, v1, s[16:19], s46 offen offset:1152 sc1
    v_cvt_pk_bf16_f32 v118, v134, -v150
    buffer_store_dword v118, v1, s[16:19], s46 offen offset:1280 sc1
    v_cvt_pk_bf16_f32 v119, v135, -v151
    buffer_store_dword v119, v1, s[16:19], s46 offen offset:1408 sc1
    v_cvt_pk_bf16_f32 v120, v136, -v152
    buffer_store_dword v120, v1, s[16:19], s46 offen offset:2048 sc1
    v_cvt_pk_bf16_f32 v121, v137, -v153
    buffer_store_dword v121, v1, s[16:19], s46 offen offset:2176 sc1
    v_cvt_pk_bf16_f32 v122, v138, -v154
    buffer_store_dword v122, v1, s[16:19], s46 offen offset:2304 sc1
    v_cvt_pk_bf16_f32 v123, v139, -v155
    buffer_store_dword v123, v1, s[16:19], s46 offen offset:2432 sc1
    v_cvt_pk_bf16_f32 v124, v140, -v156
    buffer_store_dword v124, v1, s[16:19], s46 offen offset:3072 sc1
    v_cvt_pk_bf16_f32 v125, v141, -v157
    s_waitcnt vmcnt(54)
    buffer_store_dword v125, v1, s[16:19], s46 offen offset:3200 sc1
    v_cvt_pk_bf16_f32 v126, v142, -v158
    buffer_store_dword v126, v1, s[16:19], s46 offen offset:3328 sc1
    v_cvt_pk_bf16_f32 v127, v143, -v159
    buffer_store_dword v127, v1, s[16:19], s46 offen offset:3456 sc1
    s_waitcnt vmcnt(0)
    s_lshl_b32 s46, s44, 2
    s_add_u32 s46, s46, 32768
    s_mov_b64 s[6:7], exec
    s_mov_b64 exec, 1
    v_mov_b32 v4, s39
    v_mov_b32 v5, 0
    buffer_store_dword v4, v5, s[76:79], s46 offen sc1
    s_mov_b64 exec, s[6:7]
    s_branch FK_fftd
FK_nofft:
    s_mov_b32 s91, -1
    buffer_load_dwordx4 a[0:3], v88, s[96:99], s33 offen offset:0 sc1
    buffer_load_dwordx4 a[4:7], v89, s[96:99], s33 offen offset:0 sc1
    buffer_load_dwordx4 a[8:11], v90, s[96:99], s33 offen offset:0 sc1
    buffer_load_dwordx4 a[12:15], v91, s[96:99], s33 offen offset:0 sc1
    buffer_load_dwordx4 a[16:19], v88, s[96:99], s33 offen offset:1024 sc1
    buffer_load_dwordx4 a[20:23], v89, s[96:99], s33 offen offset:1024 sc1
    buffer_load_dwordx4 a[24:27], v90, s[96:99], s33 offen offset:1024 sc1
    buffer_load_dwordx4 a[28:31], v91, s[96:99], s33 offen offset:1024 sc1
    buffer_load_dwordx4 a[32:35], v88, s[96:99], s33 offen offset:2048 sc1
    buffer_load_dwordx4 a[36:39], v89, s[96:99], s33 offen offset:2048 sc1
    buffer_load_dwordx4 a[40:43], v90, s[96:99], s33 offen offset:2048 sc1
    buffer_load_dwordx4 a[44:47], v91, s[96:99], s33 offen offset:2048 sc1
    buffer_load_dwordx4 a[48:51], v88, s[96:99], s33 offen offset:3072 sc1
    buffer_load_dwordx4 a[52:55], v89, s[96:99], s33 offen offset:3072 sc1
    buffer_load_dwordx4 a[56:59], v90, s[96:99], s33 offen offset:3072 sc1
    buffer_load_dwordx4 a[60:63], v91, s[96:99], s33 offen offset:3072 sc1
    s_add_u32 s33, s33, 4096
    buffer_load_dwordx4 a[64:67], v88, s[96:99], s33 offen offset:0 sc1
    buffer_load_dwordx4 a[68:71], v89, s[96:99], s33 offen offset:0 sc1
    buffer_load_dwordx4 a[72:75], v90, s[96:99], s33 offen offset:0 sc1
    buffer_load_dwordx4 a[76:79], v91, s[96:99], s33 offen offset:0 sc1
    buffer_load_dwordx4 a[80:83], v88, s[96:99], s33 offen offset:1024 sc1
    buffer_load_dwordx4 a[84:87], v89, s[96:99], s33 offen offset:1024 sc1
    buffer_load_dwordx4 a[88:91], v90, s[96:99], s33 offen offset:1024 sc1
    buffer_load_dwordx4 a[92:95], v91, s[96:99], s33 offen offset:1024 sc1
    buffer_load_dwordx4 a[96:99], v88, s[96:99], s33 offen offset:2048 sc1
    buffer_load_dwordx4 a[100:103], v89, s[96:99], s33 offen offset:2048 sc1
    buffer_load_dwordx4 a[104:107], v90, s[96:99], s33 offen offset:2048 sc1
    buffer_load_dwordx4 a[108:111], v91, s[96:99], s33 offen offset:2048 sc1
    buffer_load_dwordx4 a[112:115], v88, s[96:99], s33 offen offset:3072 sc1
    buffer_load_dwordx4 a[116:119], v89, s[96:99], s33 offen offset:3072 sc1
    buffer_load_dwordx4 a[120:123], v90, s[96:99], s33 offen offset:3072 sc1
    buffer_load_dwordx4 a[124:127], v91, s[96:99], s33 offen offset:3072 sc1
    s_add_u32 s33, s33, 4096
    s_mul_i32 s50, s40, 18
    s_add_u32 s50, s50, s43
    s_add_u32 s84, s8, 0x300000
    s_addc_u32 s85, s9, 0
    s_mov_b32 s86, 0xa2000
    s_mov_b32 s87, 0x20000
    s_mov_b32 s44, 0x3ae38e39
    s_mov_b32 s45, 0xc4100000
    s_lshl_b32 s46, s3, 6
    s_mul_i32 s47, s50, 1152
    v_add_u32 v101, s46, v0
    v_mov_b32 v113, 0x3e800000
    v_add_u32 v103, 0, v101
    v_add_u32 v102, s47, v103
    v_lshlrev_b32 v122, 2, v102
    v_and_b32 v104, 3, v102
    v_bfe_u32 v105, v102, 2, 6
    v_lshrrev_b32 v106, 8, v102
    v_mul_u32_u24 v107, 7282, v106
    v_lshrrev_b32 v107, 16, v107
    v_mul_u32_u24 v108, 9, v107
    v_sub_u32 v108, v106, v108
    v_mul_u32_u24 v109, 3641, v107
    v_lshrrev_b32 v109, 16, v109
    v_mul_u32_u24 v110, 18, v109
    v_sub_u32 v110, v107, v110
    v_lshrrev_b32 v111, 4, v105
    v_lshlrev_b32 v110, 4, v110
    v_lshl_add_u32 v110, v111, 2, v110
    v_add_u32 v110, v110, v104
    v_mul_u32_u24 v111, 80, v109
    v_add_u32 v111, 256, v111
    v_lshlrev_b32 v112, 6, v109
    v_subrev_u32 v112, 80, v112
    v_cmp_gt_u32 vcc, 5, v108
    s_nop 1
    v_cndmask_b32 v111, v112, v111, vcc
    v_lshl_add_u32 v111, v108, 4, v111
    v_and_b32 v112, 15, v105
    v_add_u32 v111, v111, v112
    v_cvt_f32_u32 v109, v111
    v_cvt_f32_u32 v111, v110
    v_mov_b32 v112, 0.5
    v_cmp_eq_u32 vcc, 0, v110
    v_mov_b32 v114, 0x43900000
    s_nop 0
    v_cndmask_b32 v115, v111, v114, vcc
    v_cndmask_b32 v112, v112, v113, vcc
    v_mul_f32 v116, v111, v109
    v_mul_f32 v117, s44, v116
    v_floor_f32 v117, v117
    v_fma_f32 v116, v117, s45, v116
    v_fma_f32 v116, v116, s44, v113
    v_sin_f32 v120, v116
    v_mul_f32 v118, v115, v109
    v_mul_f32 v119, s44, v118
    v_floor_f32 v119, v119
    v_fma_f32 v118, v119, s45, v118
    v_fma_f32 v118, v118, s44, v112
    v_sin_f32 v121, v118
    s_nop 0
    v_cvt_pk_bf16_f32 v120, v120, v121
    buffer_store_dword v120, v122, s[84:87], 0 offen sc1
    v_add_u32 v103, 256, v101
    v_add_u32 v102, s47, v103
    v_lshlrev_b32 v122, 2, v102
    v_and_b32 v104, 3, v102
    v_bfe_u32 v105, v102, 2, 6
    v_lshrrev_b32 v106, 8, v102
    v_mul_u32_u24 v107, 7282, v106
    v_lshrrev_b32 v107, 16, v107
    v_mul_u32_u24 v108, 9, v107
    v_sub_u32 v108, v106, v108
    v_mul_u32_u24 v109, 3641, v107
    v_lshrrev_b32 v109, 16, v109
    v_mul_u32_u24 v110, 18, v109
    v_sub_u32 v110, v107, v110
    v_lshrrev_b32 v111, 4, v105
    v_lshlrev_b32 v110, 4, v110
    v_lshl_add_u32 v110, v111, 2, v110
    v_add_u32 v110, v110, v104
    v_mul_u32_u24 v111, 80, v109
    v_add_u32 v111, 256, v111
    v_lshlrev_b32 v112, 6, v109
    v_subrev_u32 v112, 80, v112
    v_cmp_gt_u32 vcc, 5, v108
    s_nop 1
    v_cndmask_b32 v111, v112, v111, vcc
    v_lshl_add_u32 v111, v108, 4, v111
    v_and_b32 v112, 15, v105
    v_add_u32 v111, v111, v112
    v_cvt_f32_u32 v109, v111
    v_cvt_f32_u32 v111, v110
    v_mov_b32 v112, 0.5
    v_cmp_eq_u32 vcc, 0, v110
    v_mov_b32 v114, 0x43900000
    s_nop 0
    v_cndmask_b32 v115, v111, v114, vcc
    v_cndmask_b32 v112, v112, v113, vcc
    v_mul_f32 v116, v111, v109
    v_mul_f32 v117, s44, v116
    v_floor_f32 v117, v117
    v_fma_f32 v116, v117, s45, v116
    v_fma_f32 v116, v116, s44, v113
    v_sin_f32 v120, v116
    v_mul_f32 v118, v115, v109
    v_mul_f32 v119, s44, v118
    v_floor_f32 v119, v119
    v_fma_f32 v118, v119, s45, v118
    v_fma_f32 v118, v118, s44, v112
    v_sin_f32 v121, v118
    s_nop 0
    v_cvt_pk_bf16_f32 v120, v120, v121
    buffer_store_dword v120, v122, s[84:87], 0 offen sc1
    v_add_u32 v103, 512, v101
    v_add_u32 v102, s47, v103
    v_lshlrev_b32 v122, 2, v102
    v_and_b32 v104, 3, v102
    v_bfe_u32 v105, v102, 2, 6
    v_lshrrev_b32 v106, 8, v102
    v_mul_u32_u24 v107, 7282, v106
    v_lshrrev_b32 v107, 16, v107
    v_mul_u32_u24 v108, 9, v107
    v_sub_u32 v108, v106, v108
    v_mul_u32_u24 v109, 3641, v107
    v_lshrrev_b32 v109, 16, v109
    v_mul_u32_u24 v110, 18, v109
    v_sub_u32 v110, v107, v110
    v_lshrrev_b32 v111, 4, v105
    v_lshlrev_b32 v110, 4, v110
    v_lshl_add_u32 v110, v111, 2, v110
    v_add_u32 v110, v110, v104
    v_mul_u32_u24 v111, 80, v109
    v_add_u32 v111, 256, v111
    v_lshlrev_b32 v112, 6, v109
    v_subrev_u32 v112, 80, v112
    v_cmp_gt_u32 vcc, 5, v108
    s_nop 1
    v_cndmask_b32 v111, v112, v111, vcc
    v_lshl_add_u32 v111, v108, 4, v111
    v_and_b32 v112, 15, v105
    v_add_u32 v111, v111, v112
    v_cvt_f32_u32 v109, v111
    v_cvt_f32_u32 v111, v110
    v_mov_b32 v112, 0.5
    v_cmp_eq_u32 vcc, 0, v110
    v_mov_b32 v114, 0x43900000
    s_nop 0
    v_cndmask_b32 v115, v111, v114, vcc
    v_cndmask_b32 v112, v112, v113, vcc
    v_mul_f32 v116, v111, v109
    v_mul_f32 v117, s44, v116
    v_floor_f32 v117, v117
    v_fma_f32 v116, v117, s45, v116
    v_fma_f32 v116, v116, s44, v113
    v_sin_f32 v120, v116
    v_mul_f32 v118, v115, v109
    v_mul_f32 v119, s44, v118
    v_floor_f32 v119, v119
    v_fma_f32 v118, v119, s45, v118
    v_fma_f32 v118, v118, s44, v112
    v_sin_f32 v121, v118
    s_nop 0
    v_cvt_pk_bf16_f32 v120, v120, v121
    buffer_store_dword v120, v122, s[84:87], 0 offen sc1
    v_add_u32 v103, 768, v101
    v_add_u32 v102, s47, v103
    v_lshlrev_b32 v122, 2, v102
    v_and_b32 v104, 3, v102
    v_bfe_u32 v105, v102, 2, 6
    v_lshrrev_b32 v106, 8, v102
    v_mul_u32_u24 v107, 7282, v106
    v_lshrrev_b32 v107, 16, v107
    v_mul_u32_u24 v108, 9, v107
    v_sub_u32 v108, v106, v108
    v_mul_u32_u24 v109, 3641, v107
    v_lshrrev_b32 v109, 16, v109
    v_mul_u32_u24 v110, 18, v109
    v_sub_u32 v110, v107, v110
    v_lshrrev_b32 v111, 4, v105
    v_lshlrev_b32 v110, 4, v110
    v_lshl_add_u32 v110, v111, 2, v110
    v_add_u32 v110, v110, v104
    v_mul_u32_u24 v111, 80, v109
    v_add_u32 v111, 256, v111
    v_lshlrev_b32 v112, 6, v109
    v_subrev_u32 v112, 80, v112
    v_cmp_gt_u32 vcc, 5, v108
    s_nop 1
    v_cndmask_b32 v111, v112, v111, vcc
    v_lshl_add_u32 v111, v108, 4, v111
    v_and_b32 v112, 15, v105
    v_add_u32 v111, v111, v112
    v_cvt_f32_u32 v109, v111
    v_cvt_f32_u32 v111, v110
    v_mov_b32 v112, 0.5
    v_cmp_eq_u32 vcc, 0, v110
    v_mov_b32 v114, 0x43900000
    s_nop 0
    v_cndmask_b32 v115, v111, v114, vcc
    v_cndmask_b32 v112, v112, v113, vcc
    v_mul_f32 v116, v111, v109
    v_mul_f32 v117, s44, v116
    v_floor_f32 v117, v117
    v_fma_f32 v116, v117, s45, v116
    v_fma_f32 v116, v116, s44, v113
    v_sin_f32 v120, v116
    v_mul_f32 v118, v115, v109
    v_mul_f32 v119, s44, v118
    v_floor_f32 v119, v119
    v_fma_f32 v118, v119, s45, v118
    v_fma_f32 v118, v118, s44, v112
    v_sin_f32 v121, v118
    s_nop 0
    v_cvt_pk_bf16_f32 v120, v120, v121
    buffer_store_dword v120, v122, s[84:87], 0 offen sc1
    v_add_u32 v103, 1024, v101
    v_add_u32 v102, s47, v103
    v_lshlrev_b32 v122, 2, v102
    v_cmp_gt_u32 vcc, 1152, v103
    v_mov_b32 v123, -1
    s_nop 0
    v_cndmask_b32 v122, v123, v122, vcc
    v_and_b32 v104, 3, v102
    v_bfe_u32 v105, v102, 2, 6
    v_lshrrev_b32 v106, 8, v102
    v_mul_u32_u24 v107, 7282, v106
    v_lshrrev_b32 v107, 16, v107
    v_mul_u32_u24 v108, 9, v107
    v_sub_u32 v108, v106, v108
    v_mul_u32_u24 v109, 3641, v107
    v_lshrrev_b32 v109, 16, v109
    v_mul_u32_u24 v110, 18, v109
    v_sub_u32 v110, v107, v110
    v_lshrrev_b32 v111, 4, v105
    v_lshlrev_b32 v110, 4, v110
    v_lshl_add_u32 v110, v111, 2, v110
    v_add_u32 v110, v110, v104
    v_mul_u32_u24 v111, 80, v109
    v_add_u32 v111, 256, v111
    v_lshlrev_b32 v112, 6, v109
    v_subrev_u32 v112, 80, v112
    v_cmp_gt_u32 vcc, 5, v108
    s_nop 1
    v_cndmask_b32 v111, v112, v111, vcc
    v_lshl_add_u32 v111, v108, 4, v111
    v_and_b32 v112, 15, v105
    v_add_u32 v111, v111, v112
    v_cvt_f32_u32 v109, v111
    v_cvt_f32_u32 v111, v110
    v_mov_b32 v112, 0.5
    v_cmp_eq_u32 vcc, 0, v110
    v_mov_b32 v114, 0x43900000
    s_nop 0
    v_cndmask_b32 v115, v111, v114, vcc
    v_cndmask_b32 v112, v112, v113, vcc
    v_mul_f32 v116, v111, v109
    v_mul_f32 v117, s44, v116
    v_floor_f32 v117, v117
    v_fma_f32 v116, v117, s45, v116
    v_fma_f32 v116, v116, s44, v113
    v_sin_f32 v120, v116
    v_mul_f32 v118, v115, v109
    v_mul_f32 v119, s44, v118
    v_floor_f32 v119, v119
    v_fma_f32 v118, v119, s45, v118
    v_fma_f32 v118, v118, s44, v112
    v_sin_f32 v121, v118
    s_nop 0
    v_cvt_pk_bf16_f32 v120, v120, v121
    buffer_store_dword v120, v122, s[84:87], 0 offen sc1
FK_fftd:
    s_mov_b32 s4, s72
    s_mov_b32 s5, s73
    s_mov_b32 s12, s4
    s_mov_b32 s13, s5
    s_mov_b32 s14, 0x510000
    s_mov_b32 s15, 0x20000
    s_mul_i32 s44, s41, 576
    s_lshl_b32 s45, s3, 5
    s_add_u32 s52, s44, s45
    s_add_u32 s53, s52, 128
    s_lshr_b32 s46, s3, 1
    s_mul_i32 s46, s46, 80
    s_and_b32 s47, s3, 1
    s_lshl_b32 s47, s47, 5
    s_add_u32 s54, s44, s46
    s_add_u32 s54, s54, s47
    s_add_u32 s54, s54, 256
    s_add_u32 s55, s54, 160
    s_mul_i32 s46, s3, 160
    s_add_u32 s56, s44, s46
    s_add_u32 s56, s56, 320
    s_mul_i32 s52, s52, 1152
    s_mul_i32 s53, s53, 1152
    s_mul_i32 s54, s54, 1152
    s_mul_i32 s55, s55, 1152
    s_mul_i32 s56, s56, 1152
    s_mul_i32 s57, s42, 160
    s_add_u32 s57, s57, 512
    s_lshl_b32 s58, s42, 7
    v_add_u32 v2, 0, v0
    v_mul_u32_u24 v3, 6554, v2
    v_lshrrev_b32 v3, 16, v3
    v_mul_u32_u24 v4, 10, v3
    v_sub_u32 v4, v2, v4
    v_mul_u32_u24 v5, 1152, v3
    v_lshl_add_u32 v10, v4, 4, v5
    v_add_u32 v2, 64, v0
    v_mul_u32_u24 v3, 6554, v2
    v_lshrrev_b32 v3, 16, v3
    v_mul_u32_u24 v4, 10, v3
    v_sub_u32 v4, v2, v4
    v_mul_u32_u24 v5, 1152, v3
    v_lshl_add_u32 v11, v4, 4, v5
    v_add_u32 v2, 128, v0
    v_mul_u32_u24 v3, 6554, v2
    v_lshrrev_b32 v3, 16, v3
    v_mul_u32_u24 v4, 10, v3
    v_sub_u32 v4, v2, v4
    v_mul_u32_u24 v5, 1152, v3
    v_lshl_add_u32 v12, v4, 4, v5
    v_add_u32 v2, 192, v0
    v_mul_u32_u24 v3, 6554, v2
    v_lshrrev_b32 v3, 16, v3
    v_mul_u32_u24 v4, 10, v3
    v_sub_u32 v4, v2, v4
    v_mul_u32_u24 v5, 1152, v3
    v_lshl_add_u32 v13, v4, 4, v5
    v_add_u32 v2, 256, v0
    v_mul_u32_u24 v3, 6554, v2
    v_lshrrev_b32 v3, 16, v3
    v_mul_u32_u24 v4, 10, v3
    v_sub_u32 v4, v2, v4
    v_mul_u32_u24 v5, 1152, v3
    v_lshl_add_u32 v14, v4, 4, v5
    s_mul_i32 s34, s3, 5120
    s_mov_b32 s12, s4
    s_mov_b32 s13, s5
    s_mov_b32 s14, 0x510000
    s_mov_b32 s15, 0x20000
    s_mov_b32 s24, s4
    s_mov_b32 s25, s5
    s_cmp_lt_u32 s3, 2
    s_mov_b32 s26, 0
    s_mov_b32 s47, 0x510000
    s_cselect_b32 s26, s47, s26
    s_mov_b32 s27, 0x20000
    s_add_u32 s16, s8, 0x2400000
    s_addc_u32 s17, s9, 0
    s_mov_b32 s18, 0x1200000
    s_mov_b32 s19, 0x20000
    v_add_u32 v2, 0, v0
    v_cmp_le_u32 vcc, 160, v2
    v_mov_b32 v6, 73728
    s_nop 0
    v_cndmask_b32 v6, 0, v6, vcc
    v_add_u32 v15, v10, v6
    v_add_u32 v2, 64, v0
    v_cmp_le_u32 vcc, 160, v2
    v_mov_b32 v6, 73728
    s_nop 0
    v_cndmask_b32 v6, 0, v6, vcc
    v_add_u32 v16, v11, v6
    v_add_u32 v2, 128, v0
    v_cmp_le_u32 vcc, 160, v2
    v_mov_b32 v6, 73728
    s_nop 0
    v_cndmask_b32 v6, 0, v6, vcc
    v_add_u32 v17, v12, v6
    v_add_u32 v2, 192, v0
    v_cmp_le_u32 vcc, 160, v2
    v_mov_b32 v6, 73728
    s_nop 0
    v_cndmask_b32 v6, 0, v6, vcc
    v_add_u32 v18, v13, v6
    v_add_u32 v2, 256, v0
    v_cmp_le_u32 vcc, 160, v2
    v_mov_b32 v6, 73728
    s_nop 0
    v_cndmask_b32 v6, 0, v6, vcc
    v_add_u32 v19, v14, v6
    v_lshrrev_b32 v2, 3, v0
    v_bfe_u32 v3, v0, 1, 2
    v_bfe_u32 v4, v0, 4, 2
    v_xor_b32 v3, v3, v4
    v_and_b32 v4, 1, v0
    v_lshlrev_b32 v3, 5, v3
    v_lshl_add_u32 v3, v4, 4, v3
    v_mul_u32_u24 v2, 1152, v2
    v_add_u32 v20, v2, v3
    v_add_u32 v21, 9216, v20
    v_add_u32 v22, 9216, v21
    v_add_u32 v23, 9216, v22
    v_mov_b32 v24, v20
    v_mov_b32 v25, v21
    v_add_u32 v26, 73728, v22
    v_add_u32 v27, 73728, v23
    v_lshrrev_b32 v2, 4, v0
    v_bfe_u32 v3, v0, 2, 2
    v_lshl_add_u32 v2, v2, 2, v3
    v_and_b32 v3, 3, v0
    v_lshlrev_b32 v3, 3, v3
    v_mul_u32_u24 v32, 160, v2
    v_add_u32 v32, v32, v3
    v_add_u32 v33, 61440, v32
    v_bfe_u32 v4, v2, 1, 2
    v_lshlrev_b32 v5, 7, v2
    v_add_u32 v5, v5, v3
    v_xor_b32 v7, 0, v4
    v_lshl_add_u32 v34, v7, 5, v5
    v_add_u32 v38, 61440, v34
    v_xor_b32 v7, 1, v4
    v_lshl_add_u32 v35, v7, 5, v5
    v_add_u32 v39, 61440, v35
    v_xor_b32 v7, 2, v4
    v_lshl_add_u32 v36, v7, 5, v5
    v_add_u32 v40, 61440, v36
    v_xor_b32 v7, 3, v4
    v_lshl_add_u32 v37, v7, 5, v5
    v_add_u32 v41, 61440, v37
    s_lshl_b32 s35, s3, 12
    s_add_u32 s96, s8, 0x1000000
    s_addc_u32 s97, s9, 0
    s_mov_b32 s98, 0x1200000
    s_mov_b32 s99, 0x20000
    v_lshlrev_b32 v6, 4, v0
    s_mul_i32 s45, s3, 589824
    v_add_u32 v28, s45, v6
    v_add_u32 v29, 147456, v28
    v_add_u32 v30, 147456, v29
    v_add_u32 v31, 147456, v30
    s_mul_i32 s33, s40, 2359296
    s_mul_i32 s45, s41, 18432
    s_add_u32 s33, s33, s45
    s_add_u32 s33, s33, 8192
    s_waitcnt vmcnt(0)
    s_barrier
    s_cmp_eq_u32 s3, 0
    s_cbranch_scc0 FK_h1
    s_cmp_ge_u32 s43, 18
    s_cbranch_scc1 FK_h0
    s_mul_i32 s50, s40, 18
    s_add_u32 s50, s50, s43
    s_lshl_b32 s46, s50, 2
    s_add_u32 s46, s46, 40960
    s_mov_b64 s[6:7], exec
    s_mov_b64 exec, 1
    v_mov_b32 v4, s39
    v_mov_b32 v5, 0
    buffer_store_dword v4, v5, s[76:79], s46 offen sc1
    s_mov_b64 exec, s[6:7]
FK_h0:
    s_lshl_b32 s46, s40, 3
    s_add_u32 s46, s46, s41
    s_lshl_b32 s46, s46, 7
    s_add_u32 s46, s46, 20480
    v_min_u32 v3, 7, v0
    v_lshlrev_b32 v3, 2, v3
    v_add_u32 v3, s46, v3
    s_mov_b32 s5, 0
FK_sh_l:
    buffer_load_dword v4, v3, s[76:79], 0 offen sc1
    s_waitcnt vmcnt(0)
FK_sh_c:
    v_xor_b32 v2, s39, v4
    v_cmp_ne_u32 vcc, 0, v2
    s_add_u32 s5, s5, 1
    s_cmp_ge_u32 s5, 20000
    s_cbranch_scc1 FK_sh_x
    s_nop 0
    s_cmp_eq_u64 vcc, 0
    s_cbranch_scc1 FK_sh_x
    s_sleep 1
    s_branch FK_sh_l
FK_sh_x:
FK_h1:
    s_add_u32 s80, s8, 0xa00000
    s_addc_u32 s81, s9, 0
    s_mov_b32 s82, 0x242000
    s_mov_b32 s83, 0x20000
    s_add_u32 s84, s8, 0x300000
    s_addc_u32 s85, s9, 0
    s_mov_b32 s86, 0xa2000
    s_mov_b32 s87, 0x20000
    v_min_u32 v42, 63, v0
    v_lshlrev_b32 v42, 4, v42
    v_add_u32 v42, 32768, v42
    v_min_u32 v43, 32, v0
    v_lshlrev_b32 v43, 2, v43
    v_add_u32 v43, 33792, v43
    v_min_u32 v44, 35, v0
    v_lshlrev_b32 v44, 4, v44
    v_add_u32 v44, 40960, v44
    s_lshl_b32 s46, s40, 2
    s_add_u32 s46, s46, s42
    s_lshl_b32 s46, s46, 7
    s_add_u32 s46, s46, 49152
    v_min_u32 v45, 7, v0
    v_lshlrev_b32 v45, 2, v45
    v_add_u32 v45, s46, v45
    s_barrier
    s_lshl_b32 s45, s40, 2
    s_add_u32 s45, s45, s42
    s_lshl_b32 s45, s45, 3
    s_lshl_b32 s46, s3, 1
    s_add_u32 s45, s45, s46
    s_lshl_b32 s45, s45, 3
    s_add_u32 s45, s45, s41
    s_mul_i32 s50, s45, 9216
    v_lshlrev_b32 v1, 4, v0
    v_lshlrev_b32 v2, 3, v0
    ds_read_b64_tr_b16 v[48:49], v32 offset:20480
    ds_read_b64_tr_b16 v[50:51], v32 offset:23040
    ds_read_b64_tr_b16 v[52:53], v32 offset:20512
    ds_read_b64_tr_b16 v[54:55], v32 offset:23072
    ds_read_b64_tr_b16 v[56:57], v32 offset:20544
    ds_read_b64_tr_b16 v[58:59], v32 offset:23104
    s_waitcnt lgkmcnt(4)
    v_mfma_f32_16x16x32_bf16 v[96:99], v[48:51], a[0:3], 0
    ds_read_b64_tr_b16 v[60:61], v32 offset:20576
    v_mfma_f32_16x16x32_bf16 v[100:103], v[48:51], a[4:7], 0
    ds_read_b64_tr_b16 v[62:63], v32 offset:23136
    v_mfma_f32_16x16x32_bf16 v[104:107], v[48:51], a[8:11], 0
    v_mfma_f32_16x16x32_bf16 v[108:111], v[48:51], a[12:15], 0
    s_barrier
    s_waitcnt lgkmcnt(4)
    v_mfma_f32_16x16x32_bf16 v[112:115], v[52:55], a[0:3], 0
    ds_read_b64_tr_b16 v[48:49], v32 offset:20608
    v_mfma_f32_16x16x32_bf16 v[116:119], v[52:55], a[4:7], 0
    ds_read_b64_tr_b16 v[50:51], v32 offset:23168
    v_mfma_f32_16x16x32_bf16 v[120:123], v[52:55], a[8:11], 0
    s_add_u32 s32, s55, s57
    s_add_u32 m0, s34, 0
    v_mfma_f32_16x16x32_bf16 v[124:127], v[52:55], a[12:15], 0
    buffer_load_dwordx4 v10, s[12:15], s32 offen lds
    s_waitcnt lgkmcnt(4)
    v_mfma_f32_16x16x32_bf16 v[128:131], v[56:59], a[0:3], 0
    ds_read_b64_tr_b16 v[52:53], v32 offset:25600
    v_mfma_f32_16x16x32_bf16 v[132:135], v[56:59], a[4:7], 0
    ds_read_b64_tr_b16 v[54:55], v32 offset:28160
    v_mfma_f32_16x16x32_bf16 v[136:139], v[56:59], a[8:11], 0
    s_add_u32 m0, s34, 1024
    v_mfma_f32_16x16x32_bf16 v[140:143], v[56:59], a[12:15], 0
    buffer_load_dwordx4 v11, s[12:15], s32 offen lds
    s_waitcnt lgkmcnt(4)
    v_mfma_f32_16x16x32_bf16 v[144:147], v[60:63], a[0:3], 0
    ds_read_b64_tr_b16 v[56:57], v32 offset:25632
    v_mfma_f32_16x16x32_bf16 v[148:151], v[60:63], a[4:7], 0
    ds_read_b64_tr_b16 v[58:59], v32 offset:28192
    v_mfma_f32_16x16x32_bf16 v[152:155], v[60:63], a[8:11], 0
    s_add_u32 m0, s34, 2048
    v_mfma_f32_16x16x32_bf16 v[156:159], v[60:63], a[12:15], 0
    buffer_load_dwordx4 v12, s[12:15], s32 offen lds
    s_waitcnt lgkmcnt(4)
    v_mfma_f32_16x16x32_bf16 v[160:163], v[48:51], a[0:3], 0
    ds_read_b64_tr_b16 v[60:61], v32 offset:25664
    v_mfma_f32_16x16x32_bf16 v[164:167], v[48:51], a[4:7], 0
    ds_read_b64_tr_b16 v[62:63], v32 offset:28224
    v_mfma_f32_16x16x32_bf16 v[168:171], v[48:51], a[8:11], 0
    s_add_u32 m0, s34, 3072
    v_mfma_f32_16x16x32_bf16 v[172:175], v[48:51], a[12:15], 0
    buffer_load_dwordx4 v13, s[12:15], s32 offen lds
    s_waitcnt lgkmcnt(4)
    v_mfma_f32_16x16x32_bf16 v[96:99], v[52:55], a[16:19], v[96:99]
    ds_read_b64_tr_b16 v[48:49], v32 offset:25696
    v_mfma_f32_16x16x32_bf16 v[100:103], v[52:55], a[20:23], v[100:103]
    ds_read_b64_tr_b16 v[50:51], v32 offset:28256
    v_mfma_f32_16x16x32_bf16 v[104:107], v[52:55], a[24:27], v[104:107]
    s_add_u32 m0, s34, 4096
    v_mfma_f32_16x16x32_bf16 v[108:111], v[52:55], a[28:31], v[108:111]
    buffer_load_dwordx4 v14, s[12:15], s32 offen lds
    s_waitcnt lgkmcnt(4)
    v_mfma_f32_16x16x32_bf16 v[112:115], v[56:59], a[16:19], v[112:115]
    ds_read_b64_tr_b16 v[52:53], v32 offset:25728
    v_mfma_f32_16x16x32_bf16 v[116:119], v[56:59], a[20:23], v[116:119]
    ds_read_b64_tr_b16 v[54:55], v32 offset:28288
    v_mfma_f32_16x16x32_bf16 v[120:123], v[56:59], a[24:27], v[120:123]
    buffer_load_dwordx4 a[128:131], v28, s[96:99], s33 offen offset:0 sc1
    v_mfma_f32_16x16x32_bf16 v[124:127], v[56:59], a[28:31], v[124:127]
    buffer_load_dwordx4 a[132:135], v29, s[96:99], s33 offen offset:0 sc1
    s_waitcnt lgkmcnt(4)
    v_mfma_f32_16x16x32_bf16 v[128:131], v[60:63], a[16:19], v[128:131]
    ds_read_b64_tr_b16 v[56:57], v32 offset:30720
    v_mfma_f32_16x16x32_bf16 v[132:135], v[60:63], a[20:23], v[132:135]
    ds_read_b64_tr_b16 v[58:59], v32 offset:33280
    v_mfma_f32_16x16x32_bf16 v[136:139], v[60:63], a[24:27], v[136:139]
    buffer_load_dwordx4 a[136:139], v30, s[96:99], s33 offen offset:0 sc1
    v_mfma_f32_16x16x32_bf16 v[140:143], v[60:63], a[28:31], v[140:143]
    buffer_load_dwordx4 a[140:143], v31, s[96:99], s33 offen offset:0 sc1
    s_waitcnt lgkmcnt(4)
    v_mfma_f32_16x16x32_bf16 v[144:147], v[48:51], a[16:19], v[144:147]
    ds_read_b64_tr_b16 v[60:61], v32 offset:30752
    v_mfma_f32_16x16x32_bf16 v[148:151], v[48:51], a[20:23], v[148:151]
    ds_read_b64_tr_b16 v[62:63], v32 offset:33312
    v_mfma_f32_16x16x32_bf16 v[152:155], v[48:51], a[24:27], v[152:155]
    buffer_load_dwordx4 a[144:147], v28, s[96:99], s33 offen offset:1024 sc1
    v_mfma_f32_16x16x32_bf16 v[156:159], v[48:51], a[28:31], v[156:159]
    s_waitcnt lgkmcnt(4)
    v_mfma_f32_16x16x32_bf16 v[160:163], v[52:55], a[16:19], v[160:163]
    ds_read_b64_tr_b16 v[48:49], v32 offset:30784
    v_mfma_f32_16x16x32_bf16 v[164:167], v[52:55], a[20:23], v[164:167]
    ds_read_b64_tr_b16 v[50:51], v32 offset:33344
    v_mfma_f32_16x16x32_bf16 v[168:171], v[52:55], a[24:27], v[168:171]
    buffer_load_dwordx4 a[148:151], v29, s[96:99], s33 offen offset:1024 sc1
    v_mfma_f32_16x16x32_bf16 v[172:175], v[52:55], a[28:31], v[172:175]
    s_waitcnt lgkmcnt(4)
    v_mfma_f32_16x16x32_bf16 v[96:99], v[56:59], a[32:35], v[96:99]
    ds_read_b64_tr_b16 v[52:53], v32 offset:30816
    v_mfma_f32_16x16x32_bf16 v[100:103], v[56:59], a[36:39], v[100:103]
    ds_read_b64_tr_b16 v[54:55], v32 offset:33376
    v_mfma_f32_16x16x32_bf16 v[104:107], v[56:59], a[40:43], v[104:107]
    buffer_load_dwordx4 a[152:155], v30, s[96:99], s33 offen offset:1024 sc1
    v_mfma_f32_16x16x32_bf16 v[108:111], v[56:59], a[44:47], v[108:111]
    s_waitcnt lgkmcnt(4)
    v_mfma_f32_16x16x32_bf16 v[112:115], v[60:63], a[32:35], v[112:115]
    ds_read_b64_tr_b16 v[56:57], v32 offset:30848
    v_mfma_f32_16x16x32_bf16 v[116:119], v[60:63], a[36:39], v[116:119]
    ds_read_b64_tr_b16 v[58:59], v32 offset:33408
    v_mfma_f32_16x16x32_bf16 v[120:123], v[60:63], a[40:43], v[120:123]
    buffer_load_dwordx4 a[156:159], v31, s[96:99], s33 offen offset:1024 sc1
    v_mfma_f32_16x16x32_bf16 v[124:127], v[60:63], a[44:47], v[124:127]
    s_waitcnt lgkmcnt(4)
    v_mfma_f32_16x16x32_bf16 v[128:131], v[48:51], a[32:35], v[128:131]
    ds_read_b64_tr_b16 v[60:61], v32 offset:35840
    v_mfma_f32_16x16x32_bf16 v[132:135], v[48:51], a[36:39], v[132:135]
    ds_read_b64_tr_b16 v[62:63], v32 offset:38400
    v_mfma_f32_16x16x32_bf16 v[136:139], v[48:51], a[40:43], v[136:139]
    buffer_load_dwordx4 a[160:163], v28, s[96:99], s33 offen offset:2048 sc1
    v_mfma_f32_16x16x32_bf16 v[140:143], v[48:51], a[44:47], v[140:143]
    s_waitcnt lgkmcnt(4)
    v_mfma_f32_16x16x32_bf16 v[144:147], v[52:55], a[32:35], v[144:147]
    ds_read_b64_tr_b16 v[48:49], v32 offset:35872
    v_mfma_f32_16x16x32_bf16 v[148:151], v[52:55], a[36:39], v[148:151]
    ds_read_b64_tr_b16 v[50:51], v32 offset:38432
    v_mfma_f32_16x16x32_bf16 v[152:155], v[52:55], a[40:43], v[152:155]
    buffer_load_dwordx4 a[164:167], v29, s[96:99], s33 offen offset:2048 sc1
    v_mfma_f32_16x16x32_bf16 v[156:159], v[52:55], a[44:47], v[156:159]
    buffer_load_dwordx4 a[168:171], v30, s[96:99], s33 offen offset:2048 sc1
    s_waitcnt lgkmcnt(4)
    v_mfma_f32_16x16x32_bf16 v[160:163], v[56:59], a[32:35], v[160:163]
    ds_read_b64_tr_b16 v[52:53], v32 offset:35904
    v_mfma_f32_16x16x32_bf16 v[164:167], v[56:59], a[36:39], v[164:167]
    ds_read_b64_tr_b16 v[54:55], v32 offset:38464
    v_mfma_f32_16x16x32_bf16 v[168:171], v[56:59], a[40:43], v[168:171]
    buffer_load_dwordx4 a[172:175], v31, s[96:99], s33 offen offset:2048 sc1
    v_mfma_f32_16x16x32_bf16 v[172:175], v[56:59], a[44:47], v[172:175]
    s_waitcnt lgkmcnt(4)
    v_mfma_f32_16x16x32_bf16 v[96:99], v[60:63], a[48:51], v[96:99]
    ds_read_b64_tr_b16 v[56:57], v32 offset:35936
    v_mfma_f32_16x16x32_bf16 v[100:103], v[60:63], a[52:55], v[100:103]
    ds_read_b64_tr_b16 v[58:59], v32 offset:38496
    v_mfma_f32_16x16x32_bf16 v[104:107], v[60:63], a[56:59], v[104:107]
    buffer_load_dwordx4 a[176:179], v28, s[96:99], s33 offen offset:3072 sc1
    v_mfma_f32_16x16x32_bf16 v[108:111], v[60:63], a[60:63], v[108:111]
    s_waitcnt lgkmcnt(4)
    v_mfma_f32_16x16x32_bf16 v[112:115], v[48:51], a[48:51], v[112:115]
    ds_read_b64_tr_b16 v[60:61], v32 offset:35968
    v_mfma_f32_16x16x32_bf16 v[116:119], v[48:51], a[52:55], v[116:119]
    ds_read_b64_tr_b16 v[62:63], v32 offset:38528
    v_mfma_f32_16x16x32_bf16 v[120:123], v[48:51], a[56:59], v[120:123]
    buffer_load_dwordx4 a[180:183], v29, s[96:99], s33 offen offset:3072 sc1
    v_mfma_f32_16x16x32_bf16 v[124:127], v[48:51], a[60:63], v[124:127]
    s_waitcnt lgkmcnt(4)
    v_mfma_f32_16x16x32_bf16 v[128:131], v[52:55], a[48:51], v[128:131]
    ds_read_b64_tr_b16 v[48:49], v32 offset:40960
    v_mfma_f32_16x16x32_bf16 v[132:135], v[52:55], a[52:55], v[132:135]
    ds_read_b64_tr_b16 v[50:51], v32 offset:43520
    v_mfma_f32_16x16x32_bf16 v[136:139], v[52:55], a[56:59], v[136:139]
    buffer_load_dwordx4 a[184:187], v30, s[96:99], s33 offen offset:3072 sc1
    v_mfma_f32_16x16x32_bf16 v[140:143], v[52:55], a[60:63], v[140:143]
    s_waitcnt lgkmcnt(4)
    v_mfma_f32_16x16x32_bf16 v[144:147], v[56:59], a[48:51], v[144:147]
    ds_read_b64_tr_b16 v[52:53], v32 offset:40992
    v_mfma_f32_16x16x32_bf16 v[148:151], v[56:59], a[52:55], v[148:151]
    ds_read_b64_tr_b16 v[54:55], v32 offset:43552
    v_mfma_f32_16x16x32_bf16 v[152:155], v[56:59], a[56:59], v[152:155]
    buffer_load_dwordx4 a[188:191], v31, s[96:99], s33 offen offset:3072 sc1
    s_add_u32 s33, s33, 4096
    v_mfma_f32_16x16x32_bf16 v[156:159], v[56:59], a[60:63], v[156:159]
    s_waitcnt lgkmcnt(4)
    v_mfma_f32_16x16x32_bf16 v[160:163], v[60:63], a[48:51], v[160:163]
    ds_read_b64_tr_b16 v[56:57], v32 offset:41024
    v_mfma_f32_16x16x32_bf16 v[164:167], v[60:63], a[52:55], v[164:167]
    ds_read_b64_tr_b16 v[58:59], v32 offset:43584
    v_mfma_f32_16x16x32_bf16 v[168:171], v[60:63], a[56:59], v[168:171]
    v_mfma_f32_16x16x32_bf16 v[172:175], v[60:63], a[60:63], v[172:175]
    s_waitcnt lgkmcnt(4)
    v_mfma_f32_16x16x32_bf16 v[96:99], v[48:51], a[64:67], v[96:99]
    ds_read_b64_tr_b16 v[60:61], v32 offset:41056
    v_mfma_f32_16x16x32_bf16 v[100:103], v[48:51], a[68:71], v[100:103]
    ds_read_b64_tr_b16 v[62:63], v32 offset:43616
    v_mfma_f32_16x16x32_bf16 v[104:107], v[48:51], a[72:75], v[104:107]
    v_mfma_f32_16x16x32_bf16 v[108:111], v[48:51], a[76:79], v[108:111]
    s_barrier
    s_waitcnt lgkmcnt(4)
    v_mfma_f32_16x16x32_bf16 v[112:115], v[52:55], a[64:67], v[112:115]
    ds_read_b64_tr_b16 v[48:49], v32 offset:41088
    v_mfma_f32_16x16x32_bf16 v[116:119], v[52:55], a[68:71], v[116:119]
    ds_read_b64_tr_b16 v[50:51], v32 offset:43648
    v_mfma_f32_16x16x32_bf16 v[120:123], v[52:55], a[72:75], v[120:123]
    s_add_u32 s32, s56, s57
    s_add_u32 m0, s34, 20480
    v_mfma_f32_16x16x32_bf16 v[124:127], v[52:55], a[76:79], v[124:127]
    buffer_load_dwordx4 v15, s[24:27], s32 offen lds
    s_waitcnt lgkmcnt(4)
    v_mfma_f32_16x16x32_bf16 v[128:131], v[56:59], a[64:67], v[128:131]
    ds_read_b64_tr_b16 v[52:53], v32 offset:46080
    v_mfma_f32_16x16x32_bf16 v[132:135], v[56:59], a[68:71], v[132:135]
    ds_read_b64_tr_b16 v[54:55], v32 offset:48640
    v_mfma_f32_16x16x32_bf16 v[136:139], v[56:59], a[72:75], v[136:139]
    s_add_u32 m0, s34, 21504
    v_mfma_f32_16x16x32_bf16 v[140:143], v[56:59], a[76:79], v[140:143]
    buffer_load_dwordx4 v16, s[24:27], s32 offen lds
    s_waitcnt lgkmcnt(4)
    v_mfma_f32_16x16x32_bf16 v[144:147], v[60:63], a[64:67], v[144:147]
    ds_read_b64_tr_b16 v[56:57], v32 offset:46112
    v_mfma_f32_16x16x32_bf16 v[148:151], v[60:63], a[68:71], v[148:151]
    ds_read_b64_tr_b16 v[58:59], v32 offset:48672
    v_mfma_f32_16x16x32_bf16 v[152:155], v[60:63], a[72:75], v[152:155]
    s_add_u32 m0, s34, 22528
    v_mfma_f32_16x16x32_bf16 v[156:159], v[60:63], a[76:79], v[156:159]
    buffer_load_dwordx4 v17, s[24:27], s32 offen lds
    s_waitcnt lgkmcnt(4)
    v_mfma_f32_16x16x32_bf16 v[160:163], v[48:51], a[64:67], v[160:163]
    ds_read_b64_tr_b16 v[60:61], v32 offset:46144
    v_mfma_f32_16x16x32_bf16 v[164:167], v[48:51], a[68:71], v[164:167]
    ds_read_b64_tr_b16 v[62:63], v32 offset:48704
    v_mfma_f32_16x16x32_bf16 v[168:171], v[48:51], a[72:75], v[168:171]
    s_add_u32 m0, s34, 23552
    v_mfma_f32_16x16x32_bf16 v[172:175], v[48:51], a[76:79], v[172:175]
    buffer_load_dwordx4 v18, s[24:27], s32 offen lds
    s_waitcnt lgkmcnt(4)
    v_mfma_f32_16x16x32_bf16 v[96:99], v[52:55], a[80:83], v[96:99]
    ds_read_b64_tr_b16 v[48:49], v32 offset:46176
    v_mfma_f32_16x16x32_bf16 v[100:103], v[52:55], a[84:87], v[100:103]
    ds_read_b64_tr_b16 v[50:51], v32 offset:48736
    v_mfma_f32_16x16x32_bf16 v[104:107], v[52:55], a[88:91], v[104:107]
    s_add_u32 m0, s34, 24576
    v_mfma_f32_16x16x32_bf16 v[108:111], v[52:55], a[92:95], v[108:111]
    buffer_load_dwordx4 v19, s[24:27], s32 offen lds
    s_waitcnt lgkmcnt(4)
    v_mfma_f32_16x16x32_bf16 v[112:115], v[56:59], a[80:83], v[112:115]
    ds_read_b64_tr_b16 v[52:53], v32 offset:46208
    v_mfma_f32_16x16x32_bf16 v[116:119], v[56:59], a[84:87], v[116:119]
    ds_read_b64_tr_b16 v[54:55], v32 offset:48768
    v_mfma_f32_16x16x32_bf16 v[120:123], v[56:59], a[88:91], v[120:123]
    buffer_load_dwordx4 a[192:195], v28, s[96:99], s33 offen offset:0 sc1
    v_mfma_f32_16x16x32_bf16 v[124:127], v[56:59], a[92:95], v[124:127]
    buffer_load_dwordx4 a[196:199], v29, s[96:99], s33 offen offset:0 sc1
    s_waitcnt lgkmcnt(4)
    v_mfma_f32_16x16x32_bf16 v[128:131], v[60:63], a[80:83], v[128:131]
    ds_read_b64_tr_b16 v[56:57], v32 offset:51200
    v_mfma_f32_16x16x32_bf16 v[132:135], v[60:63], a[84:87], v[132:135]
    ds_read_b64_tr_b16 v[58:59], v32 offset:53760
    v_mfma_f32_16x16x32_bf16 v[136:139], v[60:63], a[88:91], v[136:139]
    buffer_load_dwordx4 a[200:203], v30, s[96:99], s33 offen offset:0 sc1
    v_mfma_f32_16x16x32_bf16 v[140:143], v[60:63], a[92:95], v[140:143]
    buffer_load_dwordx4 a[204:207], v31, s[96:99], s33 offen offset:0 sc1
    s_waitcnt lgkmcnt(4)
    v_mfma_f32_16x16x32_bf16 v[144:147], v[48:51], a[80:83], v[144:147]
    ds_read_b64_tr_b16 v[60:61], v32 offset:51232
    v_mfma_f32_16x16x32_bf16 v[148:151], v[48:51], a[84:87], v[148:151]
    ds_read_b64_tr_b16 v[62:63], v32 offset:53792
    v_mfma_f32_16x16x32_bf16 v[152:155], v[48:51], a[88:91], v[152:155]
    buffer_load_dwordx4 a[208:211], v28, s[96:99], s33 offen offset:1024 sc1
    v_mfma_f32_16x16x32_bf16 v[156:159], v[48:51], a[92:95], v[156:159]
    s_waitcnt lgkmcnt(4)
    v_mfma_f32_16x16x32_bf16 v[160:163], v[52:55], a[80:83], v[160:163]
    ds_read_b64_tr_b16 v[48:49], v32 offset:51264
    v_mfma_f32_16x16x32_bf16 v[164:167], v[52:55], a[84:87], v[164:167]
    ds_read_b64_tr_b16 v[50:51], v32 offset:53824
    v_mfma_f32_16x16x32_bf16 v[168:171], v[52:55], a[88:91], v[168:171]
    buffer_load_dwordx4 a[212:215], v29, s[96:99], s33 offen offset:1024 sc1
    v_mfma_f32_16x16x32_bf16 v[172:175], v[52:55], a[92:95], v[172:175]
    s_waitcnt lgkmcnt(4)
    v_mfma_f32_16x16x32_bf16 v[96:99], v[56:59], a[96:99], v[96:99]
    ds_read_b64_tr_b16 v[52:53], v32 offset:51296
    v_mfma_f32_16x16x32_bf16 v[100:103], v[56:59], a[100:103], v[100:103]
    ds_read_b64_tr_b16 v[54:55], v32 offset:53856
    v_mfma_f32_16x16x32_bf16 v[104:107], v[56:59], a[104:107], v[104:107]
    buffer_load_dwordx4 a[216:219], v30, s[96:99], s33 offen offset:1024 sc1
    v_mfma_f32_16x16x32_bf16 v[108:111], v[56:59], a[108:111], v[108:111]
    s_waitcnt lgkmcnt(4)
    v_mfma_f32_16x16x32_bf16 v[112:115], v[60:63], a[96:99], v[112:115]
    ds_read_b64_tr_b16 v[56:57], v32 offset:51328
    v_mfma_f32_16x16x32_bf16 v[116:119], v[60:63], a[100:103], v[116:119]
    ds_read_b64_tr_b16 v[58:59], v32 offset:53888
    v_mfma_f32_16x16x32_bf16 v[120:123], v[60:63], a[104:107], v[120:123]
    buffer_load_dwordx4 a[220:223], v31, s[96:99], s33 offen offset:1024 sc1
    v_mfma_f32_16x16x32_bf16 v[124:127], v[60:63], a[108:111], v[124:127]
    s_waitcnt lgkmcnt(4)
    v_mfma_f32_16x16x32_bf16 v[128:131], v[48:51], a[96:99], v[128:131]
    ds_read_b64_tr_b16 v[60:61], v32 offset:56320
    v_mfma_f32_16x16x32_bf16 v[132:135], v[48:51], a[100:103], v[132:135]
    ds_read_b64_tr_b16 v[62:63], v32 offset:58880
    v_mfma_f32_16x16x32_bf16 v[136:139], v[48:51], a[104:107], v[136:139]
    buffer_load_dwordx4 a[224:227], v28, s[96:99], s33 offen offset:2048 sc1
    v_mfma_f32_16x16x32_bf16 v[140:143], v[48:51], a[108:111], v[140:143]
    s_waitcnt lgkmcnt(4)
    v_mfma_f32_16x16x32_bf16 v[144:147], v[52:55], a[96:99], v[144:147]
    ds_read_b64_tr_b16 v[48:49], v32 offset:56352
    v_mfma_f32_16x16x32_bf16 v[148:151], v[52:55], a[100:103], v[148:151]
    ds_read_b64_tr_b16 v[50:51], v32 offset:58912
    v_mfma_f32_16x16x32_bf16 v[152:155], v[52:55], a[104:107], v[152:155]
    buffer_load_dwordx4 a[228:231], v29, s[96:99], s33 offen offset:2048 sc1
    v_mfma_f32_16x16x32_bf16 v[156:159], v[52:55], a[108:111], v[156:159]
    buffer_load_dwordx4 a[232:235], v30, s[96:99], s33 offen offset:2048 sc1
    s_waitcnt lgkmcnt(4)
    v_mfma_f32_16x16x32_bf16 v[160:163], v[56:59], a[96:99], v[160:163]
    ds_read_b64_tr_b16 v[52:53], v32 offset:56384
    v_mfma_f32_16x16x32_bf16 v[164:167], v[56:59], a[100:103], v[164:167]
    ds_read_b64_tr_b16 v[54:55], v32 offset:58944
    v_mfma_f32_16x16x32_bf16 v[168:171], v[56:59], a[104:107], v[168:171]
    buffer_load_dwordx4 a[236:239], v31, s[96:99], s33 offen offset:2048 sc1
    v_mfma_f32_16x16x32_bf16 v[172:175], v[56:59], a[108:111], v[172:175]
    s_waitcnt lgkmcnt(4)
    v_mfma_f32_16x16x32_bf16 v[96:99], v[60:63], a[112:115], v[96:99]
    ds_read_b64_tr_b16 v[56:57], v32 offset:56416
    v_mfma_f32_16x16x32_bf16 v[100:103], v[60:63], a[116:119], v[100:103]
    ds_read_b64_tr_b16 v[58:59], v32 offset:58976
    v_mfma_f32_16x16x32_bf16 v[104:107], v[60:63], a[120:123], v[104:107]
    buffer_load_dwordx4 a[240:243], v28, s[96:99], s33 offen offset:3072 sc1
    v_mfma_f32_16x16x32_bf16 v[108:111], v[60:63], a[124:127], v[108:111]
    s_waitcnt lgkmcnt(4)
    v_mfma_f32_16x16x32_bf16 v[112:115], v[48:51], a[112:115], v[112:115]
    ds_read_b64_tr_b16 v[60:61], v32 offset:56448
    v_mfma_f32_16x16x32_bf16 v[116:119], v[48:51], a[116:119], v[116:119]
    ds_read_b64_tr_b16 v[62:63], v32 offset:59008
    v_mfma_f32_16x16x32_bf16 v[120:123], v[48:51], a[120:123], v[120:123]
    buffer_load_dwordx4 a[244:247], v29, s[96:99], s33 offen offset:3072 sc1
    v_mfma_f32_16x16x32_bf16 v[124:127], v[48:51], a[124:127], v[124:127]
    s_waitcnt lgkmcnt(4)
    v_mfma_f32_16x16x32_bf16 v[128:131], v[52:55], a[112:115], v[128:131]
    ds_read_b64_tr_b16 v[48:49], v33 offset:0
    v_mfma_f32_16x16x32_bf16 v[132:135], v[52:55], a[116:119], v[132:135]
    ds_read_b64_tr_b16 v[50:51], v33 offset:2560
    v_mfma_f32_16x16x32_bf16 v[136:139], v[52:55], a[120:123], v[136:139]
    buffer_load_dwordx4 a[248:251], v30, s[96:99], s33 offen offset:3072 sc1
    v_mfma_f32_16x16x32_bf16 v[140:143], v[52:55], a[124:127], v[140:143]
    s_waitcnt lgkmcnt(4)
    v_mfma_f32_16x16x32_bf16 v[144:147], v[56:59], a[112:115], v[144:147]
    ds_read_b64_tr_b16 v[52:53], v33 offset:32
    v_mfma_f32_16x16x32_bf16 v[148:151], v[56:59], a[116:119], v[148:151]
    ds_read_b64_tr_b16 v[54:55], v33 offset:2592
    v_mfma_f32_16x16x32_bf16 v[152:155], v[56:59], a[120:123], v[152:155]
    buffer_load_dwordx4 a[252:255], v31, s[96:99], s33 offen offset:3072 sc1
    s_add_u32 s33, s33, 4096
    v_mfma_f32_16x16x32_bf16 v[156:159], v[56:59], a[124:127], v[156:159]
    s_waitcnt lgkmcnt(4)
    v_mfma_f32_16x16x32_bf16 v[160:163], v[60:63], a[112:115], v[160:163]
    ds_read_b64_tr_b16 v[56:57], v33 offset:64
    v_mfma_f32_16x16x32_bf16 v[164:167], v[60:63], a[116:119], v[164:167]
    ds_read_b64_tr_b16 v[58:59], v33 offset:2624
    v_mfma_f32_16x16x32_bf16 v[168:171], v[60:63], a[120:123], v[168:171]
    v_mfma_f32_16x16x32_bf16 v[172:175], v[60:63], a[124:127], v[172:175]
    s_waitcnt vmcnt(21) lgkmcnt(4)
    v_mfma_f32_16x16x32_bf16 v[96:99], v[48:51], a[128:131], v[96:99]
    ds_read_b64_tr_b16 v[60:61], v33 offset:96
    v_mfma_f32_16x16x32_bf16 v[100:103], v[48:51], a[132:135], v[100:103]
    ds_read_b64_tr_b16 v[62:63], v33 offset:2656
    v_mfma_f32_16x16x32_bf16 v[104:107], v[48:51], a[136:139], v[104:107]
    v_mfma_f32_16x16x32_bf16 v[108:111], v[48:51], a[140:143], v[108:111]
    s_waitcnt vmcnt(37)
    s_barrier
    s_waitcnt lgkmcnt(4)
    v_mfma_f32_16x16x32_bf16 v[112:115], v[52:55], a[128:131], v[112:115]
    ds_read_b64_tr_b16 v[48:49], v33 offset:128
    v_mfma_f32_16x16x32_bf16 v[116:119], v[52:55], a[132:135], v[116:119]
    ds_read_b64_tr_b16 v[50:51], v33 offset:2688
    v_mfma_f32_16x16x32_bf16 v[120:123], v[52:55], a[136:139], v[120:123]
    s_add_u32 s32, s52, s58
    s_add_u32 m0, s35, 40960
    v_mfma_f32_16x16x32_bf16 v[124:127], v[52:55], a[140:143], v[124:127]
    buffer_load_dwordx4 v20, s[12:15], s32 offen lds
    s_waitcnt lgkmcnt(4)
    v_mfma_f32_16x16x32_bf16 v[128:131], v[56:59], a[128:131], v[128:131]
    ds_read_b64_tr_b16 v[52:53], v33 offset:5120
    v_mfma_f32_16x16x32_bf16 v[132:135], v[56:59], a[132:135], v[132:135]
    ds_read_b64_tr_b16 v[54:55], v33 offset:7680
    v_mfma_f32_16x16x32_bf16 v[136:139], v[56:59], a[136:139], v[136:139]
    s_add_u32 m0, s35, 41984
    v_mfma_f32_16x16x32_bf16 v[140:143], v[56:59], a[140:143], v[140:143]
    buffer_load_dwordx4 v21, s[12:15], s32 offen lds
    s_waitcnt lgkmcnt(4)
    v_mfma_f32_16x16x32_bf16 v[144:147], v[60:63], a[128:131], v[144:147]
    ds_read_b64_tr_b16 v[56:57], v33 offset:5152
    v_mfma_f32_16x16x32_bf16 v[148:151], v[60:63], a[132:135], v[148:151]
    ds_read_b64_tr_b16 v[58:59], v33 offset:7712
    v_mfma_f32_16x16x32_bf16 v[152:155], v[60:63], a[136:139], v[152:155]
    v_mfma_f32_16x16x32_bf16 v[156:159], v[60:63], a[140:143], v[156:159]
    s_waitcnt lgkmcnt(4)
    v_mfma_f32_16x16x32_bf16 v[160:163], v[48:51], a[128:131], v[160:163]
    ds_read_b64_tr_b16 v[60:61], v33 offset:5184
    v_mfma_f32_16x16x32_bf16 v[164:167], v[48:51], a[132:135], v[164:167]
    ds_read_b64_tr_b16 v[62:63], v33 offset:7744
    v_mfma_f32_16x16x32_bf16 v[168:171], v[48:51], a[136:139], v[168:171]
    s_add_u32 m0, s35, 43008
    v_mfma_f32_16x16x32_bf16 v[172:175], v[48:51], a[140:143], v[172:175]
    buffer_load_dwordx4 v22, s[12:15], s32 offen lds
    s_waitcnt lgkmcnt(4)
    v_mfma_f32_16x16x32_bf16 v[96:99], v[52:55], a[144:147], v[96:99]
    ds_read_b64_tr_b16 v[48:49], v33 offset:5216
    v_mfma_f32_16x16x32_bf16 v[100:103], v[52:55], a[148:151], v[100:103]
    ds_read_b64_tr_b16 v[50:51], v33 offset:7776
    v_mfma_f32_16x16x32_bf16 v[104:107], v[52:55], a[152:155], v[104:107]
    s_add_u32 m0, s35, 44032
    v_mfma_f32_16x16x32_bf16 v[108:111], v[52:55], a[156:159], v[108:111]
    buffer_load_dwordx4 v23, s[12:15], s32 offen lds
    s_waitcnt lgkmcnt(4)
    v_mfma_f32_16x16x32_bf16 v[112:115], v[56:59], a[144:147], v[112:115]
    ds_read_b64_tr_b16 v[52:53], v33 offset:5248
    v_mfma_f32_16x16x32_bf16 v[116:119], v[56:59], a[148:151], v[116:119]
    ds_read_b64_tr_b16 v[54:55], v33 offset:7808
    v_mfma_f32_16x16x32_bf16 v[120:123], v[56:59], a[152:155], v[120:123]
    v_mfma_f32_16x16x32_bf16 v[124:127], v[56:59], a[156:159], v[124:127]
    s_waitcnt lgkmcnt(4)
    v_mfma_f32_16x16x32_bf16 v[128:131], v[60:63], a[144:147], v[128:131]
    ds_read_b64_tr_b16 v[56:57], v33 offset:10240
    v_mfma_f32_16x16x32_bf16 v[132:135], v[60:63], a[148:151], v[132:135]
    ds_read_b64_tr_b16 v[58:59], v33 offset:12800
    v_mfma_f32_16x16x32_bf16 v[136:139], v[60:63], a[152:155], v[136:139]
    buffer_load_dwordx4 v[64:67], v28, s[96:99], s33 offen offset:0 sc1
    v_mfma_f32_16x16x32_bf16 v[140:143], v[60:63], a[156:159], v[140:143]
    s_waitcnt lgkmcnt(4)
    v_mfma_f32_16x16x32_bf16 v[144:147], v[48:51], a[144:147], v[144:147]
    ds_read_b64_tr_b16 v[60:61], v33 offset:10272
    v_mfma_f32_16x16x32_bf16 v[148:151], v[48:51], a[148:151], v[148:151]
    ds_read_b64_tr_b16 v[62:63], v33 offset:12832
    v_mfma_f32_16x16x32_bf16 v[152:155], v[48:51], a[152:155], v[152:155]
    buffer_load_dwordx4 v[68:71], v29, s[96:99], s33 offen offset:0 sc1
    v_mfma_f32_16x16x32_bf16 v[156:159], v[48:51], a[156:159], v[156:159]
    s_waitcnt lgkmcnt(4)
    v_mfma_f32_16x16x32_bf16 v[160:163], v[52:55], a[144:147], v[160:163]
    ds_read_b64_tr_b16 v[48:49], v33 offset:10304
    v_mfma_f32_16x16x32_bf16 v[164:167], v[52:55], a[148:151], v[164:167]
    ds_read_b64_tr_b16 v[50:51], v33 offset:12864
    v_mfma_f32_16x16x32_bf16 v[168:171], v[52:55], a[152:155], v[168:171]
    v_mfma_f32_16x16x32_bf16 v[172:175], v[52:55], a[156:159], v[172:175]
    s_waitcnt lgkmcnt(4)
    v_mfma_f32_16x16x32_bf16 v[96:99], v[56:59], a[160:163], v[96:99]
    ds_read_b64_tr_b16 v[52:53], v33 offset:10336
    v_mfma_f32_16x16x32_bf16 v[100:103], v[56:59], a[164:167], v[100:103]
    ds_read_b64_tr_b16 v[54:55], v33 offset:12896
    v_mfma_f32_16x16x32_bf16 v[104:107], v[56:59], a[168:171], v[104:107]
    buffer_load_dwordx4 v[72:75], v30, s[96:99], s33 offen offset:0 sc1
    v_mfma_f32_16x16x32_bf16 v[108:111], v[56:59], a[172:175], v[108:111]
    s_waitcnt lgkmcnt(4)
    v_mfma_f32_16x16x32_bf16 v[112:115], v[60:63], a[160:163], v[112:115]
    ds_read_b64_tr_b16 v[56:57], v33 offset:10368
    v_mfma_f32_16x16x32_bf16 v[116:119], v[60:63], a[164:167], v[116:119]
    ds_read_b64_tr_b16 v[58:59], v33 offset:12928
    v_mfma_f32_16x16x32_bf16 v[120:123], v[60:63], a[168:171], v[120:123]
    buffer_load_dwordx4 v[76:79], v31, s[96:99], s33 offen offset:0 sc1
    v_mfma_f32_16x16x32_bf16 v[124:127], v[60:63], a[172:175], v[124:127]
    s_waitcnt lgkmcnt(4)
    v_mfma_f32_16x16x32_bf16 v[128:131], v[48:51], a[160:163], v[128:131]
    ds_read_b64_tr_b16 v[60:61], v33 offset:15360
    v_mfma_f32_16x16x32_bf16 v[132:135], v[48:51], a[164:167], v[132:135]
    ds_read_b64_tr_b16 v[62:63], v33 offset:17920
    v_mfma_f32_16x16x32_bf16 v[136:139], v[48:51], a[168:171], v[136:139]
    v_mfma_f32_16x16x32_bf16 v[140:143], v[48:51], a[172:175], v[140:143]
    s_waitcnt lgkmcnt(4)
    v_mfma_f32_16x16x32_bf16 v[144:147], v[52:55], a[160:163], v[144:147]
    ds_read_b64_tr_b16 v[48:49], v33 offset:15392
    v_mfma_f32_16x16x32_bf16 v[148:151], v[52:55], a[164:167], v[148:151]
    ds_read_b64_tr_b16 v[50:51], v33 offset:17952
    v_mfma_f32_16x16x32_bf16 v[152:155], v[52:55], a[168:171], v[152:155]
    buffer_load_dwordx4 v[80:83], v28, s[96:99], s33 offen offset:1024 sc1
    v_mfma_f32_16x16x32_bf16 v[156:159], v[52:55], a[172:175], v[156:159]
    s_waitcnt lgkmcnt(4)
    v_mfma_f32_16x16x32_bf16 v[160:163], v[56:59], a[160:163], v[160:163]
    ds_read_b64_tr_b16 v[52:53], v33 offset:15424
    v_mfma_f32_16x16x32_bf16 v[164:167], v[56:59], a[164:167], v[164:167]
    ds_read_b64_tr_b16 v[54:55], v33 offset:17984
    v_mfma_f32_16x16x32_bf16 v[168:171], v[56:59], a[168:171], v[168:171]
    buffer_load_dwordx4 v[84:87], v29, s[96:99], s33 offen offset:1024 sc1
    v_mfma_f32_16x16x32_bf16 v[172:175], v[56:59], a[172:175], v[172:175]
    s_waitcnt lgkmcnt(4)
    v_mfma_f32_16x16x32_bf16 v[96:99], v[60:63], a[176:179], v[96:99]
    ds_read_b64_tr_b16 v[56:57], v33 offset:15456
    v_mfma_f32_16x16x32_bf16 v[100:103], v[60:63], a[180:183], v[100:103]
    ds_read_b64_tr_b16 v[58:59], v33 offset:18016
    v_mfma_f32_16x16x32_bf16 v[104:107], v[60:63], a[184:187], v[104:107]
    v_mfma_f32_16x16x32_bf16 v[108:111], v[60:63], a[188:191], v[108:111]
    s_waitcnt lgkmcnt(4)
    v_mfma_f32_16x16x32_bf16 v[112:115], v[48:51], a[176:179], v[112:115]
    ds_read_b64_tr_b16 v[60:61], v33 offset:15488
    v_mfma_f32_16x16x32_bf16 v[116:119], v[48:51], a[180:183], v[116:119]
    ds_read_b64_tr_b16 v[62:63], v33 offset:18048
    v_mfma_f32_16x16x32_bf16 v[120:123], v[48:51], a[184:187], v[120:123]
    buffer_load_dwordx4 v[88:91], v30, s[96:99], s33 offen offset:1024 sc1
    v_mfma_f32_16x16x32_bf16 v[124:127], v[48:51], a[188:191], v[124:127]
    s_waitcnt lgkmcnt(4)
    v_mfma_f32_16x16x32_bf16 v[128:131], v[52:55], a[176:179], v[128:131]
    ds_read_b64_tr_b16 v[48:49], v32 offset:0
    v_mfma_f32_16x16x32_bf16 v[132:135], v[52:55], a[180:183], v[132:135]
    ds_read_b64_tr_b16 v[50:51], v32 offset:2560
    v_mfma_f32_16x16x32_bf16 v[136:139], v[52:55], a[184:187], v[136:139]
    buffer_load_dwordx4 v[92:95], v31, s[96:99], s33 offen offset:1024 sc1
    s_add_u32 s33, s33, 4096
    v_mfma_f32_16x16x32_bf16 v[140:143], v[52:55], a[188:191], v[140:143]
    s_waitcnt lgkmcnt(4)
    v_mfma_f32_16x16x32_bf16 v[144:147], v[56:59], a[176:179], v[144:147]
    ds_read_b64_tr_b16 v[52:53], v32 offset:32
    v_mfma_f32_16x16x32_bf16 v[148:151], v[56:59], a[180:183], v[148:151]
    ds_read_b64_tr_b16 v[54:55], v32 offset:2592
    v_mfma_f32_16x16x32_bf16 v[152:155], v[56:59], a[184:187], v[152:155]
    v_mfma_f32_16x16x32_bf16 v[156:159], v[56:59], a[188:191], v[156:159]
    s_waitcnt lgkmcnt(4)
    v_mfma_f32_16x16x32_bf16 v[160:163], v[60:63], a[176:179], v[160:163]
    ds_read_b64_tr_b16 v[56:57], v32 offset:64
    v_mfma_f32_16x16x32_bf16 v[164:167], v[60:63], a[180:183], v[164:167]
    ds_read_b64_tr_b16 v[58:59], v32 offset:2624
    v_mfma_f32_16x16x32_bf16 v[168:171], v[60:63], a[184:187], v[168:171]
    v_mfma_f32_16x16x32_bf16 v[172:175], v[60:63], a[188:191], v[172:175]
    s_waitcnt vmcnt(12) lgkmcnt(4)
    v_mfma_f32_16x16x32_bf16 v[96:99], v[48:51], a[192:195], v[96:99]
    ds_read_b64_tr_b16 v[60:61], v32 offset:96
    v_mfma_f32_16x16x32_bf16 v[100:103], v[48:51], a[196:199], v[100:103]
    ds_read_b64_tr_b16 v[62:63], v32 offset:2656
    v_mfma_f32_16x16x32_bf16 v[104:107], v[48:51], a[200:203], v[104:107]
    v_mfma_f32_16x16x32_bf16 v[108:111], v[48:51], a[204:207], v[108:111]
    s_waitcnt vmcnt(28)
    s_barrier
    s_waitcnt lgkmcnt(4)
    v_mfma_f32_16x16x32_bf16 v[112:115], v[52:55], a[192:195], v[112:115]
    ds_read_b64_tr_b16 v[48:49], v32 offset:128
    v_mfma_f32_16x16x32_bf16 v[116:119], v[52:55], a[196:199], v[116:119]
    ds_read_b64_tr_b16 v[50:51], v32 offset:2688
    v_mfma_f32_16x16x32_bf16 v[120:123], v[52:55], a[200:203], v[120:123]
    s_add_u32 s32, s53, s58
    s_add_u32 m0, s35, 61440
    v_mfma_f32_16x16x32_bf16 v[124:127], v[52:55], a[204:207], v[124:127]
    buffer_load_dwordx4 v20, s[12:15], s32 offen lds
    s_waitcnt lgkmcnt(4)
    v_mfma_f32_16x16x32_bf16 v[128:131], v[56:59], a[192:195], v[128:131]
    ds_read_b64_tr_b16 v[52:53], v32 offset:5120
    v_mfma_f32_16x16x32_bf16 v[132:135], v[56:59], a[196:199], v[132:135]
    ds_read_b64_tr_b16 v[54:55], v32 offset:7680
    v_mfma_f32_16x16x32_bf16 v[136:139], v[56:59], a[200:203], v[136:139]
    v_mfma_f32_16x16x32_bf16 v[140:143], v[56:59], a[204:207], v[140:143]
    s_waitcnt lgkmcnt(4)
    v_mfma_f32_16x16x32_bf16 v[144:147], v[60:63], a[192:195], v[144:147]
    ds_read_b64_tr_b16 v[56:57], v32 offset:5152
    v_mfma_f32_16x16x32_bf16 v[148:151], v[60:63], a[196:199], v[148:151]
    ds_read_b64_tr_b16 v[58:59], v32 offset:7712
    v_mfma_f32_16x16x32_bf16 v[152:155], v[60:63], a[200:203], v[152:155]
    v_mfma_f32_16x16x32_bf16 v[156:159], v[60:63], a[204:207], v[156:159]
    s_waitcnt lgkmcnt(4)
    v_mfma_f32_16x16x32_bf16 v[160:163], v[48:51], a[192:195], v[160:163]
    ds_read_b64_tr_b16 v[60:61], v32 offset:5184
    v_mfma_f32_16x16x32_bf16 v[164:167], v[48:51], a[196:199], v[164:167]
    ds_read_b64_tr_b16 v[62:63], v32 offset:7744
    v_mfma_f32_16x16x32_bf16 v[168:171], v[48:51], a[200:203], v[168:171]
    v_mfma_f32_16x16x32_bf16 v[172:175], v[48:51], a[204:207], v[172:175]
    s_waitcnt lgkmcnt(4)
    v_mfma_f32_16x16x32_bf16 v[96:99], v[52:55], a[208:211], v[96:99]
    ds_read_b64_tr_b16 v[48:49], v32 offset:5216
    v_mfma_f32_16x16x32_bf16 v[100:103], v[52:55], a[212:215], v[100:103]
    ds_read_b64_tr_b16 v[50:51], v32 offset:7776
    v_mfma_f32_16x16x32_bf16 v[104:107], v[52:55], a[216:219], v[104:107]
    s_add_u32 m0, s35, 62464
    v_mfma_f32_16x16x32_bf16 v[108:111], v[52:55], a[220:223], v[108:111]
    buffer_load_dwordx4 v21, s[12:15], s32 offen lds
    s_waitcnt lgkmcnt(4)
    v_mfma_f32_16x16x32_bf16 v[112:115], v[56:59], a[208:211], v[112:115]
    ds_read_b64_tr_b16 v[52:53], v32 offset:5248
    v_mfma_f32_16x16x32_bf16 v[116:119], v[56:59], a[212:215], v[116:119]
    ds_read_b64_tr_b16 v[54:55], v32 offset:7808
    v_mfma_f32_16x16x32_bf16 v[120:123], v[56:59], a[216:219], v[120:123]
    v_mfma_f32_16x16x32_bf16 v[124:127], v[56:59], a[220:223], v[124:127]
    s_waitcnt lgkmcnt(4)
    v_mfma_f32_16x16x32_bf16 v[128:131], v[60:63], a[208:211], v[128:131]
    ds_read_b64_tr_b16 v[56:57], v32 offset:10240
    v_mfma_f32_16x16x32_bf16 v[132:135], v[60:63], a[212:215], v[132:135]
    ds_read_b64_tr_b16 v[58:59], v32 offset:12800
    v_mfma_f32_16x16x32_bf16 v[136:139], v[60:63], a[216:219], v[136:139]
    v_mfma_f32_16x16x32_bf16 v[140:143], v[60:63], a[220:223], v[140:143]
    s_waitcnt lgkmcnt(4)
    v_mfma_f32_16x16x32_bf16 v[144:147], v[48:51], a[208:211], v[144:147]
    ds_read_b64_tr_b16 v[60:61], v32 offset:10272
    v_mfma_f32_16x16x32_bf16 v[148:151], v[48:51], a[212:215], v[148:151]
    ds_read_b64_tr_b16 v[62:63], v32 offset:12832
    v_mfma_f32_16x16x32_bf16 v[152:155], v[48:51], a[216:219], v[152:155]
    v_mfma_f32_16x16x32_bf16 v[156:159], v[48:51], a[220:223], v[156:159]
    s_waitcnt lgkmcnt(4)
    v_mfma_f32_16x16x32_bf16 v[160:163], v[52:55], a[208:211], v[160:163]
    ds_read_b64_tr_b16 v[48:49], v32 offset:10304
    v_mfma_f32_16x16x32_bf16 v[164:167], v[52:55], a[212:215], v[164:167]
    ds_read_b64_tr_b16 v[50:51], v32 offset:12864
    v_mfma_f32_16x16x32_bf16 v[168:171], v[52:55], a[216:219], v[168:171]
    v_mfma_f32_16x16x32_bf16 v[172:175], v[52:55], a[220:223], v[172:175]
    s_waitcnt lgkmcnt(4)
    v_mfma_f32_16x16x32_bf16 v[96:99], v[56:59], a[224:227], v[96:99]
    ds_read_b64_tr_b16 v[52:53], v32 offset:10336
    v_mfma_f32_16x16x32_bf16 v[100:103], v[56:59], a[228:231], v[100:103]
    ds_read_b64_tr_b16 v[54:55], v32 offset:12896
    v_mfma_f32_16x16x32_bf16 v[104:107], v[56:59], a[232:235], v[104:107]
    s_add_u32 m0, s35, 63488
    v_mfma_f32_16x16x32_bf16 v[108:111], v[56:59], a[236:239], v[108:111]
    buffer_load_dwordx4 v22, s[12:15], s32 offen lds
    s_waitcnt lgkmcnt(4)
    v_mfma_f32_16x16x32_bf16 v[112:115], v[60:63], a[224:227], v[112:115]
    ds_read_b64_tr_b16 v[56:57], v32 offset:10368
    v_mfma_f32_16x16x32_bf16 v[116:119], v[60:63], a[228:231], v[116:119]
    ds_read_b64_tr_b16 v[58:59], v32 offset:12928
    v_mfma_f32_16x16x32_bf16 v[120:123], v[60:63], a[232:235], v[120:123]
    v_mfma_f32_16x16x32_bf16 v[124:127], v[60:63], a[236:239], v[124:127]
    s_waitcnt lgkmcnt(4)
    v_mfma_f32_16x16x32_bf16 v[128:131], v[48:51], a[224:227], v[128:131]
    ds_read_b64_tr_b16 v[60:61], v32 offset:15360
    v_mfma_f32_16x16x32_bf16 v[132:135], v[48:51], a[228:231], v[132:135]
    ds_read_b64_tr_b16 v[62:63], v32 offset:17920
    v_mfma_f32_16x16x32_bf16 v[136:139], v[48:51], a[232:235], v[136:139]
    v_mfma_f32_16x16x32_bf16 v[140:143], v[48:51], a[236:239], v[140:143]
    s_waitcnt lgkmcnt(4)
    v_mfma_f32_16x16x32_bf16 v[144:147], v[52:55], a[224:227], v[144:147]
    ds_read_b64_tr_b16 v[48:49], v32 offset:15392
    v_mfma_f32_16x16x32_bf16 v[148:151], v[52:55], a[228:231], v[148:151]
    ds_read_b64_tr_b16 v[50:51], v32 offset:17952
    v_mfma_f32_16x16x32_bf16 v[152:155], v[52:55], a[232:235], v[152:155]
    v_mfma_f32_16x16x32_bf16 v[156:159], v[52:55], a[236:239], v[156:159]
    s_waitcnt lgkmcnt(4)
    v_mfma_f32_16x16x32_bf16 v[160:163], v[56:59], a[224:227], v[160:163]
    ds_read_b64_tr_b16 v[52:53], v32 offset:15424
    v_mfma_f32_16x16x32_bf16 v[164:167], v[56:59], a[228:231], v[164:167]
    ds_read_b64_tr_b16 v[54:55], v32 offset:17984
    v_mfma_f32_16x16x32_bf16 v[168:171], v[56:59], a[232:235], v[168:171]
    s_add_u32 m0, s35, 64512
    v_mfma_f32_16x16x32_bf16 v[172:175], v[56:59], a[236:239], v[172:175]
    buffer_load_dwordx4 v23, s[12:15], s32 offen lds
    s_waitcnt lgkmcnt(4)
    v_mfma_f32_16x16x32_bf16 v[96:99], v[60:63], a[240:243], v[96:99]
    ds_read_b64_tr_b16 v[56:57], v32 offset:15456
    v_mfma_f32_16x16x32_bf16 v[100:103], v[60:63], a[244:247], v[100:103]
    ds_read_b64_tr_b16 v[58:59], v32 offset:18016
    v_mfma_f32_16x16x32_bf16 v[104:107], v[60:63], a[248:251], v[104:107]
    v_mfma_f32_16x16x32_bf16 v[108:111], v[60:63], a[252:255], v[108:111]
    s_waitcnt lgkmcnt(4)
    v_mfma_f32_16x16x32_bf16 v[112:115], v[48:51], a[240:243], v[112:115]
    ds_read_b64_tr_b16 v[60:61], v32 offset:15488
    v_mfma_f32_16x16x32_bf16 v[116:119], v[48:51], a[244:247], v[116:119]
    ds_read_b64_tr_b16 v[62:63], v32 offset:18048
    v_mfma_f32_16x16x32_bf16 v[120:123], v[48:51], a[248:251], v[120:123]
    v_mfma_f32_16x16x32_bf16 v[124:127], v[48:51], a[252:255], v[124:127]
    s_waitcnt lgkmcnt(4)
    v_mfma_f32_16x16x32_bf16 v[128:131], v[52:55], a[240:243], v[128:131]
    ds_read_b64_tr_b16 v[48:49], v32 offset:20480
    v_mfma_f32_16x16x32_bf16 v[132:135], v[52:55], a[244:247], v[132:135]
    ds_read_b64_tr_b16 v[50:51], v32 offset:23040
    v_mfma_f32_16x16x32_bf16 v[136:139], v[52:55], a[248:251], v[136:139]
    v_mfma_f32_16x16x32_bf16 v[140:143], v[52:55], a[252:255], v[140:143]
    s_waitcnt lgkmcnt(4)
    v_mfma_f32_16x16x32_bf16 v[144:147], v[56:59], a[240:243], v[144:147]
    ds_read_b64_tr_b16 v[52:53], v32 offset:20512
    v_mfma_f32_16x16x32_bf16 v[148:151], v[56:59], a[244:247], v[148:151]
    ds_read_b64_tr_b16 v[54:55], v32 offset:23072
    v_mfma_f32_16x16x32_bf16 v[152:155], v[56:59], a[248:251], v[152:155]
    v_mfma_f32_16x16x32_bf16 v[156:159], v[56:59], a[252:255], v[156:159]
    s_waitcnt lgkmcnt(4)
    v_mfma_f32_16x16x32_bf16 v[160:163], v[60:63], a[240:243], v[160:163]
    ds_read_b64_tr_b16 v[56:57], v32 offset:20544
    v_mfma_f32_16x16x32_bf16 v[164:167], v[60:63], a[244:247], v[164:167]
    ds_read_b64_tr_b16 v[58:59], v32 offset:23104
    v_mfma_f32_16x16x32_bf16 v[168:171], v[60:63], a[248:251], v[168:171]
    v_mfma_f32_16x16x32_bf16 v[172:175], v[60:63], a[252:255], v[172:175]
    s_waitcnt vmcnt(4) lgkmcnt(4)
    v_mfma_f32_16x16x32_bf16 v[96:99], v[48:51], v[64:67], v[96:99]
    ds_read_b64_tr_b16 v[60:61], v32 offset:20576
    v_mfma_f32_16x16x32_bf16 v[100:103], v[48:51], v[68:71], v[100:103]
    ds_read_b64_tr_b16 v[62:63], v32 offset:23136
    v_mfma_f32_16x16x32_bf16 v[104:107], v[48:51], v[72:75], v[104:107]
    v_mfma_f32_16x16x32_bf16 v[108:111], v[48:51], v[76:79], v[108:111]
    s_waitcnt vmcnt(12)
    s_barrier
    s_cmp_eq_u32 s3, 0
    s_cbranch_scc0 FK_tf
    buffer_load_dwordx4 v[248:251], v42, s[76:79], 0 offen sc1
    buffer_load_dword v252, v43, s[76:79], 0 offen sc1
    buffer_load_dwordx4 v[244:247], v44, s[76:79], 0 offen sc1
FK_tf:
    s_waitcnt lgkmcnt(4)
    v_mfma_f32_16x16x32_bf16 v[112:115], v[52:55], v[64:67], v[112:115]
    ds_read_b64_tr_b16 v[48:49], v32 offset:20608
    v_mfma_f32_16x16x32_bf16 v[116:119], v[52:55], v[68:71], v[116:119]
    ds_read_b64_tr_b16 v[50:51], v32 offset:23168
    v_mfma_f32_16x16x32_bf16 v[120:123], v[52:55], v[72:75], v[120:123]
    s_add_u32 s32, s54, s58
    s_add_u32 m0, s35, 0
    v_mfma_f32_16x16x32_bf16 v[124:127], v[52:55], v[76:79], v[124:127]
    buffer_load_dwordx4 v20, s[12:15], s32 offen lds
    s_waitcnt lgkmcnt(4)
    v_mfma_f32_16x16x32_bf16 v[128:131], v[56:59], v[64:67], v[128:131]
    ds_read_b64_tr_b16 v[52:53], v32 offset:25600
    v_mfma_f32_16x16x32_bf16 v[132:135], v[56:59], v[68:71], v[132:135]
    ds_read_b64_tr_b16 v[54:55], v32 offset:28160
    v_mfma_f32_16x16x32_bf16 v[136:139], v[56:59], v[72:75], v[136:139]
    v_mfma_f32_16x16x32_bf16 v[140:143], v[56:59], v[76:79], v[140:143]
    s_waitcnt lgkmcnt(4)
    v_mfma_f32_16x16x32_bf16 v[144:147], v[60:63], v[64:67], v[144:147]
    ds_read_b64_tr_b16 v[56:57], v32 offset:25632
    v_mfma_f32_16x16x32_bf16 v[148:151], v[60:63], v[68:71], v[148:151]
    ds_read_b64_tr_b16 v[58:59], v32 offset:28192
    v_mfma_f32_16x16x32_bf16 v[152:155], v[60:63], v[72:75], v[152:155]
    s_add_u32 m0, s35, 1024
    v_mfma_f32_16x16x32_bf16 v[156:159], v[60:63], v[76:79], v[156:159]
    buffer_load_dwordx4 v21, s[12:15], s32 offen lds
    s_waitcnt lgkmcnt(4)
    v_mfma_f32_16x16x32_bf16 v[160:163], v[48:51], v[64:67], v[160:163]
    ds_read_b64_tr_b16 v[60:61], v32 offset:25664
    v_mfma_f32_16x16x32_bf16 v[164:167], v[48:51], v[68:71], v[164:167]
    ds_read_b64_tr_b16 v[62:63], v32 offset:28224
    v_mfma_f32_16x16x32_bf16 v[168:171], v[48:51], v[72:75], v[168:171]
    v_mfma_f32_16x16x32_bf16 v[172:175], v[48:51], v[76:79], v[172:175]
    s_waitcnt lgkmcnt(4)
    v_mfma_f32_16x16x32_bf16 v[96:99], v[52:55], v[80:83], v[96:99]
    ds_read_b64_tr_b16 v[48:49], v32 offset:25696
    v_mfma_f32_16x16x32_bf16 v[100:103], v[52:55], v[84:87], v[100:103]
    ds_read_b64_tr_b16 v[50:51], v32 offset:28256
    v_mfma_f32_16x16x32_bf16 v[104:107], v[52:55], v[88:91], v[104:107]
    s_add_u32 m0, s35, 2048
    v_mfma_f32_16x16x32_bf16 v[108:111], v[52:55], v[92:95], v[108:111]
    buffer_load_dwordx4 v22, s[12:15], s32 offen lds
    s_waitcnt lgkmcnt(4)
    v_mfma_f32_16x16x32_bf16 v[112:115], v[56:59], v[80:83], v[112:115]
    ds_read_b64_tr_b16 v[52:53], v32 offset:25728
    v_mfma_f32_16x16x32_bf16 v[116:119], v[56:59], v[84:87], v[116:119]
    ds_read_b64_tr_b16 v[54:55], v32 offset:28288
    v_mfma_f32_16x16x32_bf16 v[120:123], v[56:59], v[88:91], v[120:123]
    v_mfma_f32_16x16x32_bf16 v[124:127], v[56:59], v[92:95], v[124:127]
    s_waitcnt lgkmcnt(4)
    v_mfma_f32_16x16x32_bf16 v[128:131], v[60:63], v[80:83], v[128:131]
    s_add_u32 m0, s35, 3072
    v_mfma_f32_16x16x32_bf16 v[132:135], v[60:63], v[84:87], v[132:135]
    buffer_load_dwordx4 v23, s[12:15], s32 offen lds
    v_mfma_f32_16x16x32_bf16 v[136:139], v[60:63], v[88:91], v[136:139]
    v_mfma_f32_16x16x32_bf16 v[140:143], v[60:63], v[92:95], v[140:143]
    s_waitcnt lgkmcnt(2)
    v_mfma_f32_16x16x32_bf16 v[144:147], v[48:51], v[80:83], v[144:147]
    v_mfma_f32_16x16x32_bf16 v[148:151], v[48:51], v[84:87], v[148:151]
    v_mfma_f32_16x16x32_bf16 v[152:155], v[48:51], v[88:91], v[152:155]
    v_mfma_f32_16x16x32_bf16 v[156:159], v[48:51], v[92:95], v[156:159]
    s_waitcnt lgkmcnt(0)
    v_mfma_f32_16x16x32_bf16 v[160:163], v[52:55], v[80:83], v[160:163]
    v_mfma_f32_16x16x32_bf16 v[164:167], v[52:55], v[84:87], v[164:167]
    v_mfma_f32_16x16x32_bf16 v[168:171], v[52:55], v[88:91], v[168:171]
    v_mfma_f32_16x16x32_bf16 v[172:175], v[52:55], v[92:95], v[172:175]
    s_nop 7
    v_cvt_pk_bf16_f32 v176, v96, v97
    v_cvt_pk_bf16_f32 v177, v98, v99
    v_cvt_pk_bf16_f32 v178, v112, v113
    v_cvt_pk_bf16_f32 v179, v114, v115
    v_cvt_pk_bf16_f32 v180, v128, v129
    v_cvt_pk_bf16_f32 v181, v130, v131
    v_cvt_pk_bf16_f32 v182, v144, v145
    v_cvt_pk_bf16_f32 v183, v146, v147
    v_cvt_pk_bf16_f32 v184, v160, v161
    v_cvt_pk_bf16_f32 v185, v162, v163
    v_cvt_pk_bf16_f32 v186, v100, v101
    v_cvt_pk_bf16_f32 v187, v102, v103
    v_cvt_pk_bf16_f32 v188, v116, v117
    v_cvt_pk_bf16_f32 v189, v118, v119
    v_cvt_pk_bf16_f32 v190, v132, v133
    v_cvt_pk_bf16_f32 v191, v134, v135
    v_cvt_pk_bf16_f32 v192, v148, v149
    v_cvt_pk_bf16_f32 v193, v150, v151
    v_cvt_pk_bf16_f32 v194, v164, v165
    v_cvt_pk_bf16_f32 v195, v166, v167
    v_cvt_pk_bf16_f32 v196, v104, v105
    v_cvt_pk_bf16_f32 v197, v106, v107
    v_cvt_pk_bf16_f32 v198, v120, v121
    v_cvt_pk_bf16_f32 v199, v122, v123
    v_cvt_pk_bf16_f32 v200, v136, v137
    v_cvt_pk_bf16_f32 v201, v138, v139
    v_cvt_pk_bf16_f32 v202, v152, v153
    v_cvt_pk_bf16_f32 v203, v154, v155
    v_cvt_pk_bf16_f32 v204, v168, v169
    v_cvt_pk_bf16_f32 v205, v170, v171
    v_cvt_pk_bf16_f32 v206, v108, v109
    v_cvt_pk_bf16_f32 v207, v110, v111
    v_cvt_pk_bf16_f32 v208, v124, v125
    v_cvt_pk_bf16_f32 v209, v126, v127
    v_cvt_pk_bf16_f32 v210, v140, v141
    v_cvt_pk_bf16_f32 v211, v142, v143
    v_cvt_pk_bf16_f32 v212, v156, v157
    v_cvt_pk_bf16_f32 v213, v158, v159
    v_cvt_pk_bf16_f32 v214, v172, v173
    v_cvt_pk_bf16_f32 v215, v174, v175
    s_cmp_eq_u32 s3, 0
    s_cbranch_scc0 FK_tb2
    s_waitcnt vmcnt(4)
    s_mov_b32 s5, 0
    s_branch FK_st_c
FK_st_l:
    buffer_load_dwordx4 v[248:251], v42, s[76:79], 0 offen sc1
    buffer_load_dword v252, v43, s[76:79], 0 offen sc1
    buffer_load_dwordx4 v[244:247], v44, s[76:79], 0 offen sc1
    s_waitcnt vmcnt(0)
FK_st_c:
    v_xor_b32 v2, s39, v248
    v_xor_b32 v249, s39, v249
    v_or_b32 v2, v2, v249
    v_xor_b32 v250, s39, v250
    v_or_b32 v2, v2, v250
    v_xor_b32 v251, s39, v251
    v_or_b32 v2, v2, v251
    v_xor_b32 v252, s39, v252
    v_or_b32 v2, v2, v252
    v_xor_b32 v244, s39, v244
    v_or_b32 v2, v2, v244
    v_xor_b32 v245, s39, v245
    v_or_b32 v2, v2, v245
    v_xor_b32 v246, s39, v246
    v_or_b32 v2, v2, v246
    v_xor_b32 v247, s39, v247
    v_or_b32 v2, v2, v247
    v_cmp_ne_u32 vcc, 0, v2
    s_add_u32 s5, s5, 1
    s_cmp_ge_u32 s5, 20000
    s_cbranch_scc1 FK_st_x
    s_nop 0
    s_cmp_eq_u64 vcc, 0
    s_cbranch_scc1 FK_st_x
    s_sleep 1
    s_branch FK_st_l
FK_st_x:
    s_cmp_eq_u32 s2, 0
    s_cbranch_scc0 FK_tb2
    s_mov_b32 s46, 0
    s_mov_b64 s[6:7], exec
    s_mov_b64 exec, 1
    v_mov_b32 v4, s39
    v_mov_b32 v5, 0
    buffer_store_dword v4, v5, s[76:79], s46 offen sc1
    s_mov_b64 exec, s[6:7]
FK_tb2:
    s_lshl_b32 s44, s40, 8
    s_lshl_b32 s45, s41, 5
    s_add_u32 s44, s44, s45
    s_mul_i32 s45, s3, 5
    s_cmp_eq_u32 s3, 3
    s_cselect_b32 s46, 1, 0
    s_sub_u32 s45, s45, s46
    s_mul_i32 s46, s42, 18
    s_add_u32 s46, s46, s45
    s_mul_i32 s46, s46, 9216
    s_lshl_b32 s47, s45, 17
    s_lshl_b32 s48, s44, 2
    s_add_u32 s47, s47, s48
    v_lshrrev_b32 v3, 4, v0
    v_and_b32 v4, 15, v0
    v_lshlrev_b32 v5, 15, v3
    v_lshl_add_u32 v5, v4, 2, v5
    v_mul_u32_u24 v6, 1152, v4
    v_lshl_add_u32 v6, v3, 3, v6
    v_lshlrev_b32 v2, 3, v0
    ds_read_b64_tr_b16 v[56:57], v34 offset:40960
    ds_read_b64_tr_b16 v[58:59], v34 offset:43008
    ds_read_b64_tr_b16 v[60:61], v35 offset:40960
    ds_read_b64_tr_b16 v[62:63], v35 offset:43008
    ds_read_b64_tr_b16 v[48:49], v36 offset:40960
    ds_read_b64_tr_b16 v[50:51], v36 offset:43008
    s_waitcnt lgkmcnt(4)
    v_mfma_f32_16x16x32_bf16 v[96:99], v[56:59], a[0:3], 0
    ds_read_b64_tr_b16 v[52:53], v37 offset:40960
    v_mfma_f32_16x16x32_bf16 v[100:103], v[56:59], a[4:7], 0
    ds_read_b64_tr_b16 v[54:55], v37 offset:43008
    v_mfma_f32_16x16x32_bf16 v[104:107], v[56:59], a[8:11], 0
    v_mfma_f32_16x16x32_bf16 v[108:111], v[56:59], a[12:15], 0
    s_waitcnt vmcnt(4)
    s_barrier
    s_waitcnt lgkmcnt(4)
    v_mfma_f32_16x16x32_bf16 v[112:115], v[60:63], a[0:3], 0
    ds_read_b64_tr_b16 v[56:57], v34 offset:45056
    v_mfma_f32_16x16x32_bf16 v[116:119], v[60:63], a[4:7], 0
    ds_read_b64_tr_b16 v[58:59], v34 offset:47104
    v_mfma_f32_16x16x32_bf16 v[120:123], v[60:63], a[8:11], 0
    s_add_u32 s32, s55, s58
    s_add_u32 m0, s35, 20480
    v_mfma_f32_16x16x32_bf16 v[124:127], v[60:63], a[12:15], 0
    buffer_load_dwordx4 v20, s[12:15], s32 offen lds
    s_waitcnt lgkmcnt(4)
    v_mfma_f32_16x16x32_bf16 v[128:131], v[48:51], a[0:3], 0
    ds_read_b64_tr_b16 v[60:61], v35 offset:45056
    v_mfma_f32_16x16x32_bf16 v[132:135], v[48:51], a[4:7], 0
    ds_read_b64_tr_b16 v[62:63], v35 offset:47104
    v_mfma_f32_16x16x32_bf16 v[136:139], v[48:51], a[8:11], 0
    s_add_u32 m0, s35, 21504
    v_mfma_f32_16x16x32_bf16 v[140:143], v[48:51], a[12:15], 0
    buffer_load_dwordx4 v21, s[12:15], s32 offen lds
    s_waitcnt lgkmcnt(4)
    v_mfma_f32_16x16x32_bf16 v[144:147], v[52:55], a[0:3], 0
    ds_read_b64_tr_b16 v[48:49], v36 offset:45056
    v_mfma_f32_16x16x32_bf16 v[148:151], v[52:55], a[4:7], 0
    ds_read_b64_tr_b16 v[50:51], v36 offset:47104
    v_mfma_f32_16x16x32_bf16 v[152:155], v[52:55], a[8:11], 0
    s_add_u32 m0, s35, 22528
    v_mfma_f32_16x16x32_bf16 v[156:159], v[52:55], a[12:15], 0
    buffer_load_dwordx4 v22, s[12:15], s32 offen lds
    s_waitcnt lgkmcnt(4)
    v_mfma_f32_16x16x32_bf16 v[96:99], v[56:59], a[16:19], v[96:99]
    ds_read_b64_tr_b16 v[52:53], v37 offset:45056
    v_mfma_f32_16x16x32_bf16 v[100:103], v[56:59], a[20:23], v[100:103]
    ds_read_b64_tr_b16 v[54:55], v37 offset:47104
    v_mfma_f32_16x16x32_bf16 v[104:107], v[56:59], a[24:27], v[104:107]
    v_mfma_f32_16x16x32_bf16 v[108:111], v[56:59], a[28:31], v[108:111]
    s_waitcnt lgkmcnt(4)
    v_mfma_f32_16x16x32_bf16 v[112:115], v[60:63], a[16:19], v[112:115]
    ds_read_b64_tr_b16 v[56:57], v34 offset:49152
    v_mfma_f32_16x16x32_bf16 v[116:119], v[60:63], a[20:23], v[116:119]
    ds_read_b64_tr_b16 v[58:59], v34 offset:51200
    v_mfma_f32_16x16x32_bf16 v[120:123], v[60:63], a[24:27], v[120:123]
    s_add_u32 m0, s35, 23552
    v_mfma_f32_16x16x32_bf16 v[124:127], v[60:63], a[28:31], v[124:127]
    buffer_load_dwordx4 v23, s[12:15], s32 offen lds
    s_waitcnt lgkmcnt(4)
    v_mfma_f32_16x16x32_bf16 v[128:131], v[48:51], a[16:19], v[128:131]
    ds_read_b64_tr_b16 v[60:61], v35 offset:49152
    v_mfma_f32_16x16x32_bf16 v[132:135], v[48:51], a[20:23], v[132:135]
    ds_read_b64_tr_b16 v[62:63], v35 offset:51200
    v_mfma_f32_16x16x32_bf16 v[136:139], v[48:51], a[24:27], v[136:139]
    s_add_u32 s51, s50, 0
    v_mfma_f32_16x16x32_bf16 v[140:143], v[48:51], a[28:31], v[140:143]
    buffer_store_dwordx4 v[176:179], v1, s[16:19], s51 offen sc1
    s_waitcnt lgkmcnt(4)
    v_mfma_f32_16x16x32_bf16 v[144:147], v[52:55], a[16:19], v[144:147]
    ds_read_b64_tr_b16 v[48:49], v36 offset:49152
    v_mfma_f32_16x16x32_bf16 v[148:151], v[52:55], a[20:23], v[148:151]
    ds_read_b64_tr_b16 v[50:51], v36 offset:51200
    v_mfma_f32_16x16x32_bf16 v[152:155], v[52:55], a[24:27], v[152:155]
    v_mfma_f32_16x16x32_bf16 v[156:159], v[52:55], a[28:31], v[156:159]
    s_waitcnt lgkmcnt(4)
    v_mfma_f32_16x16x32_bf16 v[96:99], v[56:59], a[32:35], v[96:99]
    ds_read_b64_tr_b16 v[52:53], v37 offset:49152
    v_mfma_f32_16x16x32_bf16 v[100:103], v[56:59], a[36:39], v[100:103]
    ds_read_b64_tr_b16 v[54:55], v37 offset:51200
    v_mfma_f32_16x16x32_bf16 v[104:107], v[56:59], a[40:43], v[104:107]
    buffer_store_dwordx4 v[180:183], v1, s[16:19], s51 offen offset:1024 sc1
    v_mfma_f32_16x16x32_bf16 v[108:111], v[56:59], a[44:47], v[108:111]
    s_waitcnt lgkmcnt(4)
    v_mfma_f32_16x16x32_bf16 v[112:115], v[60:63], a[32:35], v[112:115]
    ds_read_b64_tr_b16 v[56:57], v34 offset:53248
    v_mfma_f32_16x16x32_bf16 v[116:119], v[60:63], a[36:39], v[116:119]
    ds_read_b64_tr_b16 v[58:59], v34 offset:55296
    v_mfma_f32_16x16x32_bf16 v[120:123], v[60:63], a[40:43], v[120:123]
    buffer_store_dwordx2 v[184:185], v2, s[16:19], s51 offen offset:2048 sc1
    s_add_u32 s51, s50, 4608
    v_mfma_f32_16x16x32_bf16 v[124:127], v[60:63], a[44:47], v[124:127]
    s_waitcnt lgkmcnt(4)
    v_mfma_f32_16x16x32_bf16 v[128:131], v[48:51], a[32:35], v[128:131]
    ds_read_b64_tr_b16 v[60:61], v35 offset:53248
    v_mfma_f32_16x16x32_bf16 v[132:135], v[48:51], a[36:39], v[132:135]
    ds_read_b64_tr_b16 v[62:63], v35 offset:55296
    v_mfma_f32_16x16x32_bf16 v[136:139], v[48:51], a[40:43], v[136:139]
    buffer_store_dwordx4 v[186:189], v1, s[16:19], s51 offen sc1
    v_mfma_f32_16x16x32_bf16 v[140:143], v[48:51], a[44:47], v[140:143]
    s_waitcnt lgkmcnt(4)
    v_mfma_f32_16x16x32_bf16 v[144:147], v[52:55], a[32:35], v[144:147]
    ds_read_b64_tr_b16 v[48:49], v36 offset:53248
    v_mfma_f32_16x16x32_bf16 v[148:151], v[52:55], a[36:39], v[148:151]
    ds_read_b64_tr_b16 v[50:51], v36 offset:55296
    v_mfma_f32_16x16x32_bf16 v[152:155], v[52:55], a[40:43], v[152:155]
    v_mfma_f32_16x16x32_bf16 v[156:159], v[52:55], a[44:47], v[156:159]
    s_waitcnt lgkmcnt(4)
    v_mfma_f32_16x16x32_bf16 v[96:99], v[56:59], a[48:51], v[96:99]
    ds_read_b64_tr_b16 v[52:53], v37 offset:53248
    v_mfma_f32_16x16x32_bf16 v[100:103], v[56:59], a[52:55], v[100:103]
    ds_read_b64_tr_b16 v[54:55], v37 offset:55296
    v_mfma_f32_16x16x32_bf16 v[104:107], v[56:59], a[56:59], v[104:107]
    buffer_store_dwordx4 v[190:193], v1, s[16:19], s51 offen offset:1024 sc1
    v_mfma_f32_16x16x32_bf16 v[108:111], v[56:59], a[60:63], v[108:111]
    s_waitcnt lgkmcnt(4)
    v_mfma_f32_16x16x32_bf16 v[112:115], v[60:63], a[48:51], v[112:115]
    ds_read_b64_tr_b16 v[56:57], v38 offset:0
    v_mfma_f32_16x16x32_bf16 v[116:119], v[60:63], a[52:55], v[116:119]
    ds_read_b64_tr_b16 v[58:59], v38 offset:2048
    v_mfma_f32_16x16x32_bf16 v[120:123], v[60:63], a[56:59], v[120:123]
    buffer_store_dwordx2 v[194:195], v2, s[16:19], s51 offen offset:2048 sc1
    v_mfma_f32_16x16x32_bf16 v[124:127], v[60:63], a[60:63], v[124:127]
    s_waitcnt lgkmcnt(4)
    v_mfma_f32_16x16x32_bf16 v[128:131], v[48:51], a[48:51], v[128:131]
    ds_read_b64_tr_b16 v[60:61], v39 offset:0
    v_mfma_f32_16x16x32_bf16 v[132:135], v[48:51], a[52:55], v[132:135]
    ds_read_b64_tr_b16 v[62:63], v39 offset:2048
    v_mfma_f32_16x16x32_bf16 v[136:139], v[48:51], a[56:59], v[136:139]
    v_mfma_f32_16x16x32_bf16 v[140:143], v[48:51], a[60:63], v[140:143]
    s_waitcnt lgkmcnt(4)
    v_mfma_f32_16x16x32_bf16 v[144:147], v[52:55], a[48:51], v[144:147]
    ds_read_b64_tr_b16 v[48:49], v40 offset:0
    v_mfma_f32_16x16x32_bf16 v[148:151], v[52:55], a[52:55], v[148:151]
    ds_read_b64_tr_b16 v[50:51], v40 offset:2048
    v_mfma_f32_16x16x32_bf16 v[152:155], v[52:55], a[56:59], v[152:155]
    v_mfma_f32_16x16x32_bf16 v[156:159], v[52:55], a[60:63], v[156:159]
    s_waitcnt lgkmcnt(4)
    v_mfma_f32_16x16x32_bf16 v[96:99], v[56:59], a[64:67], v[96:99]
    ds_read_b64_tr_b16 v[52:53], v41 offset:0
    v_mfma_f32_16x16x32_bf16 v[100:103], v[56:59], a[68:71], v[100:103]
    ds_read_b64_tr_b16 v[54:55], v41 offset:2048
    v_mfma_f32_16x16x32_bf16 v[104:107], v[56:59], a[72:75], v[104:107]
    v_mfma_f32_16x16x32_bf16 v[108:111], v[56:59], a[76:79], v[108:111]
    s_waitcnt vmcnt(10)
    s_barrier
    s_waitcnt lgkmcnt(4)
    v_mfma_f32_16x16x32_bf16 v[112:115], v[60:63], a[64:67], v[112:115]
    ds_read_b64_tr_b16 v[56:57], v38 offset:4096
    v_mfma_f32_16x16x32_bf16 v[116:119], v[60:63], a[68:71], v[116:119]
    ds_read_b64_tr_b16 v[58:59], v38 offset:6144
    v_mfma_f32_16x16x32_bf16 v[120:123], v[60:63], a[72:75], v[120:123]
    s_add_u32 s32, s56, s58
    s_add_u32 m0, s35, 40960
    v_mfma_f32_16x16x32_bf16 v[124:127], v[60:63], a[76:79], v[124:127]
    buffer_load_dwordx4 v24, s[24:27], s32 offen lds
    s_waitcnt lgkmcnt(4)
    v_mfma_f32_16x16x32_bf16 v[128:131], v[48:51], a[64:67], v[128:131]
    ds_read_b64_tr_b16 v[60:61], v39 offset:4096
    v_mfma_f32_16x16x32_bf16 v[132:135], v[48:51], a[68:71], v[132:135]
    ds_read_b64_tr_b16 v[62:63], v39 offset:6144
    v_mfma_f32_16x16x32_bf16 v[136:139], v[48:51], a[72:75], v[136:139]
    s_add_u32 m0, s35, 41984
    v_mfma_f32_16x16x32_bf16 v[140:143], v[48:51], a[76:79], v[140:143]
    buffer_load_dwordx4 v25, s[24:27], s32 offen lds
    s_waitcnt lgkmcnt(4)
    v_mfma_f32_16x16x32_bf16 v[144:147], v[52:55], a[64:67], v[144:147]
    ds_read_b64_tr_b16 v[48:49], v40 offset:4096
    v_mfma_f32_16x16x32_bf16 v[148:151], v[52:55], a[68:71], v[148:151]
    ds_read_b64_tr_b16 v[50:51], v40 offset:6144
    v_mfma_f32_16x16x32_bf16 v[152:155], v[52:55], a[72:75], v[152:155]
    s_add_u32 m0, s35, 43008
    v_mfma_f32_16x16x32_bf16 v[156:159], v[52:55], a[76:79], v[156:159]
    buffer_load_dwordx4 v26, s[24:27], s32 offen lds
    s_waitcnt lgkmcnt(4)
    v_mfma_f32_16x16x32_bf16 v[96:99], v[56:59], a[80:83], v[96:99]
    ds_read_b64_tr_b16 v[52:53], v41 offset:4096
    v_mfma_f32_16x16x32_bf16 v[100:103], v[56:59], a[84:87], v[100:103]
    ds_read_b64_tr_b16 v[54:55], v41 offset:6144
    v_mfma_f32_16x16x32_bf16 v[104:107], v[56:59], a[88:91], v[104:107]
    s_add_u32 m0, s35, 44032
    v_mfma_f32_16x16x32_bf16 v[108:111], v[56:59], a[92:95], v[108:111]
    buffer_load_dwordx4 v27, s[24:27], s32 offen lds
    s_waitcnt lgkmcnt(4)
    v_mfma_f32_16x16x32_bf16 v[112:115], v[60:63], a[80:83], v[112:115]
    ds_read_b64_tr_b16 v[56:57], v38 offset:8192
    v_mfma_f32_16x16x32_bf16 v[116:119], v[60:63], a[84:87], v[116:119]
    ds_read_b64_tr_b16 v[58:59], v38 offset:10240
    v_mfma_f32_16x16x32_bf16 v[120:123], v[60:63], a[88:91], v[120:123]
    s_add_u32 s51, s50, 73728
    v_mfma_f32_16x16x32_bf16 v[124:127], v[60:63], a[92:95], v[124:127]
    buffer_store_dwordx4 v[196:199], v1, s[16:19], s51 offen sc1
    s_waitcnt lgkmcnt(4)
    v_mfma_f32_16x16x32_bf16 v[128:131], v[48:51], a[80:83], v[128:131]
    ds_read_b64_tr_b16 v[60:61], v39 offset:8192
    v_mfma_f32_16x16x32_bf16 v[132:135], v[48:51], a[84:87], v[132:135]
    ds_read_b64_tr_b16 v[62:63], v39 offset:10240
    v_mfma_f32_16x16x32_bf16 v[136:139], v[48:51], a[88:91], v[136:139]
    buffer_store_dwordx4 v[200:203], v1, s[16:19], s51 offen offset:1024 sc1
    v_mfma_f32_16x16x32_bf16 v[140:143], v[48:51], a[92:95], v[140:143]
    buffer_store_dwordx2 v[204:205], v2, s[16:19], s51 offen offset:2048 sc1
    s_waitcnt lgkmcnt(4)
    v_mfma_f32_16x16x32_bf16 v[144:147], v[52:55], a[80:83], v[144:147]
    ds_read_b64_tr_b16 v[48:49], v40 offset:8192
    v_mfma_f32_16x16x32_bf16 v[148:151], v[52:55], a[84:87], v[148:151]
    ds_read_b64_tr_b16 v[50:51], v40 offset:10240
    v_mfma_f32_16x16x32_bf16 v[152:155], v[52:55], a[88:91], v[152:155]
    s_add_u32 s51, s50, 78336
    v_mfma_f32_16x16x32_bf16 v[156:159], v[52:55], a[92:95], v[156:159]
    buffer_store_dwordx4 v[206:209], v1, s[16:19], s51 offen sc1
    s_waitcnt lgkmcnt(4)
    v_mfma_f32_16x16x32_bf16 v[96:99], v[56:59], a[96:99], v[96:99]
    ds_read_b64_tr_b16 v[52:53], v41 offset:8192
    v_mfma_f32_16x16x32_bf16 v[100:103], v[56:59], a[100:103], v[100:103]
    ds_read_b64_tr_b16 v[54:55], v41 offset:10240
    v_mfma_f32_16x16x32_bf16 v[104:107], v[56:59], a[104:107], v[104:107]
    buffer_store_dwordx4 v[210:213], v1, s[16:19], s51 offen offset:1024 sc1
    v_mfma_f32_16x16x32_bf16 v[108:111], v[56:59], a[108:111], v[108:111]
    buffer_store_dwordx2 v[214:215], v2, s[16:19], s51 offen offset:2048 sc1
    s_waitcnt lgkmcnt(4)
    v_mfma_f32_16x16x32_bf16 v[112:115], v[60:63], a[96:99], v[112:115]
    ds_read_b64_tr_b16 v[56:57], v38 offset:12288
    v_mfma_f32_16x16x32_bf16 v[116:119], v[60:63], a[100:103], v[116:119]
    ds_read_b64_tr_b16 v[58:59], v38 offset:14336
    v_mfma_f32_16x16x32_bf16 v[120:123], v[60:63], a[104:107], v[120:123]
    s_add_u32 s48, s47, 0
    v_mfma_f32_16x16x32_bf16 v[124:127], v[60:63], a[108:111], v[124:127]
    buffer_load_dword v10, v5, s[80:83], s48 offen offset:0 sc1
    s_waitcnt lgkmcnt(4)
    v_mfma_f32_16x16x32_bf16 v[128:131], v[48:51], a[96:99], v[128:131]
    ds_read_b64_tr_b16 v[60:61], v39 offset:12288
    v_mfma_f32_16x16x32_bf16 v[132:135], v[48:51], a[100:103], v[132:135]
    ds_read_b64_tr_b16 v[62:63], v39 offset:14336
    v_mfma_f32_16x16x32_bf16 v[136:139], v[48:51], a[104:107], v[136:139]
    buffer_load_dword v11, v5, s[80:83], s48 offen offset:64 sc1
    s_lshl_b32 s48, s44, 2
    v_mfma_f32_16x16x32_bf16 v[140:143], v[48:51], a[108:111], v[140:143]
    s_add_u32 s48, s48, 2359296
    s_waitcnt lgkmcnt(4)
    v_mfma_f32_16x16x32_bf16 v[144:147], v[52:55], a[96:99], v[144:147]
    ds_read_b64_tr_b16 v[48:49], v40 offset:12288
    v_mfma_f32_16x16x32_bf16 v[148:151], v[52:55], a[100:103], v[148:151]
    ds_read_b64_tr_b16 v[50:51], v40 offset:14336
    v_mfma_f32_16x16x32_bf16 v[152:155], v[52:55], a[104:107], v[152:155]
    buffer_load_dword v12, v5, s[80:83], s48 offen offset:0 sc1
    v_mfma_f32_16x16x32_bf16 v[156:159], v[52:55], a[108:111], v[156:159]
    buffer_load_dword v13, v5, s[80:83], s48 offen offset:64 sc1
    s_waitcnt lgkmcnt(4)
    v_mfma_f32_16x16x32_bf16 v[96:99], v[56:59], a[112:115], v[96:99]
    ds_read_b64_tr_b16 v[52:53], v41 offset:12288
    v_mfma_f32_16x16x32_bf16 v[100:103], v[56:59], a[116:119], v[100:103]
    ds_read_b64_tr_b16 v[54:55], v41 offset:14336
    v_mfma_f32_16x16x32_bf16 v[104:107], v[56:59], a[120:123], v[104:107]
    s_add_u32 s48, s47, 8192
    v_mfma_f32_16x16x32_bf16 v[108:111], v[56:59], a[124:127], v[108:111]
    buffer_load_dword a37, v5, s[80:83], s48 offen offset:0 sc1
    s_waitcnt lgkmcnt(4)
    v_mfma_f32_16x16x32_bf16 v[112:115], v[60:63], a[112:115], v[112:115]
    ds_read_b64_tr_b16 v[56:57], v34 offset:0
    v_mfma_f32_16x16x32_bf16 v[116:119], v[60:63], a[116:119], v[116:119]
    ds_read_b64_tr_b16 v[58:59], v34 offset:2048
    v_mfma_f32_16x16x32_bf16 v[120:123], v[60:63], a[120:123], v[120:123]
    buffer_load_dword a41, v5, s[80:83], s48 offen offset:64 sc1
    s_add_u32 s48, s47, 16384
    v_mfma_f32_16x16x32_bf16 v[124:127], v[60:63], a[124:127], v[124:127]
    buffer_load_dword a38, v5, s[80:83], s48 offen offset:0 sc1
    s_waitcnt lgkmcnt(4)
    v_mfma_f32_16x16x32_bf16 v[128:131], v[48:51], a[112:115], v[128:131]
    ds_read_b64_tr_b16 v[60:61], v35 offset:0
    v_mfma_f32_16x16x32_bf16 v[132:135], v[48:51], a[116:119], v[132:135]
    ds_read_b64_tr_b16 v[62:63], v35 offset:2048
    v_mfma_f32_16x16x32_bf16 v[136:139], v[48:51], a[120:123], v[136:139]
    buffer_load_dword a42, v5, s[80:83], s48 offen offset:64 sc1
    s_add_u32 s48, s47, 24576
    v_mfma_f32_16x16x32_bf16 v[140:143], v[48:51], a[124:127], v[140:143]
    buffer_load_dword a39, v5, s[80:83], s48 offen offset:0 sc1
    s_waitcnt lgkmcnt(4)
    v_mfma_f32_16x16x32_bf16 v[144:147], v[52:55], a[112:115], v[144:147]
    ds_read_b64_tr_b16 v[48:49], v36 offset:0
    v_mfma_f32_16x16x32_bf16 v[148:151], v[52:55], a[116:119], v[148:151]
    ds_read_b64_tr_b16 v[50:51], v36 offset:2048
    v_mfma_f32_16x16x32_bf16 v[152:155], v[52:55], a[120:123], v[152:155]
    buffer_load_dword a43, v5, s[80:83], s48 offen offset:64 sc1
    s_add_u32 s48, s46, 0
    v_mfma_f32_16x16x32_bf16 v[156:159], v[52:55], a[124:127], v[156:159]
    buffer_load_dwordx4 a[0:3], v1, s[84:87], s48 offen offset:0
    buffer_load_dwordx4 a[4:7], v1, s[84:87], s48 offen offset:1024
    buffer_load_dwordx4 a[8:11], v1, s[84:87], s48 offen offset:2048
    buffer_load_dwordx4 a[12:15], v1, s[84:87], s48 offen offset:3072
    s_add_u32 s48, s46, 4096
    buffer_load_dwordx4 a[16:19], v1, s[84:87], s48 offen offset:0
    buffer_load_dwordx4 a[20:23], v1, s[84:87], s48 offen offset:1024
    buffer_load_dwordx4 a[24:27], v1, s[84:87], s48 offen offset:2048
    buffer_load_dwordx4 a[28:31], v1, s[84:87], s48 offen offset:3072
    s_add_u32 s48, s46, 8192
    buffer_load_dwordx4 a[32:35], v1, s[84:87], s48 offen offset:0
    s_add_u32 s46, s46, 9216
    s_add_u32 s47, s47, 131072
    s_waitcnt lgkmcnt(4)
    v_mfma_f32_16x16x32_bf16 v[96:99], v[56:59], a[128:131], v[96:99]
    ds_read_b64_tr_b16 v[52:53], v37 offset:0
    v_mfma_f32_16x16x32_bf16 v[100:103], v[56:59], a[132:135], v[100:103]
    ds_read_b64_tr_b16 v[54:55], v37 offset:2048
    v_mfma_f32_16x16x32_bf16 v[104:107], v[56:59], a[136:139], v[104:107]
    v_mfma_f32_16x16x32_bf16 v[108:111], v[56:59], a[140:143], v[108:111]
    s_waitcnt vmcnt(35)
    s_barrier
    s_waitcnt lgkmcnt(4)
    v_mfma_f32_16x16x32_bf16 v[112:115], v[60:63], a[128:131], v[112:115]
    ds_read_b64_tr_b16 v[56:57], v34 offset:4096
    v_mfma_f32_16x16x32_bf16 v[116:119], v[60:63], a[132:135], v[116:119]
    ds_read_b64_tr_b16 v[58:59], v34 offset:6144
    v_mfma_f32_16x16x32_bf16 v[120:123], v[60:63], a[136:139], v[120:123]
    s_add_u32 s48, s47, 0
    v_mfma_f32_16x16x32_bf16 v[124:127], v[60:63], a[140:143], v[124:127]
    buffer_load_dword a80, v5, s[80:83], s48 offen offset:0 sc1
    s_waitcnt lgkmcnt(4)
    v_mfma_f32_16x16x32_bf16 v[128:131], v[48:51], a[128:131], v[128:131]
    ds_read_b64_tr_b16 v[60:61], v35 offset:4096
    v_mfma_f32_16x16x32_bf16 v[132:135], v[48:51], a[132:135], v[132:135]
    ds_read_b64_tr_b16 v[62:63], v35 offset:6144
    v_mfma_f32_16x16x32_bf16 v[136:139], v[48:51], a[136:139], v[136:139]
    buffer_load_dword a84, v5, s[80:83], s48 offen offset:64 sc1
    s_add_u32 s48, s47, 8192
    v_mfma_f32_16x16x32_bf16 v[140:143], v[48:51], a[140:143], v[140:143]
    buffer_load_dword a81, v5, s[80:83], s48 offen offset:0 sc1
    s_waitcnt lgkmcnt(4)
    v_mfma_f32_16x16x32_bf16 v[144:147], v[52:55], a[128:131], v[144:147]
    ds_read_b64_tr_b16 v[48:49], v36 offset:4096
    v_mfma_f32_16x16x32_bf16 v[148:151], v[52:55], a[132:135], v[148:151]
    ds_read_b64_tr_b16 v[50:51], v36 offset:6144
    v_mfma_f32_16x16x32_bf16 v[152:155], v[52:55], a[136:139], v[152:155]
    buffer_load_dword a85, v5, s[80:83], s48 offen offset:64 sc1
    s_add_u32 s48, s47, 16384
    v_mfma_f32_16x16x32_bf16 v[156:159], v[52:55], a[140:143], v[156:159]
    s_waitcnt lgkmcnt(4)
    v_mfma_f32_16x16x32_bf16 v[96:99], v[56:59], a[144:147], v[96:99]
    ds_read_b64_tr_b16 v[52:53], v37 offset:4096
    v_mfma_f32_16x16x32_bf16 v[100:103], v[56:59], a[148:151], v[100:103]
    ds_read_b64_tr_b16 v[54:55], v37 offset:6144
    v_mfma_f32_16x16x32_bf16 v[104:107], v[56:59], a[152:155], v[104:107]
    buffer_load_dword a82, v5, s[80:83], s48 offen offset:0 sc1
    v_mfma_f32_16x16x32_bf16 v[108:111], v[56:59], a[156:159], v[108:111]
    s_waitcnt lgkmcnt(4)
    v_mfma_f32_16x16x32_bf16 v[112:115], v[60:63], a[144:147], v[112:115]
    ds_read_b64_tr_b16 v[56:57], v34 offset:8192
    v_mfma_f32_16x16x32_bf16 v[116:119], v[60:63], a[148:151], v[116:119]
    ds_read_b64_tr_b16 v[58:59], v34 offset:10240
    v_mfma_f32_16x16x32_bf16 v[120:123], v[60:63], a[152:155], v[120:123]
    buffer_load_dword a86, v5, s[80:83], s48 offen offset:64 sc1
    s_add_u32 s48, s47, 24576
    v_mfma_f32_16x16x32_bf16 v[124:127], v[60:63], a[156:159], v[124:127]
    buffer_load_dword a83, v5, s[80:83], s48 offen offset:0 sc1
    s_waitcnt lgkmcnt(4)
    v_mfma_f32_16x16x32_bf16 v[128:131], v[48:51], a[144:147], v[128:131]
    ds_read_b64_tr_b16 v[60:61], v35 offset:8192
    v_mfma_f32_16x16x32_bf16 v[132:135], v[48:51], a[148:151], v[132:135]
    ds_read_b64_tr_b16 v[62:63], v35 offset:10240
    v_mfma_f32_16x16x32_bf16 v[136:139], v[48:51], a[152:155], v[136:139]
    buffer_load_dword a87, v5, s[80:83], s48 offen offset:64 sc1
    s_add_u32 s48, s46, 0
    v_mfma_f32_16x16x32_bf16 v[140:143], v[48:51], a[156:159], v[140:143]
    s_waitcnt lgkmcnt(4)
    v_mfma_f32_16x16x32_bf16 v[144:147], v[52:55], a[144:147], v[144:147]
    ds_read_b64_tr_b16 v[48:49], v36 offset:8192
    v_mfma_f32_16x16x32_bf16 v[148:151], v[52:55], a[148:151], v[148:151]
    ds_read_b64_tr_b16 v[50:51], v36 offset:10240
    v_mfma_f32_16x16x32_bf16 v[152:155], v[52:55], a[152:155], v[152:155]
    buffer_load_dwordx4 a[44:47], v1, s[84:87], s48 offen offset:0
    v_mfma_f32_16x16x32_bf16 v[156:159], v[52:55], a[156:159], v[156:159]
    s_waitcnt lgkmcnt(4)
    v_mfma_f32_16x16x32_bf16 v[96:99], v[56:59], a[160:163], v[96:99]
    ds_read_b64_tr_b16 v[52:53], v37 offset:8192
    v_mfma_f32_16x16x32_bf16 v[100:103], v[56:59], a[164:167], v[100:103]
    ds_read_b64_tr_b16 v[54:55], v37 offset:10240
    v_mfma_f32_16x16x32_bf16 v[104:107], v[56:59], a[168:171], v[104:107]
    buffer_load_dwordx4 a[48:51], v1, s[84:87], s48 offen offset:1024
    v_mfma_f32_16x16x32_bf16 v[108:111], v[56:59], a[172:175], v[108:111]
    s_waitcnt lgkmcnt(4)
    v_mfma_f32_16x16x32_bf16 v[112:115], v[60:63], a[160:163], v[112:115]
    ds_read_b64_tr_b16 v[56:57], v34 offset:12288
    v_mfma_f32_16x16x32_bf16 v[116:119], v[60:63], a[164:167], v[116:119]
    ds_read_b64_tr_b16 v[58:59], v34 offset:14336
    v_mfma_f32_16x16x32_bf16 v[120:123], v[60:63], a[168:171], v[120:123]
    buffer_load_dwordx4 a[52:55], v1, s[84:87], s48 offen offset:2048
    v_mfma_f32_16x16x32_bf16 v[124:127], v[60:63], a[172:175], v[124:127]
    s_waitcnt lgkmcnt(4)
    v_mfma_f32_16x16x32_bf16 v[128:131], v[48:51], a[160:163], v[128:131]
    ds_read_b64_tr_b16 v[60:61], v35 offset:12288
    v_mfma_f32_16x16x32_bf16 v[132:135], v[48:51], a[164:167], v[132:135]
    ds_read_b64_tr_b16 v[62:63], v35 offset:14336
    v_mfma_f32_16x16x32_bf16 v[136:139], v[48:51], a[168:171], v[136:139]
    buffer_load_dwordx4 a[56:59], v1, s[84:87], s48 offen offset:3072
    s_add_u32 s48, s46, 4096
    v_mfma_f32_16x16x32_bf16 v[140:143], v[48:51], a[172:175], v[140:143]
    buffer_load_dwordx4 a[60:63], v1, s[84:87], s48 offen offset:0
    s_waitcnt lgkmcnt(4)
    v_mfma_f32_16x16x32_bf16 v[144:147], v[52:55], a[160:163], v[144:147]
    ds_read_b64_tr_b16 v[48:49], v36 offset:12288
    v_mfma_f32_16x16x32_bf16 v[148:151], v[52:55], a[164:167], v[148:151]
    ds_read_b64_tr_b16 v[50:51], v36 offset:14336
    v_mfma_f32_16x16x32_bf16 v[152:155], v[52:55], a[168:171], v[152:155]
    buffer_load_dwordx4 a[64:67], v1, s[84:87], s48 offen offset:1024
    v_mfma_f32_16x16x32_bf16 v[156:159], v[52:55], a[172:175], v[156:159]
    s_waitcnt lgkmcnt(4)
    v_mfma_f32_16x16x32_bf16 v[96:99], v[56:59], a[176:179], v[96:99]
    ds_read_b64_tr_b16 v[52:53], v37 offset:12288
    v_mfma_f32_16x16x32_bf16 v[100:103], v[56:59], a[180:183], v[100:103]
    ds_read_b64_tr_b16 v[54:55], v37 offset:14336
    v_mfma_f32_16x16x32_bf16 v[104:107], v[56:59], a[184:187], v[104:107]
    buffer_load_dwordx4 a[68:71], v1, s[84:87], s48 offen offset:2048
    v_mfma_f32_16x16x32_bf16 v[108:111], v[56:59], a[188:191], v[108:111]
    s_waitcnt lgkmcnt(4)
    v_mfma_f32_16x16x32_bf16 v[112:115], v[60:63], a[176:179], v[112:115]
    ds_read_b64_tr_b16 v[56:57], v34 offset:20480
    v_mfma_f32_16x16x32_bf16 v[116:119], v[60:63], a[180:183], v[116:119]
    ds_read_b64_tr_b16 v[58:59], v34 offset:22528
    v_mfma_f32_16x16x32_bf16 v[120:123], v[60:63], a[184:187], v[120:123]
    buffer_load_dwordx4 a[72:75], v1, s[84:87], s48 offen offset:3072
    s_add_u32 s48, s46, 8192
    v_mfma_f32_16x16x32_bf16 v[124:127], v[60:63], a[188:191], v[124:127]
    s_waitcnt lgkmcnt(4)
    v_mfma_f32_16x16x32_bf16 v[128:131], v[48:51], a[176:179], v[128:131]
    ds_read_b64_tr_b16 v[60:61], v35 offset:20480
    v_mfma_f32_16x16x32_bf16 v[132:135], v[48:51], a[180:183], v[132:135]
    ds_read_b64_tr_b16 v[62:63], v35 offset:22528
    v_mfma_f32_16x16x32_bf16 v[136:139], v[48:51], a[184:187], v[136:139]
    buffer_load_dwordx4 a[76:79], v1, s[84:87], s48 offen offset:0
    s_add_u32 s46, s46, 9216
    v_mfma_f32_16x16x32_bf16 v[140:143], v[48:51], a[188:191], v[140:143]
    s_add_u32 s47, s47, 131072
    s_waitcnt lgkmcnt(4)
    v_mfma_f32_16x16x32_bf16 v[144:147], v[52:55], a[176:179], v[144:147]
    ds_read_b64_tr_b16 v[48:49], v36 offset:20480
    v_mfma_f32_16x16x32_bf16 v[148:151], v[52:55], a[180:183], v[148:151]
    ds_read_b64_tr_b16 v[50:51], v36 offset:22528
    v_mfma_f32_16x16x32_bf16 v[152:155], v[52:55], a[184:187], v[152:155]
    v_mfma_f32_16x16x32_bf16 v[156:159], v[52:55], a[188:191], v[156:159]
    s_waitcnt lgkmcnt(4)
    v_mfma_f32_16x16x32_bf16 v[96:99], v[56:59], a[192:195], v[96:99]
    ds_read_b64_tr_b16 v[52:53], v37 offset:20480
    v_mfma_f32_16x16x32_bf16 v[100:103], v[56:59], a[196:199], v[100:103]
    ds_read_b64_tr_b16 v[54:55], v37 offset:22528
    v_mfma_f32_16x16x32_bf16 v[104:107], v[56:59], a[200:203], v[104:107]
    v_mfma_f32_16x16x32_bf16 v[108:111], v[56:59], a[204:207], v[108:111]
    s_waitcnt vmcnt(36)
    s_barrier
    s_cmp_eq_u32 s3, 0
    s_cbranch_scc0 FK_fpa
    s_lshl_b32 s90, s40, 2
    s_add_u32 s90, s90, s42
    s_lshl_b32 s90, s90, 7
    s_lshl_b32 s91, s41, 2
    s_add_u32 s90, s90, s91
    s_add_u32 s90, s90, 49152
    s_mov_b64 s[6:7], exec
    s_mov_b64 exec, 1
    v_mov_b32 v46, s39
    v_mov_b32 v47, 0
    buffer_store_dword v46, v47, s[76:79], s90 offen sc1
    s_mov_b64 exec, s[6:7]
FK_fpa:
    s_waitcnt lgkmcnt(4)
    v_mfma_f32_16x16x32_bf16 v[112:115], v[60:63], a[192:195], v[112:115]
    ds_read_b64_tr_b16 v[56:57], v34 offset:24576
    v_mfma_f32_16x16x32_bf16 v[116:119], v[60:63], a[196:199], v[116:119]
    ds_read_b64_tr_b16 v[58:59], v34 offset:26624
    v_mfma_f32_16x16x32_bf16 v[120:123], v[60:63], a[200:203], v[120:123]
    s_add_u32 s48, s47, 0
    v_mfma_f32_16x16x32_bf16 v[124:127], v[60:63], a[204:207], v[124:127]
    buffer_load_dword a124, v5, s[80:83], s48 offen offset:0 sc1
    s_waitcnt lgkmcnt(4)
    v_mfma_f32_16x16x32_bf16 v[128:131], v[48:51], a[192:195], v[128:131]
    ds_read_b64_tr_b16 v[60:61], v35 offset:24576
    v_mfma_f32_16x16x32_bf16 v[132:135], v[48:51], a[196:199], v[132:135]
    ds_read_b64_tr_b16 v[62:63], v35 offset:26624
    v_mfma_f32_16x16x32_bf16 v[136:139], v[48:51], a[200:203], v[136:139]
    buffer_load_dword a128, v5, s[80:83], s48 offen offset:64 sc1
    s_add_u32 s48, s47, 8192
    v_mfma_f32_16x16x32_bf16 v[140:143], v[48:51], a[204:207], v[140:143]
    buffer_load_dword a125, v5, s[80:83], s48 offen offset:0 sc1
    s_waitcnt lgkmcnt(4)
    v_mfma_f32_16x16x32_bf16 v[144:147], v[52:55], a[192:195], v[144:147]
    ds_read_b64_tr_b16 v[48:49], v36 offset:24576
    v_mfma_f32_16x16x32_bf16 v[148:151], v[52:55], a[196:199], v[148:151]
    ds_read_b64_tr_b16 v[50:51], v36 offset:26624
    v_mfma_f32_16x16x32_bf16 v[152:155], v[52:55], a[200:203], v[152:155]
    buffer_load_dword a129, v5, s[80:83], s48 offen offset:64 sc1
    s_add_u32 s48, s47, 16384
    v_mfma_f32_16x16x32_bf16 v[156:159], v[52:55], a[204:207], v[156:159]
    buffer_load_dword a126, v5, s[80:83], s48 offen offset:0 sc1
    s_waitcnt lgkmcnt(4)
    v_mfma_f32_16x16x32_bf16 v[96:99], v[56:59], a[208:211], v[96:99]
    ds_read_b64_tr_b16 v[52:53], v37 offset:24576
    v_mfma_f32_16x16x32_bf16 v[100:103], v[56:59], a[212:215], v[100:103]
    ds_read_b64_tr_b16 v[54:55], v37 offset:26624
    v_mfma_f32_16x16x32_bf16 v[104:107], v[56:59], a[216:219], v[104:107]
    buffer_load_dword a130, v5, s[80:83], s48 offen offset:64 sc1
    s_add_u32 s48, s47, 24576
    v_mfma_f32_16x16x32_bf16 v[108:111], v[56:59], a[220:223], v[108:111]
    buffer_load_dword a127, v5, s[80:83], s48 offen offset:0 sc1
    s_waitcnt lgkmcnt(4)
    v_mfma_f32_16x16x32_bf16 v[112:115], v[60:63], a[208:211], v[112:115]
    ds_read_b64_tr_b16 v[56:57], v34 offset:28672
    v_mfma_f32_16x16x32_bf16 v[116:119], v[60:63], a[212:215], v[116:119]
    ds_read_b64_tr_b16 v[58:59], v34 offset:30720
    v_mfma_f32_16x16x32_bf16 v[120:123], v[60:63], a[216:219], v[120:123]
    buffer_load_dword a131, v5, s[80:83], s48 offen offset:64 sc1
    s_add_u32 s48, s46, 0
    v_mfma_f32_16x16x32_bf16 v[124:127], v[60:63], a[220:223], v[124:127]
    buffer_load_dwordx4 a[88:91], v1, s[84:87], s48 offen offset:0
    s_waitcnt lgkmcnt(4)
    v_mfma_f32_16x16x32_bf16 v[128:131], v[48:51], a[208:211], v[128:131]
    ds_read_b64_tr_b16 v[60:61], v35 offset:28672
    v_mfma_f32_16x16x32_bf16 v[132:135], v[48:51], a[212:215], v[132:135]
    ds_read_b64_tr_b16 v[62:63], v35 offset:30720
    v_mfma_f32_16x16x32_bf16 v[136:139], v[48:51], a[216:219], v[136:139]
    buffer_load_dwordx4 a[92:95], v1, s[84:87], s48 offen offset:1024
    v_mfma_f32_16x16x32_bf16 v[140:143], v[48:51], a[220:223], v[140:143]
    buffer_load_dwordx4 a[96:99], v1, s[84:87], s48 offen offset:2048
    s_waitcnt lgkmcnt(4)
    v_mfma_f32_16x16x32_bf16 v[144:147], v[52:55], a[208:211], v[144:147]
    ds_read_b64_tr_b16 v[48:49], v36 offset:28672
    v_mfma_f32_16x16x32_bf16 v[148:151], v[52:55], a[212:215], v[148:151]
    ds_read_b64_tr_b16 v[50:51], v36 offset:30720
    v_mfma_f32_16x16x32_bf16 v[152:155], v[52:55], a[216:219], v[152:155]
    buffer_load_dwordx4 a[100:103], v1, s[84:87], s48 offen offset:3072
    s_add_u32 s48, s46, 4096
    v_mfma_f32_16x16x32_bf16 v[156:159], v[52:55], a[220:223], v[156:159]
    buffer_load_dwordx4 a[104:107], v1, s[84:87], s48 offen offset:0
    s_waitcnt lgkmcnt(4)
    v_mfma_f32_16x16x32_bf16 v[96:99], v[56:59], a[224:227], v[96:99]
    ds_read_b64_tr_b16 v[52:53], v37 offset:28672
    v_mfma_f32_16x16x32_bf16 v[100:103], v[56:59], a[228:231], v[100:103]
    ds_read_b64_tr_b16 v[54:55], v37 offset:30720
    v_mfma_f32_16x16x32_bf16 v[104:107], v[56:59], a[232:235], v[104:107]
    buffer_load_dwordx4 a[108:111], v1, s[84:87], s48 offen offset:1024
    v_mfma_f32_16x16x32_bf16 v[108:111], v[56:59], a[236:239], v[108:111]
    buffer_load_dwordx4 a[112:115], v1, s[84:87], s48 offen offset:2048
    s_waitcnt lgkmcnt(4)
    v_mfma_f32_16x16x32_bf16 v[112:115], v[60:63], a[224:227], v[112:115]
    ds_read_b64_tr_b16 v[56:57], v34 offset:32768
    v_mfma_f32_16x16x32_bf16 v[116:119], v[60:63], a[228:231], v[116:119]
    ds_read_b64_tr_b16 v[58:59], v34 offset:34816
    v_mfma_f32_16x16x32_bf16 v[120:123], v[60:63], a[232:235], v[120:123]
    buffer_load_dwordx4 a[116:119], v1, s[84:87], s48 offen offset:3072
    s_add_u32 s48, s46, 8192
    v_mfma_f32_16x16x32_bf16 v[124:127], v[60:63], a[236:239], v[124:127]
    buffer_load_dwordx4 a[120:123], v1, s[84:87], s48 offen offset:0
    s_waitcnt lgkmcnt(4)
    v_mfma_f32_16x16x32_bf16 v[128:131], v[48:51], a[224:227], v[128:131]
    ds_read_b64_tr_b16 v[60:61], v35 offset:32768
    v_mfma_f32_16x16x32_bf16 v[132:135], v[48:51], a[228:231], v[132:135]
    ds_read_b64_tr_b16 v[62:63], v35 offset:34816
    v_mfma_f32_16x16x32_bf16 v[136:139], v[48:51], a[232:235], v[136:139]
    s_add_u32 s46, s46, 9216
    s_add_u32 s47, s47, 131072
    v_mfma_f32_16x16x32_bf16 v[140:143], v[48:51], a[236:239], v[140:143]
    s_add_u32 s48, s47, 0
    s_waitcnt lgkmcnt(4)
    v_mfma_f32_16x16x32_bf16 v[144:147], v[52:55], a[224:227], v[144:147]
    ds_read_b64_tr_b16 v[48:49], v36 offset:32768
    v_mfma_f32_16x16x32_bf16 v[148:151], v[52:55], a[228:231], v[148:151]
    ds_read_b64_tr_b16 v[50:51], v36 offset:34816
    v_mfma_f32_16x16x32_bf16 v[152:155], v[52:55], a[232:235], v[152:155]
    buffer_load_dword a168, v5, s[80:83], s48 offen offset:0 sc1
    v_mfma_f32_16x16x32_bf16 v[156:159], v[52:55], a[236:239], v[156:159]
    buffer_load_dword a172, v5, s[80:83], s48 offen offset:64 sc1
    s_waitcnt lgkmcnt(4)
    v_mfma_f32_16x16x32_bf16 v[96:99], v[56:59], a[240:243], v[96:99]
    ds_read_b64_tr_b16 v[52:53], v37 offset:32768
    v_mfma_f32_16x16x32_bf16 v[100:103], v[56:59], a[244:247], v[100:103]
    ds_read_b64_tr_b16 v[54:55], v37 offset:34816
    v_mfma_f32_16x16x32_bf16 v[104:107], v[56:59], a[248:251], v[104:107]
    s_add_u32 s48, s47, 8192
    v_mfma_f32_16x16x32_bf16 v[108:111], v[56:59], a[252:255], v[108:111]
    buffer_load_dword a169, v5, s[80:83], s48 offen offset:0 sc1
    s_waitcnt lgkmcnt(4)
    v_mfma_f32_16x16x32_bf16 v[112:115], v[60:63], a[240:243], v[112:115]
    ds_read_b64_tr_b16 v[56:57], v34 offset:40960
    v_mfma_f32_16x16x32_bf16 v[116:119], v[60:63], a[244:247], v[116:119]
    ds_read_b64_tr_b16 v[58:59], v34 offset:43008
    v_mfma_f32_16x16x32_bf16 v[120:123], v[60:63], a[248:251], v[120:123]
    buffer_load_dword a173, v5, s[80:83], s48 offen offset:64 sc1
    s_add_u32 s48, s47, 16384
    v_mfma_f32_16x16x32_bf16 v[124:127], v[60:63], a[252:255], v[124:127]
    buffer_load_dword a170, v5, s[80:83], s48 offen offset:0 sc1
    s_waitcnt lgkmcnt(4)
    v_mfma_f32_16x16x32_bf16 v[128:131], v[48:51], a[240:243], v[128:131]
    ds_read_b64_tr_b16 v[60:61], v35 offset:40960
    v_mfma_f32_16x16x32_bf16 v[132:135], v[48:51], a[244:247], v[132:135]
    ds_read_b64_tr_b16 v[62:63], v35 offset:43008
    v_mfma_f32_16x16x32_bf16 v[136:139], v[48:51], a[248:251], v[136:139]
    buffer_load_dword a174, v5, s[80:83], s48 offen offset:64 sc1
    s_add_u32 s48, s47, 24576
    v_mfma_f32_16x16x32_bf16 v[140:143], v[48:51], a[252:255], v[140:143]
    buffer_load_dword a171, v5, s[80:83], s48 offen offset:0 sc1
    s_waitcnt lgkmcnt(4)
    v_mfma_f32_16x16x32_bf16 v[144:147], v[52:55], a[240:243], v[144:147]
    ds_read_b64_tr_b16 v[48:49], v36 offset:40960
    v_mfma_f32_16x16x32_bf16 v[148:151], v[52:55], a[244:247], v[148:151]
    ds_read_b64_tr_b16 v[50:51], v36 offset:43008
    v_mfma_f32_16x16x32_bf16 v[152:155], v[52:55], a[248:251], v[152:155]
    s_waitcnt vmcnt(54)
    buffer_load_dword a175, v5, s[80:83], s48 offen offset:64 sc1
    s_add_u32 s48, s46, 0
    v_mfma_f32_16x16x32_bf16 v[156:159], v[52:55], a[252:255], v[156:159]
    buffer_load_dwordx4 a[132:135], v1, s[84:87], s48 offen offset:0
    buffer_load_dwordx4 a[136:139], v1, s[84:87], s48 offen offset:1024
    buffer_load_dwordx4 a[140:143], v1, s[84:87], s48 offen offset:2048
    buffer_load_dwordx4 a[144:147], v1, s[84:87], s48 offen offset:3072
    s_add_u32 s48, s46, 4096
    buffer_load_dwordx4 a[148:151], v1, s[84:87], s48 offen offset:0
    buffer_load_dwordx4 a[152:155], v1, s[84:87], s48 offen offset:1024
    s_waitcnt vmcnt(54)
    buffer_load_dwordx4 a[156:159], v1, s[84:87], s48 offen offset:2048
    buffer_load_dwordx4 a[160:163], v1, s[84:87], s48 offen offset:3072
    s_add_u32 s48, s46, 8192
    buffer_load_dwordx4 a[164:167], v1, s[84:87], s48 offen offset:0
    s_add_u32 s46, s46, 9216
    s_add_u32 s47, s47, 131072
    s_waitcnt lgkmcnt(4)
    v_mfma_f32_16x16x32_bf16 v[96:99], v[56:59], v[64:67], v[96:99]
    ds_read_b64_tr_b16 v[52:53], v37 offset:40960
    v_mfma_f32_16x16x32_bf16 v[100:103], v[56:59], v[68:71], v[100:103]
    ds_read_b64_tr_b16 v[54:55], v37 offset:43008
    v_mfma_f32_16x16x32_bf16 v[104:107], v[56:59], v[72:75], v[104:107]
    v_mfma_f32_16x16x32_bf16 v[108:111], v[56:59], v[76:79], v[108:111]
    s_barrier
    buffer_load_dword v46, v45, s[76:79], 0 offen sc1
    s_waitcnt lgkmcnt(4)
    v_mfma_f32_16x16x32_bf16 v[112:115], v[60:63], v[64:67], v[112:115]
    ds_read_b64_tr_b16 v[56:57], v34 offset:45056
    v_mfma_f32_16x16x32_bf16 v[116:119], v[60:63], v[68:71], v[116:119]
    ds_read_b64_tr_b16 v[58:59], v34 offset:47104
    v_mfma_f32_16x16x32_bf16 v[120:123], v[60:63], v[72:75], v[120:123]
    s_cmp_ge_u32 s3, 2
    s_cselect_b32 s47, 0x242000, s47
    v_mfma_f32_16x16x32_bf16 v[124:127], v[60:63], v[76:79], v[124:127]
    s_cselect_b32 s46, 0, s46
    s_waitcnt lgkmcnt(4)
    v_mfma_f32_16x16x32_bf16 v[128:131], v[48:51], v[64:67], v[128:131]
    ds_read_b64_tr_b16 v[60:61], v35 offset:45056
    v_mfma_f32_16x16x32_bf16 v[132:135], v[48:51], v[68:71], v[132:135]
    ds_read_b64_tr_b16 v[62:63], v35 offset:47104
    v_mfma_f32_16x16x32_bf16 v[136:139], v[48:51], v[72:75], v[136:139]
    s_add_u32 s48, s47, 0
    v_mfma_f32_16x16x32_bf16 v[140:143], v[48:51], v[76:79], v[140:143]
    buffer_load_dword a212, v5, s[80:83], s48 offen offset:0 sc1
    s_waitcnt lgkmcnt(4)
    v_mfma_f32_16x16x32_bf16 v[144:147], v[52:55], v[64:67], v[144:147]
    ds_read_b64_tr_b16 v[48:49], v36 offset:45056
    v_mfma_f32_16x16x32_bf16 v[148:151], v[52:55], v[68:71], v[148:151]
    ds_read_b64_tr_b16 v[50:51], v36 offset:47104
    v_mfma_f32_16x16x32_bf16 v[152:155], v[52:55], v[72:75], v[152:155]
    buffer_load_dword a216, v5, s[80:83], s48 offen offset:64 sc1
    s_add_u32 s48, s47, 8192
    v_mfma_f32_16x16x32_bf16 v[156:159], v[52:55], v[76:79], v[156:159]
    buffer_load_dword a213, v5, s[80:83], s48 offen offset:0 sc1
    s_waitcnt lgkmcnt(4)
    v_mfma_f32_16x16x32_bf16 v[96:99], v[56:59], v[80:83], v[96:99]
    ds_read_b64_tr_b16 v[52:53], v37 offset:45056
    v_mfma_f32_16x16x32_bf16 v[100:103], v[56:59], v[84:87], v[100:103]
    ds_read_b64_tr_b16 v[54:55], v37 offset:47104
    v_mfma_f32_16x16x32_bf16 v[104:107], v[56:59], v[88:91], v[104:107]
    s_waitcnt vmcnt(54)
    buffer_load_dword a217, v5, s[80:83], s48 offen offset:64 sc1
    s_add_u32 s48, s47, 16384
    v_mfma_f32_16x16x32_bf16 v[108:111], v[56:59], v[92:95], v[108:111]
    buffer_load_dword a214, v5, s[80:83], s48 offen offset:0 sc1
    s_waitcnt lgkmcnt(4)
    v_mfma_f32_16x16x32_bf16 v[112:115], v[60:63], v[80:83], v[112:115]
    buffer_load_dword a218, v5, s[80:83], s48 offen offset:64 sc1
    v_mfma_f32_16x16x32_bf16 v[116:119], v[60:63], v[84:87], v[116:119]
    s_add_u32 s48, s47, 24576
    v_mfma_f32_16x16x32_bf16 v[120:123], v[60:63], v[88:91], v[120:123]
    buffer_load_dword a215, v5, s[80:83], s48 offen offset:0 sc1
    v_mfma_f32_16x16x32_bf16 v[124:127], v[60:63], v[92:95], v[124:127]
    buffer_load_dword a219, v5, s[80:83], s48 offen offset:64 sc1
    s_waitcnt lgkmcnt(2)
    v_mfma_f32_16x16x32_bf16 v[128:131], v[48:51], v[80:83], v[128:131]
    s_add_u32 s48, s46, 0
    v_mfma_f32_16x16x32_bf16 v[132:135], v[48:51], v[84:87], v[132:135]
    buffer_load_dwordx4 a[176:179], v1, s[84:87], s48 offen offset:0
    v_mfma_f32_16x16x32_bf16 v[136:139], v[48:51], v[88:91], v[136:139]
    buffer_load_dwordx4 a[180:183], v1, s[84:87], s48 offen offset:1024
    v_mfma_f32_16x16x32_bf16 v[140:143], v[48:51], v[92:95], v[140:143]
    s_waitcnt vmcnt(54)
    buffer_load_dwordx4 a[184:187], v1, s[84:87], s48 offen offset:2048
    s_waitcnt lgkmcnt(0)
    v_mfma_f32_16x16x32_bf16 v[144:147], v[52:55], v[80:83], v[144:147]
    buffer_load_dwordx4 a[188:191], v1, s[84:87], s48 offen offset:3072
    v_mfma_f32_16x16x32_bf16 v[148:151], v[52:55], v[84:87], v[148:151]
    s_add_u32 s48, s46, 4096
    v_mfma_f32_16x16x32_bf16 v[152:155], v[52:55], v[88:91], v[152:155]
    buffer_load_dwordx4 a[192:195], v1, s[84:87], s48 offen offset:0
    v_mfma_f32_16x16x32_bf16 v[156:159], v[52:55], v[92:95], v[156:159]
    buffer_load_dwordx4 a[196:199], v1, s[84:87], s48 offen offset:1024
    buffer_load_dwordx4 a[200:203], v1, s[84:87], s48 offen offset:2048
    buffer_load_dwordx4 a[204:207], v1, s[84:87], s48 offen offset:3072
    s_add_u32 s48, s46, 8192
    buffer_load_dwordx4 a[208:211], v1, s[84:87], s48 offen offset:0
    s_add_u32 s46, s46, 9216
    s_add_u32 s47, s47, 131072
    s_nop 7
    v_cvt_pk_bf16_f32 v216, v96, v97
    v_cvt_pk_bf16_f32 v217, v98, v99
    v_cvt_pk_bf16_f32 v218, v112, v113
    v_cvt_pk_bf16_f32 v219, v114, v115
    v_cvt_pk_bf16_f32 v220, v128, v129
    v_cvt_pk_bf16_f32 v221, v130, v131
    v_cvt_pk_bf16_f32 v222, v144, v145
    v_cvt_pk_bf16_f32 v223, v146, v147
    v_cvt_pk_bf16_f32 v224, v100, v101
    v_cvt_pk_bf16_f32 v225, v102, v103
    v_cvt_pk_bf16_f32 v226, v116, v117
    v_cvt_pk_bf16_f32 v227, v118, v119
    v_cvt_pk_bf16_f32 v228, v132, v133
    v_cvt_pk_bf16_f32 v229, v134, v135
    v_cvt_pk_bf16_f32 v230, v148, v149
    v_cvt_pk_bf16_f32 v231, v150, v151
    v_cvt_pk_bf16_f32 v232, v104, v105
    v_cvt_pk_bf16_f32 v233, v106, v107
    v_cvt_pk_bf16_f32 v234, v120, v121
    v_cvt_pk_bf16_f32 v235, v122, v123
    v_cvt_pk_bf16_f32 v236, v136, v137
    v_cvt_pk_bf16_f32 v237, v138, v139
    v_cvt_pk_bf16_f32 v238, v152, v153
    v_cvt_pk_bf16_f32 v239, v154, v155
    v_cvt_pk_bf16_f32 v240, v108, v109
    v_cvt_pk_bf16_f32 v241, v110, v111
    v_cvt_pk_bf16_f32 v242, v124, v125
    v_cvt_pk_bf16_f32 v243, v126, v127
    v_cvt_pk_bf16_f32 v244, v140, v141
    v_cvt_pk_bf16_f32 v245, v142, v143
    v_cvt_pk_bf16_f32 v246, v156, v157
    v_cvt_pk_bf16_f32 v247, v158, v159
    s_add_u32 s51, s50, 2560
    s_waitcnt vmcnt(54)
    buffer_store_dwordx4 v[216:219], v1, s[16:19], s51 offen sc1
    buffer_store_dwordx4 v[220:223], v1, s[16:19], s51 offen offset:1024 sc1
    s_add_u32 s51, s50, 7168
    buffer_store_dwordx4 v[224:227], v1, s[16:19], s51 offen sc1
    buffer_store_dwordx4 v[228:231], v1, s[16:19], s51 offen offset:1024 sc1
    s_add_u32 s51, s50, 76288
    buffer_store_dwordx4 v[232:235], v1, s[16:19], s51 offen sc1
    buffer_store_dwordx4 v[236:239], v1, s[16:19], s51 offen offset:1024 sc1
    s_add_u32 s51, s50, 80896
    buffer_store_dwordx4 v[240:243], v1, s[16:19], s51 offen sc1
    s_waitcnt vmcnt(54)
    buffer_store_dwordx4 v[244:247], v1, s[16:19], s51 offen offset:1024 sc1
    s_waitcnt vmcnt(62)
    s_cmp_eq_u32 s3, 0
    s_mov_b64 s[46:47], 0xffff
    s_cselect_b64 vcc, s[46:47], 0
    s_mov_b32 s48, 0x05040100
    v_perm_b32 v12, v12, v10, s48
    v_perm_b32 v13, v13, v11, s48
    v_cndmask_b32 v10, v10, v12, vcc
    v_accvgpr_write_b32 a36, v10
    v_cndmask_b32 v11, v11, v13, vcc
    v_accvgpr_write_b32 a40, v11
    v_mfma_f32_16x16x32_bf16 v[96:99], a[0:3], a[36:39], 0
    s_nop 0
    v_mfma_f32_16x16x32_bf16 v[100:103], a[0:3], a[40:43], 0
    v_mfma_f32_16x16x32_bf16 v[104:107], a[4:7], a[36:39], 0
    v_mfma_f32_16x16x32_bf16 v[108:111], a[4:7], a[40:43], 0
    v_mfma_f32_16x16x32_bf16 v[112:115], a[8:11], a[36:39], 0
    v_mfma_f32_16x16x32_bf16 v[116:119], a[8:11], a[40:43], 0
    v_mfma_f32_16x16x32_bf16 v[120:123], a[12:15], a[36:39], 0
    v_mfma_f32_16x16x32_bf16 v[124:127], a[12:15], a[40:43], 0
    v_mfma_f32_16x16x32_bf16 v[128:131], a[16:19], a[36:39], 0
    v_mfma_f32_16x16x32_bf16 v[132:135], a[16:19], a[40:43], 0
    v_mfma_f32_16x16x32_bf16 v[136:139], a[20:23], a[36:39], 0
    v_mfma_f32_16x16x32_bf16 v[140:143], a[20:23], a[40:43], 0
    v_mfma_f32_16x16x32_bf16 v[144:147], a[24:27], a[36:39], 0
    v_mfma_f32_16x16x32_bf16 v[148:151], a[24:27], a[40:43], 0
    v_mfma_f32_16x16x32_bf16 v[152:155], a[28:31], a[36:39], 0
    v_mfma_f32_16x16x32_bf16 v[156:159], a[28:31], a[40:43], 0
    v_mfma_f32_16x16x32_bf16 v[160:163], a[32:35], a[36:39], 0
    v_mfma_f32_16x16x32_bf16 v[164:167], a[32:35], a[40:43], 0
    s_waitcnt vmcnt(60)
    v_mfma_f32_16x16x32_bf16 v[96:99], a[44:47], a[80:83], v[96:99]
    v_mfma_f32_16x16x32_bf16 v[100:103], a[44:47], a[84:87], v[100:103]
    v_mfma_f32_16x16x32_bf16 v[104:107], a[48:51], a[80:83], v[104:107]
    v_mfma_f32_16x16x32_bf16 v[108:111], a[48:51], a[84:87], v[108:111]
    v_mfma_f32_16x16x32_bf16 v[112:115], a[52:55], a[80:83], v[112:115]
    v_mfma_f32_16x16x32_bf16 v[116:119], a[52:55], a[84:87], v[116:119]
    v_mfma_f32_16x16x32_bf16 v[120:123], a[56:59], a[80:83], v[120:123]
    v_mfma_f32_16x16x32_bf16 v[124:127], a[56:59], a[84:87], v[124:127]
    v_mfma_f32_16x16x32_bf16 v[128:131], a[60:63], a[80:83], v[128:131]
    v_mfma_f32_16x16x32_bf16 v[132:135], a[60:63], a[84:87], v[132:135]
    v_mfma_f32_16x16x32_bf16 v[136:139], a[64:67], a[80:83], v[136:139]
    v_mfma_f32_16x16x32_bf16 v[140:143], a[64:67], a[84:87], v[140:143]
    v_mfma_f32_16x16x32_bf16 v[144:147], a[68:71], a[80:83], v[144:147]
    v_mfma_f32_16x16x32_bf16 v[148:151], a[68:71], a[84:87], v[148:151]
    v_mfma_f32_16x16x32_bf16 v[152:155], a[72:75], a[80:83], v[152:155]
    v_mfma_f32_16x16x32_bf16 v[156:159], a[72:75], a[84:87], v[156:159]
    v_mfma_f32_16x16x32_bf16 v[160:163], a[76:79], a[80:83], v[160:163]
    v_mfma_f32_16x16x32_bf16 v[164:167], a[76:79], a[84:87], v[164:167]
    s_waitcnt vmcnt(43)
    v_mfma_f32_16x16x32_bf16 v[96:99], a[88:91], a[124:127], v[96:99]
    v_mfma_f32_16x16x32_bf16 v[100:103], a[88:91], a[128:131], v[100:103]
    v_mfma_f32_16x16x32_bf16 v[104:107], a[92:95], a[124:127], v[104:107]
    v_mfma_f32_16x16x32_bf16 v[108:111], a[92:95], a[128:131], v[108:111]
    v_mfma_f32_16x16x32_bf16 v[112:115], a[96:99], a[124:127], v[112:115]
    v_mfma_f32_16x16x32_bf16 v[116:119], a[96:99], a[128:131], v[116:119]
    v_mfma_f32_16x16x32_bf16 v[120:123], a[100:103], a[124:127], v[120:123]
    v_mfma_f32_16x16x32_bf16 v[124:127], a[100:103], a[128:131], v[124:127]
    v_mfma_f32_16x16x32_bf16 v[128:131], a[104:107], a[124:127], v[128:131]
    v_mfma_f32_16x16x32_bf16 v[132:135], a[104:107], a[128:131], v[132:135]
    v_mfma_f32_16x16x32_bf16 v[136:139], a[108:111], a[124:127], v[136:139]
    v_mfma_f32_16x16x32_bf16 v[140:143], a[108:111], a[128:131], v[140:143]
    v_mfma_f32_16x16x32_bf16 v[144:147], a[112:115], a[124:127], v[144:147]
    v_mfma_f32_16x16x32_bf16 v[148:151], a[112:115], a[128:131], v[148:151]
    v_mfma_f32_16x16x32_bf16 v[152:155], a[116:119], a[124:127], v[152:155]
    v_mfma_f32_16x16x32_bf16 v[156:159], a[116:119], a[128:131], v[156:159]
    v_mfma_f32_16x16x32_bf16 v[160:163], a[120:123], a[124:127], v[160:163]
    v_mfma_f32_16x16x32_bf16 v[164:167], a[120:123], a[128:131], v[164:167]
    s_waitcnt vmcnt(26)
    v_mfma_f32_16x16x32_bf16 v[96:99], a[132:135], a[168:171], v[96:99]
    v_mfma_f32_16x16x32_bf16 v[100:103], a[132:135], a[172:175], v[100:103]
    v_mfma_f32_16x16x32_bf16 v[104:107], a[136:139], a[168:171], v[104:107]
    v_mfma_f32_16x16x32_bf16 v[108:111], a[136:139], a[172:175], v[108:111]
    v_mfma_f32_16x16x32_bf16 v[112:115], a[140:143], a[168:171], v[112:115]
    v_mfma_f32_16x16x32_bf16 v[116:119], a[140:143], a[172:175], v[116:119]
    v_mfma_f32_16x16x32_bf16 v[120:123], a[144:147], a[168:171], v[120:123]
    v_mfma_f32_16x16x32_bf16 v[124:127], a[144:147], a[172:175], v[124:127]
    v_mfma_f32_16x16x32_bf16 v[128:131], a[148:151], a[168:171], v[128:131]
    v_mfma_f32_16x16x32_bf16 v[132:135], a[148:151], a[172:175], v[132:135]
    v_mfma_f32_16x16x32_bf16 v[136:139], a[152:155], a[168:171], v[136:139]
    v_mfma_f32_16x16x32_bf16 v[140:143], a[152:155], a[172:175], v[140:143]
    v_mfma_f32_16x16x32_bf16 v[144:147], a[156:159], a[168:171], v[144:147]
    v_mfma_f32_16x16x32_bf16 v[148:151], a[156:159], a[172:175], v[148:151]
    v_mfma_f32_16x16x32_bf16 v[152:155], a[160:163], a[168:171], v[152:155]
    v_mfma_f32_16x16x32_bf16 v[156:159], a[160:163], a[172:175], v[156:159]
    v_mfma_f32_16x16x32_bf16 v[160:163], a[164:167], a[168:171], v[160:163]
    v_mfma_f32_16x16x32_bf16 v[164:167], a[164:167], a[172:175], v[164:167]
    s_waitcnt vmcnt(8)
    v_mfma_f32_16x16x32_bf16 v[96:99], a[176:179], a[212:215], v[96:99]
    v_mfma_f32_16x16x32_bf16 v[100:103], a[176:179], a[216:219], v[100:103]
    v_mfma_f32_16x16x32_bf16 v[104:107], a[180:183], a[212:215], v[104:107]
    v_mfma_f32_16x16x32_bf16 v[108:111], a[180:183], a[216:219], v[108:111]
    v_mfma_f32_16x16x32_bf16 v[112:115], a[184:187], a[212:215], v[112:115]
    v_mfma_f32_16x16x32_bf16 v[116:119], a[184:187], a[216:219], v[116:119]
    v_mfma_f32_16x16x32_bf16 v[120:123], a[188:191], a[212:215], v[120:123]
    v_mfma_f32_16x16x32_bf16 v[124:127], a[188:191], a[216:219], v[124:127]
    v_mfma_f32_16x16x32_bf16 v[128:131], a[192:195], a[212:215], v[128:131]
    v_mfma_f32_16x16x32_bf16 v[132:135], a[192:195], a[216:219], v[132:135]
    v_mfma_f32_16x16x32_bf16 v[136:139], a[196:199], a[212:215], v[136:139]
    v_mfma_f32_16x16x32_bf16 v[140:143], a[196:199], a[216:219], v[140:143]
    v_mfma_f32_16x16x32_bf16 v[144:147], a[200:203], a[212:215], v[144:147]
    v_mfma_f32_16x16x32_bf16 v[148:151], a[200:203], a[216:219], v[148:151]
    v_mfma_f32_16x16x32_bf16 v[152:155], a[204:207], a[212:215], v[152:155]
    v_mfma_f32_16x16x32_bf16 v[156:159], a[204:207], a[216:219], v[156:159]
    v_mfma_f32_16x16x32_bf16 v[160:163], a[208:211], a[212:215], v[160:163]
    v_mfma_f32_16x16x32_bf16 v[164:167], a[208:211], a[216:219], v[164:167]
    s_mul_i32 s45, s3, 18432
    v_add_u32 v7, s45, v1
    v_add_u32 v7, 81920, v7
    s_nop 4
    ds_write_b128 v7, v[96:99] offset:0
    ds_write_b128 v7, v[100:103] offset:1024
    ds_write_b128 v7, v[104:107] offset:2048
    ds_write_b128 v7, v[108:111] offset:3072
    ds_write_b128 v7, v[112:115] offset:4096
    ds_write_b128 v7, v[116:119] offset:5120
    ds_write_b128 v7, v[120:123] offset:6144
    ds_write_b128 v7, v[124:127] offset:7168
    ds_write_b128 v7, v[128:131] offset:8192
    ds_write_b128 v7, v[132:135] offset:9216
    ds_write_b128 v7, v[136:139] offset:10240
    ds_write_b128 v7, v[140:143] offset:11264
    ds_write_b128 v7, v[144:147] offset:12288
    ds_write_b128 v7, v[148:151] offset:13312
    ds_write_b128 v7, v[152:155] offset:14336
    ds_write_b128 v7, v[156:159] offset:15360
    ds_write_b128 v7, v[160:163] offset:16384
    ds_write_b128 v7, v[164:167] offset:17408
    s_add_u32 s20, s8, 0x2400000
    s_addc_u32 s21, s9, 0
    s_mov_b32 s22, 0x1200000
    s_mov_b32 s23, 0x20000
    s_mov_b32 s24, s60
    s_mov_b32 s25, s61
    s_mov_b32 s26, 0x240000
    s_mov_b32 s27, 0x20000
    s_lshl_b32 s45, s40, 2
    s_add_u32 s45, s45, s42
    s_lshl_b32 s45, s45, 3
    s_add_u32 s45, s45, s41
    s_mul_i32 s88, s45, 73728
    s_mul_i32 s89, s44, 1152
    s_mov_b32 s28, s74
    s_mov_b32 s29, s75
    s_mov_b32 s30, 0x240000
    s_mov_b32 s31, 0x20000
    s_lshl_b32 s46, s40, 2
    s_add_u32 s46, s46, s42
    s_lshl_b32 s46, s46, 7
    s_lshl_b32 s47, s41, 2
    s_add_u32 s47, s46, s47
    s_add_u32 s47, s47, 36864
    s_add_u32 s46, s46, 36864
    v_min_u32 v3, 7, v0
    v_lshlrev_b32 v3, 2, v3
    v_add_u32 v3, s46, v3
    s_waitcnt vmcnt(0) lgkmcnt(0)
    s_barrier
    s_cmp_eq_u32 s3, 0
    s_cbranch_scc0 FK_t1
    s_mov_b64 s[6:7], exec
    s_mov_b64 exec, 1
    v_mov_b32 v4, s39
    v_mov_b32 v5, 0
    buffer_store_dword v4, v5, s[76:79], s47 offen sc1
    s_mov_b64 exec, s[6:7]
FK_t1:
    s_mov_b32 s5, 0
    s_branch FK_spa_c
FK_spa_l:
    buffer_load_dword v46, v45, s[76:79], 0 offen sc1
    s_waitcnt vmcnt(0)
FK_spa_c:
    v_xor_b32 v4, s39, v46
    v_cmp_ne_u32 vcc, 0, v4
    s_add_u32 s5, s5, 1
    s_cmp_ge_u32 s5, 20000
    s_cbranch_scc1 FK_spa_x
    s_nop 0
    s_cmp_eq_u64 vcc, 0
    s_cbranch_scc1 FK_spa_x
    s_sleep 1
    s_branch FK_spa_l
FK_spa_x:
    s_mov_b32 s56, 0x00003f80
    s_mov_b32 s57, 0x3f800000
    v_add_u32 v7, 81920, v1
    v_add_u32 v8, 36864, v7
    s_cmp_lg_u32 s3, 0
    s_cbranch_scc1 FK_z1
    s_add_u32 s46, s88, 0
    buffer_load_dwordx4 v[168:171], v1, s[20:23], s46 offen sc1
    s_add_u32 s46, s88, 9216
    buffer_load_dwordx4 v[172:175], v1, s[20:23], s46 offen sc1
    s_add_u32 s46, s88, 18432
    buffer_load_dwordx4 v[176:179], v1, s[20:23], s46 offen sc1
    s_add_u32 s46, s88, 27648
    buffer_load_dwordx4 v[180:183], v1, s[20:23], s46 offen sc1
    s_add_u32 s46, s88, 36864
    buffer_load_dwordx4 v[184:187], v1, s[20:23], s46 offen sc1
    s_add_u32 s46, s88, 46080
    buffer_load_dwordx4 v[188:191], v1, s[20:23], s46 offen sc1
    s_add_u32 s46, s88, 55296
    buffer_load_dwordx4 v[192:195], v1, s[20:23], s46 offen sc1
    s_add_u32 s46, s88, 64512
    buffer_load_dwordx4 v[196:199], v1, s[20:23], s46 offen sc1
    s_mul_i32 s46, s42, 160
    s_add_u32 s46, s46, 512
    s_add_u32 s46, s46, s89
    buffer_load_dwordx2 v[16:17], v6, s[24:27], s46 offen
    s_mul_i32 s46, s42, 160
    s_add_u32 s46, s46, 544
    s_add_u32 s46, s46, s89
    buffer_load_dwordx2 v[18:19], v6, s[24:27], s46 offen
    s_add_u32 s46, s88, 2048
    buffer_load_dwordx2 v[200:201], v2, s[20:23], s46 offen sc1
    s_add_u32 s46, s88, 11264
    buffer_load_dwordx2 v[202:203], v2, s[20:23], s46 offen sc1
    s_add_u32 s46, s88, 20480
    buffer_load_dwordx2 v[204:205], v2, s[20:23], s46 offen sc1
    s_add_u32 s46, s88, 29696
    buffer_load_dwordx2 v[206:207], v2, s[20:23], s46 offen sc1
    s_add_u32 s46, s88, 38912
    buffer_load_dwordx2 v[208:209], v2, s[20:23], s46 offen sc1
    s_add_u32 s46, s88, 48128
    buffer_load_dwordx2 v[210:211], v2, s[20:23], s46 offen sc1
    s_add_u32 s46, s88, 57344
    buffer_load_dwordx2 v[212:213], v2, s[20:23], s46 offen sc1
    s_add_u32 s46, s88, 66560
    buffer_load_dwordx2 v[214:215], v2, s[20:23], s46 offen sc1
    s_mul_i32 s46, s42, 160
    s_add_u32 s46, s46, 640
    s_add_u32 s46, s46, s89
    buffer_load_dwordx2 v[20:21], v6, s[24:27], s46 offen
    s_lshl_b32 s46, s42, 7
    s_add_u32 s46, s46, 0
    s_add_u32 s46, s46, s89
    buffer_load_dwordx2 v[24:25], v6, s[24:27], s46 offen
    s_lshl_b32 s46, s42, 7
    s_add_u32 s46, s46, 32
    s_add_u32 s46, s46, s89
    buffer_load_dwordx2 v[26:27], v6, s[24:27], s46 offen
    buffer_load_dword v4, v3, s[76:79], 0 offen sc1
    ds_read_b128 v[32:35], v7 offset:0
    ds_read_b128 v[36:39], v7 offset:18432
    ds_read_b128 v[40:43], v8 offset:0
    ds_read_b128 v[44:47], v8 offset:18432
    ds_read_b128 v[48:51], v7 offset:2048
    ds_read_b128 v[52:55], v7 offset:20480
    ds_read_b128 v[56:59], v8 offset:2048
    ds_read_b128 v[60:63], v8 offset:20480
    s_waitcnt lgkmcnt(0)
    v_pk_add_f32 v[68:69], v[32:33], v[36:37]
    v_pk_add_f32 v[40:41], v[40:41], v[44:45]
    v_pk_add_f32 v[70:71], v[34:35], v[38:39]
    v_pk_add_f32 v[42:43], v[42:43], v[46:47]
    v_pk_add_f32 v[68:69], v[68:69], v[40:41]
    v_pk_add_f32 v[70:71], v[70:71], v[42:43]
    v_pk_add_f32 v[72:73], v[48:49], v[52:53]
    v_pk_add_f32 v[56:57], v[56:57], v[60:61]
    v_pk_add_f32 v[74:75], v[50:51], v[54:55]
    v_pk_add_f32 v[58:59], v[58:59], v[62:63]
    v_pk_add_f32 v[72:73], v[72:73], v[56:57]
    v_pk_add_f32 v[74:75], v[74:75], v[58:59]
    ds_read_b128 v[32:35], v7 offset:8192
    ds_read_b128 v[36:39], v7 offset:26624
    ds_read_b128 v[40:43], v8 offset:8192
    ds_read_b128 v[44:47], v8 offset:26624
    s_waitcnt lgkmcnt(0)
    v_pk_add_f32 v[76:77], v[32:33], v[36:37]
    v_pk_add_f32 v[40:41], v[40:41], v[44:45]
    v_pk_add_f32 v[78:79], v[34:35], v[38:39]
    v_pk_add_f32 v[42:43], v[42:43], v[46:47]
    v_pk_add_f32 v[76:77], v[76:77], v[40:41]
    v_pk_add_f32 v[78:79], v[78:79], v[42:43]
    ds_read_b128 v[32:35], v7 offset:10240
    ds_read_b128 v[36:39], v7 offset:28672
    ds_read_b128 v[40:43], v8 offset:10240
    ds_read_b128 v[44:47], v8 offset:28672
    ds_read_b128 v[48:51], v7 offset:12288
    ds_read_b128 v[52:55], v7 offset:30720
    ds_read_b128 v[56:59], v8 offset:12288
    ds_read_b128 v[60:63], v8 offset:30720
    s_waitcnt lgkmcnt(0)
    v_pk_add_f32 v[80:81], v[32:33], v[36:37]
    v_pk_add_f32 v[40:41], v[40:41], v[44:45]
    v_pk_add_f32 v[82:83], v[34:35], v[38:39]
    v_pk_add_f32 v[42:43], v[42:43], v[46:47]
    v_pk_add_f32 v[80:81], v[80:81], v[40:41]
    v_pk_add_f32 v[82:83], v[82:83], v[42:43]
    v_pk_add_f32 v[84:85], v[48:49], v[52:53]
    v_pk_add_f32 v[56:57], v[56:57], v[60:61]
    v_pk_add_f32 v[86:87], v[50:51], v[54:55]
    v_pk_add_f32 v[58:59], v[58:59], v[62:63]
    v_pk_add_f32 v[84:85], v[84:85], v[56:57]
    v_pk_add_f32 v[86:87], v[86:87], v[58:59]
    s_waitcnt vmcnt(0)
    s_mov_b32 s5, 0
    s_branch FK_sp0_c
FK_sp0_l:
    buffer_load_dword v4, v3, s[76:79], 0 offen sc1
    s_waitcnt vmcnt(0)
FK_sp0_c:
    v_xor_b32 v5, s39, v4
    v_cmp_ne_u32 vcc, 0, v5
    s_add_u32 s5, s5, 1
    s_cmp_ge_u32 s5, 20000
    s_cbranch_scc1 FK_sp0_x
    s_nop 0
    s_cmp_eq_u64 vcc, 0
    s_cbranch_scc1 FK_sp0_x
    s_sleep 1
    s_branch FK_sp0_l
FK_sp0_x:
    s_add_u32 s46, s88, 2560
    buffer_load_dwordx4 v[216:219], v1, s[20:23], s46 offen sc1
    s_add_u32 s46, s88, 11776
    buffer_load_dwordx4 v[220:223], v1, s[20:23], s46 offen sc1
    s_add_u32 s46, s88, 20992
    buffer_load_dwordx4 v[224:227], v1, s[20:23], s46 offen sc1
    s_add_u32 s46, s88, 30208
    buffer_load_dwordx4 v[228:231], v1, s[20:23], s46 offen sc1
    s_add_u32 s46, s88, 39424
    buffer_load_dwordx4 v[232:235], v1, s[20:23], s46 offen sc1
    s_add_u32 s46, s88, 48640
    buffer_load_dwordx4 v[236:239], v1, s[20:23], s46 offen sc1
    s_add_u32 s46, s88, 57856
    buffer_load_dwordx4 v[240:243], v1, s[20:23], s46 offen sc1
    s_add_u32 s46, s88, 67072
    buffer_load_dwordx4 v[244:247], v1, s[20:23], s46 offen sc1
    v_dot2_f32_bf16 v68, v16, s56, v68
    v_dot2_f32_bf16 v69, v16, s57, v69
    v_dot2_f32_bf16 v70, v17, s56, v70
    v_dot2_f32_bf16 v71, v17, s57, v71
    v_dot2_f32_bf16 v72, v18, s56, v72
    v_dot2_f32_bf16 v73, v18, s57, v73
    v_dot2_f32_bf16 v74, v19, s56, v74
    v_dot2_f32_bf16 v75, v19, s57, v75
    v_dot2_f32_bf16 v68, v168, s56, v68
    v_dot2_f32_bf16 v69, v168, s57, v69
    v_dot2_f32_bf16 v70, v169, s56, v70
    v_dot2_f32_bf16 v71, v169, s57, v71
    v_dot2_f32_bf16 v72, v170, s56, v72
    v_dot2_f32_bf16 v73, v170, s57, v73
    v_dot2_f32_bf16 v74, v171, s56, v74
    v_dot2_f32_bf16 v75, v171, s57, v75
    v_dot2_f32_bf16 v68, v172, s56, v68
    v_dot2_f32_bf16 v69, v172, s57, v69
    v_dot2_f32_bf16 v70, v173, s56, v70
    v_dot2_f32_bf16 v71, v173, s57, v71
    v_dot2_f32_bf16 v72, v174, s56, v72
    v_dot2_f32_bf16 v73, v174, s57, v73
    v_dot2_f32_bf16 v74, v175, s56, v74
    v_dot2_f32_bf16 v75, v175, s57, v75
    v_dot2_f32_bf16 v68, v176, s56, v68
    v_dot2_f32_bf16 v69, v176, s57, v69
    v_dot2_f32_bf16 v70, v177, s56, v70
    v_dot2_f32_bf16 v71, v177, s57, v71
    v_dot2_f32_bf16 v72, v178, s56, v72
    v_dot2_f32_bf16 v73, v178, s57, v73
    v_dot2_f32_bf16 v74, v179, s56, v74
    v_dot2_f32_bf16 v75, v179, s57, v75
    v_dot2_f32_bf16 v68, v180, s56, v68
    v_dot2_f32_bf16 v69, v180, s57, v69
    v_dot2_f32_bf16 v70, v181, s56, v70
    v_dot2_f32_bf16 v71, v181, s57, v71
    v_dot2_f32_bf16 v72, v182, s56, v72
    v_dot2_f32_bf16 v73, v182, s57, v73
    v_dot2_f32_bf16 v74, v183, s56, v74
    v_dot2_f32_bf16 v75, v183, s57, v75
    v_dot2_f32_bf16 v68, v184, s56, v68
    v_dot2_f32_bf16 v69, v184, s57, v69
    v_dot2_f32_bf16 v70, v185, s56, v70
    v_dot2_f32_bf16 v71, v185, s57, v71
    v_dot2_f32_bf16 v72, v186, s56, v72
    v_dot2_f32_bf16 v73, v186, s57, v73
    v_dot2_f32_bf16 v74, v187, s56, v74
    v_dot2_f32_bf16 v75, v187, s57, v75
    v_dot2_f32_bf16 v68, v188, s56, v68
    v_dot2_f32_bf16 v69, v188, s57, v69
    v_dot2_f32_bf16 v70, v189, s56, v70
    v_dot2_f32_bf16 v71, v189, s57, v71
    v_dot2_f32_bf16 v72, v190, s56, v72
    v_dot2_f32_bf16 v73, v190, s57, v73
    v_dot2_f32_bf16 v74, v191, s56, v74
    v_dot2_f32_bf16 v75, v191, s57, v75
    v_dot2_f32_bf16 v68, v192, s56, v68
    v_dot2_f32_bf16 v69, v192, s57, v69
    v_dot2_f32_bf16 v70, v193, s56, v70
    v_dot2_f32_bf16 v71, v193, s57, v71
    v_dot2_f32_bf16 v72, v194, s56, v72
    v_dot2_f32_bf16 v73, v194, s57, v73
    v_dot2_f32_bf16 v74, v195, s56, v74
    v_dot2_f32_bf16 v75, v195, s57, v75
    v_dot2_f32_bf16 v68, v196, s56, v68
    v_dot2_f32_bf16 v69, v196, s57, v69
    v_dot2_f32_bf16 v70, v197, s56, v70
    v_dot2_f32_bf16 v71, v197, s57, v71
    v_dot2_f32_bf16 v72, v198, s56, v72
    v_dot2_f32_bf16 v73, v198, s57, v73
    v_dot2_f32_bf16 v74, v199, s56, v74
    v_dot2_f32_bf16 v75, v199, s57, v75
    s_nop 2
    v_cvt_pk_bf16_f32 v64, v68, v69
    v_cvt_pk_bf16_f32 v65, v70, v71
    s_mul_i32 s46, s42, 160
    s_add_u32 s46, s46, 512
    s_add_u32 s46, s46, s89
    buffer_store_dwordx2 v[64:65], v6, s[28:31], s46 offen
    v_cvt_pk_bf16_f32 v66, v72, v73
    v_cvt_pk_bf16_f32 v67, v74, v75
    s_mul_i32 s46, s42, 160
    s_add_u32 s46, s46, 544
    s_add_u32 s46, s46, s89
    buffer_store_dwordx2 v[66:67], v6, s[28:31], s46 offen
    s_nop 1
    v_dot2_f32_bf16 v76, v20, s56, v76
    v_dot2_f32_bf16 v77, v20, s57, v77
    v_dot2_f32_bf16 v78, v21, s56, v78
    v_dot2_f32_bf16 v79, v21, s57, v79
    v_dot2_f32_bf16 v76, v200, s56, v76
    v_dot2_f32_bf16 v77, v200, s57, v77
    v_dot2_f32_bf16 v78, v201, s56, v78
    v_dot2_f32_bf16 v79, v201, s57, v79
    v_dot2_f32_bf16 v76, v202, s56, v76
    v_dot2_f32_bf16 v77, v202, s57, v77
    v_dot2_f32_bf16 v78, v203, s56, v78
    v_dot2_f32_bf16 v79, v203, s57, v79
    v_dot2_f32_bf16 v76, v204, s56, v76
    v_dot2_f32_bf16 v77, v204, s57, v77
    v_dot2_f32_bf16 v78, v205, s56, v78
    v_dot2_f32_bf16 v79, v205, s57, v79
    v_dot2_f32_bf16 v76, v206, s56, v76
    v_dot2_f32_bf16 v77, v206, s57, v77
    v_dot2_f32_bf16 v78, v207, s56, v78
    v_dot2_f32_bf16 v79, v207, s57, v79
    v_dot2_f32_bf16 v76, v208, s56, v76
    v_dot2_f32_bf16 v77, v208, s57, v77
    v_dot2_f32_bf16 v78, v209, s56, v78
    v_dot2_f32_bf16 v79, v209, s57, v79
    v_dot2_f32_bf16 v76, v210, s56, v76
    v_dot2_f32_bf16 v77, v210, s57, v77
    v_dot2_f32_bf16 v78, v211, s56, v78
    v_dot2_f32_bf16 v79, v211, s57, v79
    v_dot2_f32_bf16 v76, v212, s56, v76
    v_dot2_f32_bf16 v77, v212, s57, v77
    v_dot2_f32_bf16 v78, v213, s56, v78
    v_dot2_f32_bf16 v79, v213, s57, v79
    v_dot2_f32_bf16 v76, v214, s56, v76
    v_dot2_f32_bf16 v77, v214, s57, v77
    v_dot2_f32_bf16 v78, v215, s56, v78
    v_dot2_f32_bf16 v79, v215, s57, v79
    s_nop 2
    v_cvt_pk_bf16_f32 v64, v76, v77
    v_cvt_pk_bf16_f32 v65, v78, v79
    s_mul_i32 s46, s42, 160
    s_add_u32 s46, s46, 640
    s_add_u32 s46, s46, s89
    buffer_store_dwordx2 v[64:65], v6, s[28:31], s46 offen
    s_nop 1
    s_waitcnt vmcnt(3)
    v_dot2_f32_bf16 v80, v24, s56, v80
    v_dot2_f32_bf16 v81, v24, s57, v81
    v_dot2_f32_bf16 v82, v25, s56, v82
    v_dot2_f32_bf16 v83, v25, s57, v83
    v_dot2_f32_bf16 v84, v26, s56, v84
    v_dot2_f32_bf16 v85, v26, s57, v85
    v_dot2_f32_bf16 v86, v27, s56, v86
    v_dot2_f32_bf16 v87, v27, s57, v87
    v_dot2_f32_bf16 v80, v216, s56, v80
    v_dot2_f32_bf16 v81, v216, s57, v81
    v_dot2_f32_bf16 v82, v217, s56, v82
    v_dot2_f32_bf16 v83, v217, s57, v83
    v_dot2_f32_bf16 v84, v218, s56, v84
    v_dot2_f32_bf16 v85, v218, s57, v85
    v_dot2_f32_bf16 v86, v219, s56, v86
    v_dot2_f32_bf16 v87, v219, s57, v87
    v_dot2_f32_bf16 v80, v220, s56, v80
    v_dot2_f32_bf16 v81, v220, s57, v81
    v_dot2_f32_bf16 v82, v221, s56, v82
    v_dot2_f32_bf16 v83, v221, s57, v83
    v_dot2_f32_bf16 v84, v222, s56, v84
    v_dot2_f32_bf16 v85, v222, s57, v85
    v_dot2_f32_bf16 v86, v223, s56, v86
    v_dot2_f32_bf16 v87, v223, s57, v87
    v_dot2_f32_bf16 v80, v224, s56, v80
    v_dot2_f32_bf16 v81, v224, s57, v81
    v_dot2_f32_bf16 v82, v225, s56, v82
    v_dot2_f32_bf16 v83, v225, s57, v83
    v_dot2_f32_bf16 v84, v226, s56, v84
    v_dot2_f32_bf16 v85, v226, s57, v85
    v_dot2_f32_bf16 v86, v227, s56, v86
    v_dot2_f32_bf16 v87, v227, s57, v87
    v_dot2_f32_bf16 v80, v228, s56, v80
    v_dot2_f32_bf16 v81, v228, s57, v81
    v_dot2_f32_bf16 v82, v229, s56, v82
    v_dot2_f32_bf16 v83, v229, s57, v83
    v_dot2_f32_bf16 v84, v230, s56, v84
    v_dot2_f32_bf16 v85, v230, s57, v85
    v_dot2_f32_bf16 v86, v231, s56, v86
    v_dot2_f32_bf16 v87, v231, s57, v87
    v_dot2_f32_bf16 v80, v232, s56, v80
    v_dot2_f32_bf16 v81, v232, s57, v81
    v_dot2_f32_bf16 v82, v233, s56, v82
    v_dot2_f32_bf16 v83, v233, s57, v83
    v_dot2_f32_bf16 v84, v234, s56, v84
    v_dot2_f32_bf16 v85, v234, s57, v85
    v_dot2_f32_bf16 v86, v235, s56, v86
    v_dot2_f32_bf16 v87, v235, s57, v87
    v_dot2_f32_bf16 v80, v236, s56, v80
    v_dot2_f32_bf16 v81, v236, s57, v81
    v_dot2_f32_bf16 v82, v237, s56, v82
    v_dot2_f32_bf16 v83, v237, s57, v83
    v_dot2_f32_bf16 v84, v238, s56, v84
    v_dot2_f32_bf16 v85, v238, s57, v85
    v_dot2_f32_bf16 v86, v239, s56, v86
    v_dot2_f32_bf16 v87, v239, s57, v87
    v_dot2_f32_bf16 v80, v240, s56, v80
    v_dot2_f32_bf16 v81, v240, s57, v81
    v_dot2_f32_bf16 v82, v241, s56, v82
    v_dot2_f32_bf16 v83, v241, s57, v83
    v_dot2_f32_bf16 v84, v242, s56, v84
    v_dot2_f32_bf16 v85, v242, s57, v85
    v_dot2_f32_bf16 v86, v243, s56, v86
    v_dot2_f32_bf16 v87, v243, s57, v87
    v_dot2_f32_bf16 v80, v244, s56, v80
    v_dot2_f32_bf16 v81, v244, s57, v81
    v_dot2_f32_bf16 v82, v245, s56, v82
    v_dot2_f32_bf16 v83, v245, s57, v83
    v_dot2_f32_bf16 v84, v246, s56, v84
    v_dot2_f32_bf16 v85, v246, s57, v85
    v_dot2_f32_bf16 v86, v247, s56, v86
    v_dot2_f32_bf16 v87, v247, s57, v87
    s_nop 2
    v_cvt_pk_bf16_f32 v64, v80, v81
    v_cvt_pk_bf16_f32 v65, v82, v83
    s_lshl_b32 s46, s42, 7
    s_add_u32 s46, s46, 0
    s_add_u32 s46, s46, s89
    buffer_store_dwordx2 v[64:65], v6, s[28:31], s46 offen
    v_cvt_pk_bf16_f32 v66, v84, v85
    v_cvt_pk_bf16_f32 v67, v86, v87
    s_lshl_b32 s46, s42, 7
    s_add_u32 s46, s46, 32
    s_add_u32 s46, s46, s89
    buffer_store_dwordx2 v[66:67], v6, s[28:31], s46 offen
    s_nop 1
    s_branch FK_fin
FK_z1:
    s_cmp_lg_u32 s3, 1
    s_cbranch_scc1 FK_z2
    s_add_u32 s46, s88, 1024
    buffer_load_dwordx4 v[168:171], v1, s[20:23], s46 offen sc1
    s_add_u32 s46, s88, 10240
    buffer_load_dwordx4 v[172:175], v1, s[20:23], s46 offen sc1
    s_add_u32 s46, s88, 19456
    buffer_load_dwordx4 v[176:179], v1, s[20:23], s46 offen sc1
    s_add_u32 s46, s88, 28672
    buffer_load_dwordx4 v[180:183], v1, s[20:23], s46 offen sc1
    s_add_u32 s46, s88, 37888
    buffer_load_dwordx4 v[184:187], v1, s[20:23], s46 offen sc1
    s_add_u32 s46, s88, 47104
    buffer_load_dwordx4 v[188:191], v1, s[20:23], s46 offen sc1
    s_add_u32 s46, s88, 56320
    buffer_load_dwordx4 v[192:195], v1, s[20:23], s46 offen sc1
    s_add_u32 s46, s88, 65536
    buffer_load_dwordx4 v[196:199], v1, s[20:23], s46 offen sc1
    s_mul_i32 s46, s42, 160
    s_add_u32 s46, s46, 576
    s_add_u32 s46, s46, s89
    buffer_load_dwordx2 v[16:17], v6, s[24:27], s46 offen
    s_mul_i32 s46, s42, 160
    s_add_u32 s46, s46, 608
    s_add_u32 s46, s46, s89
    buffer_load_dwordx2 v[18:19], v6, s[24:27], s46 offen
    s_lshl_b32 s46, s42, 7
    s_add_u32 s46, s46, 64
    s_add_u32 s46, s46, s89
    buffer_load_dwordx2 v[24:25], v6, s[24:27], s46 offen
    s_lshl_b32 s46, s42, 7
    s_add_u32 s46, s46, 96
    s_add_u32 s46, s46, s89
    buffer_load_dwordx2 v[26:27], v6, s[24:27], s46 offen
    buffer_load_dword v4, v3, s[76:79], 0 offen sc1
    ds_read_b128 v[32:35], v7 offset:4096
    ds_read_b128 v[36:39], v7 offset:22528
    ds_read_b128 v[40:43], v8 offset:4096
    ds_read_b128 v[44:47], v8 offset:22528
    ds_read_b128 v[48:51], v7 offset:6144
    ds_read_b128 v[52:55], v7 offset:24576
    ds_read_b128 v[56:59], v8 offset:6144
    ds_read_b128 v[60:63], v8 offset:24576
    s_waitcnt lgkmcnt(0)
    v_pk_add_f32 v[68:69], v[32:33], v[36:37]
    v_pk_add_f32 v[40:41], v[40:41], v[44:45]
    v_pk_add_f32 v[70:71], v[34:35], v[38:39]
    v_pk_add_f32 v[42:43], v[42:43], v[46:47]
    v_pk_add_f32 v[68:69], v[68:69], v[40:41]
    v_pk_add_f32 v[70:71], v[70:71], v[42:43]
    v_pk_add_f32 v[72:73], v[48:49], v[52:53]
    v_pk_add_f32 v[56:57], v[56:57], v[60:61]
    v_pk_add_f32 v[74:75], v[50:51], v[54:55]
    v_pk_add_f32 v[58:59], v[58:59], v[62:63]
    v_pk_add_f32 v[72:73], v[72:73], v[56:57]
    v_pk_add_f32 v[74:75], v[74:75], v[58:59]
    ds_read_b128 v[32:35], v7 offset:14336
    ds_read_b128 v[36:39], v7 offset:32768
    ds_read_b128 v[40:43], v8 offset:14336
    ds_read_b128 v[44:47], v8 offset:32768
    ds_read_b128 v[48:51], v7 offset:16384
    ds_read_b128 v[52:55], v7 offset:34816
    ds_read_b128 v[56:59], v8 offset:16384
    ds_read_b128 v[60:63], v8 offset:34816
    s_waitcnt lgkmcnt(0)
    v_pk_add_f32 v[80:81], v[32:33], v[36:37]
    v_pk_add_f32 v[40:41], v[40:41], v[44:45]
    v_pk_add_f32 v[82:83], v[34:35], v[38:39]
    v_pk_add_f32 v[42:43], v[42:43], v[46:47]
    v_pk_add_f32 v[80:81], v[80:81], v[40:41]
    v_pk_add_f32 v[82:83], v[82:83], v[42:43]
    v_pk_add_f32 v[84:85], v[48:49], v[52:53]
    v_pk_add_f32 v[56:57], v[56:57], v[60:61]
    v_pk_add_f32 v[86:87], v[50:51], v[54:55]
    v_pk_add_f32 v[58:59], v[58:59], v[62:63]
    v_pk_add_f32 v[84:85], v[84:85], v[56:57]
    v_pk_add_f32 v[86:87], v[86:87], v[58:59]
    s_waitcnt vmcnt(0)
    s_mov_b32 s5, 0
    s_branch FK_sp1_c
FK_sp1_l:
    buffer_load_dword v4, v3, s[76:79], 0 offen sc1
    s_waitcnt vmcnt(0)
FK_sp1_c:
    v_xor_b32 v5, s39, v4
    v_cmp_ne_u32 vcc, 0, v5
    s_add_u32 s5, s5, 1
    s_cmp_ge_u32 s5, 20000
    s_cbranch_scc1 FK_sp1_x
    s_nop 0
    s_cmp_eq_u64 vcc, 0
    s_cbranch_scc1 FK_sp1_x
    s_sleep 1
    s_branch FK_sp1_l
FK_sp1_x:
    s_add_u32 s46, s88, 3584
    buffer_load_dwordx4 v[216:219], v1, s[20:23], s46 offen sc1
    s_add_u32 s46, s88, 12800
    buffer_load_dwordx4 v[220:223], v1, s[20:23], s46 offen sc1
    s_add_u32 s46, s88, 22016
    buffer_load_dwordx4 v[224:227], v1, s[20:23], s46 offen sc1
    s_add_u32 s46, s88, 31232
    buffer_load_dwordx4 v[228:231], v1, s[20:23], s46 offen sc1
    s_add_u32 s46, s88, 40448
    buffer_load_dwordx4 v[232:235], v1, s[20:23], s46 offen sc1
    s_add_u32 s46, s88, 49664
    buffer_load_dwordx4 v[236:239], v1, s[20:23], s46 offen sc1
    s_add_u32 s46, s88, 58880
    buffer_load_dwordx4 v[240:243], v1, s[20:23], s46 offen sc1
    s_add_u32 s46, s88, 68096
    buffer_load_dwordx4 v[244:247], v1, s[20:23], s46 offen sc1
    v_dot2_f32_bf16 v68, v16, s56, v68
    v_dot2_f32_bf16 v69, v16, s57, v69
    v_dot2_f32_bf16 v70, v17, s56, v70
    v_dot2_f32_bf16 v71, v17, s57, v71
    v_dot2_f32_bf16 v72, v18, s56, v72
    v_dot2_f32_bf16 v73, v18, s57, v73
    v_dot2_f32_bf16 v74, v19, s56, v74
    v_dot2_f32_bf16 v75, v19, s57, v75
    v_dot2_f32_bf16 v68, v168, s56, v68
    v_dot2_f32_bf16 v69, v168, s57, v69
    v_dot2_f32_bf16 v70, v169, s56, v70
    v_dot2_f32_bf16 v71, v169, s57, v71
    v_dot2_f32_bf16 v72, v170, s56, v72
    v_dot2_f32_bf16 v73, v170, s57, v73
    v_dot2_f32_bf16 v74, v171, s56, v74
    v_dot2_f32_bf16 v75, v171, s57, v75
    v_dot2_f32_bf16 v68, v172, s56, v68
    v_dot2_f32_bf16 v69, v172, s57, v69
    v_dot2_f32_bf16 v70, v173, s56, v70
    v_dot2_f32_bf16 v71, v173, s57, v71
    v_dot2_f32_bf16 v72, v174, s56, v72
    v_dot2_f32_bf16 v73, v174, s57, v73
    v_dot2_f32_bf16 v74, v175, s56, v74
    v_dot2_f32_bf16 v75, v175, s57, v75
    v_dot2_f32_bf16 v68, v176, s56, v68
    v_dot2_f32_bf16 v69, v176, s57, v69
    v_dot2_f32_bf16 v70, v177, s56, v70
    v_dot2_f32_bf16 v71, v177, s57, v71
    v_dot2_f32_bf16 v72, v178, s56, v72
    v_dot2_f32_bf16 v73, v178, s57, v73
    v_dot2_f32_bf16 v74, v179, s56, v74
    v_dot2_f32_bf16 v75, v179, s57, v75
    v_dot2_f32_bf16 v68, v180, s56, v68
    v_dot2_f32_bf16 v69, v180, s57, v69
    v_dot2_f32_bf16 v70, v181, s56, v70
    v_dot2_f32_bf16 v71, v181, s57, v71
    v_dot2_f32_bf16 v72, v182, s56, v72
    v_dot2_f32_bf16 v73, v182, s57, v73
    v_dot2_f32_bf16 v74, v183, s56, v74
    v_dot2_f32_bf16 v75, v183, s57, v75
    v_dot2_f32_bf16 v68, v184, s56, v68
    v_dot2_f32_bf16 v69, v184, s57, v69
    v_dot2_f32_bf16 v70, v185, s56, v70
    v_dot2_f32_bf16 v71, v185, s57, v71
    v_dot2_f32_bf16 v72, v186, s56, v72
    v_dot2_f32_bf16 v73, v186, s57, v73
    v_dot2_f32_bf16 v74, v187, s56, v74
    v_dot2_f32_bf16 v75, v187, s57, v75
    v_dot2_f32_bf16 v68, v188, s56, v68
    v_dot2_f32_bf16 v69, v188, s57, v69
    v_dot2_f32_bf16 v70, v189, s56, v70
    v_dot2_f32_bf16 v71, v189, s57, v71
    v_dot2_f32_bf16 v72, v190, s56, v72
    v_dot2_f32_bf16 v73, v190, s57, v73
    v_dot2_f32_bf16 v74, v191, s56, v74
    v_dot2_f32_bf16 v75, v191, s57, v75
    v_dot2_f32_bf16 v68, v192, s56, v68
    v_dot2_f32_bf16 v69, v192, s57, v69
    v_dot2_f32_bf16 v70, v193, s56, v70
    v_dot2_f32_bf16 v71, v193, s57, v71
    v_dot2_f32_bf16 v72, v194, s56, v72
    v_dot2_f32_bf16 v73, v194, s57, v73
    v_dot2_f32_bf16 v74, v195, s56, v74
    v_dot2_f32_bf16 v75, v195, s57, v75
    v_dot2_f32_bf16 v68, v196, s56, v68
    v_dot2_f32_bf16 v69, v196, s57, v69
    v_dot2_f32_bf16 v70, v197, s56, v70
    v_dot2_f32_bf16 v71, v197, s57, v71
    v_dot2_f32_bf16 v72, v198, s56, v72
    v_dot2_f32_bf16 v73, v198, s57, v73
    v_dot2_f32_bf16 v74, v199, s56, v74
    v_dot2_f32_bf16 v75, v199, s57, v75
    s_nop 2
    v_cvt_pk_bf16_f32 v64, v68, v69
    v_cvt_pk_bf16_f32 v65, v70, v71
    s_mul_i32 s46, s42, 160
    s_add_u32 s46, s46, 576
    s_add_u32 s46, s46, s89
    buffer_store_dwordx2 v[64:65], v6, s[28:31], s46 offen
    v_cvt_pk_bf16_f32 v66, v72, v73
    v_cvt_pk_bf16_f32 v67, v74, v75
    s_mul_i32 s46, s42, 160
    s_add_u32 s46, s46, 608
    s_add_u32 s46, s46, s89
    buffer_store_dwordx2 v[66:67], v6, s[28:31], s46 offen
    s_nop 1
    s_waitcnt vmcnt(2)
    v_dot2_f32_bf16 v80, v24, s56, v80
    v_dot2_f32_bf16 v81, v24, s57, v81
    v_dot2_f32_bf16 v82, v25, s56, v82
    v_dot2_f32_bf16 v83, v25, s57, v83
    v_dot2_f32_bf16 v84, v26, s56, v84
    v_dot2_f32_bf16 v85, v26, s57, v85
    v_dot2_f32_bf16 v86, v27, s56, v86
    v_dot2_f32_bf16 v87, v27, s57, v87
    v_dot2_f32_bf16 v80, v216, s56, v80
    v_dot2_f32_bf16 v81, v216, s57, v81
    v_dot2_f32_bf16 v82, v217, s56, v82
    v_dot2_f32_bf16 v83, v217, s57, v83
    v_dot2_f32_bf16 v84, v218, s56, v84
    v_dot2_f32_bf16 v85, v218, s57, v85
    v_dot2_f32_bf16 v86, v219, s56, v86
    v_dot2_f32_bf16 v87, v219, s57, v87
    v_dot2_f32_bf16 v80, v220, s56, v80
    v_dot2_f32_bf16 v81, v220, s57, v81
    v_dot2_f32_bf16 v82, v221, s56, v82
    v_dot2_f32_bf16 v83, v221, s57, v83
    v_dot2_f32_bf16 v84, v222, s56, v84
    v_dot2_f32_bf16 v85, v222, s57, v85
    v_dot2_f32_bf16 v86, v223, s56, v86
    v_dot2_f32_bf16 v87, v223, s57, v87
    v_dot2_f32_bf16 v80, v224, s56, v80
    v_dot2_f32_bf16 v81, v224, s57, v81
    v_dot2_f32_bf16 v82, v225, s56, v82
    v_dot2_f32_bf16 v83, v225, s57, v83
    v_dot2_f32_bf16 v84, v226, s56, v84
    v_dot2_f32_bf16 v85, v226, s57, v85
    v_dot2_f32_bf16 v86, v227, s56, v86
    v_dot2_f32_bf16 v87, v227, s57, v87
    v_dot2_f32_bf16 v80, v228, s56, v80
    v_dot2_f32_bf16 v81, v228, s57, v81
    v_dot2_f32_bf16 v82, v229, s56, v82
    v_dot2_f32_bf16 v83, v229, s57, v83
    v_dot2_f32_bf16 v84, v230, s56, v84
    v_dot2_f32_bf16 v85, v230, s57, v85
    v_dot2_f32_bf16 v86, v231, s56, v86
    v_dot2_f32_bf16 v87, v231, s57, v87
    v_dot2_f32_bf16 v80, v232, s56, v80
    v_dot2_f32_bf16 v81, v232, s57, v81
    v_dot2_f32_bf16 v82, v233, s56, v82
    v_dot2_f32_bf16 v83, v233, s57, v83
    v_dot2_f32_bf16 v84, v234, s56, v84
    v_dot2_f32_bf16 v85, v234, s57, v85
    v_dot2_f32_bf16 v86, v235, s56, v86
    v_dot2_f32_bf16 v87, v235, s57, v87
    v_dot2_f32_bf16 v80, v236, s56, v80
    v_dot2_f32_bf16 v81, v236, s57, v81
    v_dot2_f32_bf16 v82, v237, s56, v82
    v_dot2_f32_bf16 v83, v237, s57, v83
    v_dot2_f32_bf16 v84, v238, s56, v84
    v_dot2_f32_bf16 v85, v238, s57, v85
    v_dot2_f32_bf16 v86, v239, s56, v86
    v_dot2_f32_bf16 v87, v239, s57, v87
    v_dot2_f32_bf16 v80, v240, s56, v80
    v_dot2_f32_bf16 v81, v240, s57, v81
    v_dot2_f32_bf16 v82, v241, s56, v82
    v_dot2_f32_bf16 v83, v241, s57, v83
    v_dot2_f32_bf16 v84, v242, s56, v84
    v_dot2_f32_bf16 v85, v242, s57, v85
    v_dot2_f32_bf16 v86, v243, s56, v86
    v_dot2_f32_bf16 v87, v243, s57, v87
    v_dot2_f32_bf16 v80, v244, s56, v80
    v_dot2_f32_bf16 v81, v244, s57, v81
    v_dot2_f32_bf16 v82, v245, s56, v82
    v_dot2_f32_bf16 v83, v245, s57, v83
    v_dot2_f32_bf16 v84, v246, s56, v84
    v_dot2_f32_bf16 v85, v246, s57, v85
    v_dot2_f32_bf16 v86, v247, s56, v86
    v_dot2_f32_bf16 v87, v247, s57, v87
    s_nop 2
    v_cvt_pk_bf16_f32 v64, v80, v81
    v_cvt_pk_bf16_f32 v65, v82, v83
    s_lshl_b32 s46, s42, 7
    s_add_u32 s46, s46, 64
    s_add_u32 s46, s46, s89
    buffer_store_dwordx2 v[64:65], v6, s[28:31], s46 offen
    v_cvt_pk_bf16_f32 v66, v84, v85
    v_cvt_pk_bf16_f32 v67, v86, v87
    s_lshl_b32 s46, s42, 7
    s_add_u32 s46, s46, 96
    s_add_u32 s46, s46, s89
    buffer_store_dwordx2 v[66:67], v6, s[28:31], s46 offen
    s_nop 1
    s_branch FK_fin
FK_z2:
    s_cmp_lg_u32 s3, 2
    s_cbranch_scc1 FK_z3
    s_add_u32 s46, s88, 4608
    buffer_load_dwordx4 v[168:171], v1, s[20:23], s46 offen sc1
    s_add_u32 s46, s88, 13824
    buffer_load_dwordx4 v[172:175], v1, s[20:23], s46 offen sc1
    s_add_u32 s46, s88, 23040
    buffer_load_dwordx4 v[176:179], v1, s[20:23], s46 offen sc1
    s_add_u32 s46, s88, 32256
    buffer_load_dwordx4 v[180:183], v1, s[20:23], s46 offen sc1
    s_add_u32 s46, s88, 41472
    buffer_load_dwordx4 v[184:187], v1, s[20:23], s46 offen sc1
    s_add_u32 s46, s88, 50688
    buffer_load_dwordx4 v[188:191], v1, s[20:23], s46 offen sc1
    s_add_u32 s46, s88, 59904
    buffer_load_dwordx4 v[192:195], v1, s[20:23], s46 offen sc1
    s_add_u32 s46, s88, 69120
    buffer_load_dwordx4 v[196:199], v1, s[20:23], s46 offen sc1
    s_mul_i32 s46, s42, 160
    s_add_u32 s46, s46, 512
    s_add_u32 s46, s46, s89
    s_add_u32 s46, s46, 18432
    buffer_load_dwordx2 v[16:17], v6, s[24:27], s46 offen
    s_mul_i32 s46, s42, 160
    s_add_u32 s46, s46, 544
    s_add_u32 s46, s46, s89
    s_add_u32 s46, s46, 18432
    buffer_load_dwordx2 v[18:19], v6, s[24:27], s46 offen
    s_add_u32 s46, s88, 6656
    buffer_load_dwordx2 v[200:201], v2, s[20:23], s46 offen sc1
    s_add_u32 s46, s88, 15872
    buffer_load_dwordx2 v[202:203], v2, s[20:23], s46 offen sc1
    s_add_u32 s46, s88, 25088
    buffer_load_dwordx2 v[204:205], v2, s[20:23], s46 offen sc1
    s_add_u32 s46, s88, 34304
    buffer_load_dwordx2 v[206:207], v2, s[20:23], s46 offen sc1
    s_add_u32 s46, s88, 43520
    buffer_load_dwordx2 v[208:209], v2, s[20:23], s46 offen sc1
    s_add_u32 s46, s88, 52736
    buffer_load_dwordx2 v[210:211], v2, s[20:23], s46 offen sc1
    s_add_u32 s46, s88, 61952
    buffer_load_dwordx2 v[212:213], v2, s[20:23], s46 offen sc1
    s_add_u32 s46, s88, 71168
    buffer_load_dwordx2 v[214:215], v2, s[20:23], s46 offen sc1
    s_mul_i32 s46, s42, 160
    s_add_u32 s46, s46, 640
    s_add_u32 s46, s46, s89
    s_add_u32 s46, s46, 18432
    buffer_load_dwordx2 v[20:21], v6, s[24:27], s46 offen
    s_lshl_b32 s46, s42, 7
    s_add_u32 s46, s46, 0
    s_add_u32 s46, s46, s89
    s_add_u32 s46, s46, 18432
    buffer_load_dwordx2 v[24:25], v6, s[24:27], s46 offen
    s_lshl_b32 s46, s42, 7
    s_add_u32 s46, s46, 32
    s_add_u32 s46, s46, s89
    s_add_u32 s46, s46, 18432
    buffer_load_dwordx2 v[26:27], v6, s[24:27], s46 offen
    buffer_load_dword v4, v3, s[76:79], 0 offen sc1
    ds_read_b128 v[32:35], v7 offset:1024
    ds_read_b128 v[36:39], v7 offset:19456
    ds_read_b128 v[40:43], v8 offset:1024
    ds_read_b128 v[44:47], v8 offset:19456
    ds_read_b128 v[48:51], v7 offset:3072
    ds_read_b128 v[52:55], v7 offset:21504
    ds_read_b128 v[56:59], v8 offset:3072
    ds_read_b128 v[60:63], v8 offset:21504
    s_waitcnt lgkmcnt(0)
    v_pk_add_f32 v[68:69], v[32:33], v[36:37]
    v_pk_add_f32 v[40:41], v[40:41], v[44:45]
    v_pk_add_f32 v[70:71], v[34:35], v[38:39]
    v_pk_add_f32 v[42:43], v[42:43], v[46:47]
    v_pk_add_f32 v[68:69], v[68:69], v[40:41]
    v_pk_add_f32 v[70:71], v[70:71], v[42:43]
    v_pk_add_f32 v[72:73], v[48:49], v[52:53]
    v_pk_add_f32 v[56:57], v[56:57], v[60:61]
    v_pk_add_f32 v[74:75], v[50:51], v[54:55]
    v_pk_add_f32 v[58:59], v[58:59], v[62:63]
    v_pk_add_f32 v[72:73], v[72:73], v[56:57]
    v_pk_add_f32 v[74:75], v[74:75], v[58:59]
    ds_read_b128 v[32:35], v7 offset:9216
    ds_read_b128 v[36:39], v7 offset:27648
    ds_read_b128 v[40:43], v8 offset:9216
    ds_read_b128 v[44:47], v8 offset:27648
    s_waitcnt lgkmcnt(0)
    v_pk_add_f32 v[76:77], v[32:33], v[36:37]
    v_pk_add_f32 v[40:41], v[40:41], v[44:45]
    v_pk_add_f32 v[78:79], v[34:35], v[38:39]
    v_pk_add_f32 v[42:43], v[42:43], v[46:47]
    v_pk_add_f32 v[76:77], v[76:77], v[40:41]
    v_pk_add_f32 v[78:79], v[78:79], v[42:43]
    ds_read_b128 v[32:35], v7 offset:11264
    ds_read_b128 v[36:39], v7 offset:29696
    ds_read_b128 v[40:43], v8 offset:11264
    ds_read_b128 v[44:47], v8 offset:29696
    ds_read_b128 v[48:51], v7 offset:13312
    ds_read_b128 v[52:55], v7 offset:31744
    ds_read_b128 v[56:59], v8 offset:13312
    ds_read_b128 v[60:63], v8 offset:31744
    s_waitcnt lgkmcnt(0)
    v_pk_add_f32 v[80:81], v[32:33], v[36:37]
    v_pk_add_f32 v[40:41], v[40:41], v[44:45]
    v_pk_add_f32 v[82:83], v[34:35], v[38:39]
    v_pk_add_f32 v[42:43], v[42:43], v[46:47]
    v_pk_add_f32 v[80:81], v[80:81], v[40:41]
    v_pk_add_f32 v[82:83], v[82:83], v[42:43]
    v_pk_add_f32 v[84:85], v[48:49], v[52:53]
    v_pk_add_f32 v[56:57], v[56:57], v[60:61]
    v_pk_add_f32 v[86:87], v[50:51], v[54:55]
    v_pk_add_f32 v[58:59], v[58:59], v[62:63]
    v_pk_add_f32 v[84:85], v[84:85], v[56:57]
    v_pk_add_f32 v[86:87], v[86:87], v[58:59]
    s_waitcnt vmcnt(0)
    s_mov_b32 s5, 0
    s_branch FK_sp2_c
FK_sp2_l:
    buffer_load_dword v4, v3, s[76:79], 0 offen sc1
    s_waitcnt vmcnt(0)
FK_sp2_c:
    v_xor_b32 v5, s39, v4
    v_cmp_ne_u32 vcc, 0, v5
    s_add_u32 s5, s5, 1
    s_cmp_ge_u32 s5, 20000
    s_cbranch_scc1 FK_sp2_x
    s_nop 0
    s_cmp_eq_u64 vcc, 0
    s_cbranch_scc1 FK_sp2_x
    s_sleep 1
    s_branch FK_sp2_l
FK_sp2_x:
    s_add_u32 s46, s88, 7168
    buffer_load_dwordx4 v[216:219], v1, s[20:23], s46 offen sc1
    s_add_u32 s46, s88, 16384
    buffer_load_dwordx4 v[220:223], v1, s[20:23], s46 offen sc1
    s_add_u32 s46, s88, 25600
    buffer_load_dwordx4 v[224:227], v1, s[20:23], s46 offen sc1
    s_add_u32 s46, s88, 34816
    buffer_load_dwordx4 v[228:231], v1, s[20:23], s46 offen sc1
    s_add_u32 s46, s88, 44032
    buffer_load_dwordx4 v[232:235], v1, s[20:23], s46 offen sc1
    s_add_u32 s46, s88, 53248
    buffer_load_dwordx4 v[236:239], v1, s[20:23], s46 offen sc1
    s_add_u32 s46, s88, 62464
    buffer_load_dwordx4 v[240:243], v1, s[20:23], s46 offen sc1
    s_add_u32 s46, s88, 71680
    buffer_load_dwordx4 v[244:247], v1, s[20:23], s46 offen sc1
    v_dot2_f32_bf16 v68, v16, s56, v68
    v_dot2_f32_bf16 v69, v16, s57, v69
    v_dot2_f32_bf16 v70, v17, s56, v70
    v_dot2_f32_bf16 v71, v17, s57, v71
    v_dot2_f32_bf16 v72, v18, s56, v72
    v_dot2_f32_bf16 v73, v18, s57, v73
    v_dot2_f32_bf16 v74, v19, s56, v74
    v_dot2_f32_bf16 v75, v19, s57, v75
    v_dot2_f32_bf16 v68, v168, s56, v68
    v_dot2_f32_bf16 v69, v168, s57, v69
    v_dot2_f32_bf16 v70, v169, s56, v70
    v_dot2_f32_bf16 v71, v169, s57, v71
    v_dot2_f32_bf16 v72, v170, s56, v72
    v_dot2_f32_bf16 v73, v170, s57, v73
    v_dot2_f32_bf16 v74, v171, s56, v74
    v_dot2_f32_bf16 v75, v171, s57, v75
    v_dot2_f32_bf16 v68, v172, s56, v68
    v_dot2_f32_bf16 v69, v172, s57, v69
    v_dot2_f32_bf16 v70, v173, s56, v70
    v_dot2_f32_bf16 v71, v173, s57, v71
    v_dot2_f32_bf16 v72, v174, s56, v72
    v_dot2_f32_bf16 v73, v174, s57, v73
    v_dot2_f32_bf16 v74, v175, s56, v74
    v_dot2_f32_bf16 v75, v175, s57, v75
    v_dot2_f32_bf16 v68, v176, s56, v68
    v_dot2_f32_bf16 v69, v176, s57, v69
    v_dot2_f32_bf16 v70, v177, s56, v70
    v_dot2_f32_bf16 v71, v177, s57, v71
    v_dot2_f32_bf16 v72, v178, s56, v72
    v_dot2_f32_bf16 v73, v178, s57, v73
    v_dot2_f32_bf16 v74, v179, s56, v74
    v_dot2_f32_bf16 v75, v179, s57, v75
    v_dot2_f32_bf16 v68, v180, s56, v68
    v_dot2_f32_bf16 v69, v180, s57, v69
    v_dot2_f32_bf16 v70, v181, s56, v70
    v_dot2_f32_bf16 v71, v181, s57, v71
    v_dot2_f32_bf16 v72, v182, s56, v72
    v_dot2_f32_bf16 v73, v182, s57, v73
    v_dot2_f32_bf16 v74, v183, s56, v74
    v_dot2_f32_bf16 v75, v183, s57, v75
    v_dot2_f32_bf16 v68, v184, s56, v68
    v_dot2_f32_bf16 v69, v184, s57, v69
    v_dot2_f32_bf16 v70, v185, s56, v70
    v_dot2_f32_bf16 v71, v185, s57, v71
    v_dot2_f32_bf16 v72, v186, s56, v72
    v_dot2_f32_bf16 v73, v186, s57, v73
    v_dot2_f32_bf16 v74, v187, s56, v74
    v_dot2_f32_bf16 v75, v187, s57, v75
    v_dot2_f32_bf16 v68, v188, s56, v68
    v_dot2_f32_bf16 v69, v188, s57, v69
    v_dot2_f32_bf16 v70, v189, s56, v70
    v_dot2_f32_bf16 v71, v189, s57, v71
    v_dot2_f32_bf16 v72, v190, s56, v72
    v_dot2_f32_bf16 v73, v190, s57, v73
    v_dot2_f32_bf16 v74, v191, s56, v74
    v_dot2_f32_bf16 v75, v191, s57, v75
    v_dot2_f32_bf16 v68, v192, s56, v68
    v_dot2_f32_bf16 v69, v192, s57, v69
    v_dot2_f32_bf16 v70, v193, s56, v70
    v_dot2_f32_bf16 v71, v193, s57, v71
    v_dot2_f32_bf16 v72, v194, s56, v72
    v_dot2_f32_bf16 v73, v194, s57, v73
    v_dot2_f32_bf16 v74, v195, s56, v74
    v_dot2_f32_bf16 v75, v195, s57, v75
    v_dot2_f32_bf16 v68, v196, s56, v68
    v_dot2_f32_bf16 v69, v196, s57, v69
    v_dot2_f32_bf16 v70, v197, s56, v70
    v_dot2_f32_bf16 v71, v197, s57, v71
    v_dot2_f32_bf16 v72, v198, s56, v72
    v_dot2_f32_bf16 v73, v198, s57, v73
    v_dot2_f32_bf16 v74, v199, s56, v74
    v_dot2_f32_bf16 v75, v199, s57, v75
    s_nop 2
    v_cvt_pk_bf16_f32 v64, v68, v69
    v_cvt_pk_bf16_f32 v65, v70, v71
    s_mul_i32 s46, s42, 160
    s_add_u32 s46, s46, 512
    s_add_u32 s46, s46, s89
    s_add_u32 s46, s46, 18432
    buffer_store_dwordx2 v[64:65], v6, s[28:31], s46 offen
    v_cvt_pk_bf16_f32 v66, v72, v73
    v_cvt_pk_bf16_f32 v67, v74, v75
    s_mul_i32 s46, s42, 160
    s_add_u32 s46, s46, 544
    s_add_u32 s46, s46, s89
    s_add_u32 s46, s46, 18432
    buffer_store_dwordx2 v[66:67], v6, s[28:31], s46 offen
    s_nop 1
    v_dot2_f32_bf16 v76, v20, s56, v76
    v_dot2_f32_bf16 v77, v20, s57, v77
    v_dot2_f32_bf16 v78, v21, s56, v78
    v_dot2_f32_bf16 v79, v21, s57, v79
    v_dot2_f32_bf16 v76, v200, s56, v76
    v_dot2_f32_bf16 v77, v200, s57, v77
    v_dot2_f32_bf16 v78, v201, s56, v78
    v_dot2_f32_bf16 v79, v201, s57, v79
    v_dot2_f32_bf16 v76, v202, s56, v76
    v_dot2_f32_bf16 v77, v202, s57, v77
    v_dot2_f32_bf16 v78, v203, s56, v78
    v_dot2_f32_bf16 v79, v203, s57, v79
    v_dot2_f32_bf16 v76, v204, s56, v76
    v_dot2_f32_bf16 v77, v204, s57, v77
    v_dot2_f32_bf16 v78, v205, s56, v78
    v_dot2_f32_bf16 v79, v205, s57, v79
    v_dot2_f32_bf16 v76, v206, s56, v76
    v_dot2_f32_bf16 v77, v206, s57, v77
    v_dot2_f32_bf16 v78, v207, s56, v78
    v_dot2_f32_bf16 v79, v207, s57, v79
    v_dot2_f32_bf16 v76, v208, s56, v76
    v_dot2_f32_bf16 v77, v208, s57, v77
    v_dot2_f32_bf16 v78, v209, s56, v78
    v_dot2_f32_bf16 v79, v209, s57, v79
    v_dot2_f32_bf16 v76, v210, s56, v76
    v_dot2_f32_bf16 v77, v210, s57, v77
    v_dot2_f32_bf16 v78, v211, s56, v78
    v_dot2_f32_bf16 v79, v211, s57, v79
    v_dot2_f32_bf16 v76, v212, s56, v76
    v_dot2_f32_bf16 v77, v212, s57, v77
    v_dot2_f32_bf16 v78, v213, s56, v78
    v_dot2_f32_bf16 v79, v213, s57, v79
    v_dot2_f32_bf16 v76, v214, s56, v76
    v_dot2_f32_bf16 v77, v214, s57, v77
    v_dot2_f32_bf16 v78, v215, s56, v78
    v_dot2_f32_bf16 v79, v215, s57, v79
    s_nop 2
    v_cvt_pk_bf16_f32 v64, v76, v77
    v_cvt_pk_bf16_f32 v65, v78, v79
    s_mul_i32 s46, s42, 160
    s_add_u32 s46, s46, 640
    s_add_u32 s46, s46, s89
    s_add_u32 s46, s46, 18432
    buffer_store_dwordx2 v[64:65], v6, s[28:31], s46 offen
    s_nop 1
    s_waitcnt vmcnt(3)
    v_dot2_f32_bf16 v80, v24, s56, v80
    v_dot2_f32_bf16 v81, v24, s57, v81
    v_dot2_f32_bf16 v82, v25, s56, v82
    v_dot2_f32_bf16 v83, v25, s57, v83
    v_dot2_f32_bf16 v84, v26, s56, v84
    v_dot2_f32_bf16 v85, v26, s57, v85
    v_dot2_f32_bf16 v86, v27, s56, v86
    v_dot2_f32_bf16 v87, v27, s57, v87
    v_dot2_f32_bf16 v80, v216, s56, v80
    v_dot2_f32_bf16 v81, v216, s57, v81
    v_dot2_f32_bf16 v82, v217, s56, v82
    v_dot2_f32_bf16 v83, v217, s57, v83
    v_dot2_f32_bf16 v84, v218, s56, v84
    v_dot2_f32_bf16 v85, v218, s57, v85
    v_dot2_f32_bf16 v86, v219, s56, v86
    v_dot2_f32_bf16 v87, v219, s57, v87
    v_dot2_f32_bf16 v80, v220, s56, v80
    v_dot2_f32_bf16 v81, v220, s57, v81
    v_dot2_f32_bf16 v82, v221, s56, v82
    v_dot2_f32_bf16 v83, v221, s57, v83
    v_dot2_f32_bf16 v84, v222, s56, v84
    v_dot2_f32_bf16 v85, v222, s57, v85
    v_dot2_f32_bf16 v86, v223, s56, v86
    v_dot2_f32_bf16 v87, v223, s57, v87
    v_dot2_f32_bf16 v80, v224, s56, v80
    v_dot2_f32_bf16 v81, v224, s57, v81
    v_dot2_f32_bf16 v82, v225, s56, v82
    v_dot2_f32_bf16 v83, v225, s57, v83
    v_dot2_f32_bf16 v84, v226, s56, v84
    v_dot2_f32_bf16 v85, v226, s57, v85
    v_dot2_f32_bf16 v86, v227, s56, v86
    v_dot2_f32_bf16 v87, v227, s57, v87
    v_dot2_f32_bf16 v80, v228, s56, v80
    v_dot2_f32_bf16 v81, v228, s57, v81
    v_dot2_f32_bf16 v82, v229, s56, v82
    v_dot2_f32_bf16 v83, v229, s57, v83
    v_dot2_f32_bf16 v84, v230, s56, v84
    v_dot2_f32_bf16 v85, v230, s57, v85
    v_dot2_f32_bf16 v86, v231, s56, v86
    v_dot2_f32_bf16 v87, v231, s57, v87
    v_dot2_f32_bf16 v80, v232, s56, v80
    v_dot2_f32_bf16 v81, v232, s57, v81
    v_dot2_f32_bf16 v82, v233, s56, v82
    v_dot2_f32_bf16 v83, v233, s57, v83
    v_dot2_f32_bf16 v84, v234, s56, v84
    v_dot2_f32_bf16 v85, v234, s57, v85
    v_dot2_f32_bf16 v86, v235, s56, v86
    v_dot2_f32_bf16 v87, v235, s57, v87
    v_dot2_f32_bf16 v80, v236, s56, v80
    v_dot2_f32_bf16 v81, v236, s57, v81
    v_dot2_f32_bf16 v82, v237, s56, v82
    v_dot2_f32_bf16 v83, v237, s57, v83
    v_dot2_f32_bf16 v84, v238, s56, v84
    v_dot2_f32_bf16 v85, v238, s57, v85
    v_dot2_f32_bf16 v86, v239, s56, v86
    v_dot2_f32_bf16 v87, v239, s57, v87
    v_dot2_f32_bf16 v80, v240, s56, v80
    v_dot2_f32_bf16 v81, v240, s57, v81
    v_dot2_f32_bf16 v82, v241, s56, v82
    v_dot2_f32_bf16 v83, v241, s57, v83
    v_dot2_f32_bf16 v84, v242, s56, v84
    v_dot2_f32_bf16 v85, v242, s57, v85
    v_dot2_f32_bf16 v86, v243, s56, v86
    v_dot2_f32_bf16 v87, v243, s57, v87
    v_dot2_f32_bf16 v80, v244, s56, v80
    v_dot2_f32_bf16 v81, v244, s57, v81
    v_dot2_f32_bf16 v82, v245, s56, v82
    v_dot2_f32_bf16 v83, v245, s57, v83
    v_dot2_f32_bf16 v84, v246, s56, v84
    v_dot2_f32_bf16 v85, v246, s57, v85
    v_dot2_f32_bf16 v86, v247, s56, v86
    v_dot2_f32_bf16 v87, v247, s57, v87
    s_nop 2
    v_cvt_pk_bf16_f32 v64, v80, v81
    v_cvt_pk_bf16_f32 v65, v82, v83
    s_lshl_b32 s46, s42, 7
    s_add_u32 s46, s46, 0
    s_add_u32 s46, s46, s89
    s_add_u32 s46, s46, 18432
    buffer_store_dwordx2 v[64:65], v6, s[28:31], s46 offen
    v_cvt_pk_bf16_f32 v66, v84, v85
    v_cvt_pk_bf16_f32 v67, v86, v87
    s_lshl_b32 s46, s42, 7
    s_add_u32 s46, s46, 32
    s_add_u32 s46, s46, s89
    s_add_u32 s46, s46, 18432
    buffer_store_dwordx2 v[66:67], v6, s[28:31], s46 offen
    s_nop 1
    s_branch FK_fin
FK_z3:
    s_add_u32 s46, s88, 5632
    buffer_load_dwordx4 v[168:171], v1, s[20:23], s46 offen sc1
    s_add_u32 s46, s88, 14848
    buffer_load_dwordx4 v[172:175], v1, s[20:23], s46 offen sc1
    s_add_u32 s46, s88, 24064
    buffer_load_dwordx4 v[176:179], v1, s[20:23], s46 offen sc1
    s_add_u32 s46, s88, 33280
    buffer_load_dwordx4 v[180:183], v1, s[20:23], s46 offen sc1
    s_add_u32 s46, s88, 42496
    buffer_load_dwordx4 v[184:187], v1, s[20:23], s46 offen sc1
    s_add_u32 s46, s88, 51712
    buffer_load_dwordx4 v[188:191], v1, s[20:23], s46 offen sc1
    s_add_u32 s46, s88, 60928
    buffer_load_dwordx4 v[192:195], v1, s[20:23], s46 offen sc1
    s_add_u32 s46, s88, 70144
    buffer_load_dwordx4 v[196:199], v1, s[20:23], s46 offen sc1
    s_mul_i32 s46, s42, 160
    s_add_u32 s46, s46, 576
    s_add_u32 s46, s46, s89
    s_add_u32 s46, s46, 18432
    buffer_load_dwordx2 v[16:17], v6, s[24:27], s46 offen
    s_mul_i32 s46, s42, 160
    s_add_u32 s46, s46, 608
    s_add_u32 s46, s46, s89
    s_add_u32 s46, s46, 18432
    buffer_load_dwordx2 v[18:19], v6, s[24:27], s46 offen
    s_lshl_b32 s46, s42, 7
    s_add_u32 s46, s46, 64
    s_add_u32 s46, s46, s89
    s_add_u32 s46, s46, 18432
    buffer_load_dwordx2 v[24:25], v6, s[24:27], s46 offen
    s_lshl_b32 s46, s42, 7
    s_add_u32 s46, s46, 96
    s_add_u32 s46, s46, s89
    s_add_u32 s46, s46, 18432
    buffer_load_dwordx2 v[26:27], v6, s[24:27], s46 offen
    buffer_load_dword v4, v3, s[76:79], 0 offen sc1
    ds_read_b128 v[32:35], v7 offset:5120
    ds_read_b128 v[36:39], v7 offset:23552
    ds_read_b128 v[40:43], v8 offset:5120
    ds_read_b128 v[44:47], v8 offset:23552
    ds_read_b128 v[48:51], v7 offset:7168
    ds_read_b128 v[52:55], v7 offset:25600
    ds_read_b128 v[56:59], v8 offset:7168
    ds_read_b128 v[60:63], v8 offset:25600
    s_waitcnt lgkmcnt(0)
    v_pk_add_f32 v[68:69], v[32:33], v[36:37]
    v_pk_add_f32 v[40:41], v[40:41], v[44:45]
    v_pk_add_f32 v[70:71], v[34:35], v[38:39]
    v_pk_add_f32 v[42:43], v[42:43], v[46:47]
    v_pk_add_f32 v[68:69], v[68:69], v[40:41]
    v_pk_add_f32 v[70:71], v[70:71], v[42:43]
    v_pk_add_f32 v[72:73], v[48:49], v[52:53]
    v_pk_add_f32 v[56:57], v[56:57], v[60:61]
    v_pk_add_f32 v[74:75], v[50:51], v[54:55]
    v_pk_add_f32 v[58:59], v[58:59], v[62:63]
    v_pk_add_f32 v[72:73], v[72:73], v[56:57]
    v_pk_add_f32 v[74:75], v[74:75], v[58:59]
    ds_read_b128 v[32:35], v7 offset:15360
    ds_read_b128 v[36:39], v7 offset:33792
    ds_read_b128 v[40:43], v8 offset:15360
    ds_read_b128 v[44:47], v8 offset:33792
    ds_read_b128 v[48:51], v7 offset:17408
    ds_read_b128 v[52:55], v7 offset:35840
    ds_read_b128 v[56:59], v8 offset:17408
    ds_read_b128 v[60:63], v8 offset:35840
    s_waitcnt lgkmcnt(0)
    v_pk_add_f32 v[80:81], v[32:33], v[36:37]
    v_pk_add_f32 v[40:41], v[40:41], v[44:45]
    v_pk_add_f32 v[82:83], v[34:35], v[38:39]
    v_pk_add_f32 v[42:43], v[42:43], v[46:47]
    v_pk_add_f32 v[80:81], v[80:81], v[40:41]
    v_pk_add_f32 v[82:83], v[82:83], v[42:43]
    v_pk_add_f32 v[84:85], v[48:49], v[52:53]
    v_pk_add_f32 v[56:57], v[56:57], v[60:61]
    v_pk_add_f32 v[86:87], v[50:51], v[54:55]
    v_pk_add_f32 v[58:59], v[58:59], v[62:63]
    v_pk_add_f32 v[84:85], v[84:85], v[56:57]
    v_pk_add_f32 v[86:87], v[86:87], v[58:59]
    s_waitcnt vmcnt(0)
    s_mov_b32 s5, 0
    s_branch FK_sp3_c
FK_sp3_l:
    buffer_load_dword v4, v3, s[76:79], 0 offen sc1
    s_waitcnt vmcnt(0)
FK_sp3_c:
    v_xor_b32 v5, s39, v4
    v_cmp_ne_u32 vcc, 0, v5
    s_add_u32 s5, s5, 1
    s_cmp_ge_u32 s5, 20000
    s_cbranch_scc1 FK_sp3_x
    s_nop 0
    s_cmp_eq_u64 vcc, 0
    s_cbranch_scc1 FK_sp3_x
    s_sleep 1
    s_branch FK_sp3_l
FK_sp3_x:
    s_add_u32 s46, s88, 8192
    buffer_load_dwordx4 v[216:219], v1, s[20:23], s46 offen sc1
    s_add_u32 s46, s88, 17408
    buffer_load_dwordx4 v[220:223], v1, s[20:23], s46 offen sc1
    s_add_u32 s46, s88, 26624
    buffer_load_dwordx4 v[224:227], v1, s[20:23], s46 offen sc1
    s_add_u32 s46, s88, 35840
    buffer_load_dwordx4 v[228:231], v1, s[20:23], s46 offen sc1
    s_add_u32 s46, s88, 45056
    buffer_load_dwordx4 v[232:235], v1, s[20:23], s46 offen sc1
    s_add_u32 s46, s88, 54272
    buffer_load_dwordx4 v[236:239], v1, s[20:23], s46 offen sc1
    s_add_u32 s46, s88, 63488
    buffer_load_dwordx4 v[240:243], v1, s[20:23], s46 offen sc1
    s_add_u32 s46, s88, 72704
    buffer_load_dwordx4 v[244:247], v1, s[20:23], s46 offen sc1
    v_dot2_f32_bf16 v68, v16, s56, v68
    v_dot2_f32_bf16 v69, v16, s57, v69
    v_dot2_f32_bf16 v70, v17, s56, v70
    v_dot2_f32_bf16 v71, v17, s57, v71
    v_dot2_f32_bf16 v72, v18, s56, v72
    v_dot2_f32_bf16 v73, v18, s57, v73
    v_dot2_f32_bf16 v74, v19, s56, v74
    v_dot2_f32_bf16 v75, v19, s57, v75
    v_dot2_f32_bf16 v68, v168, s56, v68
    v_dot2_f32_bf16 v69, v168, s57, v69
    v_dot2_f32_bf16 v70, v169, s56, v70
    v_dot2_f32_bf16 v71, v169, s57, v71
    v_dot2_f32_bf16 v72, v170, s56, v72
    v_dot2_f32_bf16 v73, v170, s57, v73
    v_dot2_f32_bf16 v74, v171, s56, v74
    v_dot2_f32_bf16 v75, v171, s57, v75
    v_dot2_f32_bf16 v68, v172, s56, v68
    v_dot2_f32_bf16 v69, v172, s57, v69
    v_dot2_f32_bf16 v70, v173, s56, v70
    v_dot2_f32_bf16 v71, v173, s57, v71
    v_dot2_f32_bf16 v72, v174, s56, v72
    v_dot2_f32_bf16 v73, v174, s57, v73
    v_dot2_f32_bf16 v74, v175, s56, v74
    v_dot2_f32_bf16 v75, v175, s57, v75
    v_dot2_f32_bf16 v68, v176, s56, v68
    v_dot2_f32_bf16 v69, v176, s57, v69
    v_dot2_f32_bf16 v70, v177, s56, v70
    v_dot2_f32_bf16 v71, v177, s57, v71
    v_dot2_f32_bf16 v72, v178, s56, v72
    v_dot2_f32_bf16 v73, v178, s57, v73
    v_dot2_f32_bf16 v74, v179, s56, v74
    v_dot2_f32_bf16 v75, v179, s57, v75
    v_dot2_f32_bf16 v68, v180, s56, v68
    v_dot2_f32_bf16 v69, v180, s57, v69
    v_dot2_f32_bf16 v70, v181, s56, v70
    v_dot2_f32_bf16 v71, v181, s57, v71
    v_dot2_f32_bf16 v72, v182, s56, v72
    v_dot2_f32_bf16 v73, v182, s57, v73
    v_dot2_f32_bf16 v74, v183, s56, v74
    v_dot2_f32_bf16 v75, v183, s57, v75
    v_dot2_f32_bf16 v68, v184, s56, v68
    v_dot2_f32_bf16 v69, v184, s57, v69
    v_dot2_f32_bf16 v70, v185, s56, v70
    v_dot2_f32_bf16 v71, v185, s57, v71
    v_dot2_f32_bf16 v72, v186, s56, v72
    v_dot2_f32_bf16 v73, v186, s57, v73
    v_dot2_f32_bf16 v74, v187, s56, v74
    v_dot2_f32_bf16 v75, v187, s57, v75
    v_dot2_f32_bf16 v68, v188, s56, v68
    v_dot2_f32_bf16 v69, v188, s57, v69
    v_dot2_f32_bf16 v70, v189, s56, v70
    v_dot2_f32_bf16 v71, v189, s57, v71
    v_dot2_f32_bf16 v72, v190, s56, v72
    v_dot2_f32_bf16 v73, v190, s57, v73
    v_dot2_f32_bf16 v74, v191, s56, v74
    v_dot2_f32_bf16 v75, v191, s57, v75
    v_dot2_f32_bf16 v68, v192, s56, v68
    v_dot2_f32_bf16 v69, v192, s57, v69
    v_dot2_f32_bf16 v70, v193, s56, v70
    v_dot2_f32_bf16 v71, v193, s57, v71
    v_dot2_f32_bf16 v72, v194, s56, v72
    v_dot2_f32_bf16 v73, v194, s57, v73
    v_dot2_f32_bf16 v74, v195, s56, v74
    v_dot2_f32_bf16 v75, v195, s57, v75
    v_dot2_f32_bf16 v68, v196, s56, v68
    v_dot2_f32_bf16 v69, v196, s57, v69
    v_dot2_f32_bf16 v70, v197, s56, v70
    v_dot2_f32_bf16 v71, v197, s57, v71
    v_dot2_f32_bf16 v72, v198, s56, v72
    v_dot2_f32_bf16 v73, v198, s57, v73
    v_dot2_f32_bf16 v74, v199, s56, v74
    v_dot2_f32_bf16 v75, v199, s57, v75
    s_nop 2
    v_cvt_pk_bf16_f32 v64, v68, v69
    v_cvt_pk_bf16_f32 v65, v70, v71
    s_mul_i32 s46, s42, 160
    s_add_u32 s46, s46, 576
    s_add_u32 s46, s46, s89
    s_add_u32 s46, s46, 18432
    buffer_store_dwordx2 v[64:65], v6, s[28:31], s46 offen
    v_cvt_pk_bf16_f32 v66, v72, v73
    v_cvt_pk_bf16_f32 v67, v74, v75
    s_mul_i32 s46, s42, 160
    s_add_u32 s46, s46, 608
    s_add_u32 s46, s46, s89
    s_add_u32 s46, s46, 18432
    buffer_store_dwordx2 v[66:67], v6, s[28:31], s46 offen
    s_nop 1
    s_waitcnt vmcnt(2)
    v_dot2_f32_bf16 v80, v24, s56, v80
    v_dot2_f32_bf16 v81, v24, s57, v81
    v_dot2_f32_bf16 v82, v25, s56, v82
    v_dot2_f32_bf16 v83, v25, s57, v83
    v_dot2_f32_bf16 v84, v26, s56, v84
    v_dot2_f32_bf16 v85, v26, s57, v85
    v_dot2_f32_bf16 v86, v27, s56, v86
    v_dot2_f32_bf16 v87, v27, s57, v87
    v_dot2_f32_bf16 v80, v216, s56, v80
    v_dot2_f32_bf16 v81, v216, s57, v81
    v_dot2_f32_bf16 v82, v217, s56, v82
    v_dot2_f32_bf16 v83, v217, s57, v83
    v_dot2_f32_bf16 v84, v218, s56, v84
    v_dot2_f32_bf16 v85, v218, s57, v85
    v_dot2_f32_bf16 v86, v219, s56, v86
    v_dot2_f32_bf16 v87, v219, s57, v87
    v_dot2_f32_bf16 v80, v220, s56, v80
    v_dot2_f32_bf16 v81, v220, s57, v81
    v_dot2_f32_bf16 v82, v221, s56, v82
    v_dot2_f32_bf16 v83, v221, s57, v83
    v_dot2_f32_bf16 v84, v222, s56, v84
    v_dot2_f32_bf16 v85, v222, s57, v85
    v_dot2_f32_bf16 v86, v223, s56, v86
    v_dot2_f32_bf16 v87, v223, s57, v87
    v_dot2_f32_bf16 v80, v224, s56, v80
    v_dot2_f32_bf16 v81, v224, s57, v81
    v_dot2_f32_bf16 v82, v225, s56, v82
    v_dot2_f32_bf16 v83, v225, s57, v83
    v_dot2_f32_bf16 v84, v226, s56, v84
    v_dot2_f32_bf16 v85, v226, s57, v85
    v_dot2_f32_bf16 v86, v227, s56, v86
    v_dot2_f32_bf16 v87, v227, s57, v87
    v_dot2_f32_bf16 v80, v228, s56, v80
    v_dot2_f32_bf16 v81, v228, s57, v81
    v_dot2_f32_bf16 v82, v229, s56, v82
    v_dot2_f32_bf16 v83, v229, s57, v83
    v_dot2_f32_bf16 v84, v230, s56, v84
    v_dot2_f32_bf16 v85, v230, s57, v85
    v_dot2_f32_bf16 v86, v231, s56, v86
    v_dot2_f32_bf16 v87, v231, s57, v87
    v_dot2_f32_bf16 v80, v232, s56, v80
    v_dot2_f32_bf16 v81, v232, s57, v81
    v_dot2_f32_bf16 v82, v233, s56, v82
    v_dot2_f32_bf16 v83, v233, s57, v83
    v_dot2_f32_bf16 v84, v234, s56, v84
    v_dot2_f32_bf16 v85, v234, s57, v85
    v_dot2_f32_bf16 v86, v235, s56, v86
    v_dot2_f32_bf16 v87, v235, s57, v87
    v_dot2_f32_bf16 v80, v236, s56, v80
    v_dot2_f32_bf16 v81, v236, s57, v81
    v_dot2_f32_bf16 v82, v237, s56, v82
    v_dot2_f32_bf16 v83, v237, s57, v83
    v_dot2_f32_bf16 v84, v238, s56, v84
    v_dot2_f32_bf16 v85, v238, s57, v85
    v_dot2_f32_bf16 v86, v239, s56, v86
    v_dot2_f32_bf16 v87, v239, s57, v87
    v_dot2_f32_bf16 v80, v240, s56, v80
    v_dot2_f32_bf16 v81, v240, s57, v81
    v_dot2_f32_bf16 v82, v241, s56, v82
    v_dot2_f32_bf16 v83, v241, s57, v83
    v_dot2_f32_bf16 v84, v242, s56, v84
    v_dot2_f32_bf16 v85, v242, s57, v85
    v_dot2_f32_bf16 v86, v243, s56, v86
    v_dot2_f32_bf16 v87, v243, s57, v87
    v_dot2_f32_bf16 v80, v244, s56, v80
    v_dot2_f32_bf16 v81, v244, s57, v81
    v_dot2_f32_bf16 v82, v245, s56, v82
    v_dot2_f32_bf16 v83, v245, s57, v83
    v_dot2_f32_bf16 v84, v246, s56, v84
    v_dot2_f32_bf16 v85, v246, s57, v85
    v_dot2_f32_bf16 v86, v247, s56, v86
    v_dot2_f32_bf16 v87, v247, s57, v87
    s_nop 2
    v_cvt_pk_bf16_f32 v64, v80, v81
    v_cvt_pk_bf16_f32 v65, v82, v83
    s_lshl_b32 s46, s42, 7
    s_add_u32 s46, s46, 64
    s_add_u32 s46, s46, s89
    s_add_u32 s46, s46, 18432
    buffer_store_dwordx2 v[64:65], v6, s[28:31], s46 offen
    v_cvt_pk_bf16_f32 v66, v84, v85
    v_cvt_pk_bf16_f32 v67, v86, v87
    s_lshl_b32 s46, s42, 7
    s_add_u32 s46, s46, 96
    s_add_u32 s46, s46, s89
    s_add_u32 s46, s46, 18432
    buffer_store_dwordx2 v[66:67], v6, s[28:31], s46 offen
    s_nop 1
    s_branch FK_fin
FK_fin:
FK_end:
    s_endpgm
.section .rodata,"a"
.p2align 6
.amdhsa_kernel parallel_sum__spectral_gfnet__glu_gated_bilinear__prompt_kernel
  .amdhsa_next_free_vgpr 512
  .amdhsa_next_free_sgpr 102
  .amdhsa_accum_offset 256
  .amdhsa_group_segment_fixed_size 0
  .amdhsa_kernarg_size 80
  .amdhsa_user_sgpr_count 2
  .amdhsa_user_sgpr_kernarg_segment_ptr 1
  .amdhsa_system_sgpr_workgroup_id_x 1
  .amdhsa_float_denorm_mode_32 3
.end_amdhsa_kernel
```
